```python
import torch

def _softmax(x, axis=-1):
    return torch.softmax(x, dim=axis)
def _gelu(x):
    return torch.nn.functional.gelu(x, approximate="tanh")
def _silu(x):
    return torch.nn.functional.silu(x)
def _sigmoid(x):
    return torch.sigmoid(x)
def _layernorm(x, axis=-1, eps=1e-5):
    m = x.mean(dim=axis, keepdim=True)
    v = x.var(dim=axis, keepdim=True, unbiased=False)
    return (x - m) / torch.sqrt(v + eps)
def _scatter_add(tgt, idx, src, axis=0):
    return tgt.clone().index_add_(axis, idx, src)
def _segment_sum(src, seg, n):
    out = torch.zeros((n,) + src.shape[1:], dtype=src.dtype)
    return out.index_add_(0, seg, src)
def _pad(x, pw):
    flat = tuple(v for pair in reversed(pw) for v in pair)
    return torch.nn.functional.pad(x, flat)

kernel_name = 'standalone__mha_softmax__near_ridge'

def setup_inputs():

    _w = (lambda a: (lambda t: t.to(torch.bfloat16) if t.is_floating_point() else t)(torch.as_tensor(a)))
    B, H, Sq, Sk, D = 16, 16, 848, 512, 256
    return {
        "q": _w((lambda *s: torch.randn(*s, dtype=torch.bfloat16) * 0.8)(B, H, Sq, D)),
        "k": _w((lambda *s: torch.randn(*s, dtype=torch.bfloat16) * 0.8)(B, H, Sk, D)),
        "v": _w((lambda *s: torch.randn(*s, dtype=torch.bfloat16) * 0.05)(B, H, Sk, D)),
    }

def reference(q, k, v):
    scale = q.shape[-1] ** -0.5
    scores = torch.einsum("bhqd,bhkd->bhqk", q, k) * scale
    p = _softmax(scores, axis=-1)
    return torch.einsum("bhqk,bhkd->bhqd", p, v)
```

```asm
; @launch grid=(256,1,1) block=(256,1,1) lds=163840
.amdgcn_target "amdgcn-amd-amdhsa--gfx950"
.text
.globl standalone__mha_softmax__near_ridge_kernel
.p2align 8
.type standalone__mha_softmax__near_ridge_kernel,@function
standalone__mha_softmax__near_ridge_kernel:
    s_load_dwordx4 s[80:83], s[0:1], 0
    s_load_dwordx4 s[84:87], s[0:1], 16

    s_cmp_lt_u32 s2, 256
    s_cbranch_scc1 L_start
    s_endpgm
L_start:
    v_lshrrev_b32 v1, 6, v0
    v_and_b32 v2, 63, v0
    v_readfirstlane_b32 s70, v1
    v_lshrrev_b32 v4, 4, v2
    v_lshrrev_b32 v5, 3, v2
    v_and_b32 v7, 7, v2
    v_and_b32 v6, 1, v1
    v_lshl_add_u32 v6, v6, 2, v4
    v_xor_b32 v6, v6, v7
    v_lshlrev_b32 v6, 4, v6
    v_lshl_add_u32 v6, v5, 9, v6
    v_lshl_add_u32 v78, v1, 12, v6
    v_xor_b32 v72, 0x1040, v78
    s_lshl_b32 s22, s70, 10
    s_lshl_b32 s23, s70, 12
    s_and_b32 s44, s70, 1
    s_lshl_b32 s44, s44, 10
    s_add_u32 s44, s44, s23
    s_xor_b32 s45, s44, 1024
    s_lshr_b32 s47, s70, 1
    s_lshl_b32 s47, s47, 13
    s_and_b32 s90, s2, 7
    s_lshr_b32 s91, s2, 3
    s_lshr_b32 s92, s91, 2
    s_and_b32 s91, s91, 3
    s_lshl_b32 s90, s90, 3
    s_add_u32 s90, s90, s92
    s_lshl_b32 s90, s90, 2
    s_lshl_b32 s68, s90, 18
    s_xor_b32 s93, s91, 1
    s_and_b32 s94, s93, 2
    s_lshl_b32 s94, s94, 16
    s_mov_b32 s79, s94
    s_or_b32 s20, s68, 0
    s_and_b32 s94, s93, 2
    s_lshl_b32 s97, s94, 7
    s_add_u32 s93, s91, 0
    s_and_b32 s93, s93, 3
    s_lshr_b32 s94, s93, 1
    s_mul_i32 s94, s94, 448
    s_and_b32 s95, s93, 1
    s_lshl_b32 s96, s95, 8
    s_add_u32 s94, s94, s96
    s_lshl_b32 s95, s95, 4
    s_sub_u32 s95, 64, s95
    s_mul_i32 s95, s95, s70
    s_add_u32 s94, s94, s95
    s_cmp_lt_u32 s94, 848
    s_cselect_b32 s37, 111149056, 0
    s_add_u32 s95, s90, 0
    s_mul_i32 s95, s95, 848
    s_add_u32 s94, s94, s95
    s_lshl_b32 s32, s94, 9
    s_getreg_b32 s96, hwreg(HW_REG_XCC_ID, 0, 1)
    s_mov_b32 vcc_hi, 0
    s_mov_b32 vcc_lo, s96
    s_mov_b32 s6, 0
    s_mov_b32 s7, 0x20000
    s_mov_b32 s10, 67108864
    s_mov_b32 s11, 0x20000
    s_mov_b32 s14, 67108864
    s_mov_b32 s15, 0x20000
    s_mov_b32 s18, 0
    s_mov_b32 s19, 0x20000
    s_waitcnt lgkmcnt(0)
    s_mov_b32 s8, s82
    s_and_b32 s9, s83, 0xffff
    s_mov_b32 s4, s80
    s_and_b32 s5, s81, 0xffff
    s_mov_b32 s12, s84
    s_and_b32 s13, s85, 0xffff
    s_mov_b32 s16, s86
    s_and_b32 s17, s87, 0xffff
    s_getpc_b64 s[98:99]
L_pc:
    s_add_u32 s98, s98, L_segA - L_pc
    s_addc_u32 s99, s99, 0
    s_lshr_b32 s96, s2, 3
    s_lshl_b32 s96, s96, 12
    s_add_u32 s96, s96, s22
    v_lshl_add_u32 v16, v7, 7, s96
    v_min_u32 v16, L_end - L_segA, v16
    global_load_dword v20, v16, s[98:99]
    s_mov_b32 s6, s37
    s_cmp_eq_u32 s37, 0
    s_cselect_b32 s71, 0xc7000000, 0
    s_sub_u32 s42, s32, s47
    s_xor_b32 s24, s20, 0
    s_add_u32 m0, s22, 49152
    s_nop 0
    buffer_load_dwordx4 v78, s[8:11], s24 offen offset:0 sc0 sc1 lds
    s_add_u32 m0, s22, 53120
    s_nop 0
    buffer_load_dwordx4 v78, s[8:11], s24 offen offset:128 sc0 sc1 lds
    s_add_u32 m0, s22, 57088
    s_nop 0
    buffer_load_dwordx4 v78, s[8:11], s24 offen offset:256 sc0 sc1 lds
    s_add_u32 m0, s22, 61056
    s_nop 0
    buffer_load_dwordx4 v78, s[8:11], s24 offen offset:384 sc0 sc1 lds
    s_add_u32 s43, s42, 0
    s_add_u32 m0, s44, 114688
    s_nop 0
    s_cbranch_vccnz L_tha0
    s_waitcnt vmcnt(1)
L_tha0:
    buffer_load_dwordx4 v78, s[4:7], s43 offen offset:0 sc0 sc1 nt lds
    s_add_u32 m0, s45, 114688
    s_nop 0
    s_cbranch_vccnz L_tha1
    s_waitcnt vmcnt(1)
L_tha1:
    buffer_load_dwordx4 v72, s[4:7], s43 offen offset:0 sc0 sc1 nt lds
    s_add_u32 m0, s44, 116608
    s_nop 0
    s_cbranch_vccnz L_tha2
    s_waitcnt vmcnt(1)
L_tha2:
    buffer_load_dwordx4 v78, s[4:7], s43 offen offset:128 sc0 sc1 nt lds
    s_add_u32 m0, s45, 116608
    s_nop 0
    s_cbranch_vccnz L_tha3
    s_waitcnt vmcnt(1)
L_tha3:
    buffer_load_dwordx4 v72, s[4:7], s43 offen offset:128 sc0 sc1 nt lds
    s_add_u32 s43, s42, 8192
    s_add_u32 m0, s44, 131072
    s_nop 0
    s_cbranch_vccnz L_tha4
    s_waitcnt vmcnt(1)
L_tha4:
    buffer_load_dwordx4 v78, s[4:7], s43 offen offset:0 sc0 sc1 nt lds
    s_add_u32 m0, s45, 131072
    s_nop 0
    s_cbranch_vccnz L_tha5
    s_waitcnt vmcnt(1)
L_tha5:
    buffer_load_dwordx4 v72, s[4:7], s43 offen offset:0 sc0 sc1 nt lds
    s_add_u32 m0, s44, 132992
    s_nop 0
    s_cbranch_vccnz L_tha6
    s_waitcnt vmcnt(1)
L_tha6:
    buffer_load_dwordx4 v78, s[4:7], s43 offen offset:128 sc0 sc1 nt lds
    s_add_u32 m0, s45, 132992
    s_nop 0
    s_cbranch_vccnz L_tha7
    s_waitcnt vmcnt(1)
L_tha7:
    buffer_load_dwordx4 v72, s[4:7], s43 offen offset:128 sc0 sc1 nt lds
    s_add_u32 s43, s42, 16384
    s_add_u32 m0, s44, 147456
    s_nop 0
    buffer_load_dwordx4 v78, s[4:7], s43 offen offset:0 sc0 sc1 nt lds
    s_add_u32 m0, s45, 147456
    s_nop 0
    buffer_load_dwordx4 v72, s[4:7], s43 offen offset:0 sc0 sc1 nt lds
    s_add_u32 m0, s44, 149376
    s_nop 0
    buffer_load_dwordx4 v78, s[4:7], s43 offen offset:128 sc0 sc1 nt lds
    s_add_u32 m0, s45, 149376
    s_nop 0
    buffer_load_dwordx4 v72, s[4:7], s43 offen offset:128 sc0 sc1 nt lds
    v_and_b32 v3, 15, v2
    v_lshrrev_b32 v6, 1, v7
    v_xor_b32 v6, v6, v4
    v_lshlrev_b32 v6, 5, v6
    v_lshl_add_u32 v6, v5, 9, v6
    v_and_b32 v7, 1, v2
    v_lshl_add_u32 v6, v7, 4, v6
    v_lshl_add_u32 v79, v1, 14, v6
    v_and_b32 v7, 7, v2
    v_lshlrev_b32 v6, 4, v7
    v_lshl_add_u32 v81, v5, 9, v6
    v_lshlrev_b32 v14, 12, v1
    v_add_u32 v14, 131072, v14
    v_xor_b32 v6, v7, v5
    v_lshlrev_b32 v6, 4, v6
    v_lshl_add_u32 v6, v5, 7, v6
    v_add_u32 v83, v6, v14
    v_lshrrev_b32 v6, 1, v4
    v_xor_b32 v6, v6, v7
    v_lshlrev_b32 v6, 4, v6
    v_lshl_add_u32 v6, v3, 7, v6
    v_and_b32 v7, 1, v4
    v_lshl_add_u32 v6, v7, 3, v6
    v_add_u32 v82, v6, v14
    v_lshrrev_b32 v5, 1, v3
    v_xor_b32 v5, v5, v4
    v_lshlrev_b32 v5, 4, v5
    v_lshl_add_u32 v68, v3, 7, v5
    v_xor_b32 v69, 64, v68
    v_lshl_add_u32 v8, v1, 12, v68
    v_lshl_add_u32 v9, v1, 12, v69
    v_add_u32 v10, 65536, v8
    v_add_u32 v11, 65536, v9
    v_add_u32 v12, 131072, v8
    v_add_u32 v13, 131072, v9
    v_add_u32 v70, 114688, v8
    v_add_u32 v71, 114688, v9
    v_lshrrev_b32 v5, 2, v3
    v_lshl_add_u32 v5, v4, 2, v5
    v_lshrrev_b32 v6, 1, v5
    v_and_b32 v6, 3, v6
    v_lshlrev_b32 v5, 7, v5
    v_and_b32 v7, 3, v3
    v_lshl_add_u32 v5, v7, 3, v5
    v_lshl_add_u32 v74, v6, 5, v5
    v_xor_b32 v75, 32, v74
    v_xor_b32 v76, 64, v74
    v_xor_b32 v77, 0x60, v74
    v_bfe_u32 v5, v2, 1, 1
    v_mul_u32_u24 v6, 0x3f80, v5
    v_lshl_or_b32 v6, v6, 16, v6
    v_xor_b32 v5, 0x3f803f80, v6
    v_accvgpr_write_b32 a128, v5
    v_accvgpr_write_b32 a129, v5
    v_accvgpr_write_b32 a130, v5
    v_accvgpr_write_b32 a131, v5
    v_accvgpr_write_b32 a132, v6
    v_accvgpr_write_b32 a133, v6
    v_accvgpr_write_b32 a134, v6
    v_accvgpr_write_b32 a135, v6
    v_and_b32 v5, 1, v2
    v_mul_u32_u24 v5, 0xaaaa, v5
    v_lshl_or_b32 v5, v5, 16, v5
    v_or_b32 v84, 0x44444444, v5
    s_mov_b32 s27, 0x3db8aa3b
    s_mov_b32 s28, 0x5f800000
    s_mov_b32 s29, 0
    s_mov_b32 s30, 0
    s_mov_b32 s21, s20
    s_mov_b32 s69, s91
    s_add_u32 s93, s91, 1
    s_and_b32 s93, s93, 3
    s_lshr_b32 s94, s93, 1
    s_mul_i32 s94, s94, 448
    s_and_b32 s95, s93, 1
    s_lshl_b32 s96, s95, 8
    s_add_u32 s94, s94, s96
    s_lshl_b32 s95, s95, 4
    s_sub_u32 s95, 64, s95
    s_mul_i32 s95, s95, s70
    s_add_u32 s94, s94, s95
    s_cmp_lt_u32 s94, 848
    s_cselect_b32 s38, 111149056, 0
    s_add_u32 s95, s90, 1
    s_mul_i32 s95, s95, 848
    s_add_u32 s94, s94, s95
    s_lshl_b32 s33, s94, 9
    s_add_u32 s93, s91, 2
    s_and_b32 s93, s93, 3
    s_lshr_b32 s94, s93, 1
    s_mul_i32 s94, s94, 448
    s_and_b32 s95, s93, 1
    s_lshl_b32 s96, s95, 8
    s_add_u32 s94, s94, s96
    s_lshl_b32 s95, s95, 4
    s_sub_u32 s95, 64, s95
    s_mul_i32 s95, s95, s70
    s_add_u32 s94, s94, s95
    s_cmp_lt_u32 s94, 848
    s_cselect_b32 s39, 111149056, 0
    s_add_u32 s95, s90, 2
    s_mul_i32 s95, s95, 848
    s_add_u32 s94, s94, s95
    s_lshl_b32 s34, s94, 9
    s_add_u32 s93, s91, 3
    s_and_b32 s93, s93, 3
    s_lshr_b32 s94, s93, 1
    s_mul_i32 s94, s94, 448
    s_and_b32 s95, s93, 1
    s_lshl_b32 s96, s95, 8
    s_add_u32 s94, s94, s96
    s_lshl_b32 s95, s95, 4
    s_sub_u32 s95, 64, s95
    s_mul_i32 s95, s95, s70
    s_add_u32 s94, s94, s95
    s_cmp_lt_u32 s94, 848
    s_cselect_b32 s40, 111149056, 0
    s_add_u32 s95, s90, 3
    s_mul_i32 s95, s95, 848
    s_add_u32 s94, s94, s95
    s_lshl_b32 s35, s94, 9
    s_mov_b32 s60, s32
    s_mov_b32 s64, s37
    s_mov_b32 s61, s33
    s_mov_b32 s65, s38
    s_mov_b32 s62, s34
    s_mov_b32 s66, s39
    s_mov_b32 s63, s35
    s_mov_b32 s67, s40
    s_mov_b32 s36, 0
    s_mov_b32 s41, 0
    s_mov_b32 s92, s27
    s_mov_b32 s93, s27
    s_movk_i32 s50, 3968
    s_movk_i32 s51, 1024
    s_movk_i32 s31, 4096
    s_movk_i32 s59, 16384
    s_movk_i32 s94, 4480
    s_movk_i32 s95, 13312
    s_mov_b32 s96, 49152
    s_mov_b32 s46, 0
    s_mov_b32 s3, 0
    s_mov_b32 s48, 0
    s_mov_b32 s49, 0
L_warm:
    s_mov_b64 exec, 0
    s_cmp_eq_u32 s70, 0
    s_cbranch_scc1 L_w0
    s_cmp_eq_u32 s70, 1
    s_cbranch_scc1 L_w1
    s_cmp_eq_u32 s70, 2
    s_cbranch_scc1 L_w2
    s_branch L_w3
.p2align 15
.fill 6144, 4, 0xbf800000
L_w19:
L_w20:
L_w21:
L_w22:
    s_mov_b64 exec, -1
    s_bitcmp1_b32 s69, 0
    s_cbranch_scc1 L_proB2
    s_add_u32 s43, s42, 24576
    s_add_u32 m0, s44, 98304
    s_nop 0
    buffer_load_dwordx4 v78, s[4:7], s43 offen offset:0 sc0 sc1 nt lds
    s_add_u32 m0, s45, 98304
    s_nop 0
    buffer_load_dwordx4 v72, s[4:7], s43 offen offset:0 sc0 sc1 nt lds
    s_add_u32 m0, s44, 100224
    s_nop 0
    buffer_load_dwordx4 v78, s[4:7], s43 offen offset:128 sc0 sc1 nt lds
    s_add_u32 m0, s45, 100224
    s_nop 0
    buffer_load_dwordx4 v72, s[4:7], s43 offen offset:128 sc0 sc1 nt lds
    s_add_u32 s43, s42, 256
    s_add_u32 m0, s44, 32768
    s_nop 0
    buffer_load_dwordx4 v78, s[4:7], s43 offen offset:0 sc0 sc1 nt lds
    s_add_u32 m0, s45, 32768
    s_nop 0
    buffer_load_dwordx4 v72, s[4:7], s43 offen offset:0 sc0 sc1 nt lds
    s_add_u32 m0, s44, 34688
    s_nop 0
    buffer_load_dwordx4 v78, s[4:7], s43 offen offset:128 sc0 sc1 nt lds
    s_add_u32 m0, s45, 34688
    s_nop 0
    buffer_load_dwordx4 v72, s[4:7], s43 offen offset:128 sc0 sc1 nt lds
    s_waitcnt vmcnt(16)
    ds_read_b128 a[0:3], v10 offset:49152
    ds_read_b128 a[4:7], v11 offset:49152
    ds_read_b128 a[8:11], v10 offset:51200
    ds_read_b128 a[12:15], v11 offset:51200
    s_add_u32 s43, s42, 8448
    s_add_u32 m0, s44, 114688
    s_waitcnt lgkmcnt(0)
    buffer_load_dwordx4 v78, s[4:7], s43 offen offset:0 sc0 sc1 nt lds
    s_add_u32 m0, s45, 114688
    s_nop 0
    buffer_load_dwordx4 v72, s[4:7], s43 offen offset:0 sc0 sc1 nt lds
    s_add_u32 m0, s44, 116608
    s_nop 0
    buffer_load_dwordx4 v78, s[4:7], s43 offen offset:128 sc0 sc1 nt lds
    s_add_u32 m0, s45, 116608
    s_nop 0
    buffer_load_dwordx4 v72, s[4:7], s43 offen offset:128 sc0 sc1 nt lds
    s_waitcnt vmcnt(16)
    ds_read_b128 a[32:35], v12 offset:0
    ds_read_b128 a[36:39], v13 offset:0
    ds_read_b128 a[40:43], v12 offset:2048
    ds_read_b128 a[44:47], v13 offset:2048
    s_add_u32 s43, s42, 16640
    s_add_u32 m0, s44, 131072
    s_waitcnt lgkmcnt(0)
    buffer_load_dwordx4 v78, s[4:7], s43 offen offset:0 sc0 sc1 nt lds
    s_add_u32 m0, s45, 131072
    s_nop 0
    buffer_load_dwordx4 v72, s[4:7], s43 offen offset:0 sc0 sc1 nt lds
    s_add_u32 m0, s44, 132992
    s_nop 0
    buffer_load_dwordx4 v78, s[4:7], s43 offen offset:128 sc0 sc1 nt lds
    s_add_u32 m0, s45, 132992
    s_nop 0
    buffer_load_dwordx4 v72, s[4:7], s43 offen offset:128 sc0 sc1 nt lds
    s_waitcnt vmcnt(16)
    ds_read_b128 a[64:67], v12 offset:16384
    ds_read_b128 a[68:71], v13 offset:16384
    ds_read_b128 a[72:75], v12 offset:18432
    ds_read_b128 a[76:79], v13 offset:18432
    s_add_u32 s43, s42, 24832
    s_add_u32 m0, s44, 147456
    s_waitcnt lgkmcnt(0)
    buffer_load_dwordx4 v78, s[4:7], s43 offen offset:0 sc0 sc1 nt lds
    s_add_u32 m0, s45, 147456
    s_nop 0
    buffer_load_dwordx4 v72, s[4:7], s43 offen offset:0 sc0 sc1 nt lds
    s_add_u32 m0, s44, 149376
    s_nop 0
    buffer_load_dwordx4 v78, s[4:7], s43 offen offset:128 sc0 sc1 nt lds
    s_add_u32 m0, s45, 149376
    s_nop 0
    buffer_load_dwordx4 v72, s[4:7], s43 offen offset:128 sc0 sc1 nt lds
    s_waitcnt vmcnt(16)
    ds_read_b128 a[96:99], v10 offset:32768
    ds_read_b128 a[100:103], v11 offset:32768
    ds_read_b128 a[104:107], v10 offset:34816
    ds_read_b128 a[108:111], v11 offset:34816
    s_waitcnt vmcnt(12)
    ds_read_b128 a[16:19], v8 offset:32768
    ds_read_b128 a[20:23], v9 offset:32768
    ds_read_b128 a[24:27], v8 offset:34816
    ds_read_b128 a[28:31], v9 offset:34816
    buffer_store_dword v81, v81, s[16:19], 0 offen
    s_xor_b32 s24, s20, 16384
    s_add_u32 m0, s22, 65536
    s_nop 0
    buffer_load_dwordx4 v78, s[8:11], s24 offen offset:0 sc0 sc1 lds
    s_add_u32 m0, s22, 69504
    s_nop 0
    buffer_load_dwordx4 v78, s[8:11], s24 offen offset:128 sc0 sc1 lds
    s_add_u32 m0, s22, 73472
    s_nop 0
    buffer_load_dwordx4 v78, s[8:11], s24 offen offset:256 sc0 sc1 lds
    s_add_u32 m0, s22, 77440
    buffer_store_dword v81, v81, s[16:19], 0 offen
    buffer_load_dwordx4 v78, s[8:11], s24 offen offset:384 sc0 sc1 lds
    s_barrier
    ds_read_b128 a[144:147], v68 offset:49152
    ds_read_b128 a[148:151], v69 offset:49152
    ds_read_b128 a[152:155], v68 offset:53248
    ds_read_b128 a[156:159], v69 offset:53248
    s_waitcnt vmcnt(14)
    ds_read_b128 a[48:51], v10 offset:49152
    ds_read_b128 a[52:55], v11 offset:49152
    ds_read_b128 a[56:59], v10 offset:51200
    s_waitcnt lgkmcnt(11)
    ds_read_b128 a[60:63], v11 offset:51200
    s_xor_b32 s24, s20, 32768
    s_add_u32 m0, s22, 81920
    s_nop 0
    buffer_load_dwordx4 v78, s[8:11], s24 offen offset:0 sc0 sc1 lds
    s_add_u32 m0, s22, 85888
    s_nop 0
    buffer_load_dwordx4 v78, s[8:11], s24 offen offset:128 sc0 sc1 lds
    buffer_store_dword v81, v81, s[16:19], 0 offen
    s_add_u32 m0, s22, 89856
    s_nop 0
    buffer_load_dwordx4 v78, s[8:11], s24 offen offset:256 sc0 sc1 lds
    s_add_u32 m0, s22, 93824
    s_nop 0
    buffer_load_dwordx4 v78, s[8:11], s24 offen offset:384 sc0 sc1 lds
    buffer_store_dword v81, v81, s[16:19], 0 offen
    s_waitcnt vmcnt(16)
    ds_read_b128 a[80:83], v12 offset:0
    ds_read_b128 a[84:87], v13 offset:0
    ds_read_b128 a[88:91], v12 offset:2048
    s_waitcnt lgkmcnt(11)
    ds_read_b128 a[92:95], v13 offset:2048
    s_xor_b32 s24, s20, 49152
    s_add_u32 m0, s22, 0
    s_nop 0
    buffer_load_dwordx4 v78, s[8:11], s24 offen offset:0 sc0 sc1 lds
    s_add_u32 m0, s22, 3968
    s_nop 0
    buffer_load_dwordx4 v78, s[8:11], s24 offen offset:128 sc0 sc1 lds
    buffer_store_dword v81, v81, s[16:19], 0 offen
    s_add_u32 m0, s22, 7936
    s_nop 0
    buffer_load_dwordx4 v78, s[8:11], s24 offen offset:256 sc0 sc1 lds
    s_add_u32 m0, s22, 11904
    s_nop 0
    buffer_load_dwordx4 v78, s[8:11], s24 offen offset:384 sc0 sc1 lds
    buffer_store_dword v81, v81, s[16:19], 0 offen
    s_waitcnt vmcnt(18)
    ds_read_b128 a[112:115], v12 offset:16384
    ds_read_b128 a[116:119], v13 offset:16384
    ds_read_b128 a[120:123], v12 offset:18432
    s_waitcnt lgkmcnt(11)
    ds_read_b128 a[124:127], v13 offset:18432
    v_xor_b32 v82, 96, v82
    s_waitcnt lgkmcnt(0)
    s_nop 7
    s_nop 1
    s_branch L_segA
L_proB2:
    s_add_u32 s43, s42, 256
    s_add_u32 m0, s44, 98304
    s_nop 0
    buffer_load_dwordx4 v78, s[4:7], s43 offen offset:0 sc0 sc1 nt lds
    s_add_u32 m0, s45, 98304
    s_nop 0
    buffer_load_dwordx4 v72, s[4:7], s43 offen offset:0 sc0 sc1 nt lds
    s_add_u32 m0, s44, 100224
    s_nop 0
    buffer_load_dwordx4 v78, s[4:7], s43 offen offset:128 sc0 sc1 nt lds
    s_add_u32 m0, s45, 100224
    s_nop 0
    buffer_load_dwordx4 v72, s[4:7], s43 offen offset:128 sc0 sc1 nt lds
    s_add_u32 s43, s42, 8448
    s_add_u32 m0, s44, 32768
    s_nop 0
    buffer_load_dwordx4 v78, s[4:7], s43 offen offset:0 sc0 sc1 nt lds
    s_add_u32 m0, s45, 32768
    s_nop 0
    buffer_load_dwordx4 v72, s[4:7], s43 offen offset:0 sc0 sc1 nt lds
    s_add_u32 m0, s44, 34688
    s_nop 0
    buffer_load_dwordx4 v78, s[4:7], s43 offen offset:128 sc0 sc1 nt lds
    s_add_u32 m0, s45, 34688
    s_nop 0
    buffer_load_dwordx4 v72, s[4:7], s43 offen offset:128 sc0 sc1 nt lds
    s_waitcnt vmcnt(16)
    ds_read_b128 a[0:3], v10 offset:49152
    ds_read_b128 a[4:7], v11 offset:49152
    ds_read_b128 a[8:11], v10 offset:51200
    ds_read_b128 a[12:15], v11 offset:51200
    s_add_u32 s43, s42, 16640
    s_add_u32 m0, s44, 114688
    s_waitcnt lgkmcnt(0)
    buffer_load_dwordx4 v78, s[4:7], s43 offen offset:0 sc0 sc1 nt lds
    s_add_u32 m0, s45, 114688
    s_nop 0
    buffer_load_dwordx4 v72, s[4:7], s43 offen offset:0 sc0 sc1 nt lds
    s_add_u32 m0, s44, 116608
    s_nop 0
    buffer_load_dwordx4 v78, s[4:7], s43 offen offset:128 sc0 sc1 nt lds
    s_add_u32 m0, s45, 116608
    s_nop 0
    buffer_load_dwordx4 v72, s[4:7], s43 offen offset:128 sc0 sc1 nt lds
    s_waitcnt vmcnt(16)
    ds_read_b128 a[32:35], v12 offset:0
    ds_read_b128 a[36:39], v13 offset:0
    ds_read_b128 a[40:43], v12 offset:2048
    ds_read_b128 a[44:47], v13 offset:2048
    s_waitcnt vmcnt(12)
    ds_read_b128 a[64:67], v12 offset:16384
    ds_read_b128 a[68:71], v13 offset:16384
    ds_read_b128 a[72:75], v12 offset:18432
    ds_read_b128 a[76:79], v13 offset:18432
    buffer_store_dword v81, v81, s[16:19], 0 offen
    s_xor_b32 s24, s20, 16384
    s_add_u32 m0, s22, 65536
    s_nop 0
    buffer_load_dwordx4 v78, s[8:11], s24 offen offset:0 sc0 sc1 lds
    buffer_store_dword v81, v81, s[16:19], 0 offen
    s_add_u32 m0, s22, 69504
    s_nop 0
    buffer_load_dwordx4 v78, s[8:11], s24 offen offset:128 sc0 sc1 lds
    s_add_u32 m0, s22, 73472
    s_nop 0
    buffer_load_dwordx4 v78, s[8:11], s24 offen offset:256 sc0 sc1 lds
    s_add_u32 m0, s22, 77440
    s_nop 0
    buffer_load_dwordx4 v78, s[8:11], s24 offen offset:384 sc0 sc1 lds
    buffer_store_dword v81, v81, s[16:19], 0 offen
    s_barrier
    ds_read_b128 a[144:147], v68 offset:49152
    ds_read_b128 a[148:151], v69 offset:49152
    ds_read_b128 a[152:155], v68 offset:53248
    ds_read_b128 a[156:159], v69 offset:53248
    s_waitcnt vmcnt(15)
    ds_read_b128 a[16:19], v10 offset:32768
    ds_read_b128 a[20:23], v11 offset:32768
    ds_read_b128 a[24:27], v10 offset:34816
    s_waitcnt lgkmcnt(11)
    ds_read_b128 a[28:31], v11 offset:34816
    s_xor_b32 s24, s20, 32768
    s_add_u32 m0, s22, 81920
    s_nop 0
    buffer_load_dwordx4 v78, s[8:11], s24 offen offset:0 sc0 sc1 lds
    s_add_u32 m0, s22, 85888
    s_nop 0
    buffer_load_dwordx4 v78, s[8:11], s24 offen offset:128 sc0 sc1 lds
    buffer_store_dword v81, v81, s[16:19], 0 offen
    s_add_u32 m0, s22, 89856
    s_nop 0
    buffer_load_dwordx4 v78, s[8:11], s24 offen offset:256 sc0 sc1 lds
    s_add_u32 m0, s22, 93824
    s_nop 0
    buffer_load_dwordx4 v78, s[8:11], s24 offen offset:384 sc0 sc1 lds
    buffer_store_dword v81, v81, s[16:19], 0 offen
    s_waitcnt vmcnt(17)
    ds_read_b128 a[48:51], v8 offset:32768
    ds_read_b128 a[52:55], v9 offset:32768
    ds_read_b128 a[56:59], v8 offset:34816
    s_waitcnt lgkmcnt(11)
    ds_read_b128 a[60:63], v9 offset:34816
    s_xor_b32 s24, s20, 49152
    buffer_store_dword v81, v81, s[16:19], 0 offen
    s_add_u32 m0, s22, 0
    s_nop 0
    buffer_load_dwordx4 v78, s[8:11], s24 offen offset:0 sc0 sc1 lds
    s_add_u32 m0, s22, 3968
    s_nop 0
    buffer_load_dwordx4 v78, s[8:11], s24 offen offset:128 sc0 sc1 lds
    s_add_u32 m0, s22, 7936
    s_nop 0
    buffer_load_dwordx4 v78, s[8:11], s24 offen offset:256 sc0 sc1 lds
    buffer_store_dword v81, v81, s[16:19], 0 offen
    s_add_u32 m0, s22, 11904
    s_nop 0
    buffer_load_dwordx4 v78, s[8:11], s24 offen offset:384 sc0 sc1 lds
    buffer_store_dword v81, v81, s[16:19], 0 offen
    s_waitcnt vmcnt(20)
    ds_read_b128 a[80:83], v10 offset:49152
    ds_read_b128 a[84:87], v11 offset:49152
    ds_read_b128 a[88:91], v10 offset:51200
    s_waitcnt lgkmcnt(11)
    ds_read_b128 a[92:95], v11 offset:51200
    v_xor_b32 v82, 96, v82
    s_waitcnt lgkmcnt(0)
    s_nop 7
    s_nop 1
    s_branch L_segB
.p2align 16
L_segA:
    v_mfma_f32_16x16x32_bf16 v[0:3], a[144:147], a[0:3], 0
    ds_read_b128 a[160:163], v68 offset:57344
    v_mfma_f32_16x16x32_bf16 v[4:7], a[144:147], a[32:35], 0
    ds_read_b128 a[164:167], v69 offset:57344
    v_mul_f32 v48, v64, v48
    v_mfma_f32_16x16x32_bf16 v[8:11], a[144:147], a[64:67], 0
L_w0:
    s_cbranch_execz L_w4
    s_waitcnt lgkmcnt(4)
    v_mul_f32 v49, v64, v49
    v_mul_f32 v50, v64, v50
    v_mfma_f32_16x16x32_bf16 v[12:15], a[144:147], a[96:99], 0
    v_mul_f32 v51, v64, v51
    v_cvt_pk_bf16_f32 v48, v48, v49
    v_mfma_f32_16x16x32_bf16 v[0:3], a[148:151], a[4:7], v[0:3]
    ds_read_b128 a[144:147], v68 offset:61440
    v_cvt_pk_bf16_f32 v49, v50, v51
    v_mfma_f32_16x16x32_bf16 v[4:7], a[148:151], a[36:39], v[4:7]
    ds_write_b64 v82, v[48:49] offset:0
    v_mfma_f32_16x16x32_bf16 v[8:11], a[148:151], a[68:71], v[8:11]
    v_mul_f32 v52, v65, v52
    v_mul_f32 v53, v65, v53
    v_mfma_f32_16x16x32_bf16 v[12:15], a[148:151], a[100:103], v[12:15]
    v_mul_f32 v54, v65, v54
    v_mul_f32 v55, v65, v55
    v_mfma_f32_16x16x32_bf16 v[0:3], a[152:155], a[8:11], v[0:3]
    ds_read_b128 a[148:151], v69 offset:61440
    v_cvt_pk_bf16_f32 v52, v52, v53
    v_mfma_f32_16x16x32_bf16 v[4:7], a[152:155], a[40:43], v[4:7]
    v_cvt_pk_bf16_f32 v53, v54, v55
    v_mul_f32 v56, v66, v56
    v_mfma_f32_16x16x32_bf16 v[8:11], a[152:155], a[72:75], v[8:11]
    ds_write_b64 v82, v[52:53] offset:2048
    v_mfma_f32_16x16x32_bf16 v[12:15], a[152:155], a[104:107], v[12:15]
    s_waitcnt lgkmcnt(5)
    v_mul_f32 v57, v66, v57
    v_mul_f32 v58, v66, v58
    v_mfma_f32_16x16x32_bf16 v[0:3], a[156:159], a[12:15], v[0:3]
    ds_read_b128 a[152:155], v68 offset:51200
    v_mul_f32 v59, v66, v59
    v_mfma_f32_16x16x32_bf16 v[4:7], a[156:159], a[44:47], v[4:7]
    v_cvt_pk_bf16_f32 v56, v56, v57
    v_cvt_pk_bf16_f32 v57, v58, v59
    v_mfma_f32_16x16x32_bf16 v[8:11], a[156:159], a[76:79], v[8:11]
    ds_write_b64 v82, v[56:57] offset:16384
    v_mfma_f32_16x16x32_bf16 v[12:15], a[156:159], a[108:111], v[12:15]
    v_xor_b32 v82, 96, v82
    v_accvgpr_write_b32 a136, 0
    v_mfma_f32_16x16x32_bf16 v[0:3], a[160:163], a[16:19], v[0:3]
    ds_read_b128 a[156:159], v69 offset:51200
    v_accvgpr_write_b32 a137, 0
    v_mfma_f32_16x16x32_bf16 v[4:7], a[160:163], a[48:51], v[4:7]
    v_accvgpr_write_b32 a138, 0
    v_accvgpr_write_b32 a139, 0
    v_mfma_f32_16x16x32_bf16 v[8:11], a[160:163], a[80:83], v[8:11]
    s_waitcnt lgkmcnt(6)
    v_accvgpr_write_b32 a140, 0
    v_accvgpr_write_b32 a141, 0
    v_mfma_f32_16x16x32_bf16 v[12:15], a[160:163], a[112:115], v[12:15]
    v_accvgpr_write_b32 a142, 0
    v_accvgpr_write_b32 a143, 0
    v_mfma_f32_16x16x32_bf16 v[0:3], a[164:167], a[20:23], v[0:3]
    ds_read_b128 a[160:163], v68 offset:55296
    s_add_u32 s49, s3, 20480
    v_mfma_f32_16x16x32_bf16 v[4:7], a[164:167], a[52:55], v[4:7]
    v_mfma_f32_16x16x32_bf16 v[8:11], a[164:167], a[84:87], v[8:11]
    v_mfma_f32_16x16x32_bf16 v[12:15], a[164:167], a[116:119], v[12:15]
    v_mfma_f32_16x16x32_bf16 v[0:3], a[144:147], a[24:27], v[0:3]
    ds_read_b128 a[164:167], v69 offset:55296
    v_mfma_f32_16x16x32_bf16 v[4:7], a[144:147], a[56:59], v[4:7]
    buffer_store_dwordx4 a[228:231], v81, s[16:19], s49 offen sc1
    v_mfma_f32_16x16x32_bf16 v[8:11], a[144:147], a[88:91], v[8:11]
    s_waitcnt lgkmcnt(4)
    v_mfma_f32_16x16x32_bf16 v[12:15], a[144:147], a[120:123], v[12:15]
    v_mfma_f32_16x16x32_bf16 v[0:3], a[148:151], a[28:31], v[0:3]
    ds_read_b128 a[144:147], v68 offset:59392
    v_mfma_f32_16x16x32_bf16 v[4:7], a[148:151], a[60:63], v[4:7]
    v_mfma_f32_16x16x32_bf16 v[8:11], a[148:151], a[92:95], v[8:11]
    v_mfma_f32_16x16x32_bf16 v[12:15], a[148:151], a[124:127], v[12:15]
    v_mfma_f32_16x16x32_bf16 v[16:19], a[152:155], a[0:3], 0
    ds_read_b128 a[148:151], v69 offset:59392
    v_mfma_f32_16x16x32_bf16 v[20:23], a[152:155], a[32:35], 0
    v_mfma_f32_16x16x32_bf16 v[24:27], a[152:155], a[64:67], 0
    s_waitcnt lgkmcnt(3)
    v_max3_f32 v64, v0, v1, v2
    v_max3_f32 v65, v4, v5, v6
    v_mfma_f32_16x16x32_bf16 v[28:31], a[152:155], a[96:99], 0
    v_max3_f32 v66, v8, v9, v10
    v_max3_f32 v67, v12, v13, v14
    v_mfma_f32_16x16x32_bf16 v[16:19], a[156:159], a[4:7], v[16:19]
    ds_read_b128 a[152:155], v68 offset:63488
    v_add_u32 v68, s96, v68
    v_mfma_f32_16x16x32_bf16 v[20:23], a[156:159], a[36:39], v[20:23]
    s_waitcnt vmcnt(13)
    v_max_f32 v64, v64, v3
    v_max_f32 v65, v65, v7
    v_mfma_f32_16x16x32_bf16 v[24:27], a[156:159], a[68:71], v[24:27]
    s_barrier
    v_mfma_f32_16x16x32_bf16 v[28:31], a[156:159], a[100:103], v[28:31]
    v_max_f32 v66, v66, v11
    v_max_f32 v67, v67, v15
    v_mfma_f32_16x16x32_bf16 v[16:19], a[160:163], a[8:11], v[16:19]
    ds_read_b128 a[156:159], v69 offset:63488
    v_add_u32 v69, s96, v69
    v_mfma_f32_16x16x32_bf16 v[20:23], a[160:163], a[40:43], v[20:23]
    v_mov_b32 v144, v64
    v_mov_b32 v145, v65
    v_mfma_f32_16x16x32_bf16 v[24:27], a[160:163], a[72:75], v[24:27]
    s_xor_b32 s24, s20, 65536
    v_mov_b32 v146, v66
    v_mov_b32 v147, v67
    v_mfma_f32_16x16x32_bf16 v[28:31], a[160:163], a[104:107], v[28:31]
    s_waitcnt lgkmcnt(3)
    v_permlane32_swap_b32 v64, v144
    v_mfma_f32_16x16x32_bf16 v[16:19], a[164:167], a[12:15], v[16:19]
    ds_read_b128 a[160:163], v68 offset:16384
    s_add_u32 m0, s22, 16384
    v_mfma_f32_16x16x32_bf16 v[20:23], a[164:167], a[44:47], v[20:23]
    v_permlane32_swap_b32 v65, v145
    v_mfma_f32_16x16x32_bf16 v[24:27], a[164:167], a[76:79], v[24:27]
    buffer_load_dwordx4 v78, s[8:11], s24 offen offset:0 sc0 sc1 lds
    v_mfma_f32_16x16x32_bf16 v[28:31], a[164:167], a[108:111], v[28:31]
    v_permlane32_swap_b32 v66, v146
    v_mfma_f32_16x16x32_bf16 v[16:19], a[144:147], a[16:19], v[16:19]
    ds_read_b128 a[164:167], v69 offset:16384
    v_max_f32 v64, v64, v144
    v_mfma_f32_16x16x32_bf16 v[20:23], a[144:147], a[48:51], v[20:23]
    v_permlane32_swap_b32 v67, v147
    v_mfma_f32_16x16x32_bf16 v[24:27], a[144:147], a[80:83], v[24:27]
    s_waitcnt lgkmcnt(3)
    v_max_f32 v65, v65, v145
    v_max_f32 v66, v66, v146
    v_mfma_f32_16x16x32_bf16 v[28:31], a[144:147], a[112:115], v[28:31]
    v_max_f32 v67, v67, v147
    v_mov_b32 v144, v64
    v_mfma_f32_16x16x32_bf16 v[16:19], a[148:151], a[20:23], v[16:19]
    ds_read_b128 a[144:147], v68 offset:20480
    v_mov_b32 v145, v65
    v_mfma_f32_16x16x32_bf16 v[20:23], a[148:151], a[52:55], v[20:23]
    v_mov_b32 v146, v66
    v_mov_b32 v147, v67
    v_mfma_f32_16x16x32_bf16 v[24:27], a[148:151], a[84:87], v[24:27]
    v_permlane16_swap_b32 v64, v144
    v_mfma_f32_16x16x32_bf16 v[28:31], a[148:151], a[116:119], v[28:31]
    v_permlane16_swap_b32 v65, v145
    v_mfma_f32_16x16x32_bf16 v[16:19], a[152:155], a[24:27], v[16:19]
    ds_read_b128 a[148:151], v69 offset:20480
    v_max_f32 v64, v64, v144
    v_mfma_f32_16x16x32_bf16 v[20:23], a[152:155], a[56:59], v[20:23]
    ds_read_b128 a[232:235], v83 offset:0
    v_max_f32 v65, v65, v145
    v_mfma_f32_16x16x32_bf16 v[24:27], a[152:155], a[88:91], v[24:27]
    s_add_u32 m0, m0, s50
    v_permlane16_swap_b32 v66, v146
    v_mfma_f32_16x16x32_bf16 v[28:31], a[152:155], a[120:123], v[28:31]
    s_waitcnt lgkmcnt(4)
    v_permlane16_swap_b32 v67, v147
    v_mfma_f32_16x16x32_bf16 v[16:19], a[156:159], a[28:31], v[16:19]
    ds_read_b128 a[152:155], v68 offset:24576
    v_max_f32 v66, v66, v146
    v_mfma_f32_16x16x32_bf16 v[20:23], a[156:159], a[60:63], v[20:23]
    buffer_load_dwordx4 v78, s[8:11], s24 offen offset:128 sc0 sc1 lds
    v_mfma_f32_16x16x32_bf16 v[24:27], a[156:159], a[92:95], v[24:27]
    v_max_f32 v67, v67, v147
    v_sub_f32 v148, s71, v64
    v_mfma_f32_16x16x32_bf16 v[28:31], a[156:159], a[124:127], v[28:31]
    s_xor_b32 s3, s46, 384
    v_sub_f32 v212, s71, v65
    v_sub_f32 v244, s71, v66
    v_mfma_f32_16x16x32_bf16 v[32:35], a[160:163], a[0:3], 0
    ds_read_b128 a[156:159], v69 offset:24576
    v_sub_f32 v252, s71, v67
    v_mfma_f32_16x16x32_bf16 v[36:39], a[160:163], a[32:35], 0
    s_add_u32 s48, s3, 0
    v_mul_f32 v64, s27, v148
    v_mul_f32 v65, s27, v212
    v_mfma_f32_16x16x32_bf16 v[40:43], a[160:163], a[64:67], 0
    s_waitcnt lgkmcnt(4)
    v_mul_f32 v66, s27, v244
    v_mul_f32 v67, s27, v252
    v_mfma_f32_16x16x32_bf16 v[44:47], a[160:163], a[96:99], 0
    v_mov_b32 v149, v148
    v_mov_b32 v150, v148
    v_mfma_f32_16x16x32_bf16 v[32:35], a[164:167], a[4:7], v[32:35]
    ds_read_b128 a[160:163], v68 offset:28672
    v_mov_b32 v151, v148
    v_mfma_f32_16x16x32_bf16 v[36:39], a[164:167], a[36:39], v[36:39]
    s_add_u32 m0, m0, s50
    v_mov_b32 v213, v212
    v_mov_b32 v214, v212
    v_mfma_f32_16x16x32_bf16 v[40:43], a[164:167], a[68:71], v[40:43]
    buffer_load_dwordx4 v78, s[8:11], s24 offen offset:256 sc0 sc1 lds
    v_mfma_f32_16x16x32_bf16 v[44:47], a[164:167], a[100:103], v[44:47]
    v_mov_b32 v215, v212
    v_mov_b32 v245, v244
    v_mfma_f32_16x16x32_bf16 v[32:35], a[144:147], a[8:11], v[32:35]
    ds_read_b128 a[164:167], v69 offset:28672
    v_mov_b32 v246, v244
    v_mfma_f32_16x16x32_bf16 v[36:39], a[144:147], a[40:43], v[36:39]
    s_mov_b32 s6, s38
    v_mov_b32 v247, v244
    v_mov_b32 v253, v252
    v_mfma_f32_16x16x32_bf16 v[40:43], a[144:147], a[72:75], v[40:43]
    s_sub_u32 s42, s33, s47
    v_mov_b32 v254, v252
    v_mov_b32 v255, v252
    v_mfma_f32_16x16x32_bf16 v[44:47], a[144:147], a[104:107], v[44:47]
    s_waitcnt lgkmcnt(3)
    v_fma_f32 v0, v0, s27, v64
    v_fma_f32 v1, v1, s27, v64
    v_mfma_f32_16x16x32_bf16 v[32:35], a[148:151], a[12:15], v[32:35]
    ds_read_b128 a[144:147], v68 offset:18432
    v_fma_f32 v2, v2, s27, v64
    v_mfma_f32_16x16x32_bf16 v[36:39], a[148:151], a[44:47], v[36:39]
    buffer_store_dwordx4 a[232:235], v81, s[16:19], s48 offen sc1
    v_mfma_f32_16x16x32_bf16 v[40:43], a[148:151], a[76:79], v[40:43]
    v_fma_f32 v3, v3, s27, v64
    v_fma_f32 v4, v4, s27, v65
    v_mfma_f32_16x16x32_bf16 v[44:47], a[148:151], a[108:111], v[44:47]
    v_exp_f32 v0, v0
    v_mfma_f32_16x16x32_bf16 v[32:35], a[152:155], a[16:19], v[32:35]
    ds_read_b128 a[148:151], v69 offset:18432
    v_fma_f32 v5, v5, s27, v65
    v_mfma_f32_16x16x32_bf16 v[36:39], a[152:155], a[48:51], v[36:39]
    s_add_u32 m0, m0, s50
    v_exp_f32 v1, v1
    v_mfma_f32_16x16x32_bf16 v[40:43], a[152:155], a[80:83], v[40:43]
    buffer_load_dwordx4 v78, s[8:11], s24 offen offset:384 sc0 sc1 lds
    v_mfma_f32_16x16x32_bf16 v[44:47], a[152:155], a[112:115], v[44:47]
    s_waitcnt lgkmcnt(3)
    v_exp_f32 v2, v2
    v_mfma_f32_16x16x32_bf16 v[32:35], a[156:159], a[20:23], v[32:35]
    ds_read_b128 a[152:155], v68 offset:22528
    v_cvt_pk_bf16_f32 v88, v0, v1
    v_mfma_f32_16x16x32_bf16 v[36:39], a[156:159], a[52:55], v[36:39]
    v_exp_f32 v3, v3
    v_mfma_f32_16x16x32_bf16 v[40:43], a[156:159], a[84:87], v[40:43]
    v_fma_f32 v6, v6, s27, v65
    v_fma_f32 v7, v7, s27, v65
    v_mfma_f32_16x16x32_bf16 v[44:47], a[156:159], a[116:119], v[44:47]
    v_cvt_pk_bf16_f32 v89, v2, v3
    v_fma_f32 v8, v8, s27, v66
    v_mfma_f32_16x16x32_bf16 v[32:35], a[160:163], a[24:27], v[32:35]
    ds_read_b128 a[156:159], v69 offset:22528
    v_fma_f32 v9, v9, s27, v66
    v_mfma_f32_16x16x32_bf16 v[36:39], a[160:163], a[56:59], v[36:39]
    v_exp_f32 v4, v4
    v_mfma_f32_16x16x32_bf16 v[40:43], a[160:163], a[88:91], v[40:43]
    s_add_u32 s24, s24, s59
    v_exp_f32 v5, v5
    v_mfma_f32_16x16x32_bf16 v[44:47], a[160:163], a[120:123], v[44:47]
    s_waitcnt lgkmcnt(3)
    v_exp_f32 v6, v6
    v_mfma_f32_16x16x32_bf16 v[32:35], a[164:167], a[28:31], v[32:35]
    ds_read_b128 a[160:163], v68 offset:26624
    v_cvt_pk_bf16_f32 v152, v4, v5
    v_mfma_f32_16x16x32_bf16 v[36:39], a[164:167], a[60:63], v[36:39]
    s_add_u32 m0, m0, s94
    v_exp_f32 v7, v7
    v_mfma_f32_16x16x32_bf16 v[40:43], a[164:167], a[92:95], v[40:43]
    buffer_load_dwordx4 v78, s[8:11], s24 offen offset:0 sc0 sc1 lds
    v_mfma_f32_16x16x32_bf16 v[44:47], a[164:167], a[124:127], v[44:47]
    v_cvt_pk_bf16_f32 v153, v6, v7
    v_fma_f32 v10, v10, s27, v66
    v_mfma_f32_16x16x32_bf16 v[48:51], a[144:147], a[0:3], v[148:151]
    ds_read_b128 a[164:167], v69 offset:26624
    v_fma_f32 v11, v11, s27, v66
    v_mfma_f32_16x16x32_bf16 v[52:55], a[144:147], a[32:35], v[212:215]
    v_exp_f32 v8, v8
    v_mfma_f32_16x16x32_bf16 v[56:59], a[144:147], a[64:67], v[244:247]
    s_waitcnt lgkmcnt(3)
    v_exp_f32 v9, v9
    v_mfma_f32_16x16x32_bf16 v[60:63], a[144:147], a[96:99], v[252:255]
    v_exp_f32 v10, v10
    v_mfma_f32_16x16x32_bf16 v[48:51], a[148:151], a[4:7], v[48:51]
    ds_read_b128 a[144:147], v68 offset:30720
    v_cvt_pk_bf16_f32 v216, v8, v9
    v_mfma_f32_16x16x32_bf16 v[52:55], a[148:151], a[36:39], v[52:55]
    ds_read_b128 a[236:239], v83 offset:1024
    v_fma_f32 v12, v12, s27, v67
    v_mfma_f32_16x16x32_bf16 v[56:59], a[148:151], a[68:71], v[56:59]
    s_waitcnt vmcnt(14)
    v_exp_f32 v11, v11
    v_mfma_f32_16x16x32_bf16 v[60:63], a[148:151], a[100:103], v[60:63]
    s_barrier
    v_mfma_f32_16x16x32_bf16 v[48:51], a[152:155], a[8:11], v[48:51]
    ds_read_b128 a[148:151], v69 offset:30720
    v_cvt_pk_bf16_f32 v217, v10, v11
    v_mfma_f32_16x16x32_bf16 v[52:55], a[152:155], a[40:43], v[52:55]
    s_add_u32 m0, m0, s50
    v_fma_f32 v13, v13, s27, v67
    v_fma_f32 v14, v14, s27, v67
    v_mfma_f32_16x16x32_bf16 v[56:59], a[152:155], a[72:75], v[56:59]
    buffer_load_dwordx4 v78, s[8:11], s24 offen offset:128 sc0 sc1 lds
    v_mfma_f32_16x16x32_bf16 v[60:63], a[152:155], a[104:107], v[60:63]
    s_waitcnt lgkmcnt(4)
    v_fma_f32 v15, v15, s27, v67
    v_fma_f32 v16, v16, s27, v64
    v_mfma_f32_16x16x32_bf16 v[48:51], a[156:159], a[12:15], v[48:51]
    ds_read_b128 a[152:155], v68 offset:32768
    v_fma_f32 v17, v17, s27, v64
    v_mfma_f32_16x16x32_bf16 v[52:55], a[156:159], a[44:47], v[52:55]
    s_add_u32 s49, s48, s31
    v_exp_f32 v12, v12
    v_mfma_f32_16x16x32_bf16 v[56:59], a[156:159], a[76:79], v[56:59]
    v_exp_f32 v13, v13
    v_mfma_f32_16x16x32_bf16 v[60:63], a[156:159], a[108:111], v[60:63]
    v_exp_f32 v14, v14
    v_mfma_f32_16x16x32_bf16 v[48:51], a[160:163], a[16:19], v[48:51]
    ds_read_b128 a[156:159], v69 offset:32768
    v_cvt_pk_bf16_f32 v12, v12, v13
    v_mfma_f32_16x16x32_bf16 v[52:55], a[160:163], a[48:51], v[52:55]
    v_exp_f32 v15, v15
    v_mfma_f32_16x16x32_bf16 v[56:59], a[160:163], a[80:83], v[56:59]
    s_waitcnt lgkmcnt(4)
    v_accvgpr_write_b32 a200, v12
    v_cvt_pk_bf16_f32 v14, v14, v15
    v_mfma_f32_16x16x32_bf16 v[60:63], a[160:163], a[112:115], v[60:63]
    v_accvgpr_write_b32 a201, v14
    v_fma_f32 v18, v18, s27, v64
    v_mfma_f32_16x16x32_bf16 v[48:51], a[164:167], a[20:23], v[48:51]
    ds_read_b128 a[160:163], v68 offset:36864
    v_fma_f32 v19, v19, s27, v64
    v_mfma_f32_16x16x32_bf16 v[52:55], a[164:167], a[52:55], v[52:55]
    s_add_u32 m0, m0, s50
    v_exp_f32 v16, v16
    v_mfma_f32_16x16x32_bf16 v[56:59], a[164:167], a[84:87], v[56:59]
    buffer_load_dwordx4 v78, s[8:11], s24 offen offset:256 sc0 sc1 lds
    v_mfma_f32_16x16x32_bf16 v[60:63], a[164:167], a[116:119], v[60:63]
    v_exp_f32 v17, v17
    v_mfma_f32_16x16x32_bf16 v[48:51], a[144:147], a[24:27], v[48:51]
    ds_read_b128 a[164:167], v69 offset:36864
    v_fma_f32 v20, v20, s27, v65
    v_mfma_f32_16x16x32_bf16 v[52:55], a[144:147], a[56:59], v[52:55]
    v_exp_f32 v18, v18
    v_mfma_f32_16x16x32_bf16 v[56:59], a[144:147], a[88:91], v[56:59]
    s_waitcnt lgkmcnt(3)
    v_exp_f32 v19, v19
    v_mfma_f32_16x16x32_bf16 v[60:63], a[144:147], a[120:123], v[60:63]
    buffer_store_dwordx4 a[236:239], v81, s[16:19], s49 offen sc1
    v_mfma_f32_16x16x32_bf16 v[48:51], a[148:151], a[28:31], v[48:51]
    ds_read_b128 a[144:147], v68 offset:40960
    v_cvt_pk_bf16_f32 v90, v16, v17
    v_mfma_f32_16x16x32_bf16 v[52:55], a[148:151], a[60:63], v[52:55]
    v_cvt_pk_bf16_f32 v91, v18, v19
    v_fma_f32 v21, v21, s27, v65
    v_mfma_f32_16x16x32_bf16 v[56:59], a[148:151], a[92:95], v[56:59]
    v_fma_f32 v22, v22, s27, v65
    v_fma_f32 v23, v23, s27, v65
    v_mfma_f32_16x16x32_bf16 v[60:63], a[148:151], a[124:127], v[60:63]
    v_exp_f32 v20, v20
    v_mfma_f32_16x16x32_bf16 v[0:3], a[152:155], a[0:3], v[148:151]
    ds_read_b128 a[148:151], v69 offset:40960
    v_fma_f32 v24, v24, s27, v66
    v_mfma_f32_16x16x32_bf16 v[4:7], a[152:155], a[32:35], v[212:215]
    s_add_u32 m0, m0, s50
    v_exp_f32 v21, v21
    v_exp_f32 v22, v22
    v_fma_f32 v25, v25, s27, v66
    v_pk_mul_f32 v[48:49], v[48:49], s[92:93]
    v_pk_mul_f32 v[50:51], v[50:51], s[92:93]
    v_pk_mul_f32 v[52:53], v[52:53], s[92:93]
    v_pk_mul_f32 v[54:55], v[54:55], s[92:93]
    v_pk_mul_f32 v[56:57], v[56:57], s[92:93]
    v_pk_mul_f32 v[58:59], v[58:59], s[92:93]
    v_pk_mul_f32 v[60:61], v[60:61], s[92:93]
    v_pk_mul_f32 v[62:63], v[62:63], s[92:93]
    v_mfma_f32_16x16x32_bf16 v[8:11], a[152:155], a[64:67], v[244:247]
    buffer_load_dwordx4 v78, s[8:11], s24 offen offset:384 sc0 sc1 lds
    v_mfma_f32_16x16x32_bf16 v[12:15], a[152:155], a[96:99], v[252:255]
    s_waitcnt lgkmcnt(3)
    v_exp_f32 v23, v23
    v_mfma_f32_16x16x32_bf16 v[0:3], a[156:159], a[4:7], v[0:3]
    ds_read_b128 a[152:155], v68 offset:45056
    v_cvt_pk_bf16_f32 v154, v20, v21
    v_mfma_f32_16x16x32_bf16 v[4:7], a[156:159], a[36:39], v[4:7]
    v_cvt_pk_bf16_f32 v155, v22, v23
    v_fma_f32 v26, v26, s27, v66
    v_mfma_f32_16x16x32_bf16 v[8:11], a[156:159], a[68:71], v[8:11]
    v_fma_f32 v27, v27, s27, v66
    v_fma_f32 v28, v28, s27, v67
    v_mfma_f32_16x16x32_bf16 v[12:15], a[156:159], a[100:103], v[12:15]
    v_exp_f32 v24, v24
    v_mfma_f32_16x16x32_bf16 v[0:3], a[160:163], a[8:11], v[0:3]
    ds_read_b128 a[156:159], v69 offset:45056
    v_fma_f32 v29, v29, s27, v67
    v_mfma_f32_16x16x32_bf16 v[4:7], a[160:163], a[40:43], v[4:7]
    v_exp_f32 v25, v25
    v_mfma_f32_16x16x32_bf16 v[8:11], a[160:163], a[72:75], v[8:11]
    s_add_u32 s24, s24, s59
    v_exp_f32 v26, v26
    v_mfma_f32_16x16x32_bf16 v[12:15], a[160:163], a[104:107], v[12:15]
    s_waitcnt lgkmcnt(3)
    v_exp_f32 v27, v27
    v_mfma_f32_16x16x32_bf16 v[0:3], a[164:167], a[12:15], v[0:3]
    ds_read_b128 a[160:163], v68 offset:34816
    v_cvt_pk_bf16_f32 v218, v24, v25
    v_mfma_f32_16x16x32_bf16 v[4:7], a[164:167], a[44:47], v[4:7]
    s_add_u32 m0, m0, s94
    v_cvt_pk_bf16_f32 v219, v26, v27
    v_fma_f32 v30, v30, s27, v67
    v_mfma_f32_16x16x32_bf16 v[8:11], a[164:167], a[76:79], v[8:11]
    buffer_load_dwordx4 v78, s[8:11], s24 offen offset:0 sc0 sc1 lds
    v_mfma_f32_16x16x32_bf16 v[12:15], a[164:167], a[108:111], v[12:15]
    v_fma_f32 v31, v31, s27, v67
    v_fma_f32 v32, v32, s27, v64
    v_mfma_f32_16x16x32_bf16 v[0:3], a[144:147], a[16:19], v[0:3]
    ds_read_b128 a[164:167], v69 offset:34816
    v_fma_f32 v33, v33, s27, v64
    v_mfma_f32_16x16x32_bf16 v[4:7], a[144:147], a[48:51], v[4:7]
    ds_read_b128 a[240:243], v83 offset:2048
    v_fma_f32 v34, v34, s27, v64
    v_mfma_f32_16x16x32_bf16 v[8:11], a[144:147], a[80:83], v[8:11]
    s_waitcnt lgkmcnt(4)
    v_exp_f32 v28, v28
    v_mfma_f32_16x16x32_bf16 v[12:15], a[144:147], a[112:115], v[12:15]
    v_exp_f32 v29, v29
    v_mfma_f32_16x16x32_bf16 v[0:3], a[148:151], a[20:23], v[0:3]
    ds_read_b128 a[144:147], v68 offset:38912
    v_fma_f32 v35, v35, s27, v64
    v_mfma_f32_16x16x32_bf16 v[4:7], a[148:151], a[52:55], v[4:7]
    v_exp_f32 v30, v30
    v_mfma_f32_16x16x32_bf16 v[8:11], a[148:151], a[84:87], v[8:11]
    v_exp_f32 v31, v31
    v_mfma_f32_16x16x32_bf16 v[12:15], a[148:151], a[116:119], v[12:15]
    v_cvt_pk_bf16_f32 v28, v28, v29
    v_fma_f32 v36, v36, s27, v65
    v_mfma_f32_16x16x32_bf16 v[0:3], a[152:155], a[24:27], v[0:3]
    ds_read_b128 a[148:151], v69 offset:38912
    v_cvt_pk_bf16_f32 v30, v30, v31
    v_mfma_f32_16x16x32_bf16 v[4:7], a[152:155], a[56:59], v[4:7]
    s_add_u32 m0, m0, s50
    v_accvgpr_write_b32 a202, v28
    v_accvgpr_write_b32 a203, v30
    v_mfma_f32_16x16x32_bf16 v[8:11], a[152:155], a[88:91], v[8:11]
    buffer_load_dwordx4 v78, s[8:11], s24 offen offset:128 sc0 sc1 lds
    v_mfma_f32_16x16x32_bf16 v[12:15], a[152:155], a[120:123], v[12:15]
    s_waitcnt lgkmcnt(4)
    v_exp_f32 v32, v32
    v_mfma_f32_16x16x32_bf16 v[0:3], a[156:159], a[28:31], v[0:3]
    ds_read_b128 a[152:155], v68 offset:43008
    s_add_u32 s48, s49, s31
    v_mfma_f32_16x16x32_bf16 v[4:7], a[156:159], a[60:63], v[4:7]
    v_exp_f32 v33, v33
    v_mfma_f32_16x16x32_bf16 v[8:11], a[156:159], a[92:95], v[8:11]
    v_exp_f32 v34, v34
    v_mfma_f32_16x16x32_bf16 v[12:15], a[156:159], a[124:127], v[12:15]
    v_exp_f32 v35, v35
    v_mfma_f32_16x16x32_bf16 v[16:19], a[160:163], a[0:3], v[148:151]
    ds_read_b128 a[156:159], v69 offset:43008
    v_cvt_pk_bf16_f32 v92, v32, v33
    v_mfma_f32_16x16x32_bf16 v[20:23], a[160:163], a[32:35], v[212:215]
    v_cvt_pk_bf16_f32 v93, v34, v35
    v_fma_f32 v37, v37, s27, v65
    v_mfma_f32_16x16x32_bf16 v[24:27], a[160:163], a[64:67], v[244:247]
    s_waitcnt lgkmcnt(3)
    v_fma_f32 v38, v38, s27, v65
    v_fma_f32 v39, v39, s27, v65
    v_mfma_f32_16x16x32_bf16 v[28:31], a[160:163], a[96:99], v[252:255]
    buffer_store_dwordx4 a[240:243], v81, s[16:19], s48 offen sc1
    v_mfma_f32_16x16x32_bf16 v[16:19], a[164:167], a[4:7], v[16:19]
    ds_read_b128 a[160:163], v68 offset:47104
    v_subrev_u32 v68, s96, v68
    v_mfma_f32_16x16x32_bf16 v[20:23], a[164:167], a[36:39], v[20:23]
    s_waitcnt vmcnt(15)
    v_exp_f32 v36, v36
    v_mfma_f32_16x16x32_bf16 v[24:27], a[164:167], a[68:71], v[24:27]
    s_barrier
    v_mfma_f32_16x16x32_bf16 v[28:31], a[164:167], a[100:103], v[28:31]
    v_exp_f32 v37, v37
    v_mfma_f32_16x16x32_bf16 v[16:19], a[144:147], a[8:11], v[16:19]
    ds_read_b128 a[164:167], v69 offset:47104
    v_subrev_u32 v69, s96, v69
    v_mfma_f32_16x16x32_bf16 v[20:23], a[144:147], a[40:43], v[20:23]
    s_add_u32 m0, m0, s50
    v_exp_f32 v38, v38
    v_mfma_f32_16x16x32_bf16 v[24:27], a[144:147], a[72:75], v[24:27]
    buffer_load_dwordx4 v78, s[8:11], s24 offen offset:256 sc0 sc1 lds
    v_mfma_f32_16x16x32_bf16 v[28:31], a[144:147], a[104:107], v[28:31]
    s_waitcnt lgkmcnt(3)
    v_exp_f32 v39, v39
    v_mfma_f32_16x16x32_bf16 v[16:19], a[148:151], a[12:15], v[16:19]
    ds_read_b128 a[144:147], v68 offset:0
    v_cvt_pk_bf16_f32 v156, v36, v37
    v_mfma_f32_16x16x32_bf16 v[20:23], a[148:151], a[44:47], v[20:23]
    v_cvt_pk_bf16_f32 v157, v38, v39
    v_fma_f32 v40, v40, s27, v66
    v_mfma_f32_16x16x32_bf16 v[24:27], a[148:151], a[76:79], v[24:27]
    v_fma_f32 v41, v41, s27, v66
    v_fma_f32 v42, v42, s27, v66
    v_mfma_f32_16x16x32_bf16 v[28:31], a[148:151], a[108:111], v[28:31]
    v_fma_f32 v43, v43, s27, v66
    v_fma_f32 v44, v44, s27, v67
    v_mfma_f32_16x16x32_bf16 v[16:19], a[152:155], a[16:19], v[16:19]
    ds_read_b128 a[148:151], v69 offset:0
    v_fma_f32 v45, v45, s27, v67
    v_mfma_f32_16x16x32_bf16 v[20:23], a[152:155], a[48:51], v[20:23]
    v_exp_f32 v40, v40
    v_mfma_f32_16x16x32_bf16 v[24:27], a[152:155], a[80:83], v[24:27]
    s_waitcnt lgkmcnt(3)
    v_exp_f32 v41, v41
    v_mfma_f32_16x16x32_bf16 v[28:31], a[152:155], a[112:115], v[28:31]
    v_exp_f32 v42, v42
    v_mfma_f32_16x16x32_bf16 v[16:19], a[156:159], a[20:23], v[16:19]
    ds_read_b128 a[152:155], v68 offset:4096
    v_cvt_pk_bf16_f32 v220, v40, v41
    v_mfma_f32_16x16x32_bf16 v[20:23], a[156:159], a[52:55], v[20:23]
    s_add_u32 m0, m0, s50
    v_exp_f32 v43, v43
    v_mfma_f32_16x16x32_bf16 v[24:27], a[156:159], a[84:87], v[24:27]
    buffer_load_dwordx4 v78, s[8:11], s24 offen offset:384 sc0 sc1 lds
    v_mfma_f32_16x16x32_bf16 v[28:31], a[156:159], a[116:119], v[28:31]
    v_cvt_pk_bf16_f32 v221, v42, v43
    v_fma_f32 v46, v46, s27, v67
    v_mfma_f32_16x16x32_bf16 v[16:19], a[160:163], a[24:27], v[16:19]
    ds_read_b128 a[156:159], v69 offset:4096
    v_fma_f32 v47, v47, s27, v67
    v_mfma_f32_16x16x32_bf16 v[20:23], a[160:163], a[56:59], v[20:23]
    v_exp_f32 v44, v44
    v_mfma_f32_16x16x32_bf16 v[24:27], a[160:163], a[88:91], v[24:27]
    s_waitcnt lgkmcnt(3)
    v_exp_f32 v45, v45
    v_mfma_f32_16x16x32_bf16 v[28:31], a[160:163], a[120:123], v[28:31]
    v_exp_f32 v46, v46
    v_mfma_f32_16x16x32_bf16 v[16:19], a[164:167], a[28:31], v[16:19]
    ds_read_b128 a[160:163], v68 offset:8192
    v_cvt_pk_bf16_f32 v44, v44, v45
    v_mfma_f32_16x16x32_bf16 v[20:23], a[164:167], a[60:63], v[20:23]
    ds_read_b128 a[244:247], v83 offset:3072
    v_accvgpr_write_b32 a204, v44
    v_mfma_f32_16x16x32_bf16 v[24:27], a[164:167], a[92:95], v[24:27]
    s_add_u32 s24, s24, s59
    v_exp_f32 v47, v47
    v_mfma_f32_16x16x32_bf16 v[28:31], a[164:167], a[124:127], v[28:31]
    v_exp_f32 v48, v48
    v_mfma_f32_16x16x32_bf16 v[32:35], a[144:147], a[0:3], v[148:151]
    ds_read_b128 a[164:167], v69 offset:8192
    v_cvt_pk_bf16_f32 v46, v46, v47
    v_mfma_f32_16x16x32_bf16 v[36:39], a[144:147], a[32:35], v[212:215]
    s_add_u32 m0, m0, s94
    v_exp_f32 v49, v49
    v_exp_f32 v50, v50
    v_accvgpr_write_b32 a205, v46
    v_pk_mul_f32 v[16:17], v[16:17], s[92:93]
    v_pk_mul_f32 v[18:19], v[18:19], s[92:93]
    v_pk_mul_f32 v[20:21], v[20:21], s[92:93]
    v_pk_mul_f32 v[22:23], v[22:23], s[92:93]
    v_pk_mul_f32 v[24:25], v[24:25], s[92:93]
    v_pk_mul_f32 v[26:27], v[26:27], s[92:93]
    v_pk_mul_f32 v[28:29], v[28:29], s[92:93]
    v_pk_mul_f32 v[30:31], v[30:31], s[92:93]
    v_mfma_f32_16x16x32_bf16 v[40:43], a[144:147], a[64:67], v[244:247]
    buffer_load_dwordx4 v78, s[8:11], s24 offen offset:0 sc0 sc1 lds
    v_mfma_f32_16x16x32_bf16 v[44:47], a[144:147], a[96:99], v[252:255]
    s_waitcnt lgkmcnt(4)
    v_exp_f32 v51, v51
    v_mfma_f32_16x16x32_bf16 v[32:35], a[148:151], a[4:7], v[32:35]
    ds_read_b128 a[144:147], v68 offset:12288
    v_cvt_pk_bf16_f32 v94, v48, v49
    v_mfma_f32_16x16x32_bf16 v[36:39], a[148:151], a[36:39], v[36:39]
    s_add_u32 s49, s48, s31
    v_exp_f32 v52, v52
    v_mfma_f32_16x16x32_bf16 v[40:43], a[148:151], a[68:71], v[40:43]
    v_exp_f32 v53, v53
    v_mfma_f32_16x16x32_bf16 v[44:47], a[148:151], a[100:103], v[44:47]
    v_cvt_pk_bf16_f32 v95, v50, v51
    v_mul_f32 v0, s27, v0
    v_mfma_f32_16x16x32_bf16 v[32:35], a[152:155], a[8:11], v[32:35]
    ds_read_b128 a[148:151], v69 offset:12288
    v_cvt_pk_bf16_f32 v158, v52, v53
    v_mfma_f32_16x16x32_bf16 v[36:39], a[152:155], a[40:43], v[36:39]
    v_exp_f32 v54, v54
    v_mfma_f32_16x16x32_bf16 v[40:43], a[152:155], a[72:75], v[40:43]
    s_waitcnt lgkmcnt(4)
    v_exp_f32 v55, v55
    v_mfma_f32_16x16x32_bf16 v[44:47], a[152:155], a[104:107], v[44:47]
    v_exp_f32 v56, v56
    v_mfma_f32_16x16x32_bf16 v[32:35], a[156:159], a[12:15], v[32:35]
    ds_read_b128 a[152:155], v68 offset:2048
    v_cvt_pk_bf16_f32 v159, v54, v55
    v_mfma_f32_16x16x32_bf16 v[36:39], a[156:159], a[44:47], v[36:39]
    s_add_u32 m0, m0, s50
    v_exp_f32 v57, v57
    v_mfma_f32_16x16x32_bf16 v[40:43], a[156:159], a[76:79], v[40:43]
    buffer_load_dwordx4 v78, s[8:11], s24 offen offset:128 sc0 sc1 lds
    v_mfma_f32_16x16x32_bf16 v[44:47], a[156:159], a[108:111], v[44:47]
    v_exp_f32 v58, v58
    v_mfma_f32_16x16x32_bf16 v[32:35], a[160:163], a[16:19], v[32:35]
    ds_read_b128 a[156:159], v69 offset:2048
    v_cvt_pk_bf16_f32 v222, v56, v57
    v_mfma_f32_16x16x32_bf16 v[36:39], a[160:163], a[48:51], v[36:39]
    v_exp_f32 v59, v59
    v_mfma_f32_16x16x32_bf16 v[40:43], a[160:163], a[80:83], v[40:43]
    s_waitcnt lgkmcnt(3)
    v_exp_f32 v60, v60
    v_mfma_f32_16x16x32_bf16 v[44:47], a[160:163], a[112:115], v[44:47]
    buffer_store_dwordx4 a[244:247], v81, s[16:19], s49 offen sc1
    v_mfma_f32_16x16x32_bf16 v[32:35], a[164:167], a[20:23], v[32:35]
    ds_read_b128 a[160:163], v68 offset:6144
    v_cvt_pk_bf16_f32 v223, v58, v59
    v_mfma_f32_16x16x32_bf16 v[36:39], a[164:167], a[52:55], v[36:39]
    v_exp_f32 v61, v61
    v_mfma_f32_16x16x32_bf16 v[40:43], a[164:167], a[84:87], v[40:43]
    v_exp_f32 v62, v62
    v_mfma_f32_16x16x32_bf16 v[44:47], a[164:167], a[116:119], v[44:47]
L_w1:
    s_cbranch_execz L_w5
    v_exp_f32 v63, v63
    v_mfma_f32_16x16x32_bf16 v[32:35], a[144:147], a[24:27], v[32:35]
    ds_read_b128 a[164:167], v69 offset:6144
    v_cvt_pk_bf16_f32 v60, v60, v61
    v_mfma_f32_16x16x32_bf16 v[36:39], a[144:147], a[56:59], v[36:39]
    s_add_u32 m0, m0, s50
    v_cvt_pk_bf16_f32 v62, v62, v63
    v_accvgpr_write_b32 a206, v60
    v_mfma_f32_16x16x32_bf16 v[40:43], a[144:147], a[88:91], v[40:43]
    buffer_load_dwordx4 v78, s[8:11], s24 offen offset:256 sc0 sc1 lds
    v_mfma_f32_16x16x32_bf16 v[44:47], a[144:147], a[120:123], v[44:47]
    s_waitcnt lgkmcnt(3)
    v_accvgpr_write_b32 a207, v62
    v_mul_f32 v1, s27, v1
    v_mfma_f32_16x16x32_bf16 v[32:35], a[148:151], a[28:31], v[32:35]
    ds_read_b128 a[144:147], v68 offset:10240
    v_mul_f32 v2, s27, v2
    v_mfma_f32_16x16x32_bf16 v[36:39], a[148:151], a[60:63], v[36:39]
    v_mul_f32 v3, s27, v3
    v_mul_f32 v4, s27, v4
    v_mfma_f32_16x16x32_bf16 v[40:43], a[148:151], a[92:95], v[40:43]
    v_exp_f32 v0, v0
    v_mfma_f32_16x16x32_bf16 v[44:47], a[148:151], a[124:127], v[44:47]
    v_exp_f32 v1, v1
    v_smfmac_f32_16x16x64_bf16 a[136:139], a[128:131], v[88:95], v84
    v_mul_f32 v5, s27, v5
    v_smfmac_f32_16x16x64_bf16 a[136:139], a[132:135], v[152:159], v84
    v_cvt_pk_bf16_f32 v96, v0, v1
    v_smfmac_f32_16x16x64_bf16 a[140:143], a[128:131], v[216:223], v84
    v_mul_f32 v6, s27, v6
    v_smfmac_f32_16x16x64_bf16 a[140:143], a[132:135], a[200:207], v84
    v_mul_f32 v7, s27, v7
    v_mfma_f32_16x16x32_bf16 v[48:51], a[152:155], a[0:3], v[148:151]
    ds_read_b128 a[148:151], v69 offset:10240
    v_mul_f32 v8, s27, v8
    v_mfma_f32_16x16x32_bf16 v[52:55], a[152:155], a[32:35], v[212:215]
    v_exp_f32 v2, v2
    v_mfma_f32_16x16x32_bf16 v[56:59], a[152:155], a[64:67], v[244:247]
    s_waitcnt lgkmcnt(3)
    v_exp_f32 v3, v3
    v_mfma_f32_16x16x32_bf16 v[60:63], a[152:155], a[96:99], v[252:255]
    v_exp_f32 v4, v4
    v_mfma_f32_16x16x32_bf16 v[48:51], a[156:159], a[4:7], v[48:51]
    ds_read_b128 a[152:155], v68 offset:14336
    v_cvt_pk_bf16_f32 v97, v2, v3
    v_mfma_f32_16x16x32_bf16 v[52:55], a[156:159], a[36:39], v[52:55]
    s_waitcnt vmcnt(14)
    v_exp_f32 v5, v5
    v_mfma_f32_16x16x32_bf16 v[56:59], a[156:159], a[68:71], v[56:59]
    s_barrier
    v_mfma_f32_16x16x32_bf16 v[60:63], a[156:159], a[100:103], v[60:63]
    v_exp_f32 v6, v6
    v_mfma_f32_16x16x32_bf16 v[48:51], a[160:163], a[8:11], v[48:51]
    ds_read_b128 a[156:159], v69 offset:14336
    v_cvt_pk_bf16_f32 v160, v4, v5
    v_mfma_f32_16x16x32_bf16 v[52:55], a[160:163], a[40:43], v[52:55]
    ds_read_b128 a[248:251], v83 offset:16384
    v_mul_f32 v9, s27, v9
    v_mfma_f32_16x16x32_bf16 v[56:59], a[160:163], a[72:75], v[56:59]
    s_add_u32 m0, m0, s50
    v_exp_f32 v7, v7
    v_mfma_f32_16x16x32_bf16 v[60:63], a[160:163], a[104:107], v[60:63]
    s_waitcnt lgkmcnt(4)
    v_mul_f32 v10, s27, v10
    v_cvt_pk_bf16_f32 v161, v6, v7
    v_mfma_f32_16x16x32_bf16 v[48:51], a[164:167], a[12:15], v[48:51]
    ds_read_b128 a[160:163], v68 offset:16384
    v_mul_f32 v11, s27, v11
    v_mfma_f32_16x16x32_bf16 v[52:55], a[164:167], a[44:47], v[52:55]
    buffer_load_dwordx4 v78, s[8:11], s24 offen offset:384 sc0 sc1 lds
    v_mfma_f32_16x16x32_bf16 v[56:59], a[164:167], a[76:79], v[56:59]
    v_exp_f32 v8, v8
    v_mfma_f32_16x16x32_bf16 v[60:63], a[164:167], a[108:111], v[60:63]
    v_exp_f32 v9, v9
    v_mfma_f32_16x16x32_bf16 v[48:51], a[144:147], a[16:19], v[48:51]
    ds_read_b128 a[164:167], v69 offset:16384
    v_mul_f32 v12, s27, v12
    v_mfma_f32_16x16x32_bf16 v[52:55], a[144:147], a[48:51], v[52:55]
    s_add_u32 s48, s49, s31
    v_exp_f32 v10, v10
    v_mfma_f32_16x16x32_bf16 v[56:59], a[144:147], a[80:83], v[56:59]
    s_xor_b32 s24, s20, 131072
    v_exp_f32 v11, v11
    v_mfma_f32_16x16x32_bf16 v[60:63], a[144:147], a[112:115], v[60:63]
    s_waitcnt lgkmcnt(4)
    v_cvt_pk_bf16_f32 v224, v8, v9
    v_cvt_pk_bf16_f32 v225, v10, v11
    v_mfma_f32_16x16x32_bf16 v[48:51], a[148:151], a[20:23], v[48:51]
    ds_read_b128 a[144:147], v68 offset:20480
    v_mul_f32 v13, s27, v13
    v_mfma_f32_16x16x32_bf16 v[52:55], a[148:151], a[52:55], v[52:55]
    s_add_u32 m0, m0, s94
    v_mul_f32 v14, s27, v14
    v_mul_f32 v15, s27, v15
    v_mfma_f32_16x16x32_bf16 v[56:59], a[148:151], a[84:87], v[56:59]
    buffer_load_dwordx4 v78, s[8:11], s24 offen offset:0 sc0 sc1 lds
    v_mfma_f32_16x16x32_bf16 v[60:63], a[148:151], a[116:119], v[60:63]
    v_exp_f32 v12, v12
    v_mfma_f32_16x16x32_bf16 v[48:51], a[152:155], a[24:27], v[48:51]
    ds_read_b128 a[148:151], v69 offset:20480
    v_mfma_f32_16x16x32_bf16 v[52:55], a[152:155], a[56:59], v[52:55]
    v_exp_f32 v13, v13
    v_mfma_f32_16x16x32_bf16 v[56:59], a[152:155], a[88:91], v[56:59]
    s_waitcnt lgkmcnt(3)
    v_exp_f32 v14, v14
    v_mfma_f32_16x16x32_bf16 v[60:63], a[152:155], a[120:123], v[60:63]
    buffer_store_dwordx4 a[248:251], v81, s[16:19], s48 offen sc1
    v_mfma_f32_16x16x32_bf16 v[48:51], a[156:159], a[28:31], v[48:51]
    ds_read_b128 a[152:155], v68 offset:24576
    v_cvt_pk_bf16_f32 v12, v12, v13
    v_mfma_f32_16x16x32_bf16 v[52:55], a[156:159], a[60:63], v[52:55]
    v_exp_f32 v15, v15
    v_mfma_f32_16x16x32_bf16 v[56:59], a[156:159], a[92:95], v[56:59]
    v_exp_f32 v16, v16
    v_mfma_f32_16x16x32_bf16 v[60:63], a[156:159], a[124:127], v[60:63]
    v_cvt_pk_bf16_f32 v14, v14, v15
    v_accvgpr_write_b32 a208, v12
    v_mfma_f32_16x16x32_bf16 v[0:3], a[160:163], a[0:3], v[148:151]
    ds_read_b128 a[156:159], v69 offset:24576
    v_accvgpr_write_b32 a209, v14
    v_mfma_f32_16x16x32_bf16 v[4:7], a[160:163], a[32:35], v[212:215]
    s_add_u32 m0, m0, s50
    v_exp_f32 v17, v17
    v_exp_f32 v18, v18
    v_pk_mul_f32 v[48:49], v[48:49], s[92:93]
    v_pk_mul_f32 v[50:51], v[50:51], s[92:93]
    v_pk_mul_f32 v[52:53], v[52:53], s[92:93]
    v_pk_mul_f32 v[54:55], v[54:55], s[92:93]
    v_pk_mul_f32 v[56:57], v[56:57], s[92:93]
    v_pk_mul_f32 v[58:59], v[58:59], s[92:93]
    v_pk_mul_f32 v[60:61], v[60:61], s[92:93]
    v_pk_mul_f32 v[62:63], v[62:63], s[92:93]
    v_mfma_f32_16x16x32_bf16 v[8:11], a[160:163], a[64:67], v[244:247]
    buffer_load_dwordx4 v78, s[8:11], s24 offen offset:128 sc0 sc1 lds
    v_mfma_f32_16x16x32_bf16 v[12:15], a[160:163], a[96:99], v[252:255]
    s_waitcnt lgkmcnt(3)
    v_exp_f32 v19, v19
    v_mfma_f32_16x16x32_bf16 v[0:3], a[164:167], a[4:7], v[0:3]
    ds_read_b128 a[160:163], v68 offset:28672
    v_cvt_pk_bf16_f32 v98, v16, v17
    v_mfma_f32_16x16x32_bf16 v[4:7], a[164:167], a[36:39], v[4:7]
    v_exp_f32 v20, v20
    v_mfma_f32_16x16x32_bf16 v[8:11], a[164:167], a[68:71], v[8:11]
    v_exp_f32 v21, v21
    v_mfma_f32_16x16x32_bf16 v[12:15], a[164:167], a[100:103], v[12:15]
    v_cvt_pk_bf16_f32 v99, v18, v19
    v_mul_f32 v32, s27, v32
    v_mfma_f32_16x16x32_bf16 v[0:3], a[144:147], a[8:11], v[0:3]
    ds_read_b128 a[164:167], v69 offset:28672
    v_cvt_pk_bf16_f32 v162, v20, v21
    v_mfma_f32_16x16x32_bf16 v[4:7], a[144:147], a[40:43], v[4:7]
    v_exp_f32 v22, v22
    v_mfma_f32_16x16x32_bf16 v[8:11], a[144:147], a[72:75], v[8:11]
    s_waitcnt lgkmcnt(3)
    v_exp_f32 v23, v23
    v_mfma_f32_16x16x32_bf16 v[12:15], a[144:147], a[104:107], v[12:15]
    v_exp_f32 v24, v24
    v_mfma_f32_16x16x32_bf16 v[0:3], a[148:151], a[12:15], v[0:3]
    ds_read_b128 a[144:147], v68 offset:18432
    v_cvt_pk_bf16_f32 v163, v22, v23
    v_mfma_f32_16x16x32_bf16 v[4:7], a[148:151], a[44:47], v[4:7]
    s_add_u32 m0, m0, s50
    v_exp_f32 v25, v25
    v_mfma_f32_16x16x32_bf16 v[8:11], a[148:151], a[76:79], v[8:11]
    buffer_load_dwordx4 v78, s[8:11], s24 offen offset:256 sc0 sc1 lds
    v_mfma_f32_16x16x32_bf16 v[12:15], a[148:151], a[108:111], v[12:15]
    v_exp_f32 v26, v26
    v_mfma_f32_16x16x32_bf16 v[0:3], a[152:155], a[16:19], v[0:3]
    ds_read_b128 a[148:151], v69 offset:18432
    v_cvt_pk_bf16_f32 v226, v24, v25
    v_mfma_f32_16x16x32_bf16 v[4:7], a[152:155], a[48:51], v[4:7]
    v_exp_f32 v27, v27
    v_mfma_f32_16x16x32_bf16 v[8:11], a[152:155], a[80:83], v[8:11]
    s_waitcnt lgkmcnt(3)
    v_exp_f32 v28, v28
    v_mfma_f32_16x16x32_bf16 v[12:15], a[152:155], a[112:115], v[12:15]
    v_cvt_pk_bf16_f32 v227, v26, v27
    v_mul_f32 v33, s27, v33
    v_mfma_f32_16x16x32_bf16 v[0:3], a[156:159], a[20:23], v[0:3]
    ds_read_b128 a[152:155], v68 offset:22528
    v_mul_f32 v34, s27, v34
    v_mfma_f32_16x16x32_bf16 v[4:7], a[156:159], a[52:55], v[4:7]
    ds_read_b128 a[252:255], v83 offset:17408
    v_mul_f32 v35, s27, v35
    v_mfma_f32_16x16x32_bf16 v[8:11], a[156:159], a[84:87], v[8:11]
    v_exp_f32 v29, v29
    v_mfma_f32_16x16x32_bf16 v[12:15], a[156:159], a[116:119], v[12:15]
    v_exp_f32 v30, v30
    v_mfma_f32_16x16x32_bf16 v[0:3], a[160:163], a[24:27], v[0:3]
    ds_read_b128 a[156:159], v69 offset:22528
    v_cvt_pk_bf16_f32 v28, v28, v29
    v_mfma_f32_16x16x32_bf16 v[4:7], a[160:163], a[56:59], v[4:7]
    s_add_u32 m0, m0, s50
    v_exp_f32 v31, v31
    v_mfma_f32_16x16x32_bf16 v[8:11], a[160:163], a[88:91], v[8:11]
    buffer_load_dwordx4 v78, s[8:11], s24 offen offset:384 sc0 sc1 lds
    v_mfma_f32_16x16x32_bf16 v[12:15], a[160:163], a[120:123], v[12:15]
    s_waitcnt lgkmcnt(4)
    v_cvt_pk_bf16_f32 v30, v30, v31
    v_accvgpr_write_b32 a210, v28
    v_mfma_f32_16x16x32_bf16 v[0:3], a[164:167], a[28:31], v[0:3]
    ds_read_b128 a[160:163], v68 offset:26624
    v_accvgpr_write_b32 a211, v30
    v_mfma_f32_16x16x32_bf16 v[4:7], a[164:167], a[60:63], v[4:7]
    s_add_u32 s49, s48, s31
    v_exp_f32 v32, v32
    v_mfma_f32_16x16x32_bf16 v[8:11], a[164:167], a[92:95], v[8:11]
    v_exp_f32 v33, v33
    v_mfma_f32_16x16x32_bf16 v[12:15], a[164:167], a[124:127], v[12:15]
    v_exp_f32 v34, v34
    v_mfma_f32_16x16x32_bf16 v[16:19], a[144:147], a[0:3], v[148:151]
    ds_read_b128 a[164:167], v69 offset:26624
    v_cvt_pk_bf16_f32 v100, v32, v33
    v_mfma_f32_16x16x32_bf16 v[20:23], a[144:147], a[32:35], v[212:215]
    v_exp_f32 v35, v35
    v_mfma_f32_16x16x32_bf16 v[24:27], a[144:147], a[64:67], v[244:247]
    s_waitcnt lgkmcnt(4)
    v_mul_f32 v36, s27, v36
    v_cvt_pk_bf16_f32 v101, v34, v35
    v_mfma_f32_16x16x32_bf16 v[28:31], a[144:147], a[96:99], v[252:255]
    v_mul_f32 v37, s27, v37
    v_mul_f32 v38, s27, v38
    v_mfma_f32_16x16x32_bf16 v[16:19], a[148:151], a[4:7], v[16:19]
    ds_read_b128 a[144:147], v68 offset:30720
    v_mul_f32 v39, s27, v39
    v_mfma_f32_16x16x32_bf16 v[20:23], a[148:151], a[36:39], v[20:23]
    s_waitcnt vmcnt(15)
    v_exp_f32 v36, v36
    v_mfma_f32_16x16x32_bf16 v[24:27], a[148:151], a[68:71], v[24:27]
    s_barrier
    v_mfma_f32_16x16x32_bf16 v[28:31], a[148:151], a[100:103], v[28:31]
    v_exp_f32 v37, v37
    v_mfma_f32_16x16x32_bf16 v[16:19], a[152:155], a[8:11], v[16:19]
    ds_read_b128 a[148:151], v69 offset:30720
    v_mul_f32 v40, s27, v40
    v_mfma_f32_16x16x32_bf16 v[20:23], a[152:155], a[40:43], v[20:23]
    v_exp_f32 v38, v38
    v_mfma_f32_16x16x32_bf16 v[24:27], a[152:155], a[72:75], v[24:27]
    s_add_u32 s24, s24, s59
    v_exp_f32 v39, v39
    v_mfma_f32_16x16x32_bf16 v[28:31], a[152:155], a[104:107], v[28:31]
    s_waitcnt lgkmcnt(3)
    v_cvt_pk_bf16_f32 v164, v36, v37
    v_cvt_pk_bf16_f32 v165, v38, v39
    v_mfma_f32_16x16x32_bf16 v[16:19], a[156:159], a[12:15], v[16:19]
    ds_read_b128 a[152:155], v68 offset:32768
    v_mul_f32 v41, s27, v41
    v_mfma_f32_16x16x32_bf16 v[20:23], a[156:159], a[44:47], v[20:23]
    buffer_store_dwordx4 a[252:255], v81, s[16:19], s49 offen sc1
    v_mfma_f32_16x16x32_bf16 v[24:27], a[156:159], a[76:79], v[24:27]
    s_add_u32 m0, s22, 0
    v_mul_f32 v42, s27, v42
    v_mul_f32 v43, s27, v43
    v_mfma_f32_16x16x32_bf16 v[28:31], a[156:159], a[108:111], v[28:31]
    buffer_load_dwordx4 v78, s[8:11], s24 offen offset:0 sc0 sc1 lds
    v_mfma_f32_16x16x32_bf16 v[16:19], a[160:163], a[16:19], v[16:19]
    ds_read_b128 a[156:159], v69 offset:32768
    v_mul_f32 v44, s27, v44
    v_mfma_f32_16x16x32_bf16 v[20:23], a[160:163], a[48:51], v[20:23]
    v_exp_f32 v40, v40
    v_mfma_f32_16x16x32_bf16 v[24:27], a[160:163], a[80:83], v[24:27]
    s_waitcnt lgkmcnt(3)
    v_exp_f32 v41, v41
    v_mfma_f32_16x16x32_bf16 v[28:31], a[160:163], a[112:115], v[28:31]
    v_exp_f32 v42, v42
    v_mfma_f32_16x16x32_bf16 v[16:19], a[164:167], a[20:23], v[16:19]
    ds_read_b128 a[160:163], v68 offset:36864
    v_cvt_pk_bf16_f32 v228, v40, v41
    v_mfma_f32_16x16x32_bf16 v[20:23], a[164:167], a[52:55], v[20:23]
    v_exp_f32 v43, v43
    v_mfma_f32_16x16x32_bf16 v[24:27], a[164:167], a[84:87], v[24:27]
    v_mul_f32 v45, s27, v45
    v_mul_f32 v46, s27, v46
    v_mfma_f32_16x16x32_bf16 v[28:31], a[164:167], a[116:119], v[28:31]
    v_cvt_pk_bf16_f32 v229, v42, v43
    v_mul_f32 v47, s27, v47
    v_mfma_f32_16x16x32_bf16 v[16:19], a[144:147], a[24:27], v[16:19]
    ds_read_b128 a[164:167], v69 offset:36864
    s_add_u32 m0, m0, s50
    v_mfma_f32_16x16x32_bf16 v[20:23], a[144:147], a[56:59], v[20:23]
    v_exp_f32 v44, v44
    v_mfma_f32_16x16x32_bf16 v[24:27], a[144:147], a[88:91], v[24:27]
    buffer_load_dwordx4 v78, s[8:11], s24 offen offset:128 sc0 sc1 lds
    v_mfma_f32_16x16x32_bf16 v[28:31], a[144:147], a[120:123], v[28:31]
    s_waitcnt lgkmcnt(3)
    v_exp_f32 v45, v45
    v_mfma_f32_16x16x32_bf16 v[16:19], a[148:151], a[28:31], v[16:19]
    ds_read_b128 a[144:147], v68 offset:40960
    v_mfma_f32_16x16x32_bf16 v[20:23], a[148:151], a[60:63], v[20:23]
    v_exp_f32 v46, v46
    v_mfma_f32_16x16x32_bf16 v[24:27], a[148:151], a[92:95], v[24:27]
    v_exp_f32 v47, v47
    v_mfma_f32_16x16x32_bf16 v[28:31], a[148:151], a[124:127], v[28:31]
    s_add_u32 s43, s42, 0
    v_exp_f32 v48, v48
    v_mfma_f32_16x16x32_bf16 v[32:35], a[152:155], a[0:3], v[148:151]
    ds_read_b128 a[148:151], v69 offset:40960
    v_cvt_pk_bf16_f32 v44, v44, v45
    v_mfma_f32_16x16x32_bf16 v[36:39], a[152:155], a[32:35], v[212:215]
    s_add_u32 m0, s44, 114688
    v_cvt_pk_bf16_f32 v46, v46, v47
    v_exp_f32 v49, v49
    v_accvgpr_write_b32 a212, v44
    v_accvgpr_write_b32 a213, v46
    v_pk_mul_f32 v[16:17], v[16:17], s[92:93]
    v_pk_mul_f32 v[18:19], v[18:19], s[92:93]
    v_pk_mul_f32 v[20:21], v[20:21], s[92:93]
    v_pk_mul_f32 v[22:23], v[22:23], s[92:93]
    v_pk_mul_f32 v[24:25], v[24:25], s[92:93]
    v_pk_mul_f32 v[26:27], v[26:27], s[92:93]
    v_pk_mul_f32 v[28:29], v[28:29], s[92:93]
    v_pk_mul_f32 v[30:31], v[30:31], s[92:93]
    v_mfma_f32_16x16x32_bf16 v[40:43], a[152:155], a[64:67], v[244:247]
    buffer_load_dwordx4 v78, s[4:7], s43 offen offset:0 sc0 sc1 nt lds
    v_mfma_f32_16x16x32_bf16 v[44:47], a[152:155], a[96:99], v[252:255]
    s_waitcnt lgkmcnt(3)
    v_exp_f32 v50, v50
    v_mfma_f32_16x16x32_bf16 v[32:35], a[156:159], a[4:7], v[32:35]
    ds_read_b128 a[152:155], v68 offset:45056
    v_cvt_pk_bf16_f32 v102, v48, v49
    v_mfma_f32_16x16x32_bf16 v[36:39], a[156:159], a[36:39], v[36:39]
    s_add_u32 m0, s22, 7936
    v_exp_f32 v51, v51
    v_mfma_f32_16x16x32_bf16 v[40:43], a[156:159], a[68:71], v[40:43]
    buffer_load_dwordx4 v78, s[8:11], s24 offen offset:256 sc0 sc1 lds
    v_mfma_f32_16x16x32_bf16 v[44:47], a[156:159], a[100:103], v[44:47]
    v_exp_f32 v52, v52
    v_mfma_f32_16x16x32_bf16 v[32:35], a[160:163], a[8:11], v[32:35]
    ds_read_b128 a[156:159], v69 offset:45056
    v_cvt_pk_bf16_f32 v103, v50, v51
    v_mfma_f32_16x16x32_bf16 v[36:39], a[160:163], a[40:43], v[36:39]
    s_add_u32 m0, s45, 114688
    v_exp_f32 v53, v53
    v_mfma_f32_16x16x32_bf16 v[40:43], a[160:163], a[72:75], v[40:43]
    buffer_load_dwordx4 v72, s[4:7], s43 offen offset:0 sc0 sc1 nt lds
    v_mfma_f32_16x16x32_bf16 v[44:47], a[160:163], a[104:107], v[44:47]
    s_waitcnt lgkmcnt(3)
    v_exp_f32 v54, v54
    v_mfma_f32_16x16x32_bf16 v[32:35], a[164:167], a[12:15], v[32:35]
    ds_read_b128 a[160:163], v68 offset:34816
    v_cvt_pk_bf16_f32 v166, v52, v53
    v_mfma_f32_16x16x32_bf16 v[36:39], a[164:167], a[44:47], v[36:39]
    v_exp_f32 v55, v55
    v_mfma_f32_16x16x32_bf16 v[40:43], a[164:167], a[76:79], v[40:43]
    v_exp_f32 v56, v56
    v_mfma_f32_16x16x32_bf16 v[44:47], a[164:167], a[108:111], v[44:47]
    v_cvt_pk_bf16_f32 v167, v54, v55
    v_mul_f32 v0, s27, v0
    v_mfma_f32_16x16x32_bf16 v[32:35], a[144:147], a[16:19], v[32:35]
    ds_read_b128 a[164:167], v69 offset:34816
    v_mul_f32 v1, s27, v1
    v_mfma_f32_16x16x32_bf16 v[36:39], a[144:147], a[48:51], v[36:39]
    s_add_u32 m0, s22, 11904
    v_exp_f32 v57, v57
    v_mfma_f32_16x16x32_bf16 v[40:43], a[144:147], a[80:83], v[40:43]
    buffer_load_dwordx4 v78, s[8:11], s24 offen offset:384 sc0 sc1 lds
    v_mfma_f32_16x16x32_bf16 v[44:47], a[144:147], a[112:115], v[44:47]
    s_waitcnt lgkmcnt(3)
    v_exp_f32 v58, v58
    v_mfma_f32_16x16x32_bf16 v[32:35], a[148:151], a[20:23], v[32:35]
    ds_read_b128 a[144:147], v68 offset:38912
    v_cvt_pk_bf16_f32 v230, v56, v57
    v_mfma_f32_16x16x32_bf16 v[36:39], a[148:151], a[52:55], v[36:39]
    s_add_u32 m0, s44, 116608
    v_exp_f32 v59, v59
    v_mfma_f32_16x16x32_bf16 v[40:43], a[148:151], a[84:87], v[40:43]
    buffer_load_dwordx4 v78, s[4:7], s43 offen offset:128 sc0 sc1 nt lds
    v_mfma_f32_16x16x32_bf16 v[44:47], a[148:151], a[116:119], v[44:47]
    v_cvt_pk_bf16_f32 v231, v58, v59
    v_mul_f32 v2, s27, v2
    v_mfma_f32_16x16x32_bf16 v[32:35], a[152:155], a[24:27], v[32:35]
    ds_read_b128 a[148:151], v69 offset:38912
    v_mul_f32 v3, s27, v3
    v_mfma_f32_16x16x32_bf16 v[36:39], a[152:155], a[56:59], v[36:39]
    s_add_u32 m0, s45, 116608
    v_exp_f32 v60, v60
    v_mfma_f32_16x16x32_bf16 v[40:43], a[152:155], a[88:91], v[40:43]
    buffer_load_dwordx4 v72, s[4:7], s43 offen offset:128 sc0 sc1 nt lds
    v_mfma_f32_16x16x32_bf16 v[44:47], a[152:155], a[120:123], v[44:47]
    s_waitcnt lgkmcnt(3)
    v_exp_f32 v61, v61
    v_mfma_f32_16x16x32_bf16 v[32:35], a[156:159], a[28:31], v[32:35]
    ds_read_b128 a[152:155], v68 offset:43008
    v_mul_f32 v4, s27, v4
    v_mfma_f32_16x16x32_bf16 v[36:39], a[156:159], a[60:63], v[36:39]
    v_exp_f32 v62, v62
    v_mfma_f32_16x16x32_bf16 v[40:43], a[156:159], a[92:95], v[40:43]
    v_exp_f32 v63, v63
    v_mfma_f32_16x16x32_bf16 v[44:47], a[156:159], a[124:127], v[44:47]
    v_cvt_pk_bf16_f32 v60, v60, v61
    v_mul_f32 v5, s27, v5
    v_smfmac_f32_16x16x64_bf16 a[136:139], a[128:131], v[96:103], v84
    v_cvt_pk_bf16_f32 v62, v62, v63
    v_smfmac_f32_16x16x64_bf16 a[136:139], a[132:135], v[160:167], v84
    v_accvgpr_write_b32 a214, v60
    v_smfmac_f32_16x16x64_bf16 a[140:143], a[128:131], v[224:231], v84
    v_accvgpr_write_b32 a215, v62
    s_nop 1
    v_smfmac_f32_16x16x64_bf16 a[140:143], a[132:135], a[208:215], v84
    v_mul_f32 v6, s27, v6
    v_mfma_f32_16x16x32_bf16 v[48:51], a[160:163], a[0:3], v[148:151]
    ds_read_b128 a[156:159], v69 offset:43008
    v_mul_f32 v7, s27, v7
    v_mfma_f32_16x16x32_bf16 v[52:55], a[160:163], a[32:35], v[212:215]
    v_exp_f32 v0, v0
    v_mfma_f32_16x16x32_bf16 v[56:59], a[160:163], a[64:67], v[244:247]
    s_waitcnt lgkmcnt(3)
    v_exp_f32 v1, v1
    v_mfma_f32_16x16x32_bf16 v[60:63], a[160:163], a[96:99], v[252:255]
    v_exp_f32 v2, v2
    v_mfma_f32_16x16x32_bf16 v[48:51], a[164:167], a[4:7], v[48:51]
    ds_read_b128 a[160:163], v68 offset:47104
    v_cvt_pk_bf16_f32 v104, v0, v1
    v_mfma_f32_16x16x32_bf16 v[52:55], a[164:167], a[36:39], v[52:55]
    s_waitcnt vmcnt(19)
    v_exp_f32 v3, v3
    v_mfma_f32_16x16x32_bf16 v[56:59], a[164:167], a[68:71], v[56:59]
    s_barrier
    v_mfma_f32_16x16x32_bf16 v[60:63], a[164:167], a[100:103], v[60:63]
    v_cvt_pk_bf16_f32 v105, v2, v3
    v_mul_f32 v8, s27, v8
    v_mfma_f32_16x16x32_bf16 v[48:51], a[144:147], a[8:11], v[48:51]
    ds_read_b128 a[164:167], v69 offset:47104
    v_mul_f32 v9, s27, v9
    v_mfma_f32_16x16x32_bf16 v[52:55], a[144:147], a[40:43], v[52:55]
    v_exp_f32 v4, v4
    v_mfma_f32_16x16x32_bf16 v[56:59], a[144:147], a[72:75], v[56:59]
    s_add_u32 s24, s24, s59
    v_exp_f32 v5, v5
    v_mfma_f32_16x16x32_bf16 v[60:63], a[144:147], a[104:107], v[60:63]
    s_waitcnt lgkmcnt(3)
    v_exp_f32 v6, v6
    v_mfma_f32_16x16x32_bf16 v[48:51], a[148:151], a[12:15], v[48:51]
    ds_read_b128 a[144:147], v68 offset:49152
    v_cvt_pk_bf16_f32 v168, v4, v5
    v_mfma_f32_16x16x32_bf16 v[52:55], a[148:151], a[44:47], v[52:55]
    s_add_u32 m0, s22, 16384
    v_exp_f32 v7, v7
    v_mfma_f32_16x16x32_bf16 v[56:59], a[148:151], a[76:79], v[56:59]
    buffer_load_dwordx4 v78, s[8:11], s24 offen offset:0 sc0 sc1 lds
    v_mfma_f32_16x16x32_bf16 v[60:63], a[148:151], a[108:111], v[60:63]
    v_cvt_pk_bf16_f32 v169, v6, v7
    v_mul_f32 v10, s27, v10
    v_mfma_f32_16x16x32_bf16 v[48:51], a[152:155], a[16:19], v[48:51]
    ds_read_b128 a[148:151], v69 offset:49152
    v_mul_f32 v11, s27, v11
    v_mfma_f32_16x16x32_bf16 v[52:55], a[152:155], a[48:51], v[52:55]
    v_exp_f32 v8, v8
    v_mfma_f32_16x16x32_bf16 v[56:59], a[152:155], a[80:83], v[56:59]
    s_waitcnt lgkmcnt(3)
    v_exp_f32 v9, v9
    v_mfma_f32_16x16x32_bf16 v[60:63], a[152:155], a[112:115], v[60:63]
    v_exp_f32 v10, v10
    v_mfma_f32_16x16x32_bf16 v[48:51], a[156:159], a[20:23], v[48:51]
    ds_read_b128 a[152:155], v68 offset:53248
    v_cvt_pk_bf16_f32 v232, v8, v9
    v_mfma_f32_16x16x32_bf16 v[52:55], a[156:159], a[52:55], v[52:55]
    v_exp_f32 v11, v11
    v_mfma_f32_16x16x32_bf16 v[56:59], a[156:159], a[84:87], v[56:59]
    v_mul_f32 v12, s27, v12
    v_mul_f32 v13, s27, v13
    v_mfma_f32_16x16x32_bf16 v[60:63], a[156:159], a[116:119], v[60:63]
    v_cvt_pk_bf16_f32 v233, v10, v11
    v_mul_f32 v14, s27, v14
    v_mfma_f32_16x16x32_bf16 v[48:51], a[160:163], a[24:27], v[48:51]
    ds_read_b128 a[156:159], v69 offset:53248
    v_mul_f32 v15, s27, v15
    v_mfma_f32_16x16x32_bf16 v[52:55], a[160:163], a[56:59], v[52:55]
    s_add_u32 m0, m0, s50
    v_exp_f32 v12, v12
    v_mfma_f32_16x16x32_bf16 v[56:59], a[160:163], a[88:91], v[56:59]
    buffer_load_dwordx4 v78, s[8:11], s24 offen offset:128 sc0 sc1 lds
    v_mfma_f32_16x16x32_bf16 v[60:63], a[160:163], a[120:123], v[60:63]
    s_waitcnt lgkmcnt(3)
    v_exp_f32 v13, v13
    v_mfma_f32_16x16x32_bf16 v[48:51], a[164:167], a[28:31], v[48:51]
    ds_read_b128 a[160:163], v68 offset:57344
    v_mfma_f32_16x16x32_bf16 v[52:55], a[164:167], a[60:63], v[52:55]
    v_exp_f32 v14, v14
    v_mfma_f32_16x16x32_bf16 v[56:59], a[164:167], a[92:95], v[56:59]
    v_exp_f32 v15, v15
    v_mfma_f32_16x16x32_bf16 v[60:63], a[164:167], a[124:127], v[60:63]
    v_exp_f32 v16, v16
    v_mfma_f32_16x16x32_bf16 v[0:3], a[144:147], a[0:3], v[148:151]
    ds_read_b128 a[164:167], v69 offset:57344
    v_cvt_pk_bf16_f32 v12, v12, v13
    v_mfma_f32_16x16x32_bf16 v[4:7], a[144:147], a[32:35], v[212:215]
    v_cvt_pk_bf16_f32 v14, v14, v15
    v_exp_f32 v17, v17
    v_accvgpr_write_b32 a216, v12
    v_accvgpr_write_b32 a217, v14
    v_pk_mul_f32 v[48:49], v[48:49], s[92:93]
    v_pk_mul_f32 v[50:51], v[50:51], s[92:93]
    v_pk_mul_f32 v[52:53], v[52:53], s[92:93]
    v_pk_mul_f32 v[54:55], v[54:55], s[92:93]
    v_pk_mul_f32 v[56:57], v[56:57], s[92:93]
    v_pk_mul_f32 v[58:59], v[58:59], s[92:93]
    v_pk_mul_f32 v[60:61], v[60:61], s[92:93]
    v_pk_mul_f32 v[62:63], v[62:63], s[92:93]
    v_mfma_f32_16x16x32_bf16 v[8:11], a[144:147], a[64:67], v[244:247]
    s_waitcnt lgkmcnt(3)
    v_exp_f32 v18, v18
    v_mfma_f32_16x16x32_bf16 v[12:15], a[144:147], a[96:99], v[252:255]
    v_exp_f32 v19, v19
    v_mfma_f32_16x16x32_bf16 v[0:3], a[148:151], a[4:7], v[0:3]
    ds_read_b128 a[144:147], v68 offset:61440
    v_cvt_pk_bf16_f32 v106, v16, v17
    v_mfma_f32_16x16x32_bf16 v[4:7], a[148:151], a[36:39], v[4:7]
    s_add_u32 m0, m0, s50
    v_exp_f32 v20, v20
    v_mfma_f32_16x16x32_bf16 v[8:11], a[148:151], a[68:71], v[8:11]
    buffer_load_dwordx4 v78, s[8:11], s24 offen offset:256 sc0 sc1 lds
    v_mfma_f32_16x16x32_bf16 v[12:15], a[148:151], a[100:103], v[12:15]
    v_exp_f32 v21, v21
    v_mfma_f32_16x16x32_bf16 v[0:3], a[152:155], a[8:11], v[0:3]
    ds_read_b128 a[148:151], v69 offset:61440
    v_cvt_pk_bf16_f32 v107, v18, v19
    v_mfma_f32_16x16x32_bf16 v[4:7], a[152:155], a[40:43], v[4:7]
    v_exp_f32 v22, v22
    v_mfma_f32_16x16x32_bf16 v[8:11], a[152:155], a[72:75], v[8:11]
    s_waitcnt lgkmcnt(3)
    v_exp_f32 v23, v23
    v_mfma_f32_16x16x32_bf16 v[12:15], a[152:155], a[104:107], v[12:15]
    v_cvt_pk_bf16_f32 v170, v20, v21
    v_mul_f32 v32, s27, v32
    v_mfma_f32_16x16x32_bf16 v[0:3], a[156:159], a[12:15], v[0:3]
    ds_read_b128 a[152:155], v68 offset:51200
    v_cvt_pk_bf16_f32 v171, v22, v23
    v_mfma_f32_16x16x32_bf16 v[4:7], a[156:159], a[44:47], v[4:7]
    v_exp_f32 v24, v24
    v_mfma_f32_16x16x32_bf16 v[8:11], a[156:159], a[76:79], v[8:11]
    v_exp_f32 v25, v25
    v_mfma_f32_16x16x32_bf16 v[12:15], a[156:159], a[108:111], v[12:15]
    v_exp_f32 v26, v26
    v_mfma_f32_16x16x32_bf16 v[0:3], a[160:163], a[16:19], v[0:3]
    ds_read_b128 a[156:159], v69 offset:51200
    v_cvt_pk_bf16_f32 v234, v24, v25
    v_mfma_f32_16x16x32_bf16 v[4:7], a[160:163], a[48:51], v[4:7]
    s_add_u32 m0, m0, s50
    v_exp_f32 v27, v27
    v_mfma_f32_16x16x32_bf16 v[8:11], a[160:163], a[80:83], v[8:11]
    buffer_load_dwordx4 v78, s[8:11], s24 offen offset:384 sc0 sc1 lds
    v_mfma_f32_16x16x32_bf16 v[12:15], a[160:163], a[112:115], v[12:15]
    s_waitcnt lgkmcnt(3)
    v_cvt_pk_bf16_f32 v235, v26, v27
    v_mul_f32 v33, s27, v33
    v_mfma_f32_16x16x32_bf16 v[0:3], a[164:167], a[20:23], v[0:3]
    ds_read_b128 a[160:163], v68 offset:55296
    v_mul_f32 v34, s27, v34
    v_mfma_f32_16x16x32_bf16 v[4:7], a[164:167], a[52:55], v[4:7]
    v_exp_f32 v28, v28
    v_mfma_f32_16x16x32_bf16 v[8:11], a[164:167], a[84:87], v[8:11]
    v_exp_f32 v29, v29
    v_mfma_f32_16x16x32_bf16 v[12:15], a[164:167], a[116:119], v[12:15]
    v_exp_f32 v30, v30
    v_mfma_f32_16x16x32_bf16 v[0:3], a[144:147], a[24:27], v[0:3]
    ds_read_b128 a[164:167], v69 offset:55296
    v_cvt_pk_bf16_f32 v28, v28, v29
    v_mfma_f32_16x16x32_bf16 v[4:7], a[144:147], a[56:59], v[4:7]
    v_exp_f32 v31, v31
    v_mfma_f32_16x16x32_bf16 v[8:11], a[144:147], a[88:91], v[8:11]
    s_waitcnt lgkmcnt(3)
    v_accvgpr_write_b32 a218, v28
    v_cvt_pk_bf16_f32 v30, v30, v31
    v_mfma_f32_16x16x32_bf16 v[12:15], a[144:147], a[120:123], v[12:15]
    v_accvgpr_write_b32 a219, v30
    v_mul_f32 v35, s27, v35
    v_mfma_f32_16x16x32_bf16 v[0:3], a[148:151], a[28:31], v[0:3]
    ds_read_b128 a[144:147], v68 offset:59392
    v_mul_f32 v36, s27, v36
    v_mfma_f32_16x16x32_bf16 v[4:7], a[148:151], a[60:63], v[4:7]
    v_exp_f32 v32, v32
    v_mfma_f32_16x16x32_bf16 v[8:11], a[148:151], a[92:95], v[8:11]
    v_exp_f32 v33, v33
    v_mfma_f32_16x16x32_bf16 v[12:15], a[148:151], a[124:127], v[12:15]
    v_exp_f32 v34, v34
    v_mfma_f32_16x16x32_bf16 v[16:19], a[152:155], a[0:3], v[148:151]
    ds_read_b128 a[148:151], v69 offset:59392
    v_cvt_pk_bf16_f32 v108, v32, v33
    v_mfma_f32_16x16x32_bf16 v[20:23], a[152:155], a[32:35], v[212:215]
    v_exp_f32 v35, v35
    v_mfma_f32_16x16x32_bf16 v[24:27], a[152:155], a[64:67], v[244:247]
    s_waitcnt lgkmcnt(3)
    v_mul_f32 v37, s27, v37
    v_cvt_pk_bf16_f32 v109, v34, v35
    v_mfma_f32_16x16x32_bf16 v[28:31], a[152:155], a[96:99], v[252:255]
    v_mul_f32 v38, s27, v38
    v_mul_f32 v39, s27, v39
    v_mfma_f32_16x16x32_bf16 v[16:19], a[156:159], a[4:7], v[16:19]
    ds_read_b128 a[152:155], v68 offset:63488
    v_add_u32 v68, s96, v68
    v_mfma_f32_16x16x32_bf16 v[20:23], a[156:159], a[36:39], v[20:23]
    s_waitcnt vmcnt(18)
    v_exp_f32 v36, v36
    v_mfma_f32_16x16x32_bf16 v[24:27], a[156:159], a[68:71], v[24:27]
    s_barrier
    v_mfma_f32_16x16x32_bf16 v[28:31], a[156:159], a[100:103], v[28:31]
    v_exp_f32 v37, v37
    v_mfma_f32_16x16x32_bf16 v[16:19], a[160:163], a[8:11], v[16:19]
    ds_read_b128 a[156:159], v69 offset:63488
    v_add_u32 v69, s96, v69
    v_mfma_f32_16x16x32_bf16 v[20:23], a[160:163], a[40:43], v[20:23]
    v_exp_f32 v38, v38
    v_mfma_f32_16x16x32_bf16 v[24:27], a[160:163], a[72:75], v[24:27]
    s_add_u32 s24, s24, s59
    v_exp_f32 v39, v39
    v_mfma_f32_16x16x32_bf16 v[28:31], a[160:163], a[104:107], v[28:31]
    s_waitcnt lgkmcnt(3)
    v_cvt_pk_bf16_f32 v172, v36, v37
    v_cvt_pk_bf16_f32 v173, v38, v39
    v_mfma_f32_16x16x32_bf16 v[16:19], a[164:167], a[12:15], v[16:19]
    ds_read_b128 a[160:163], v68 offset:16384
    v_mul_f32 v40, s27, v40
    v_mfma_f32_16x16x32_bf16 v[20:23], a[164:167], a[44:47], v[20:23]
    s_add_u32 m0, m0, s94
    v_mul_f32 v41, s27, v41
    v_mul_f32 v42, s27, v42
    v_mfma_f32_16x16x32_bf16 v[24:27], a[164:167], a[76:79], v[24:27]
    buffer_load_dwordx4 v78, s[8:11], s24 offen offset:0 sc0 sc1 lds
    v_mfma_f32_16x16x32_bf16 v[28:31], a[164:167], a[108:111], v[28:31]
    v_mul_f32 v43, s27, v43
    v_mul_f32 v44, s27, v44
    v_mfma_f32_16x16x32_bf16 v[16:19], a[144:147], a[16:19], v[16:19]
    ds_read_b128 a[164:167], v69 offset:16384
    v_mul_f32 v45, s27, v45
    v_mfma_f32_16x16x32_bf16 v[20:23], a[144:147], a[48:51], v[20:23]
L_w2:
    s_cbranch_execz L_w6
    v_exp_f32 v40, v40
    v_mfma_f32_16x16x32_bf16 v[24:27], a[144:147], a[80:83], v[24:27]
    s_waitcnt lgkmcnt(3)
    v_exp_f32 v41, v41
    v_mfma_f32_16x16x32_bf16 v[28:31], a[144:147], a[112:115], v[28:31]
    v_exp_f32 v42, v42
    v_mfma_f32_16x16x32_bf16 v[16:19], a[148:151], a[20:23], v[16:19]
    ds_read_b128 a[144:147], v68 offset:20480
    v_cvt_pk_bf16_f32 v236, v40, v41
    v_mfma_f32_16x16x32_bf16 v[20:23], a[148:151], a[52:55], v[20:23]
    v_exp_f32 v43, v43
    v_mfma_f32_16x16x32_bf16 v[24:27], a[148:151], a[84:87], v[24:27]
    v_mul_f32 v46, s27, v46
    v_mul_f32 v47, s27, v47
    v_mfma_f32_16x16x32_bf16 v[28:31], a[148:151], a[116:119], v[28:31]
    v_exp_f32 v44, v44
    v_mfma_f32_16x16x32_bf16 v[16:19], a[152:155], a[24:27], v[16:19]
    ds_read_b128 a[148:151], v69 offset:20480
    v_cvt_pk_bf16_f32 v237, v42, v43
    v_mfma_f32_16x16x32_bf16 v[20:23], a[152:155], a[56:59], v[20:23]
    s_add_u32 m0, m0, s50
    v_exp_f32 v45, v45
    v_mfma_f32_16x16x32_bf16 v[24:27], a[152:155], a[88:91], v[24:27]
    buffer_load_dwordx4 v78, s[8:11], s24 offen offset:128 sc0 sc1 lds
    v_mfma_f32_16x16x32_bf16 v[28:31], a[152:155], a[120:123], v[28:31]
    s_waitcnt lgkmcnt(3)
    v_exp_f32 v46, v46
    v_mfma_f32_16x16x32_bf16 v[16:19], a[156:159], a[28:31], v[16:19]
    ds_read_b128 a[152:155], v68 offset:24576
    v_cvt_pk_bf16_f32 v44, v44, v45
    v_mfma_f32_16x16x32_bf16 v[20:23], a[156:159], a[60:63], v[20:23]
    v_exp_f32 v47, v47
    v_mfma_f32_16x16x32_bf16 v[24:27], a[156:159], a[92:95], v[24:27]
    v_exp_f32 v48, v48
    v_mfma_f32_16x16x32_bf16 v[28:31], a[156:159], a[124:127], v[28:31]
    v_cvt_pk_bf16_f32 v46, v46, v47
    v_accvgpr_write_b32 a220, v44
    v_mfma_f32_16x16x32_bf16 v[32:35], a[160:163], a[0:3], v[148:151]
    ds_read_b128 a[156:159], v69 offset:24576
    v_accvgpr_write_b32 a221, v46
    v_mfma_f32_16x16x32_bf16 v[36:39], a[160:163], a[32:35], v[212:215]
    v_exp_f32 v49, v49
    v_exp_f32 v50, v50
    v_pk_mul_f32 v[16:17], v[16:17], s[92:93]
    v_pk_mul_f32 v[18:19], v[18:19], s[92:93]
    v_pk_mul_f32 v[20:21], v[20:21], s[92:93]
    v_pk_mul_f32 v[22:23], v[22:23], s[92:93]
    v_pk_mul_f32 v[24:25], v[24:25], s[92:93]
    v_pk_mul_f32 v[26:27], v[26:27], s[92:93]
    v_pk_mul_f32 v[28:29], v[28:29], s[92:93]
    v_pk_mul_f32 v[30:31], v[30:31], s[92:93]
    v_mfma_f32_16x16x32_bf16 v[40:43], a[160:163], a[64:67], v[244:247]
    s_waitcnt lgkmcnt(3)
    v_exp_f32 v51, v51
    v_mfma_f32_16x16x32_bf16 v[44:47], a[160:163], a[96:99], v[252:255]
    v_exp_f32 v52, v52
    v_mfma_f32_16x16x32_bf16 v[32:35], a[164:167], a[4:7], v[32:35]
    ds_read_b128 a[160:163], v68 offset:28672
    v_cvt_pk_bf16_f32 v110, v48, v49
    v_mfma_f32_16x16x32_bf16 v[36:39], a[164:167], a[36:39], v[36:39]
    s_add_u32 m0, m0, s50
    v_exp_f32 v53, v53
    v_mfma_f32_16x16x32_bf16 v[40:43], a[164:167], a[68:71], v[40:43]
    buffer_load_dwordx4 v78, s[8:11], s24 offen offset:256 sc0 sc1 lds
    v_mfma_f32_16x16x32_bf16 v[44:47], a[164:167], a[100:103], v[44:47]
    v_cvt_pk_bf16_f32 v111, v50, v51
    v_cvt_pk_bf16_f32 v174, v52, v53
    v_mfma_f32_16x16x32_bf16 v[32:35], a[144:147], a[8:11], v[32:35]
    ds_read_b128 a[164:167], v69 offset:28672
    v_mul_f32 v0, s27, v0
    v_mfma_f32_16x16x32_bf16 v[36:39], a[144:147], a[40:43], v[36:39]
    v_exp_f32 v54, v54
    v_mfma_f32_16x16x32_bf16 v[40:43], a[144:147], a[72:75], v[40:43]
    s_waitcnt lgkmcnt(3)
    v_exp_f32 v55, v55
    v_mfma_f32_16x16x32_bf16 v[44:47], a[144:147], a[104:107], v[44:47]
    v_exp_f32 v56, v56
    v_mfma_f32_16x16x32_bf16 v[32:35], a[148:151], a[12:15], v[32:35]
    ds_read_b128 a[144:147], v68 offset:18432
    v_cvt_pk_bf16_f32 v175, v54, v55
    v_mfma_f32_16x16x32_bf16 v[36:39], a[148:151], a[44:47], v[36:39]
    v_exp_f32 v57, v57
    v_mfma_f32_16x16x32_bf16 v[40:43], a[148:151], a[76:79], v[40:43]
    v_exp_f32 v58, v58
    v_mfma_f32_16x16x32_bf16 v[44:47], a[148:151], a[108:111], v[44:47]
    v_exp_f32 v59, v59
    v_mfma_f32_16x16x32_bf16 v[32:35], a[152:155], a[16:19], v[32:35]
    ds_read_b128 a[148:151], v69 offset:18432
    v_cvt_pk_bf16_f32 v238, v56, v57
    v_mfma_f32_16x16x32_bf16 v[36:39], a[152:155], a[48:51], v[36:39]
    s_add_u32 m0, m0, s50
    v_cvt_pk_bf16_f32 v239, v58, v59
    v_mul_f32 v1, s27, v1
    v_mfma_f32_16x16x32_bf16 v[40:43], a[152:155], a[80:83], v[40:43]
    buffer_load_dwordx4 v78, s[8:11], s24 offen offset:384 sc0 sc1 lds
    v_mfma_f32_16x16x32_bf16 v[44:47], a[152:155], a[112:115], v[44:47]
    s_waitcnt lgkmcnt(3)
    v_exp_f32 v60, v60
    v_mfma_f32_16x16x32_bf16 v[32:35], a[156:159], a[20:23], v[32:35]
    ds_read_b128 a[152:155], v68 offset:22528
    v_mul_f32 v2, s27, v2
    v_mfma_f32_16x16x32_bf16 v[36:39], a[156:159], a[52:55], v[36:39]
    v_exp_f32 v61, v61
    v_mfma_f32_16x16x32_bf16 v[40:43], a[156:159], a[84:87], v[40:43]
    v_exp_f32 v62, v62
    v_mfma_f32_16x16x32_bf16 v[44:47], a[156:159], a[116:119], v[44:47]
    v_exp_f32 v63, v63
    v_mfma_f32_16x16x32_bf16 v[32:35], a[160:163], a[24:27], v[32:35]
    ds_read_b128 a[156:159], v69 offset:22528
    v_cvt_pk_bf16_f32 v60, v60, v61
    v_mfma_f32_16x16x32_bf16 v[36:39], a[160:163], a[56:59], v[36:39]
    v_cvt_pk_bf16_f32 v62, v62, v63
    v_accvgpr_write_b32 a222, v60
    v_mfma_f32_16x16x32_bf16 v[40:43], a[160:163], a[88:91], v[40:43]
    s_waitcnt lgkmcnt(3)
    v_accvgpr_write_b32 a223, v62
    v_mul_f32 v3, s27, v3
    v_mfma_f32_16x16x32_bf16 v[44:47], a[160:163], a[120:123], v[44:47]
    v_exp_f32 v0, v0
    v_mfma_f32_16x16x32_bf16 v[32:35], a[164:167], a[28:31], v[32:35]
    ds_read_b128 a[160:163], v68 offset:26624
    v_mul_f32 v4, s27, v4
    v_mfma_f32_16x16x32_bf16 v[36:39], a[164:167], a[60:63], v[36:39]
    v_exp_f32 v1, v1
    v_mfma_f32_16x16x32_bf16 v[40:43], a[164:167], a[92:95], v[40:43]
    v_exp_f32 v2, v2
    v_mfma_f32_16x16x32_bf16 v[44:47], a[164:167], a[124:127], v[44:47]
    v_exp_f32 v3, v3
    v_smfmac_f32_16x16x64_bf16 a[136:139], a[128:131], v[104:111], v84
    v_cvt_pk_bf16_f32 v112, v0, v1
    v_smfmac_f32_16x16x64_bf16 a[136:139], a[132:135], v[168:175], v84
    v_cvt_pk_bf16_f32 v113, v2, v3
    v_smfmac_f32_16x16x64_bf16 a[140:143], a[128:131], v[232:239], v84
    v_mul_f32 v5, s27, v5
    v_smfmac_f32_16x16x64_bf16 a[140:143], a[132:135], a[216:223], v84
    v_mul_f32 v6, s27, v6
    v_mfma_f32_16x16x32_bf16 v[48:51], a[144:147], a[0:3], v[148:151]
    ds_read_b128 a[164:167], v69 offset:26624
    v_mul_f32 v7, s27, v7
    v_mfma_f32_16x16x32_bf16 v[52:55], a[144:147], a[32:35], v[212:215]
    v_exp_f32 v4, v4
    v_mfma_f32_16x16x32_bf16 v[56:59], a[144:147], a[64:67], v[244:247]
    s_waitcnt lgkmcnt(3)
    v_exp_f32 v5, v5
    v_mfma_f32_16x16x32_bf16 v[60:63], a[144:147], a[96:99], v[252:255]
    v_exp_f32 v6, v6
    v_mfma_f32_16x16x32_bf16 v[48:51], a[148:151], a[4:7], v[48:51]
    ds_read_b128 a[144:147], v68 offset:30720
    v_cvt_pk_bf16_f32 v176, v4, v5
    v_mfma_f32_16x16x32_bf16 v[52:55], a[148:151], a[36:39], v[52:55]
    s_waitcnt vmcnt(17)
    v_exp_f32 v7, v7
    v_mfma_f32_16x16x32_bf16 v[56:59], a[148:151], a[68:71], v[56:59]
    s_barrier
    v_mfma_f32_16x16x32_bf16 v[60:63], a[148:151], a[100:103], v[60:63]
    v_cvt_pk_bf16_f32 v177, v6, v7
    v_mul_f32 v8, s27, v8
    v_mfma_f32_16x16x32_bf16 v[48:51], a[152:155], a[8:11], v[48:51]
    ds_read_b128 a[148:151], v69 offset:30720
    v_mul_f32 v9, s27, v9
    v_mfma_f32_16x16x32_bf16 v[52:55], a[152:155], a[40:43], v[52:55]
    v_mul_f32 v10, s27, v10
    v_mul_f32 v11, s27, v11
    v_mfma_f32_16x16x32_bf16 v[56:59], a[152:155], a[72:75], v[56:59]
    s_xor_b32 s24, s20, 196608
    v_exp_f32 v8, v8
    v_mfma_f32_16x16x32_bf16 v[60:63], a[152:155], a[104:107], v[60:63]
    s_waitcnt lgkmcnt(3)
    v_exp_f32 v9, v9
    v_mfma_f32_16x16x32_bf16 v[48:51], a[156:159], a[12:15], v[48:51]
    ds_read_b128 a[152:155], v68 offset:32768
    v_mul_f32 v12, s27, v12
    v_mfma_f32_16x16x32_bf16 v[52:55], a[156:159], a[44:47], v[52:55]
    s_add_u32 m0, m0, s94
    v_exp_f32 v10, v10
    v_mfma_f32_16x16x32_bf16 v[56:59], a[156:159], a[76:79], v[56:59]
    buffer_load_dwordx4 v78, s[8:11], s24 offen offset:0 sc0 sc1 lds
    v_mfma_f32_16x16x32_bf16 v[60:63], a[156:159], a[108:111], v[60:63]
    v_exp_f32 v11, v11
    v_mfma_f32_16x16x32_bf16 v[48:51], a[160:163], a[16:19], v[48:51]
    ds_read_b128 a[156:159], v69 offset:32768
    v_cvt_pk_bf16_f32 v8, v8, v9
    v_mfma_f32_16x16x32_bf16 v[52:55], a[160:163], a[48:51], v[52:55]
    v_cvt_pk_bf16_f32 v10, v10, v11
    v_accvgpr_write_b32 a168, v8
    v_mfma_f32_16x16x32_bf16 v[56:59], a[160:163], a[80:83], v[56:59]
    s_waitcnt lgkmcnt(3)
    v_accvgpr_write_b32 a169, v10
    v_mul_f32 v13, s27, v13
    v_mfma_f32_16x16x32_bf16 v[60:63], a[160:163], a[112:115], v[60:63]
    v_mul_f32 v14, s27, v14
    v_mul_f32 v15, s27, v15
    v_mfma_f32_16x16x32_bf16 v[48:51], a[164:167], a[20:23], v[48:51]
    ds_read_b128 a[160:163], v68 offset:36864
    v_mfma_f32_16x16x32_bf16 v[52:55], a[164:167], a[52:55], v[52:55]
    v_exp_f32 v12, v12
    v_mfma_f32_16x16x32_bf16 v[56:59], a[164:167], a[84:87], v[56:59]
    v_exp_f32 v13, v13
    v_mfma_f32_16x16x32_bf16 v[60:63], a[164:167], a[116:119], v[60:63]
    v_exp_f32 v14, v14
    v_mfma_f32_16x16x32_bf16 v[48:51], a[144:147], a[24:27], v[48:51]
    ds_read_b128 a[164:167], v69 offset:36864
    v_cvt_pk_bf16_f32 v12, v12, v13
    v_mfma_f32_16x16x32_bf16 v[52:55], a[144:147], a[56:59], v[52:55]
    s_add_u32 m0, m0, s50
    v_exp_f32 v15, v15
    v_mfma_f32_16x16x32_bf16 v[56:59], a[144:147], a[88:91], v[56:59]
    buffer_load_dwordx4 v78, s[8:11], s24 offen offset:128 sc0 sc1 lds
    v_mfma_f32_16x16x32_bf16 v[60:63], a[144:147], a[120:123], v[60:63]
    s_waitcnt lgkmcnt(3)
    v_cvt_pk_bf16_f32 v14, v14, v15
    v_accvgpr_write_b32 a224, v12
    v_mfma_f32_16x16x32_bf16 v[48:51], a[148:151], a[28:31], v[48:51]
    ds_read_b128 a[144:147], v68 offset:40960
    v_accvgpr_write_b32 a225, v14
    v_mfma_f32_16x16x32_bf16 v[52:55], a[148:151], a[60:63], v[52:55]
    v_exp_f32 v16, v16
    v_mfma_f32_16x16x32_bf16 v[56:59], a[148:151], a[92:95], v[56:59]
    v_exp_f32 v17, v17
    v_mfma_f32_16x16x32_bf16 v[60:63], a[148:151], a[124:127], v[60:63]
    s_add_u32 s43, s42, 8192
    v_exp_f32 v18, v18
    v_mfma_f32_16x16x32_bf16 v[0:3], a[152:155], a[0:3], v[148:151]
    ds_read_b128 a[148:151], v69 offset:40960
    v_cvt_pk_bf16_f32 v114, v16, v17
    v_mfma_f32_16x16x32_bf16 v[4:7], a[152:155], a[32:35], v[212:215]
    s_add_u32 m0, s44, 131072
    v_exp_f32 v19, v19
    v_exp_f32 v20, v20
    v_mul_f32 v32, s27, v32
    v_pk_mul_f32 v[48:49], v[48:49], s[92:93]
    v_pk_mul_f32 v[50:51], v[50:51], s[92:93]
    v_pk_mul_f32 v[52:53], v[52:53], s[92:93]
    v_pk_mul_f32 v[54:55], v[54:55], s[92:93]
    v_pk_mul_f32 v[56:57], v[56:57], s[92:93]
    v_pk_mul_f32 v[58:59], v[58:59], s[92:93]
    v_pk_mul_f32 v[60:61], v[60:61], s[92:93]
    v_pk_mul_f32 v[62:63], v[62:63], s[92:93]
    v_mfma_f32_16x16x32_bf16 v[8:11], a[152:155], a[64:67], v[244:247]
    buffer_load_dwordx4 v78, s[4:7], s43 offen offset:0 sc0 sc1 nt lds
    v_mfma_f32_16x16x32_bf16 v[12:15], a[152:155], a[96:99], v[252:255]
    s_waitcnt lgkmcnt(3)
    v_exp_f32 v21, v21
    v_mfma_f32_16x16x32_bf16 v[0:3], a[156:159], a[4:7], v[0:3]
    ds_read_b128 a[152:155], v68 offset:45056
    v_cvt_pk_bf16_f32 v115, v18, v19
    v_mfma_f32_16x16x32_bf16 v[4:7], a[156:159], a[36:39], v[4:7]
    s_add_u32 m0, s22, 57088
    v_exp_f32 v22, v22
    v_mfma_f32_16x16x32_bf16 v[8:11], a[156:159], a[68:71], v[8:11]
    buffer_load_dwordx4 v78, s[8:11], s24 offen offset:256 sc0 sc1 lds
    v_mfma_f32_16x16x32_bf16 v[12:15], a[156:159], a[100:103], v[12:15]
    v_exp_f32 v23, v23
    v_mfma_f32_16x16x32_bf16 v[0:3], a[160:163], a[8:11], v[0:3]
    ds_read_b128 a[156:159], v69 offset:45056
    v_cvt_pk_bf16_f32 v178, v20, v21
    v_mfma_f32_16x16x32_bf16 v[4:7], a[160:163], a[40:43], v[4:7]
    s_add_u32 m0, s45, 131072
    v_cvt_pk_bf16_f32 v179, v22, v23
    v_mul_f32 v33, s27, v33
    v_mfma_f32_16x16x32_bf16 v[8:11], a[160:163], a[72:75], v[8:11]
    buffer_load_dwordx4 v72, s[4:7], s43 offen offset:0 sc0 sc1 nt lds
    v_mfma_f32_16x16x32_bf16 v[12:15], a[160:163], a[104:107], v[12:15]
    s_waitcnt lgkmcnt(3)
    v_exp_f32 v24, v24
    v_mfma_f32_16x16x32_bf16 v[0:3], a[164:167], a[12:15], v[0:3]
    ds_read_b128 a[160:163], v68 offset:34816
    v_mul_f32 v34, s27, v34
    v_mfma_f32_16x16x32_bf16 v[4:7], a[164:167], a[44:47], v[4:7]
    v_exp_f32 v25, v25
    v_mfma_f32_16x16x32_bf16 v[8:11], a[164:167], a[76:79], v[8:11]
    v_exp_f32 v26, v26
    v_mfma_f32_16x16x32_bf16 v[12:15], a[164:167], a[108:111], v[12:15]
    v_exp_f32 v27, v27
    v_mfma_f32_16x16x32_bf16 v[0:3], a[144:147], a[16:19], v[0:3]
    ds_read_b128 a[164:167], v69 offset:34816
    v_cvt_pk_bf16_f32 v24, v24, v25
    v_mfma_f32_16x16x32_bf16 v[4:7], a[144:147], a[48:51], v[4:7]
    s_add_u32 m0, s22, 61056
    v_cvt_pk_bf16_f32 v26, v26, v27
    v_accvgpr_write_b32 a170, v24
    v_mfma_f32_16x16x32_bf16 v[8:11], a[144:147], a[80:83], v[8:11]
    buffer_load_dwordx4 v78, s[8:11], s24 offen offset:384 sc0 sc1 lds
    v_mfma_f32_16x16x32_bf16 v[12:15], a[144:147], a[112:115], v[12:15]
    s_waitcnt lgkmcnt(3)
    v_accvgpr_write_b32 a171, v26
    v_mul_f32 v35, s27, v35
    v_mfma_f32_16x16x32_bf16 v[0:3], a[148:151], a[20:23], v[0:3]
    ds_read_b128 a[144:147], v68 offset:38912
    v_mul_f32 v36, s27, v36
    v_mfma_f32_16x16x32_bf16 v[4:7], a[148:151], a[52:55], v[4:7]
    s_add_u32 m0, s44, 132992
    v_exp_f32 v28, v28
    v_mfma_f32_16x16x32_bf16 v[8:11], a[148:151], a[84:87], v[8:11]
    buffer_load_dwordx4 v78, s[4:7], s43 offen offset:128 sc0 sc1 nt lds
    v_mfma_f32_16x16x32_bf16 v[12:15], a[148:151], a[116:119], v[12:15]
    v_exp_f32 v29, v29
    v_mfma_f32_16x16x32_bf16 v[0:3], a[152:155], a[24:27], v[0:3]
    ds_read_b128 a[148:151], v69 offset:38912
    v_mul_f32 v37, s27, v37
    v_mfma_f32_16x16x32_bf16 v[4:7], a[152:155], a[56:59], v[4:7]
    s_add_u32 m0, s45, 132992
    v_exp_f32 v30, v30
    v_mfma_f32_16x16x32_bf16 v[8:11], a[152:155], a[88:91], v[8:11]
    buffer_load_dwordx4 v72, s[4:7], s43 offen offset:128 sc0 sc1 nt lds
    v_mfma_f32_16x16x32_bf16 v[12:15], a[152:155], a[120:123], v[12:15]
    s_waitcnt lgkmcnt(3)
    v_exp_f32 v31, v31
    v_mfma_f32_16x16x32_bf16 v[0:3], a[156:159], a[28:31], v[0:3]
    ds_read_b128 a[152:155], v68 offset:43008
    v_cvt_pk_bf16_f32 v28, v28, v29
    v_mfma_f32_16x16x32_bf16 v[4:7], a[156:159], a[60:63], v[4:7]
    v_cvt_pk_bf16_f32 v30, v30, v31
    v_accvgpr_write_b32 a226, v28
    v_mfma_f32_16x16x32_bf16 v[8:11], a[156:159], a[92:95], v[8:11]
    v_accvgpr_write_b32 a227, v30
    v_mul_f32 v38, s27, v38
    v_mfma_f32_16x16x32_bf16 v[12:15], a[156:159], a[124:127], v[12:15]
    v_exp_f32 v32, v32
    v_mfma_f32_16x16x32_bf16 v[16:19], a[160:163], a[0:3], v[148:151]
    ds_read_b128 a[156:159], v69 offset:43008
    v_mul_f32 v39, s27, v39
    v_mfma_f32_16x16x32_bf16 v[20:23], a[160:163], a[32:35], v[212:215]
    v_exp_f32 v33, v33
    v_mfma_f32_16x16x32_bf16 v[24:27], a[160:163], a[64:67], v[244:247]
    s_waitcnt lgkmcnt(3)
    v_exp_f32 v34, v34
    v_mfma_f32_16x16x32_bf16 v[28:31], a[160:163], a[96:99], v[252:255]
    v_exp_f32 v35, v35
    v_mfma_f32_16x16x32_bf16 v[16:19], a[164:167], a[4:7], v[16:19]
    ds_read_b128 a[160:163], v68 offset:47104
    v_subrev_u32 v68, s96, v68
    v_mfma_f32_16x16x32_bf16 v[20:23], a[164:167], a[36:39], v[20:23]
    s_waitcnt vmcnt(18)
    v_cvt_pk_bf16_f32 v116, v32, v33
    v_cvt_pk_bf16_f32 v117, v34, v35
    v_mfma_f32_16x16x32_bf16 v[24:27], a[164:167], a[68:71], v[24:27]
    s_barrier
    v_mfma_f32_16x16x32_bf16 v[28:31], a[164:167], a[100:103], v[28:31]
    v_exp_f32 v36, v36
    v_mfma_f32_16x16x32_bf16 v[16:19], a[144:147], a[8:11], v[16:19]
    ds_read_b128 a[164:167], v69 offset:47104
    v_subrev_u32 v69, s96, v69
    v_mfma_f32_16x16x32_bf16 v[20:23], a[144:147], a[40:43], v[20:23]
    v_exp_f32 v37, v37
    v_mfma_f32_16x16x32_bf16 v[24:27], a[144:147], a[72:75], v[24:27]
    s_add_u32 s24, s24, s59
    v_exp_f32 v38, v38
    v_mfma_f32_16x16x32_bf16 v[28:31], a[144:147], a[104:107], v[28:31]
    s_waitcnt lgkmcnt(3)
    v_exp_f32 v39, v39
    v_mfma_f32_16x16x32_bf16 v[16:19], a[148:151], a[12:15], v[16:19]
    ds_read_b128 a[144:147], v68 offset:0
    v_cvt_pk_bf16_f32 v180, v36, v37
    v_mfma_f32_16x16x32_bf16 v[20:23], a[148:151], a[44:47], v[20:23]
    s_add_u32 m0, s22, 65536
    v_cvt_pk_bf16_f32 v181, v38, v39
    v_mul_f32 v40, s27, v40
    v_mfma_f32_16x16x32_bf16 v[24:27], a[148:151], a[76:79], v[24:27]
    buffer_load_dwordx4 v78, s[8:11], s24 offen offset:0 sc0 sc1 lds
    v_mfma_f32_16x16x32_bf16 v[28:31], a[148:151], a[108:111], v[28:31]
    v_mul_f32 v41, s27, v41
    v_mul_f32 v42, s27, v42
    v_mfma_f32_16x16x32_bf16 v[16:19], a[152:155], a[16:19], v[16:19]
    ds_read_b128 a[148:151], v69 offset:0
    v_mul_f32 v43, s27, v43
    v_mfma_f32_16x16x32_bf16 v[20:23], a[152:155], a[48:51], v[20:23]
    v_exp_f32 v40, v40
    v_mfma_f32_16x16x32_bf16 v[24:27], a[152:155], a[80:83], v[24:27]
    s_waitcnt lgkmcnt(3)
    v_exp_f32 v41, v41
    v_mfma_f32_16x16x32_bf16 v[28:31], a[152:155], a[112:115], v[28:31]
    v_exp_f32 v42, v42
    v_mfma_f32_16x16x32_bf16 v[16:19], a[156:159], a[20:23], v[16:19]
    ds_read_b128 a[152:155], v68 offset:4096
    v_cvt_pk_bf16_f32 v40, v40, v41
    v_mfma_f32_16x16x32_bf16 v[20:23], a[156:159], a[52:55], v[20:23]
    v_exp_f32 v43, v43
    v_mfma_f32_16x16x32_bf16 v[24:27], a[156:159], a[84:87], v[24:27]
    v_accvgpr_write_b32 a172, v40
    v_mul_f32 v44, s27, v44
    v_mfma_f32_16x16x32_bf16 v[28:31], a[156:159], a[116:119], v[28:31]
    v_cvt_pk_bf16_f32 v42, v42, v43
    v_mul_f32 v45, s27, v45
    v_mfma_f32_16x16x32_bf16 v[16:19], a[160:163], a[24:27], v[16:19]
    ds_read_b128 a[156:159], v69 offset:4096
    v_accvgpr_write_b32 a173, v42
    v_mfma_f32_16x16x32_bf16 v[20:23], a[160:163], a[56:59], v[20:23]
    s_add_u32 m0, m0, s50
    v_mul_f32 v46, s27, v46
    v_mul_f32 v47, s27, v47
    v_mfma_f32_16x16x32_bf16 v[24:27], a[160:163], a[88:91], v[24:27]
    buffer_load_dwordx4 v78, s[8:11], s24 offen offset:128 sc0 sc1 lds
    v_mfma_f32_16x16x32_bf16 v[28:31], a[160:163], a[120:123], v[28:31]
    s_waitcnt lgkmcnt(3)
    v_exp_f32 v44, v44
    v_mfma_f32_16x16x32_bf16 v[16:19], a[164:167], a[28:31], v[16:19]
    ds_read_b128 a[160:163], v68 offset:8192
    v_mfma_f32_16x16x32_bf16 v[20:23], a[164:167], a[60:63], v[20:23]
    v_exp_f32 v45, v45
    v_mfma_f32_16x16x32_bf16 v[24:27], a[164:167], a[92:95], v[24:27]
    v_exp_f32 v46, v46
    v_mfma_f32_16x16x32_bf16 v[28:31], a[164:167], a[124:127], v[28:31]
    v_exp_f32 v47, v47
    v_mfma_f32_16x16x32_bf16 v[32:35], a[144:147], a[0:3], v[148:151]
    ds_read_b128 a[164:167], v69 offset:8192
    v_cvt_pk_bf16_f32 v44, v44, v45
    v_mfma_f32_16x16x32_bf16 v[36:39], a[144:147], a[32:35], v[212:215]
    v_cvt_pk_bf16_f32 v46, v46, v47
    v_exp_f32 v48, v48
    v_accvgpr_write_b32 a228, v44
    v_accvgpr_write_b32 a229, v46
    v_pk_mul_f32 v[16:17], v[16:17], s[92:93]
    v_pk_mul_f32 v[18:19], v[18:19], s[92:93]
    v_pk_mul_f32 v[20:21], v[20:21], s[92:93]
    v_pk_mul_f32 v[22:23], v[22:23], s[92:93]
    v_pk_mul_f32 v[24:25], v[24:25], s[92:93]
    v_pk_mul_f32 v[26:27], v[26:27], s[92:93]
    v_pk_mul_f32 v[28:29], v[28:29], s[92:93]
    v_pk_mul_f32 v[30:31], v[30:31], s[92:93]
    v_mfma_f32_16x16x32_bf16 v[40:43], a[144:147], a[64:67], v[244:247]
    s_waitcnt lgkmcnt(3)
    v_exp_f32 v49, v49
    v_mfma_f32_16x16x32_bf16 v[44:47], a[144:147], a[96:99], v[252:255]
    v_exp_f32 v50, v50
    v_mfma_f32_16x16x32_bf16 v[32:35], a[148:151], a[4:7], v[32:35]
    ds_read_b128 a[144:147], v68 offset:12288
    v_cvt_pk_bf16_f32 v118, v48, v49
    v_mfma_f32_16x16x32_bf16 v[36:39], a[148:151], a[36:39], v[36:39]
    s_add_u32 m0, m0, s50
    v_exp_f32 v51, v51
    v_mfma_f32_16x16x32_bf16 v[40:43], a[148:151], a[68:71], v[40:43]
    buffer_load_dwordx4 v78, s[8:11], s24 offen offset:256 sc0 sc1 lds
    v_mfma_f32_16x16x32_bf16 v[44:47], a[148:151], a[100:103], v[44:47]
    v_exp_f32 v52, v52
    v_mfma_f32_16x16x32_bf16 v[32:35], a[152:155], a[8:11], v[32:35]
    ds_read_b128 a[148:151], v69 offset:12288
    v_cvt_pk_bf16_f32 v119, v50, v51
    v_mfma_f32_16x16x32_bf16 v[36:39], a[152:155], a[40:43], v[36:39]
    v_exp_f32 v53, v53
    v_mfma_f32_16x16x32_bf16 v[40:43], a[152:155], a[72:75], v[40:43]
    s_waitcnt lgkmcnt(3)
    v_exp_f32 v54, v54
    v_mfma_f32_16x16x32_bf16 v[44:47], a[152:155], a[104:107], v[44:47]
    v_exp_f32 v55, v55
    v_mfma_f32_16x16x32_bf16 v[32:35], a[156:159], a[12:15], v[32:35]
    ds_read_b128 a[152:155], v68 offset:2048
    v_cvt_pk_bf16_f32 v182, v52, v53
    v_mfma_f32_16x16x32_bf16 v[36:39], a[156:159], a[44:47], v[36:39]
    v_cvt_pk_bf16_f32 v183, v54, v55
    v_mul_f32 v0, s27, v0
    v_mfma_f32_16x16x32_bf16 v[40:43], a[156:159], a[76:79], v[40:43]
    v_exp_f32 v56, v56
    v_mfma_f32_16x16x32_bf16 v[44:47], a[156:159], a[108:111], v[44:47]
    v_exp_f32 v57, v57
    v_mfma_f32_16x16x32_bf16 v[32:35], a[160:163], a[16:19], v[32:35]
    ds_read_b128 a[156:159], v69 offset:2048
    v_mul_f32 v1, s27, v1
    v_mfma_f32_16x16x32_bf16 v[36:39], a[160:163], a[48:51], v[36:39]
    s_add_u32 m0, m0, s50
    v_exp_f32 v58, v58
    v_mfma_f32_16x16x32_bf16 v[40:43], a[160:163], a[80:83], v[40:43]
    buffer_load_dwordx4 v78, s[8:11], s24 offen offset:384 sc0 sc1 lds
    v_mfma_f32_16x16x32_bf16 v[44:47], a[160:163], a[112:115], v[44:47]
    s_waitcnt lgkmcnt(3)
    v_exp_f32 v59, v59
    v_mfma_f32_16x16x32_bf16 v[32:35], a[164:167], a[20:23], v[32:35]
    ds_read_b128 a[160:163], v68 offset:6144
    v_cvt_pk_bf16_f32 v56, v56, v57
    v_mfma_f32_16x16x32_bf16 v[36:39], a[164:167], a[52:55], v[36:39]
    v_cvt_pk_bf16_f32 v58, v58, v59
    v_accvgpr_write_b32 a174, v56
    v_mfma_f32_16x16x32_bf16 v[40:43], a[164:167], a[84:87], v[40:43]
    v_accvgpr_write_b32 a175, v58
    v_mul_f32 v2, s27, v2
    v_mfma_f32_16x16x32_bf16 v[44:47], a[164:167], a[116:119], v[44:47]
    v_exp_f32 v60, v60
    v_mfma_f32_16x16x32_bf16 v[32:35], a[144:147], a[24:27], v[32:35]
    ds_read_b128 a[164:167], v69 offset:6144
    v_mul_f32 v3, s27, v3
    v_mfma_f32_16x16x32_bf16 v[36:39], a[144:147], a[56:59], v[36:39]
    v_exp_f32 v61, v61
    v_mfma_f32_16x16x32_bf16 v[40:43], a[144:147], a[88:91], v[40:43]
    s_waitcnt lgkmcnt(3)
    v_exp_f32 v62, v62
    v_mfma_f32_16x16x32_bf16 v[44:47], a[144:147], a[120:123], v[44:47]
    v_exp_f32 v63, v63
    v_mfma_f32_16x16x32_bf16 v[32:35], a[148:151], a[28:31], v[32:35]
    ds_read_b128 a[144:147], v68 offset:10240
    v_cvt_pk_bf16_f32 v60, v60, v61
    v_mfma_f32_16x16x32_bf16 v[36:39], a[148:151], a[60:63], v[36:39]
    v_cvt_pk_bf16_f32 v62, v62, v63
    v_accvgpr_write_b32 a230, v60
    v_mfma_f32_16x16x32_bf16 v[40:43], a[148:151], a[92:95], v[40:43]
    v_accvgpr_write_b32 a231, v62
    v_mul_f32 v4, s27, v4
    v_mfma_f32_16x16x32_bf16 v[44:47], a[148:151], a[124:127], v[44:47]
    v_exp_f32 v0, v0
    v_smfmac_f32_16x16x64_bf16 a[136:139], a[128:131], v[112:119], v84
    v_mul_f32 v5, s27, v5
    v_smfmac_f32_16x16x64_bf16 a[136:139], a[132:135], v[176:183], v84
    v_mul_f32 v6, s27, v6
    v_smfmac_f32_16x16x64_bf16 a[140:143], a[128:131], a[168:175], v84
    v_mul_f32 v7, s27, v7
    v_smfmac_f32_16x16x64_bf16 a[140:143], a[132:135], a[224:231], v84
    v_mul_f32 v8, s27, v8
    v_mfma_f32_16x16x32_bf16 v[48:51], a[152:155], a[0:3], v[148:151]
    ds_read_b128 a[148:151], v69 offset:10240
    v_mul_f32 v9, s27, v9
    v_mfma_f32_16x16x32_bf16 v[52:55], a[152:155], a[32:35], v[212:215]
    v_exp_f32 v1, v1
    v_mfma_f32_16x16x32_bf16 v[56:59], a[152:155], a[64:67], v[244:247]
    s_waitcnt lgkmcnt(3)
    v_exp_f32 v2, v2
    v_mfma_f32_16x16x32_bf16 v[60:63], a[152:155], a[96:99], v[252:255]
    v_exp_f32 v3, v3
    v_mfma_f32_16x16x32_bf16 v[48:51], a[156:159], a[4:7], v[48:51]
    ds_read_b128 a[152:155], v68 offset:14336
    v_cvt_pk_bf16_f32 v120, v0, v1
    v_mfma_f32_16x16x32_bf16 v[52:55], a[156:159], a[36:39], v[52:55]
    s_waitcnt vmcnt(16)
    v_cvt_pk_bf16_f32 v121, v2, v3
    v_mul_f32 v10, s27, v10
    v_mfma_f32_16x16x32_bf16 v[56:59], a[156:159], a[68:71], v[56:59]
    s_barrier
    v_mfma_f32_16x16x32_bf16 v[60:63], a[156:159], a[100:103], v[60:63]
    v_exp_f32 v4, v4
    v_mfma_f32_16x16x32_bf16 v[48:51], a[160:163], a[8:11], v[48:51]
    ds_read_b128 a[156:159], v69 offset:14336
    v_mul_f32 v11, s27, v11
    v_mfma_f32_16x16x32_bf16 v[52:55], a[160:163], a[40:43], v[52:55]
    v_exp_f32 v5, v5
    v_mfma_f32_16x16x32_bf16 v[56:59], a[160:163], a[72:75], v[56:59]
    s_add_u32 s24, s24, s59
    v_exp_f32 v6, v6
    v_mfma_f32_16x16x32_bf16 v[60:63], a[160:163], a[104:107], v[60:63]
    s_waitcnt lgkmcnt(3)
    v_exp_f32 v7, v7
    v_mfma_f32_16x16x32_bf16 v[48:51], a[164:167], a[12:15], v[48:51]
    ds_read_b128 a[160:163], v68 offset:16384
    v_cvt_pk_bf16_f32 v184, v4, v5
    v_mfma_f32_16x16x32_bf16 v[52:55], a[164:167], a[44:47], v[52:55]
    s_add_u32 m0, m0, s94
    v_cvt_pk_bf16_f32 v185, v6, v7
    v_mul_f32 v12, s27, v12
    v_mfma_f32_16x16x32_bf16 v[56:59], a[164:167], a[76:79], v[56:59]
    buffer_load_dwordx4 v78, s[8:11], s24 offen offset:0 sc0 sc1 lds
    v_mfma_f32_16x16x32_bf16 v[60:63], a[164:167], a[108:111], v[60:63]
    v_exp_f32 v8, v8
    v_mfma_f32_16x16x32_bf16 v[48:51], a[144:147], a[16:19], v[48:51]
    ds_read_b128 a[164:167], v69 offset:16384
    v_mul_f32 v13, s27, v13
    v_mfma_f32_16x16x32_bf16 v[52:55], a[144:147], a[48:51], v[52:55]
    v_exp_f32 v9, v9
    v_mfma_f32_16x16x32_bf16 v[56:59], a[144:147], a[80:83], v[56:59]
    s_waitcnt lgkmcnt(3)
    v_exp_f32 v10, v10
    v_mfma_f32_16x16x32_bf16 v[60:63], a[144:147], a[112:115], v[60:63]
    v_exp_f32 v11, v11
    v_mfma_f32_16x16x32_bf16 v[48:51], a[148:151], a[20:23], v[48:51]
    ds_read_b128 a[144:147], v68 offset:20480
    v_cvt_pk_bf16_f32 v8, v8, v9
    v_mfma_f32_16x16x32_bf16 v[52:55], a[148:151], a[52:55], v[52:55]
    v_cvt_pk_bf16_f32 v10, v10, v11
    v_accvgpr_write_b32 a176, v8
    v_mfma_f32_16x16x32_bf16 v[56:59], a[148:151], a[84:87], v[56:59]
    v_accvgpr_write_b32 a177, v10
    v_mul_f32 v14, s27, v14
    v_mfma_f32_16x16x32_bf16 v[60:63], a[148:151], a[116:119], v[60:63]
    v_exp_f32 v12, v12
    v_mfma_f32_16x16x32_bf16 v[48:51], a[152:155], a[24:27], v[48:51]
    ds_read_b128 a[148:151], v69 offset:20480
    v_mul_f32 v15, s27, v15
    v_mfma_f32_16x16x32_bf16 v[52:55], a[152:155], a[56:59], v[52:55]
    s_add_u32 m0, m0, s50
    v_exp_f32 v13, v13
    v_mfma_f32_16x16x32_bf16 v[56:59], a[152:155], a[88:91], v[56:59]
    buffer_load_dwordx4 v78, s[8:11], s24 offen offset:128 sc0 sc1 lds
    v_mfma_f32_16x16x32_bf16 v[60:63], a[152:155], a[120:123], v[60:63]
    s_waitcnt lgkmcnt(3)
    v_exp_f32 v14, v14
    v_mfma_f32_16x16x32_bf16 v[48:51], a[156:159], a[28:31], v[48:51]
    ds_read_b128 a[152:155], v68 offset:24576
    v_cvt_pk_bf16_f32 v12, v12, v13
    v_mfma_f32_16x16x32_bf16 v[52:55], a[156:159], a[60:63], v[52:55]
    v_exp_f32 v15, v15
    v_mfma_f32_16x16x32_bf16 v[56:59], a[156:159], a[92:95], v[56:59]
    v_exp_f32 v16, v16
    v_mfma_f32_16x16x32_bf16 v[60:63], a[156:159], a[124:127], v[60:63]
    v_cvt_pk_bf16_f32 v14, v14, v15
    v_accvgpr_write_b32 a232, v12
    v_mfma_f32_16x16x32_bf16 v[0:3], a[160:163], a[0:3], v[148:151]
    ds_read_b128 a[156:159], v69 offset:24576
    v_accvgpr_write_b32 a233, v14
    v_mfma_f32_16x16x32_bf16 v[4:7], a[160:163], a[32:35], v[212:215]
    v_exp_f32 v17, v17
    v_exp_f32 v18, v18
    v_pk_mul_f32 v[48:49], v[48:49], s[92:93]
    v_pk_mul_f32 v[50:51], v[50:51], s[92:93]
    v_pk_mul_f32 v[52:53], v[52:53], s[92:93]
    v_pk_mul_f32 v[54:55], v[54:55], s[92:93]
    v_pk_mul_f32 v[56:57], v[56:57], s[92:93]
    v_pk_mul_f32 v[58:59], v[58:59], s[92:93]
    v_pk_mul_f32 v[60:61], v[60:61], s[92:93]
    v_pk_mul_f32 v[62:63], v[62:63], s[92:93]
    v_mfma_f32_16x16x32_bf16 v[8:11], a[160:163], a[64:67], v[244:247]
    s_waitcnt lgkmcnt(3)
    v_exp_f32 v19, v19
    v_mfma_f32_16x16x32_bf16 v[12:15], a[160:163], a[96:99], v[252:255]
    v_exp_f32 v20, v20
    v_mfma_f32_16x16x32_bf16 v[0:3], a[164:167], a[4:7], v[0:3]
    ds_read_b128 a[160:163], v68 offset:28672
    v_cvt_pk_bf16_f32 v122, v16, v17
    v_mfma_f32_16x16x32_bf16 v[4:7], a[164:167], a[36:39], v[4:7]
    s_add_u32 m0, m0, s50
    v_exp_f32 v21, v21
    v_mfma_f32_16x16x32_bf16 v[8:11], a[164:167], a[68:71], v[8:11]
L_w3:
    s_cbranch_execz L_w7
    buffer_load_dwordx4 v78, s[8:11], s24 offen offset:256 sc0 sc1 lds
    v_mfma_f32_16x16x32_bf16 v[12:15], a[164:167], a[100:103], v[12:15]
    v_cvt_pk_bf16_f32 v123, v18, v19
    v_cvt_pk_bf16_f32 v186, v20, v21
    v_mfma_f32_16x16x32_bf16 v[0:3], a[144:147], a[8:11], v[0:3]
    ds_read_b128 a[164:167], v69 offset:28672
    v_mul_f32 v32, s27, v32
    v_mfma_f32_16x16x32_bf16 v[4:7], a[144:147], a[40:43], v[4:7]
    v_exp_f32 v22, v22
    v_mfma_f32_16x16x32_bf16 v[8:11], a[144:147], a[72:75], v[8:11]
    s_waitcnt lgkmcnt(3)
    v_exp_f32 v23, v23
    v_mfma_f32_16x16x32_bf16 v[12:15], a[144:147], a[104:107], v[12:15]
    v_exp_f32 v24, v24
    v_mfma_f32_16x16x32_bf16 v[0:3], a[148:151], a[12:15], v[0:3]
    ds_read_b128 a[144:147], v68 offset:18432
    v_cvt_pk_bf16_f32 v187, v22, v23
    v_mfma_f32_16x16x32_bf16 v[4:7], a[148:151], a[44:47], v[4:7]
    v_exp_f32 v25, v25
    v_mfma_f32_16x16x32_bf16 v[8:11], a[148:151], a[76:79], v[8:11]
    v_exp_f32 v26, v26
    v_mfma_f32_16x16x32_bf16 v[12:15], a[148:151], a[108:111], v[12:15]
    v_exp_f32 v27, v27
    v_mfma_f32_16x16x32_bf16 v[0:3], a[152:155], a[16:19], v[0:3]
    ds_read_b128 a[148:151], v69 offset:18432
    v_cvt_pk_bf16_f32 v24, v24, v25
    v_mfma_f32_16x16x32_bf16 v[4:7], a[152:155], a[48:51], v[4:7]
    s_add_u32 m0, m0, s50
    v_cvt_pk_bf16_f32 v26, v26, v27
    v_accvgpr_write_b32 a178, v24
    v_mfma_f32_16x16x32_bf16 v[8:11], a[152:155], a[80:83], v[8:11]
    buffer_load_dwordx4 v78, s[8:11], s24 offen offset:384 sc0 sc1 lds
    v_mfma_f32_16x16x32_bf16 v[12:15], a[152:155], a[112:115], v[12:15]
    s_waitcnt lgkmcnt(3)
    v_accvgpr_write_b32 a179, v26
    v_mul_f32 v33, s27, v33
    v_mfma_f32_16x16x32_bf16 v[0:3], a[156:159], a[20:23], v[0:3]
    ds_read_b128 a[152:155], v68 offset:22528
    v_mul_f32 v34, s27, v34
    v_mfma_f32_16x16x32_bf16 v[4:7], a[156:159], a[52:55], v[4:7]
    v_exp_f32 v28, v28
    v_mfma_f32_16x16x32_bf16 v[8:11], a[156:159], a[84:87], v[8:11]
    v_exp_f32 v29, v29
    v_mfma_f32_16x16x32_bf16 v[12:15], a[156:159], a[116:119], v[12:15]
    v_exp_f32 v30, v30
    v_mfma_f32_16x16x32_bf16 v[0:3], a[160:163], a[24:27], v[0:3]
    ds_read_b128 a[156:159], v69 offset:22528
    v_cvt_pk_bf16_f32 v28, v28, v29
    v_mfma_f32_16x16x32_bf16 v[4:7], a[160:163], a[56:59], v[4:7]
    v_exp_f32 v31, v31
    v_mfma_f32_16x16x32_bf16 v[8:11], a[160:163], a[88:91], v[8:11]
    s_waitcnt lgkmcnt(3)
    v_accvgpr_write_b32 a234, v28
    v_cvt_pk_bf16_f32 v30, v30, v31
    v_mfma_f32_16x16x32_bf16 v[12:15], a[160:163], a[120:123], v[12:15]
    v_accvgpr_write_b32 a235, v30
    v_mul_f32 v35, s27, v35
    v_mfma_f32_16x16x32_bf16 v[0:3], a[164:167], a[28:31], v[0:3]
    ds_read_b128 a[160:163], v68 offset:26624
    v_mul_f32 v36, s27, v36
    v_mfma_f32_16x16x32_bf16 v[4:7], a[164:167], a[60:63], v[4:7]
    v_exp_f32 v32, v32
    v_mfma_f32_16x16x32_bf16 v[8:11], a[164:167], a[92:95], v[8:11]
    v_exp_f32 v33, v33
    v_mfma_f32_16x16x32_bf16 v[12:15], a[164:167], a[124:127], v[12:15]
    v_exp_f32 v34, v34
    v_mfma_f32_16x16x32_bf16 v[16:19], a[144:147], a[0:3], v[148:151]
    ds_read_b128 a[164:167], v69 offset:26624
    v_cvt_pk_bf16_f32 v124, v32, v33
    v_mfma_f32_16x16x32_bf16 v[20:23], a[144:147], a[32:35], v[212:215]
    v_exp_f32 v35, v35
    v_mfma_f32_16x16x32_bf16 v[24:27], a[144:147], a[64:67], v[244:247]
    s_waitcnt lgkmcnt(3)
    v_mul_f32 v37, s27, v37
    v_cvt_pk_bf16_f32 v125, v34, v35
    v_mfma_f32_16x16x32_bf16 v[28:31], a[144:147], a[96:99], v[252:255]
    v_mul_f32 v38, s27, v38
    v_mul_f32 v39, s27, v39
    v_mfma_f32_16x16x32_bf16 v[16:19], a[148:151], a[4:7], v[16:19]
    ds_read_b128 a[144:147], v68 offset:30720
    v_mul_f32 v40, s27, v40
    v_mfma_f32_16x16x32_bf16 v[20:23], a[148:151], a[36:39], v[20:23]
    s_waitcnt vmcnt(16)
    v_exp_f32 v36, v36
    v_mfma_f32_16x16x32_bf16 v[24:27], a[148:151], a[68:71], v[24:27]
    s_barrier
    v_mfma_f32_16x16x32_bf16 v[28:31], a[148:151], a[100:103], v[28:31]
    v_exp_f32 v37, v37
    v_mfma_f32_16x16x32_bf16 v[16:19], a[152:155], a[8:11], v[16:19]
    ds_read_b128 a[148:151], v69 offset:30720
    v_mul_f32 v41, s27, v41
    v_mfma_f32_16x16x32_bf16 v[20:23], a[152:155], a[40:43], v[20:23]
    v_exp_f32 v38, v38
    v_mfma_f32_16x16x32_bf16 v[24:27], a[152:155], a[72:75], v[24:27]
    s_add_u32 s24, s24, s59
    v_exp_f32 v39, v39
    v_mfma_f32_16x16x32_bf16 v[28:31], a[152:155], a[104:107], v[28:31]
    s_waitcnt lgkmcnt(3)
    v_cvt_pk_bf16_f32 v188, v36, v37
    v_cvt_pk_bf16_f32 v189, v38, v39
    v_mfma_f32_16x16x32_bf16 v[16:19], a[156:159], a[12:15], v[16:19]
    ds_read_b128 a[152:155], v68 offset:32768
    v_mul_f32 v42, s27, v42
    v_mfma_f32_16x16x32_bf16 v[20:23], a[156:159], a[44:47], v[20:23]
    s_add_u32 m0, s22, 0
    v_mul_f32 v43, s27, v43
    v_mul_f32 v44, s27, v44
    v_mfma_f32_16x16x32_bf16 v[24:27], a[156:159], a[76:79], v[24:27]
    buffer_load_dwordx4 v78, s[8:11], s24 offen offset:0 sc0 sc1 lds
    v_mfma_f32_16x16x32_bf16 v[28:31], a[156:159], a[108:111], v[28:31]
    v_exp_f32 v40, v40
    v_mfma_f32_16x16x32_bf16 v[16:19], a[160:163], a[16:19], v[16:19]
    ds_read_b128 a[156:159], v69 offset:32768
    v_mul_f32 v45, s27, v45
    v_mfma_f32_16x16x32_bf16 v[20:23], a[160:163], a[48:51], v[20:23]
    v_exp_f32 v41, v41
    v_mfma_f32_16x16x32_bf16 v[24:27], a[160:163], a[80:83], v[24:27]
    s_waitcnt lgkmcnt(3)
    v_exp_f32 v42, v42
    v_mfma_f32_16x16x32_bf16 v[28:31], a[160:163], a[112:115], v[28:31]
    v_exp_f32 v43, v43
    v_mfma_f32_16x16x32_bf16 v[16:19], a[164:167], a[20:23], v[16:19]
    ds_read_b128 a[160:163], v68 offset:36864
    v_cvt_pk_bf16_f32 v40, v40, v41
    v_mfma_f32_16x16x32_bf16 v[20:23], a[164:167], a[52:55], v[20:23]
    v_cvt_pk_bf16_f32 v42, v42, v43
    v_accvgpr_write_b32 a180, v40
    v_mfma_f32_16x16x32_bf16 v[24:27], a[164:167], a[84:87], v[24:27]
    v_accvgpr_write_b32 a181, v42
    v_mul_f32 v46, s27, v46
    v_mfma_f32_16x16x32_bf16 v[28:31], a[164:167], a[116:119], v[28:31]
    v_exp_f32 v44, v44
    v_mfma_f32_16x16x32_bf16 v[16:19], a[144:147], a[24:27], v[16:19]
    ds_read_b128 a[164:167], v69 offset:36864
    v_mul_f32 v47, s27, v47
    v_mfma_f32_16x16x32_bf16 v[20:23], a[144:147], a[56:59], v[20:23]
    s_add_u32 m0, m0, s50
    v_exp_f32 v45, v45
    v_mfma_f32_16x16x32_bf16 v[24:27], a[144:147], a[88:91], v[24:27]
    buffer_load_dwordx4 v78, s[8:11], s24 offen offset:128 sc0 sc1 lds
    v_mfma_f32_16x16x32_bf16 v[28:31], a[144:147], a[120:123], v[28:31]
    s_waitcnt lgkmcnt(3)
    v_exp_f32 v46, v46
    v_mfma_f32_16x16x32_bf16 v[16:19], a[148:151], a[28:31], v[16:19]
    ds_read_b128 a[144:147], v68 offset:40960
    v_cvt_pk_bf16_f32 v44, v44, v45
    v_mfma_f32_16x16x32_bf16 v[20:23], a[148:151], a[60:63], v[20:23]
    v_exp_f32 v47, v47
    v_mfma_f32_16x16x32_bf16 v[24:27], a[148:151], a[92:95], v[24:27]
    v_exp_f32 v48, v48
    v_mfma_f32_16x16x32_bf16 v[28:31], a[148:151], a[124:127], v[28:31]
    s_add_u32 s43, s42, 16384
    v_cvt_pk_bf16_f32 v46, v46, v47
    v_accvgpr_write_b32 a236, v44
    v_mfma_f32_16x16x32_bf16 v[32:35], a[152:155], a[0:3], v[148:151]
    ds_read_b128 a[148:151], v69 offset:40960
    v_exp_f32 v49, v49
    v_exp_f32 v50, v50
    v_pk_mul_f32 v[16:17], v[16:17], s[92:93]
    v_pk_mul_f32 v[18:19], v[18:19], s[92:93]
    v_pk_mul_f32 v[20:21], v[20:21], s[92:93]
    v_pk_mul_f32 v[22:23], v[22:23], s[92:93]
    v_pk_mul_f32 v[24:25], v[24:25], s[92:93]
    v_pk_mul_f32 v[26:27], v[26:27], s[92:93]
    v_pk_mul_f32 v[28:29], v[28:29], s[92:93]
    v_pk_mul_f32 v[30:31], v[30:31], s[92:93]
    v_mfma_f32_16x16x32_bf16 v[36:39], a[152:155], a[32:35], v[212:215]
    s_add_u32 m0, s44, 147456
    v_accvgpr_write_b32 a237, v46
    v_cvt_pk_bf16_f32 v126, v48, v49
    v_mfma_f32_16x16x32_bf16 v[40:43], a[152:155], a[64:67], v[244:247]
    buffer_load_dwordx4 v78, s[4:7], s43 offen offset:0 sc0 sc1 nt lds
    v_mfma_f32_16x16x32_bf16 v[44:47], a[152:155], a[96:99], v[252:255]
    s_waitcnt lgkmcnt(3)
    v_exp_f32 v51, v51
    v_mfma_f32_16x16x32_bf16 v[32:35], a[156:159], a[4:7], v[32:35]
    ds_read_b128 a[152:155], v68 offset:45056
    s_add_u32 m0, s22, 7936
    v_mfma_f32_16x16x32_bf16 v[36:39], a[156:159], a[36:39], v[36:39]
    v_exp_f32 v52, v52
    v_mfma_f32_16x16x32_bf16 v[40:43], a[156:159], a[68:71], v[40:43]
    buffer_load_dwordx4 v78, s[8:11], s24 offen offset:256 sc0 sc1 lds
    v_mfma_f32_16x16x32_bf16 v[44:47], a[156:159], a[100:103], v[44:47]
    v_exp_f32 v53, v53
    v_mfma_f32_16x16x32_bf16 v[32:35], a[160:163], a[8:11], v[32:35]
    ds_read_b128 a[156:159], v69 offset:45056
    v_cvt_pk_bf16_f32 v127, v50, v51
    v_mfma_f32_16x16x32_bf16 v[36:39], a[160:163], a[40:43], v[36:39]
    s_add_u32 m0, s45, 147456
    v_exp_f32 v54, v54
    v_mfma_f32_16x16x32_bf16 v[40:43], a[160:163], a[72:75], v[40:43]
    buffer_load_dwordx4 v72, s[4:7], s43 offen offset:0 sc0 sc1 nt lds
    v_mfma_f32_16x16x32_bf16 v[44:47], a[160:163], a[104:107], v[44:47]
    s_waitcnt lgkmcnt(3)
    v_exp_f32 v55, v55
    v_mfma_f32_16x16x32_bf16 v[32:35], a[164:167], a[12:15], v[32:35]
    ds_read_b128 a[160:163], v68 offset:34816
    v_cvt_pk_bf16_f32 v190, v52, v53
    v_mfma_f32_16x16x32_bf16 v[36:39], a[164:167], a[44:47], v[36:39]
    v_cvt_pk_bf16_f32 v191, v54, v55
    v_mul_f32 v0, s27, v0
    v_mfma_f32_16x16x32_bf16 v[40:43], a[164:167], a[76:79], v[40:43]
    v_exp_f32 v56, v56
    v_mfma_f32_16x16x32_bf16 v[44:47], a[164:167], a[108:111], v[44:47]
    v_exp_f32 v57, v57
    v_mfma_f32_16x16x32_bf16 v[32:35], a[144:147], a[16:19], v[32:35]
    ds_read_b128 a[164:167], v69 offset:34816
    v_mul_f32 v1, s27, v1
    v_mfma_f32_16x16x32_bf16 v[36:39], a[144:147], a[48:51], v[36:39]
    s_add_u32 m0, s22, 11904
    v_exp_f32 v58, v58
    v_mfma_f32_16x16x32_bf16 v[40:43], a[144:147], a[80:83], v[40:43]
    buffer_load_dwordx4 v78, s[8:11], s24 offen offset:384 sc0 sc1 lds
    v_mfma_f32_16x16x32_bf16 v[44:47], a[144:147], a[112:115], v[44:47]
    s_waitcnt lgkmcnt(3)
    v_exp_f32 v59, v59
    v_mfma_f32_16x16x32_bf16 v[32:35], a[148:151], a[20:23], v[32:35]
    ds_read_b128 a[144:147], v68 offset:38912
    v_cvt_pk_bf16_f32 v56, v56, v57
    v_mfma_f32_16x16x32_bf16 v[36:39], a[148:151], a[52:55], v[36:39]
    s_add_u32 m0, s44, 149376
    v_cvt_pk_bf16_f32 v58, v58, v59
    v_accvgpr_write_b32 a182, v56
    v_mfma_f32_16x16x32_bf16 v[40:43], a[148:151], a[84:87], v[40:43]
    buffer_load_dwordx4 v78, s[4:7], s43 offen offset:128 sc0 sc1 nt lds
    v_mfma_f32_16x16x32_bf16 v[44:47], a[148:151], a[116:119], v[44:47]
    v_accvgpr_write_b32 a183, v58
    v_mul_f32 v2, s27, v2
    v_mfma_f32_16x16x32_bf16 v[32:35], a[152:155], a[24:27], v[32:35]
    ds_read_b128 a[148:151], v69 offset:38912
    v_mul_f32 v3, s27, v3
    v_mfma_f32_16x16x32_bf16 v[36:39], a[152:155], a[56:59], v[36:39]
    s_add_u32 m0, s45, 149376
    v_exp_f32 v60, v60
    v_mfma_f32_16x16x32_bf16 v[40:43], a[152:155], a[88:91], v[40:43]
    buffer_load_dwordx4 v72, s[4:7], s43 offen offset:128 sc0 sc1 nt lds
    v_mfma_f32_16x16x32_bf16 v[44:47], a[152:155], a[120:123], v[44:47]
    s_waitcnt lgkmcnt(3)
    v_exp_f32 v61, v61
    v_mfma_f32_16x16x32_bf16 v[32:35], a[156:159], a[28:31], v[32:35]
    ds_read_b128 a[152:155], v68 offset:43008
    v_mul_f32 v4, s27, v4
    v_mfma_f32_16x16x32_bf16 v[36:39], a[156:159], a[60:63], v[36:39]
    v_exp_f32 v62, v62
    v_mfma_f32_16x16x32_bf16 v[40:43], a[156:159], a[92:95], v[40:43]
    v_exp_f32 v63, v63
    v_mfma_f32_16x16x32_bf16 v[44:47], a[156:159], a[124:127], v[44:47]
    v_cvt_pk_bf16_f32 v60, v60, v61
    v_mul_f32 v5, s27, v5
    v_smfmac_f32_16x16x64_bf16 a[136:139], a[128:131], v[120:127], v84
    v_cvt_pk_bf16_f32 v62, v62, v63
    v_smfmac_f32_16x16x64_bf16 a[136:139], a[132:135], v[184:191], v84
    v_accvgpr_write_b32 a238, v60
    v_smfmac_f32_16x16x64_bf16 a[140:143], a[128:131], a[176:183], v84
    v_accvgpr_write_b32 a239, v62
    s_nop 1
    v_smfmac_f32_16x16x64_bf16 a[140:143], a[132:135], a[232:239], v84
    v_mul_f32 v6, s27, v6
    v_mfma_f32_16x16x32_bf16 v[48:51], a[160:163], a[0:3], v[148:151]
    ds_read_b128 a[156:159], v69 offset:43008
    v_mul_f32 v7, s27, v7
    v_mfma_f32_16x16x32_bf16 v[52:55], a[160:163], a[32:35], v[212:215]
    v_exp_f32 v0, v0
    v_mfma_f32_16x16x32_bf16 v[56:59], a[160:163], a[64:67], v[244:247]
    s_waitcnt lgkmcnt(3)
    v_exp_f32 v1, v1
    v_mfma_f32_16x16x32_bf16 v[60:63], a[160:163], a[96:99], v[252:255]
    v_exp_f32 v2, v2
    v_mfma_f32_16x16x32_bf16 v[48:51], a[164:167], a[4:7], v[48:51]
    ds_read_b128 a[160:163], v68 offset:47104
    v_cvt_pk_bf16_f32 v128, v0, v1
    v_mfma_f32_16x16x32_bf16 v[52:55], a[164:167], a[36:39], v[52:55]
    s_waitcnt vmcnt(18)
    v_exp_f32 v3, v3
    v_mfma_f32_16x16x32_bf16 v[56:59], a[164:167], a[68:71], v[56:59]
    s_barrier
    v_mfma_f32_16x16x32_bf16 v[60:63], a[164:167], a[100:103], v[60:63]
    v_cvt_pk_bf16_f32 v129, v2, v3
    v_mul_f32 v8, s27, v8
    v_mfma_f32_16x16x32_bf16 v[48:51], a[144:147], a[8:11], v[48:51]
    ds_read_b128 a[164:167], v69 offset:47104
    v_mul_f32 v9, s27, v9
    v_mfma_f32_16x16x32_bf16 v[52:55], a[144:147], a[40:43], v[52:55]
    s_or_b32 s21, s20, s97
    v_exp_f32 v4, v4
    v_mfma_f32_16x16x32_bf16 v[56:59], a[144:147], a[72:75], v[56:59]
    s_xor_b32 s25, s21, 0
    v_exp_f32 v5, v5
    v_mfma_f32_16x16x32_bf16 v[60:63], a[144:147], a[104:107], v[60:63]
    s_waitcnt lgkmcnt(3)
    v_exp_f32 v6, v6
    v_mfma_f32_16x16x32_bf16 v[48:51], a[148:151], a[12:15], v[48:51]
    ds_read_b128 a[144:147], v68 offset:49152
    v_cvt_pk_bf16_f32 v192, v4, v5
    v_mfma_f32_16x16x32_bf16 v[52:55], a[148:151], a[44:47], v[52:55]
    s_add_u32 m0, s23, 16384
    v_exp_f32 v7, v7
    v_mfma_f32_16x16x32_bf16 v[56:59], a[148:151], a[76:79], v[56:59]
    buffer_load_dwordx4 v79, s[12:15], s25 offen sc0 sc1 lds
    v_mfma_f32_16x16x32_bf16 v[60:63], a[148:151], a[108:111], v[60:63]
    v_cvt_pk_bf16_f32 v193, v6, v7
    v_mul_f32 v10, s27, v10
    v_mfma_f32_16x16x32_bf16 v[48:51], a[152:155], a[16:19], v[48:51]
    ds_read_b128 a[148:151], v69 offset:49152
    v_mul_f32 v11, s27, v11
    v_mfma_f32_16x16x32_bf16 v[52:55], a[152:155], a[48:51], v[52:55]
    v_exp_f32 v8, v8
    v_mfma_f32_16x16x32_bf16 v[56:59], a[152:155], a[80:83], v[56:59]
    s_waitcnt lgkmcnt(3)
    v_exp_f32 v9, v9
    v_mfma_f32_16x16x32_bf16 v[60:63], a[152:155], a[112:115], v[60:63]
    v_exp_f32 v10, v10
    v_mfma_f32_16x16x32_bf16 v[48:51], a[156:159], a[20:23], v[48:51]
    ds_read_b128 a[152:155], v68 offset:53248
    v_cvt_pk_bf16_f32 v8, v8, v9
    v_mfma_f32_16x16x32_bf16 v[52:55], a[156:159], a[52:55], v[52:55]
    v_exp_f32 v11, v11
    v_mfma_f32_16x16x32_bf16 v[56:59], a[156:159], a[84:87], v[56:59]
    s_add_u32 s26, s25, s31
    v_accvgpr_write_b32 a184, v8
    v_cvt_pk_bf16_f32 v10, v10, v11
    v_mfma_f32_16x16x32_bf16 v[60:63], a[156:159], a[116:119], v[60:63]
    v_accvgpr_write_b32 a185, v10
    v_mul_f32 v12, s27, v12
    v_mfma_f32_16x16x32_bf16 v[48:51], a[160:163], a[24:27], v[48:51]
    ds_read_b128 a[156:159], v69 offset:53248
    v_mul_f32 v13, s27, v13
    v_mfma_f32_16x16x32_bf16 v[52:55], a[160:163], a[56:59], v[52:55]
    s_add_u32 m0, m0, s51
    v_mul_f32 v14, s27, v14
    v_mul_f32 v15, s27, v15
    v_mfma_f32_16x16x32_bf16 v[56:59], a[160:163], a[88:91], v[56:59]
    buffer_load_dwordx4 v79, s[12:15], s26 offen sc0 sc1 lds
    v_mfma_f32_16x16x32_bf16 v[60:63], a[160:163], a[120:123], v[60:63]
    s_waitcnt lgkmcnt(3)
    v_exp_f32 v12, v12
    v_mfma_f32_16x16x32_bf16 v[48:51], a[164:167], a[28:31], v[48:51]
    ds_read_b128 a[160:163], v68 offset:57344
    v_mfma_f32_16x16x32_bf16 v[52:55], a[164:167], a[60:63], v[52:55]
    v_exp_f32 v13, v13
    v_mfma_f32_16x16x32_bf16 v[56:59], a[164:167], a[92:95], v[56:59]
    v_exp_f32 v14, v14
    v_mfma_f32_16x16x32_bf16 v[60:63], a[164:167], a[124:127], v[60:63]
    v_exp_f32 v15, v15
    v_mfma_f32_16x16x32_bf16 v[0:3], a[144:147], a[0:3], v[148:151]
    ds_read_b128 a[164:167], v69 offset:57344
    v_cvt_pk_bf16_f32 v12, v12, v13
    v_mfma_f32_16x16x32_bf16 v[4:7], a[144:147], a[32:35], v[212:215]
    v_cvt_pk_bf16_f32 v14, v14, v15
    v_exp_f32 v16, v16
    v_accvgpr_write_b32 a240, v12
    v_accvgpr_write_b32 a241, v14
    v_pk_mul_f32 v[48:49], v[48:49], s[92:93]
    v_pk_mul_f32 v[50:51], v[50:51], s[92:93]
    v_pk_mul_f32 v[52:53], v[52:53], s[92:93]
    v_pk_mul_f32 v[54:55], v[54:55], s[92:93]
    v_pk_mul_f32 v[56:57], v[56:57], s[92:93]
    v_pk_mul_f32 v[58:59], v[58:59], s[92:93]
    v_pk_mul_f32 v[60:61], v[60:61], s[92:93]
    v_pk_mul_f32 v[62:63], v[62:63], s[92:93]
    v_mfma_f32_16x16x32_bf16 v[8:11], a[144:147], a[64:67], v[244:247]
    s_add_u32 s25, s26, s31
    v_exp_f32 v17, v17
    v_mfma_f32_16x16x32_bf16 v[12:15], a[144:147], a[96:99], v[252:255]
    s_waitcnt lgkmcnt(3)
    v_exp_f32 v18, v18
    v_mfma_f32_16x16x32_bf16 v[0:3], a[148:151], a[4:7], v[0:3]
    ds_read_b128 a[144:147], v68 offset:61440
    v_cvt_pk_bf16_f32 v130, v16, v17
    v_mfma_f32_16x16x32_bf16 v[4:7], a[148:151], a[36:39], v[4:7]
    s_add_u32 m0, m0, s51
    v_exp_f32 v19, v19
    v_mfma_f32_16x16x32_bf16 v[8:11], a[148:151], a[68:71], v[8:11]
    buffer_load_dwordx4 v79, s[12:15], s25 offen sc0 sc1 lds
    v_mfma_f32_16x16x32_bf16 v[12:15], a[148:151], a[100:103], v[12:15]
    v_exp_f32 v20, v20
    v_mfma_f32_16x16x32_bf16 v[0:3], a[152:155], a[8:11], v[0:3]
    ds_read_b128 a[148:151], v69 offset:61440
    v_cvt_pk_bf16_f32 v131, v18, v19
    v_mfma_f32_16x16x32_bf16 v[4:7], a[152:155], a[40:43], v[4:7]
    v_exp_f32 v21, v21
    v_mfma_f32_16x16x32_bf16 v[8:11], a[152:155], a[72:75], v[8:11]
    s_waitcnt lgkmcnt(3)
    v_exp_f32 v22, v22
    v_mfma_f32_16x16x32_bf16 v[12:15], a[152:155], a[104:107], v[12:15]
    v_exp_f32 v23, v23
    v_mfma_f32_16x16x32_bf16 v[0:3], a[156:159], a[12:15], v[0:3]
    ds_read_b128 a[152:155], v68 offset:51200
    v_cvt_pk_bf16_f32 v194, v20, v21
    v_mfma_f32_16x16x32_bf16 v[4:7], a[156:159], a[44:47], v[4:7]
    v_cvt_pk_bf16_f32 v195, v22, v23
    v_mul_f32 v32, s27, v32
    v_mfma_f32_16x16x32_bf16 v[8:11], a[156:159], a[76:79], v[8:11]
    s_add_u32 s26, s25, s31
    v_exp_f32 v24, v24
    v_mfma_f32_16x16x32_bf16 v[12:15], a[156:159], a[108:111], v[12:15]
    v_exp_f32 v25, v25
    v_mfma_f32_16x16x32_bf16 v[0:3], a[160:163], a[16:19], v[0:3]
    ds_read_b128 a[156:159], v69 offset:51200
    v_mul_f32 v33, s27, v33
    v_mfma_f32_16x16x32_bf16 v[4:7], a[160:163], a[48:51], v[4:7]
    s_add_u32 m0, m0, s51
    v_exp_f32 v26, v26
    v_mfma_f32_16x16x32_bf16 v[8:11], a[160:163], a[80:83], v[8:11]
    buffer_load_dwordx4 v79, s[12:15], s26 offen sc0 sc1 lds
    v_mfma_f32_16x16x32_bf16 v[12:15], a[160:163], a[112:115], v[12:15]
    s_waitcnt lgkmcnt(3)
    v_exp_f32 v27, v27
    v_mfma_f32_16x16x32_bf16 v[0:3], a[164:167], a[20:23], v[0:3]
    ds_read_b128 a[160:163], v68 offset:55296
    v_cvt_pk_bf16_f32 v24, v24, v25
    v_mfma_f32_16x16x32_bf16 v[4:7], a[164:167], a[52:55], v[4:7]
    v_cvt_pk_bf16_f32 v26, v26, v27
    v_accvgpr_write_b32 a186, v24
    v_mfma_f32_16x16x32_bf16 v[8:11], a[164:167], a[84:87], v[8:11]
    v_accvgpr_write_b32 a187, v26
    v_mul_f32 v34, s27, v34
    v_mfma_f32_16x16x32_bf16 v[12:15], a[164:167], a[116:119], v[12:15]
    v_exp_f32 v28, v28
    v_mfma_f32_16x16x32_bf16 v[0:3], a[144:147], a[24:27], v[0:3]
    ds_read_b128 a[164:167], v69 offset:55296
    v_mul_f32 v35, s27, v35
    v_mfma_f32_16x16x32_bf16 v[4:7], a[144:147], a[56:59], v[4:7]
    v_exp_f32 v29, v29
    v_mfma_f32_16x16x32_bf16 v[8:11], a[144:147], a[88:91], v[8:11]
    s_waitcnt lgkmcnt(3)
    v_exp_f32 v30, v30
    v_mfma_f32_16x16x32_bf16 v[12:15], a[144:147], a[120:123], v[12:15]
    v_exp_f32 v31, v31
    v_mfma_f32_16x16x32_bf16 v[0:3], a[148:151], a[28:31], v[0:3]
    ds_read_b128 a[144:147], v68 offset:59392
    v_cvt_pk_bf16_f32 v28, v28, v29
    v_mfma_f32_16x16x32_bf16 v[4:7], a[148:151], a[60:63], v[4:7]
    v_cvt_pk_bf16_f32 v30, v30, v31
    v_accvgpr_write_b32 a242, v28
    v_mfma_f32_16x16x32_bf16 v[8:11], a[148:151], a[92:95], v[8:11]
    v_accvgpr_write_b32 a243, v30
    v_mul_f32 v36, s27, v36
    v_mfma_f32_16x16x32_bf16 v[12:15], a[148:151], a[124:127], v[12:15]
    v_exp_f32 v32, v32
    v_mfma_f32_16x16x32_bf16 v[16:19], a[152:155], a[0:3], v[148:151]
    ds_read_b128 a[148:151], v69 offset:59392
    v_mul_f32 v37, s27, v37
    v_mfma_f32_16x16x32_bf16 v[20:23], a[152:155], a[32:35], v[212:215]
    v_exp_f32 v33, v33
    v_mfma_f32_16x16x32_bf16 v[24:27], a[152:155], a[64:67], v[244:247]
    s_waitcnt lgkmcnt(3)
    v_exp_f32 v34, v34
    v_mfma_f32_16x16x32_bf16 v[28:31], a[152:155], a[96:99], v[252:255]
    v_exp_f32 v35, v35
    v_mfma_f32_16x16x32_bf16 v[16:19], a[156:159], a[4:7], v[16:19]
    ds_read_b128 a[152:155], v68 offset:63488
    v_add_u32 v68, s96, v68
    v_mfma_f32_16x16x32_bf16 v[20:23], a[156:159], a[36:39], v[20:23]
    s_waitcnt vmcnt(16)
    v_cvt_pk_bf16_f32 v132, v32, v33
    v_cvt_pk_bf16_f32 v133, v34, v35
    v_mfma_f32_16x16x32_bf16 v[24:27], a[156:159], a[68:71], v[24:27]
    s_barrier
    v_mfma_f32_16x16x32_bf16 v[28:31], a[156:159], a[100:103], v[28:31]
    v_mul_f32 v38, s27, v38
    v_mul_f32 v39, s27, v39
    v_mfma_f32_16x16x32_bf16 v[16:19], a[160:163], a[8:11], v[16:19]
    ds_read_b128 a[156:159], v69 offset:63488
    v_add_u32 v69, s96, v69
    v_mfma_f32_16x16x32_bf16 v[20:23], a[160:163], a[40:43], v[20:23]
    v_exp_f32 v36, v36
    v_mfma_f32_16x16x32_bf16 v[24:27], a[160:163], a[72:75], v[24:27]
    s_xor_b32 s25, s21, 65536
    v_exp_f32 v37, v37
    v_mfma_f32_16x16x32_bf16 v[28:31], a[160:163], a[104:107], v[28:31]
    s_waitcnt lgkmcnt(3)
    v_exp_f32 v38, v38
    v_mfma_f32_16x16x32_bf16 v[16:19], a[164:167], a[12:15], v[16:19]
    ds_read_b128 a[160:163], v68 offset:16384
    v_cvt_pk_bf16_f32 v196, v36, v37
    v_mfma_f32_16x16x32_bf16 v[20:23], a[164:167], a[44:47], v[20:23]
    s_add_u32 m0, m0, s95
    v_exp_f32 v39, v39
    v_mfma_f32_16x16x32_bf16 v[24:27], a[164:167], a[76:79], v[24:27]
    buffer_load_dwordx4 v79, s[12:15], s25 offen sc0 sc1 lds
    v_mfma_f32_16x16x32_bf16 v[28:31], a[164:167], a[108:111], v[28:31]
    v_cvt_pk_bf16_f32 v197, v38, v39
    v_mul_f32 v40, s27, v40
    v_mfma_f32_16x16x32_bf16 v[16:19], a[144:147], a[16:19], v[16:19]
    ds_read_b128 a[164:167], v69 offset:16384
    v_mul_f32 v41, s27, v41
    v_mfma_f32_16x16x32_bf16 v[20:23], a[144:147], a[48:51], v[20:23]
    v_mul_f32 v42, s27, v42
    v_mul_f32 v43, s27, v43
    v_mfma_f32_16x16x32_bf16 v[24:27], a[144:147], a[80:83], v[24:27]
    s_waitcnt lgkmcnt(3)
    v_exp_f32 v40, v40
    v_mfma_f32_16x16x32_bf16 v[28:31], a[144:147], a[112:115], v[28:31]
    v_exp_f32 v41, v41
    v_mfma_f32_16x16x32_bf16 v[16:19], a[148:151], a[20:23], v[16:19]
    ds_read_b128 a[144:147], v68 offset:20480
    v_mul_f32 v44, s27, v44
    v_mfma_f32_16x16x32_bf16 v[20:23], a[148:151], a[52:55], v[20:23]
    v_exp_f32 v42, v42
    v_mfma_f32_16x16x32_bf16 v[24:27], a[148:151], a[84:87], v[24:27]
    s_add_u32 s26, s25, s31
    v_exp_f32 v43, v43
    v_mfma_f32_16x16x32_bf16 v[28:31], a[148:151], a[116:119], v[28:31]
    v_cvt_pk_bf16_f32 v40, v40, v41
    v_mul_f32 v45, s27, v45
    v_mfma_f32_16x16x32_bf16 v[16:19], a[152:155], a[24:27], v[16:19]
    ds_read_b128 a[148:151], v69 offset:20480
    v_cvt_pk_bf16_f32 v42, v42, v43
    v_mfma_f32_16x16x32_bf16 v[20:23], a[152:155], a[56:59], v[20:23]
    s_add_u32 m0, m0, s51
    v_accvgpr_write_b32 a188, v40
    v_accvgpr_write_b32 a189, v42
    v_mfma_f32_16x16x32_bf16 v[24:27], a[152:155], a[88:91], v[24:27]
    buffer_load_dwordx4 v79, s[12:15], s26 offen sc0 sc1 lds
    v_mfma_f32_16x16x32_bf16 v[28:31], a[152:155], a[120:123], v[28:31]
    s_waitcnt lgkmcnt(3)
    v_mul_f32 v46, s27, v46
    v_mul_f32 v47, s27, v47
    v_mfma_f32_16x16x32_bf16 v[16:19], a[156:159], a[28:31], v[16:19]
    ds_read_b128 a[152:155], v68 offset:24576
    v_mfma_f32_16x16x32_bf16 v[20:23], a[156:159], a[60:63], v[20:23]
    v_exp_f32 v44, v44
    v_mfma_f32_16x16x32_bf16 v[24:27], a[156:159], a[92:95], v[24:27]
    v_exp_f32 v45, v45
    v_mfma_f32_16x16x32_bf16 v[28:31], a[156:159], a[124:127], v[28:31]
    v_exp_f32 v46, v46
    v_mfma_f32_16x16x32_bf16 v[32:35], a[160:163], a[0:3], v[148:151]
    ds_read_b128 a[156:159], v69 offset:24576
    v_cvt_pk_bf16_f32 v44, v44, v45
    v_mfma_f32_16x16x32_bf16 v[36:39], a[160:163], a[32:35], v[212:215]
    v_exp_f32 v47, v47
    v_exp_f32 v48, v48
    v_accvgpr_write_b32 a244, v44
    v_pk_mul_f32 v[16:17], v[16:17], s[92:93]
    v_pk_mul_f32 v[18:19], v[18:19], s[92:93]
    v_pk_mul_f32 v[20:21], v[20:21], s[92:93]
    v_pk_mul_f32 v[22:23], v[22:23], s[92:93]
    v_pk_mul_f32 v[24:25], v[24:25], s[92:93]
    v_pk_mul_f32 v[26:27], v[26:27], s[92:93]
    v_pk_mul_f32 v[28:29], v[28:29], s[92:93]
    v_pk_mul_f32 v[30:31], v[30:31], s[92:93]
    v_mfma_f32_16x16x32_bf16 v[40:43], a[160:163], a[64:67], v[244:247]
    s_add_u32 s25, s26, s31
    v_exp_f32 v49, v49
    v_cvt_pk_bf16_f32 v46, v46, v47
    v_accvgpr_write_b32 a245, v46
    v_mfma_f32_16x16x32_bf16 v[44:47], a[160:163], a[96:99], v[252:255]
    s_waitcnt lgkmcnt(3)
    v_exp_f32 v50, v50
    v_mfma_f32_16x16x32_bf16 v[32:35], a[164:167], a[4:7], v[32:35]
    ds_read_b128 a[160:163], v68 offset:28672
    v_cvt_pk_bf16_f32 v134, v48, v49
    v_mfma_f32_16x16x32_bf16 v[36:39], a[164:167], a[36:39], v[36:39]
    s_add_u32 m0, m0, s51
    v_exp_f32 v51, v51
    v_mfma_f32_16x16x32_bf16 v[40:43], a[164:167], a[68:71], v[40:43]
    buffer_load_dwordx4 v79, s[12:15], s25 offen sc0 sc1 lds
    v_mfma_f32_16x16x32_bf16 v[44:47], a[164:167], a[100:103], v[44:47]
    v_exp_f32 v52, v52
    v_mfma_f32_16x16x32_bf16 v[32:35], a[144:147], a[8:11], v[32:35]
    ds_read_b128 a[164:167], v69 offset:28672
    v_cvt_pk_bf16_f32 v135, v50, v51
    v_mfma_f32_16x16x32_bf16 v[36:39], a[144:147], a[40:43], v[36:39]
    v_exp_f32 v53, v53
    v_mfma_f32_16x16x32_bf16 v[40:43], a[144:147], a[72:75], v[40:43]
    s_waitcnt lgkmcnt(3)
    v_exp_f32 v54, v54
    v_mfma_f32_16x16x32_bf16 v[44:47], a[144:147], a[104:107], v[44:47]
    v_exp_f32 v55, v55
    v_mfma_f32_16x16x32_bf16 v[32:35], a[148:151], a[12:15], v[32:35]
    ds_read_b128 a[144:147], v68 offset:18432
    v_cvt_pk_bf16_f32 v198, v52, v53
    v_mfma_f32_16x16x32_bf16 v[36:39], a[148:151], a[44:47], v[36:39]
    v_cvt_pk_bf16_f32 v199, v54, v55
    v_mul_f32 v0, s27, v0
    v_mfma_f32_16x16x32_bf16 v[40:43], a[148:151], a[76:79], v[40:43]
    s_add_u32 s26, s25, s31
    v_exp_f32 v56, v56
    v_mfma_f32_16x16x32_bf16 v[44:47], a[148:151], a[108:111], v[44:47]
    v_exp_f32 v57, v57
    v_mfma_f32_16x16x32_bf16 v[32:35], a[152:155], a[16:19], v[32:35]
    ds_read_b128 a[148:151], v69 offset:18432
    v_mul_f32 v1, s27, v1
    v_mfma_f32_16x16x32_bf16 v[36:39], a[152:155], a[48:51], v[36:39]
    s_add_u32 m0, m0, s51
    v_exp_f32 v58, v58
    v_mfma_f32_16x16x32_bf16 v[40:43], a[152:155], a[80:83], v[40:43]
    buffer_load_dwordx4 v79, s[12:15], s26 offen sc0 sc1 lds
    v_mfma_f32_16x16x32_bf16 v[44:47], a[152:155], a[112:115], v[44:47]
    s_waitcnt lgkmcnt(3)
    v_exp_f32 v59, v59
    v_mfma_f32_16x16x32_bf16 v[32:35], a[156:159], a[20:23], v[32:35]
    ds_read_b128 a[152:155], v68 offset:22528
    v_cvt_pk_bf16_f32 v56, v56, v57
    v_mfma_f32_16x16x32_bf16 v[36:39], a[156:159], a[52:55], v[36:39]
    v_cvt_pk_bf16_f32 v58, v58, v59
    v_accvgpr_write_b32 a190, v56
    v_mfma_f32_16x16x32_bf16 v[40:43], a[156:159], a[84:87], v[40:43]
    v_accvgpr_write_b32 a191, v58
    v_mul_f32 v2, s27, v2
    v_mfma_f32_16x16x32_bf16 v[44:47], a[156:159], a[116:119], v[44:47]
    v_exp_f32 v60, v60
    v_mfma_f32_16x16x32_bf16 v[32:35], a[160:163], a[24:27], v[32:35]
    ds_read_b128 a[156:159], v69 offset:22528
    v_mul_f32 v3, s27, v3
    v_mfma_f32_16x16x32_bf16 v[36:39], a[160:163], a[56:59], v[36:39]
    v_exp_f32 v61, v61
    v_mfma_f32_16x16x32_bf16 v[40:43], a[160:163], a[88:91], v[40:43]
    s_waitcnt lgkmcnt(3)
    v_exp_f32 v62, v62
    v_mfma_f32_16x16x32_bf16 v[44:47], a[160:163], a[120:123], v[44:47]
    v_exp_f32 v63, v63
    v_mfma_f32_16x16x32_bf16 v[32:35], a[164:167], a[28:31], v[32:35]
    ds_read_b128 a[160:163], v68 offset:26624
    v_cvt_pk_bf16_f32 v60, v60, v61
    v_mfma_f32_16x16x32_bf16 v[36:39], a[164:167], a[60:63], v[36:39]
L_w4:
    s_cbranch_execz L_w8
    v_cvt_pk_bf16_f32 v62, v62, v63
    v_accvgpr_write_b32 a246, v60
    v_mfma_f32_16x16x32_bf16 v[40:43], a[164:167], a[92:95], v[40:43]
    v_accvgpr_write_b32 a247, v62
    v_mul_f32 v4, s27, v4
    v_mfma_f32_16x16x32_bf16 v[44:47], a[164:167], a[124:127], v[44:47]
    v_exp_f32 v0, v0
    v_smfmac_f32_16x16x64_bf16 a[136:139], a[128:131], v[128:135], v84
    v_mul_f32 v5, s27, v5
    v_smfmac_f32_16x16x64_bf16 a[136:139], a[132:135], v[192:199], v84
    v_mul_f32 v6, s27, v6
    v_smfmac_f32_16x16x64_bf16 a[140:143], a[128:131], a[184:191], v84
    v_mul_f32 v7, s27, v7
    v_smfmac_f32_16x16x64_bf16 a[140:143], a[132:135], a[240:247], v84
    v_mul_f32 v8, s27, v8
    v_mfma_f32_16x16x32_bf16 v[48:51], a[144:147], a[0:3], v[148:151]
    ds_read_b128 a[164:167], v69 offset:26624
    v_mul_f32 v9, s27, v9
    v_mfma_f32_16x16x32_bf16 v[52:55], a[144:147], a[32:35], v[212:215]
    v_exp_f32 v1, v1
    v_mfma_f32_16x16x32_bf16 v[56:59], a[144:147], a[64:67], v[244:247]
    s_waitcnt lgkmcnt(3)
    v_exp_f32 v2, v2
    v_mfma_f32_16x16x32_bf16 v[60:63], a[144:147], a[96:99], v[252:255]
    v_exp_f32 v3, v3
    v_mfma_f32_16x16x32_bf16 v[48:51], a[148:151], a[4:7], v[48:51]
    ds_read_b128 a[144:147], v68 offset:30720
    v_cvt_pk_bf16_f32 v136, v0, v1
    v_mfma_f32_16x16x32_bf16 v[52:55], a[148:151], a[36:39], v[52:55]
    s_waitcnt vmcnt(16)
    v_cvt_pk_bf16_f32 v137, v2, v3
    v_mul_f32 v10, s27, v10
    v_mfma_f32_16x16x32_bf16 v[56:59], a[148:151], a[68:71], v[56:59]
    s_barrier
    v_mfma_f32_16x16x32_bf16 v[60:63], a[148:151], a[100:103], v[60:63]
    v_exp_f32 v4, v4
    v_mfma_f32_16x16x32_bf16 v[48:51], a[152:155], a[8:11], v[48:51]
    ds_read_b128 a[148:151], v69 offset:30720
    v_mul_f32 v11, s27, v11
    v_mfma_f32_16x16x32_bf16 v[52:55], a[152:155], a[40:43], v[52:55]
    v_exp_f32 v5, v5
    v_mfma_f32_16x16x32_bf16 v[56:59], a[152:155], a[72:75], v[56:59]
    s_xor_b32 s25, s21, 131072
    v_exp_f32 v6, v6
    v_mfma_f32_16x16x32_bf16 v[60:63], a[152:155], a[104:107], v[60:63]
    s_waitcnt lgkmcnt(3)
    v_exp_f32 v7, v7
    v_mfma_f32_16x16x32_bf16 v[48:51], a[156:159], a[12:15], v[48:51]
    ds_read_b128 a[152:155], v68 offset:32768
    v_cvt_pk_bf16_f32 v200, v4, v5
    v_mfma_f32_16x16x32_bf16 v[52:55], a[156:159], a[44:47], v[52:55]
    s_add_u32 m0, m0, s95
    v_cvt_pk_bf16_f32 v201, v6, v7
    v_mul_f32 v12, s27, v12
    v_mfma_f32_16x16x32_bf16 v[56:59], a[156:159], a[76:79], v[56:59]
    buffer_load_dwordx4 v79, s[12:15], s25 offen sc0 sc1 lds
    v_mfma_f32_16x16x32_bf16 v[60:63], a[156:159], a[108:111], v[60:63]
    v_exp_f32 v8, v8
    v_mfma_f32_16x16x32_bf16 v[48:51], a[160:163], a[16:19], v[48:51]
    ds_read_b128 a[156:159], v69 offset:32768
    v_mul_f32 v13, s27, v13
    v_mfma_f32_16x16x32_bf16 v[52:55], a[160:163], a[48:51], v[52:55]
    v_exp_f32 v9, v9
    v_mfma_f32_16x16x32_bf16 v[56:59], a[160:163], a[80:83], v[56:59]
    s_waitcnt lgkmcnt(3)
    v_exp_f32 v10, v10
    v_mfma_f32_16x16x32_bf16 v[60:63], a[160:163], a[112:115], v[60:63]
    v_exp_f32 v11, v11
    v_mfma_f32_16x16x32_bf16 v[48:51], a[164:167], a[20:23], v[48:51]
    ds_read_b128 a[160:163], v68 offset:36864
    v_cvt_pk_bf16_f32 v8, v8, v9
    v_mfma_f32_16x16x32_bf16 v[52:55], a[164:167], a[52:55], v[52:55]
    v_cvt_pk_bf16_f32 v10, v10, v11
    v_accvgpr_write_b32 a192, v8
    v_mfma_f32_16x16x32_bf16 v[56:59], a[164:167], a[84:87], v[56:59]
    s_add_u32 s26, s25, s31
    v_accvgpr_write_b32 a193, v10
    v_mul_f32 v14, s27, v14
    v_mfma_f32_16x16x32_bf16 v[60:63], a[164:167], a[116:119], v[60:63]
    v_exp_f32 v12, v12
    v_mfma_f32_16x16x32_bf16 v[48:51], a[144:147], a[24:27], v[48:51]
    ds_read_b128 a[164:167], v69 offset:36864
    v_mul_f32 v15, s27, v15
    v_mfma_f32_16x16x32_bf16 v[52:55], a[144:147], a[56:59], v[52:55]
    s_add_u32 m0, m0, s51
    v_exp_f32 v13, v13
    v_mfma_f32_16x16x32_bf16 v[56:59], a[144:147], a[88:91], v[56:59]
    buffer_load_dwordx4 v79, s[12:15], s26 offen sc0 sc1 lds
    v_mfma_f32_16x16x32_bf16 v[60:63], a[144:147], a[120:123], v[60:63]
    s_waitcnt lgkmcnt(3)
    v_exp_f32 v14, v14
    v_mfma_f32_16x16x32_bf16 v[48:51], a[148:151], a[28:31], v[48:51]
    ds_read_b128 a[144:147], v68 offset:40960
    v_cvt_pk_bf16_f32 v12, v12, v13
    v_mfma_f32_16x16x32_bf16 v[52:55], a[148:151], a[60:63], v[52:55]
    v_exp_f32 v15, v15
    v_mfma_f32_16x16x32_bf16 v[56:59], a[148:151], a[92:95], v[56:59]
    v_exp_f32 v16, v16
    v_mfma_f32_16x16x32_bf16 v[60:63], a[148:151], a[124:127], v[60:63]
    v_cvt_pk_bf16_f32 v14, v14, v15
    v_accvgpr_write_b32 a248, v12
    v_mfma_f32_16x16x32_bf16 v[0:3], a[152:155], a[0:3], v[148:151]
    ds_read_b128 a[148:151], v69 offset:40960
    v_accvgpr_write_b32 a249, v14
    v_mfma_f32_16x16x32_bf16 v[4:7], a[152:155], a[32:35], v[212:215]
    v_exp_f32 v17, v17
    v_exp_f32 v18, v18
    v_pk_mul_f32 v[48:49], v[48:49], s[92:93]
    v_pk_mul_f32 v[50:51], v[50:51], s[92:93]
    v_pk_mul_f32 v[52:53], v[52:53], s[92:93]
    v_pk_mul_f32 v[54:55], v[54:55], s[92:93]
    v_pk_mul_f32 v[56:57], v[56:57], s[92:93]
    v_pk_mul_f32 v[58:59], v[58:59], s[92:93]
    v_pk_mul_f32 v[60:61], v[60:61], s[92:93]
    v_pk_mul_f32 v[62:63], v[62:63], s[92:93]
    v_mfma_f32_16x16x32_bf16 v[8:11], a[152:155], a[64:67], v[244:247]
    s_add_u32 s25, s26, s31
    v_exp_f32 v19, v19
    v_mfma_f32_16x16x32_bf16 v[12:15], a[152:155], a[96:99], v[252:255]
    s_waitcnt lgkmcnt(3)
    v_exp_f32 v20, v20
    v_mfma_f32_16x16x32_bf16 v[0:3], a[156:159], a[4:7], v[0:3]
    ds_read_b128 a[152:155], v68 offset:45056
    v_cvt_pk_bf16_f32 v138, v16, v17
    v_mfma_f32_16x16x32_bf16 v[4:7], a[156:159], a[36:39], v[4:7]
    s_add_u32 m0, m0, s51
    v_exp_f32 v21, v21
    v_mfma_f32_16x16x32_bf16 v[8:11], a[156:159], a[68:71], v[8:11]
    buffer_load_dwordx4 v79, s[12:15], s25 offen sc0 sc1 lds
    v_mfma_f32_16x16x32_bf16 v[12:15], a[156:159], a[100:103], v[12:15]
    v_cvt_pk_bf16_f32 v139, v18, v19
    v_cvt_pk_bf16_f32 v202, v20, v21
    v_mfma_f32_16x16x32_bf16 v[0:3], a[160:163], a[8:11], v[0:3]
    ds_read_b128 a[156:159], v69 offset:45056
    v_mul_f32 v32, s27, v32
    v_mfma_f32_16x16x32_bf16 v[4:7], a[160:163], a[40:43], v[4:7]
    s_or_b32 s46, s32, s97
    v_exp_f32 v22, v22
    v_mfma_f32_16x16x32_bf16 v[8:11], a[160:163], a[72:75], v[8:11]
    s_mov_b32 s18, s37
    v_exp_f32 v23, v23
    v_mfma_f32_16x16x32_bf16 v[12:15], a[160:163], a[104:107], v[12:15]
    s_waitcnt lgkmcnt(3)
    v_exp_f32 v24, v24
    v_mfma_f32_16x16x32_bf16 v[0:3], a[164:167], a[12:15], v[0:3]
    ds_read_b128 a[160:163], v68 offset:34816
    v_cvt_pk_bf16_f32 v203, v22, v23
    v_mfma_f32_16x16x32_bf16 v[4:7], a[164:167], a[44:47], v[4:7]
    s_mov_b32 s32, s33
    v_exp_f32 v25, v25
    v_mfma_f32_16x16x32_bf16 v[8:11], a[164:167], a[76:79], v[8:11]
    s_add_u32 s26, s25, s31
    v_exp_f32 v26, v26
    v_mfma_f32_16x16x32_bf16 v[12:15], a[164:167], a[108:111], v[12:15]
    s_mov_b32 s37, s38
    v_exp_f32 v27, v27
    v_mfma_f32_16x16x32_bf16 v[0:3], a[144:147], a[16:19], v[0:3]
    ds_read_b128 a[164:167], v69 offset:34816
    s_mov_b32 s33, s34
    v_mfma_f32_16x16x32_bf16 v[4:7], a[144:147], a[48:51], v[4:7]
    s_add_u32 m0, m0, s51
    s_mov_b32 s38, s39
    v_cvt_pk_bf16_f32 v24, v24, v25
    v_mfma_f32_16x16x32_bf16 v[8:11], a[144:147], a[80:83], v[8:11]
    buffer_load_dwordx4 v79, s[12:15], s26 offen sc0 sc1 lds
    v_mfma_f32_16x16x32_bf16 v[12:15], a[144:147], a[112:115], v[12:15]
    s_waitcnt lgkmcnt(3)
    s_mov_b32 s34, s35
    v_cvt_pk_bf16_f32 v26, v26, v27
    v_mfma_f32_16x16x32_bf16 v[0:3], a[148:151], a[20:23], v[0:3]
    ds_read_b128 a[144:147], v68 offset:38912
    s_mov_b32 s39, s40
    v_mfma_f32_16x16x32_bf16 v[4:7], a[148:151], a[52:55], v[4:7]
    s_mov_b32 s35, s36
    s_mov_b32 s40, s41
    v_accvgpr_write_b32 a194, v24
    v_mfma_f32_16x16x32_bf16 v[8:11], a[148:151], a[84:87], v[8:11]
    s_cmp_eq_u32 s37, 0
    s_cselect_b32 s71, 0xc7000000, 0
    v_accvgpr_write_b32 a195, v26
    v_mfma_f32_16x16x32_bf16 v[12:15], a[148:151], a[116:119], v[12:15]
    v_exp_f32 v28, v28
    v_mfma_f32_16x16x32_bf16 v[0:3], a[152:155], a[24:27], v[0:3]
    ds_read_b128 a[148:151], v69 offset:38912
    v_mul_f32 v33, s27, v33
    v_mfma_f32_16x16x32_bf16 v[4:7], a[152:155], a[56:59], v[4:7]
    v_exp_f32 v29, v29
    v_mfma_f32_16x16x32_bf16 v[8:11], a[152:155], a[88:91], v[8:11]
    s_waitcnt lgkmcnt(3)
    v_exp_f32 v30, v30
    v_mfma_f32_16x16x32_bf16 v[12:15], a[152:155], a[120:123], v[12:15]
    v_exp_f32 v31, v31
    v_mfma_f32_16x16x32_bf16 v[0:3], a[156:159], a[28:31], v[0:3]
    ds_read_b128 a[152:155], v68 offset:43008
    v_cvt_pk_bf16_f32 v28, v28, v29
    v_mfma_f32_16x16x32_bf16 v[4:7], a[156:159], a[60:63], v[4:7]
    v_cvt_pk_bf16_f32 v30, v30, v31
    v_accvgpr_write_b32 a250, v28
    v_mfma_f32_16x16x32_bf16 v[8:11], a[156:159], a[92:95], v[8:11]
    v_accvgpr_write_b32 a251, v30
    v_mul_f32 v34, s27, v34
    v_mfma_f32_16x16x32_bf16 v[12:15], a[156:159], a[124:127], v[12:15]
    v_mul_f32 v35, s27, v35
    v_mul_f32 v36, s27, v36
    v_mfma_f32_16x16x32_bf16 v[16:19], a[160:163], a[0:3], v[148:151]
    ds_read_b128 a[156:159], v69 offset:43008
    v_mul_f32 v37, s27, v37
    v_mfma_f32_16x16x32_bf16 v[20:23], a[160:163], a[32:35], v[212:215]
    v_exp_f32 v32, v32
    v_mfma_f32_16x16x32_bf16 v[24:27], a[160:163], a[64:67], v[244:247]
    s_waitcnt lgkmcnt(3)
    v_exp_f32 v33, v33
    v_mfma_f32_16x16x32_bf16 v[28:31], a[160:163], a[96:99], v[252:255]
    v_exp_f32 v34, v34
    v_mfma_f32_16x16x32_bf16 v[16:19], a[164:167], a[4:7], v[16:19]
    ds_read_b128 a[160:163], v68 offset:47104
    v_subrev_u32 v68, s96, v68
    v_mfma_f32_16x16x32_bf16 v[20:23], a[164:167], a[36:39], v[20:23]
    s_waitcnt vmcnt(14)
    v_exp_f32 v35, v35
    v_mfma_f32_16x16x32_bf16 v[24:27], a[164:167], a[68:71], v[24:27]
    s_barrier
    v_mfma_f32_16x16x32_bf16 v[28:31], a[164:167], a[100:103], v[28:31]
    v_cvt_pk_bf16_f32 v140, v32, v33
    v_cvt_pk_bf16_f32 v141, v34, v35
    v_mfma_f32_16x16x32_bf16 v[16:19], a[144:147], a[8:11], v[16:19]
    ds_read_b128 a[164:167], v69 offset:47104
    v_subrev_u32 v69, s96, v69
    v_mfma_f32_16x16x32_bf16 v[20:23], a[144:147], a[40:43], v[20:23]
    v_mul_f32 v38, s27, v38
    v_mul_f32 v39, s27, v39
    v_mfma_f32_16x16x32_bf16 v[24:27], a[144:147], a[72:75], v[24:27]
    s_xor_b32 s25, s21, 196608
    v_exp_f32 v36, v36
    v_mfma_f32_16x16x32_bf16 v[28:31], a[144:147], a[104:107], v[28:31]
    s_waitcnt lgkmcnt(3)
    v_exp_f32 v37, v37
    v_mfma_f32_16x16x32_bf16 v[16:19], a[148:151], a[12:15], v[16:19]
    ds_read_b128 a[144:147], v68 offset:0
    v_mul_f32 v40, s27, v40
    v_mfma_f32_16x16x32_bf16 v[20:23], a[148:151], a[44:47], v[20:23]
    s_add_u32 m0, m0, s95
    v_exp_f32 v38, v38
    v_mfma_f32_16x16x32_bf16 v[24:27], a[148:151], a[76:79], v[24:27]
    buffer_load_dwordx4 v79, s[12:15], s25 offen sc0 sc1 lds
    v_mfma_f32_16x16x32_bf16 v[28:31], a[148:151], a[108:111], v[28:31]
    v_exp_f32 v39, v39
    v_mfma_f32_16x16x32_bf16 v[16:19], a[152:155], a[16:19], v[16:19]
    ds_read_b128 a[148:151], v69 offset:0
    v_cvt_pk_bf16_f32 v204, v36, v37
    v_mfma_f32_16x16x32_bf16 v[20:23], a[152:155], a[48:51], v[20:23]
    v_cvt_pk_bf16_f32 v205, v38, v39
    v_mul_f32 v41, s27, v41
    v_mfma_f32_16x16x32_bf16 v[24:27], a[152:155], a[80:83], v[24:27]
    s_waitcnt lgkmcnt(3)
    v_mul_f32 v42, s27, v42
    v_mul_f32 v43, s27, v43
    v_mfma_f32_16x16x32_bf16 v[28:31], a[152:155], a[112:115], v[28:31]
    v_exp_f32 v40, v40
    v_mfma_f32_16x16x32_bf16 v[16:19], a[156:159], a[20:23], v[16:19]
    ds_read_b128 a[152:155], v68 offset:4096
    v_mul_f32 v44, s27, v44
    v_mfma_f32_16x16x32_bf16 v[20:23], a[156:159], a[52:55], v[20:23]
    v_exp_f32 v41, v41
    v_mfma_f32_16x16x32_bf16 v[24:27], a[156:159], a[84:87], v[24:27]
    s_add_u32 s26, s25, s31
    v_exp_f32 v42, v42
    v_mfma_f32_16x16x32_bf16 v[28:31], a[156:159], a[116:119], v[28:31]
    v_exp_f32 v43, v43
    v_mfma_f32_16x16x32_bf16 v[16:19], a[160:163], a[24:27], v[16:19]
    ds_read_b128 a[156:159], v69 offset:4096
    v_cvt_pk_bf16_f32 v40, v40, v41
    v_mfma_f32_16x16x32_bf16 v[20:23], a[160:163], a[56:59], v[20:23]
    s_add_u32 m0, m0, s51
    v_cvt_pk_bf16_f32 v42, v42, v43
    v_accvgpr_write_b32 a196, v40
    v_mfma_f32_16x16x32_bf16 v[24:27], a[160:163], a[88:91], v[24:27]
    buffer_load_dwordx4 v79, s[12:15], s26 offen sc0 sc1 lds
    v_mfma_f32_16x16x32_bf16 v[28:31], a[160:163], a[120:123], v[28:31]
    s_waitcnt lgkmcnt(3)
    v_accvgpr_write_b32 a197, v42
    v_mul_f32 v45, s27, v45
    v_mfma_f32_16x16x32_bf16 v[16:19], a[164:167], a[28:31], v[16:19]
    ds_read_b128 a[160:163], v68 offset:8192
    v_mul_f32 v46, s27, v46
    v_mfma_f32_16x16x32_bf16 v[20:23], a[164:167], a[60:63], v[20:23]
    v_exp_f32 v44, v44
    v_mfma_f32_16x16x32_bf16 v[24:27], a[164:167], a[92:95], v[24:27]
    v_exp_f32 v45, v45
    v_mfma_f32_16x16x32_bf16 v[28:31], a[164:167], a[124:127], v[28:31]
    v_exp_f32 v46, v46
    v_mfma_f32_16x16x32_bf16 v[32:35], a[144:147], a[0:3], v[148:151]
    ds_read_b128 a[164:167], v69 offset:8192
    v_mul_f32 v47, s27, v47
    v_mfma_f32_16x16x32_bf16 v[36:39], a[144:147], a[32:35], v[212:215]
    v_exp_f32 v47, v47
    v_mfma_f32_16x16x32_bf16 v[40:43], a[144:147], a[64:67], v[244:247]
    s_add_u32 s25, s26, s31
    v_exp_f32 v48, v48
    v_cvt_pk_bf16_f32 v44, v44, v45
    v_cvt_pk_bf16_f32 v46, v46, v47
    v_accvgpr_write_b32 a252, v44
    v_accvgpr_write_b32 a253, v46
    v_mfma_f32_16x16x32_bf16 v[44:47], a[144:147], a[96:99], v[252:255]
    s_waitcnt lgkmcnt(3)
    v_exp_f32 v49, v49
    v_mfma_f32_16x16x32_bf16 v[32:35], a[148:151], a[4:7], v[32:35]
    ds_read_b128 a[144:147], v68 offset:12288
    s_add_u32 m0, m0, s51
    v_mfma_f32_16x16x32_bf16 v[36:39], a[148:151], a[36:39], v[36:39]
    v_exp_f32 v50, v50
    v_mfma_f32_16x16x32_bf16 v[40:43], a[148:151], a[68:71], v[40:43]
    buffer_load_dwordx4 v79, s[12:15], s25 offen sc0 sc1 lds
    v_mfma_f32_16x16x32_bf16 v[44:47], a[148:151], a[100:103], v[44:47]
    v_exp_f32 v51, v51
    v_mfma_f32_16x16x32_bf16 v[32:35], a[152:155], a[8:11], v[32:35]
    ds_read_b128 a[148:151], v69 offset:12288
    v_cvt_pk_bf16_f32 v142, v48, v49
    v_mfma_f32_16x16x32_bf16 v[36:39], a[152:155], a[40:43], v[36:39]
    v_exp_f32 v52, v52
    v_mfma_f32_16x16x32_bf16 v[40:43], a[152:155], a[72:75], v[40:43]
    s_waitcnt lgkmcnt(3)
    v_exp_f32 v53, v53
    v_mfma_f32_16x16x32_bf16 v[44:47], a[152:155], a[104:107], v[44:47]
    v_cvt_pk_bf16_f32 v143, v50, v51
    v_mul_f32 v0, s27, v0
    v_mfma_f32_16x16x32_bf16 v[32:35], a[156:159], a[12:15], v[32:35]
    ds_read_b128 a[152:155], v68 offset:2048
    v_cvt_pk_bf16_f32 v206, v52, v53
    v_mfma_f32_16x16x32_bf16 v[36:39], a[156:159], a[44:47], v[36:39]
    v_exp_f32 v54, v54
    v_mfma_f32_16x16x32_bf16 v[40:43], a[156:159], a[76:79], v[40:43]
    s_add_u32 s26, s25, s31
    v_exp_f32 v55, v55
    v_mfma_f32_16x16x32_bf16 v[44:47], a[156:159], a[108:111], v[44:47]
    v_exp_f32 v56, v56
    v_mfma_f32_16x16x32_bf16 v[32:35], a[160:163], a[16:19], v[32:35]
    ds_read_b128 a[156:159], v69 offset:2048
    v_cvt_pk_bf16_f32 v207, v54, v55
    v_mfma_f32_16x16x32_bf16 v[36:39], a[160:163], a[48:51], v[36:39]
    s_add_u32 m0, m0, s51
    v_exp_f32 v57, v57
    v_mfma_f32_16x16x32_bf16 v[40:43], a[160:163], a[80:83], v[40:43]
    buffer_load_dwordx4 v79, s[12:15], s26 offen sc0 sc1 lds
    v_mfma_f32_16x16x32_bf16 v[44:47], a[160:163], a[112:115], v[44:47]
    s_waitcnt lgkmcnt(3)
    v_exp_f32 v58, v58
    v_mfma_f32_16x16x32_bf16 v[32:35], a[164:167], a[20:23], v[32:35]
    ds_read_b128 a[160:163], v68 offset:6144
    v_cvt_pk_bf16_f32 v56, v56, v57
    v_mfma_f32_16x16x32_bf16 v[36:39], a[164:167], a[52:55], v[36:39]
    v_exp_f32 v59, v59
    v_mfma_f32_16x16x32_bf16 v[40:43], a[164:167], a[84:87], v[40:43]
    v_accvgpr_write_b32 a198, v56
    v_mul_f32 v1, s27, v1
    v_mfma_f32_16x16x32_bf16 v[44:47], a[164:167], a[116:119], v[44:47]
    v_cvt_pk_bf16_f32 v58, v58, v59
    v_mul_f32 v2, s27, v2
    v_mfma_f32_16x16x32_bf16 v[32:35], a[144:147], a[24:27], v[32:35]
    v_accvgpr_write_b32 a199, v58
    v_mul_f32 v3, s27, v3
    v_mfma_f32_16x16x32_bf16 v[36:39], a[144:147], a[56:59], v[36:39]
    v_exp_f32 v60, v60
    v_mfma_f32_16x16x32_bf16 v[40:43], a[144:147], a[88:91], v[40:43]
    s_waitcnt lgkmcnt(2)
    v_exp_f32 v61, v61
    v_mfma_f32_16x16x32_bf16 v[44:47], a[144:147], a[120:123], v[44:47]
    v_exp_f32 v62, v62
    v_mfma_f32_16x16x32_bf16 v[32:35], a[148:151], a[28:31], v[32:35]
    ds_read_b128 a[144:147], v69 offset:6144
    v_cvt_pk_bf16_f32 v60, v60, v61
    v_mfma_f32_16x16x32_bf16 v[36:39], a[148:151], a[60:63], v[36:39]
    v_exp_f32 v63, v63
    v_mfma_f32_16x16x32_bf16 v[40:43], a[148:151], a[92:95], v[40:43]
    v_accvgpr_write_b32 a254, v60
    v_mul_f32 v4, s27, v4
    v_mfma_f32_16x16x32_bf16 v[44:47], a[148:151], a[124:127], v[44:47]
    v_cvt_pk_bf16_f32 v62, v62, v63
    v_mul_f32 v5, s27, v5
    v_smfmac_f32_16x16x64_bf16 a[136:139], a[128:131], v[136:143], v84
    v_accvgpr_write_b32 a255, v62
    v_smfmac_f32_16x16x64_bf16 a[136:139], a[132:135], v[200:207], v84
    v_mul_f32 v6, s27, v6
    v_smfmac_f32_16x16x64_bf16 a[140:143], a[128:131], a[192:199], v84
    v_mul_f32 v7, s27, v7
    v_smfmac_f32_16x16x64_bf16 a[140:143], a[132:135], a[248:255], v84
    v_mul_f32 v8, s27, v8
    v_mfma_f32_16x16x32_bf16 v[48:51], a[152:155], a[0:3], v[148:151]
    ds_read_b128 a[148:151], v68 offset:10240
    v_mul_f32 v9, s27, v9
    v_mfma_f32_16x16x32_bf16 v[52:55], a[152:155], a[32:35], v[212:215]
    v_exp_f32 v0, v0
    v_mfma_f32_16x16x32_bf16 v[56:59], a[152:155], a[64:67], v[244:247]
    s_waitcnt lgkmcnt(2)
    v_exp_f32 v1, v1
    v_mfma_f32_16x16x32_bf16 v[60:63], a[152:155], a[96:99], v[252:255]
    v_exp_f32 v2, v2
    v_mfma_f32_16x16x32_bf16 v[48:51], a[156:159], a[4:7], v[48:51]
    ds_read_b128 a[152:155], v69 offset:10240
    v_cvt_pk_bf16_f32 v144, v0, v1
    v_mfma_f32_16x16x32_bf16 v[52:55], a[156:159], a[36:39], v[52:55]
    s_waitcnt vmcnt(8)
    v_exp_f32 v3, v3
    v_mfma_f32_16x16x32_bf16 v[56:59], a[156:159], a[68:71], v[56:59]
    s_barrier
    v_mfma_f32_16x16x32_bf16 v[60:63], a[156:159], a[100:103], v[60:63]
    v_cvt_pk_bf16_f32 v145, v2, v3
    v_mul_f32 v10, s27, v10
    v_mfma_f32_16x16x32_bf16 v[48:51], a[160:163], a[8:11], v[48:51]
    ds_read_b128 a[156:159], v68 offset:14336
    v_mul_f32 v11, s27, v11
    v_mfma_f32_16x16x32_bf16 v[52:55], a[160:163], a[40:43], v[52:55]
    v_exp_f32 v4, v4
    v_mfma_f32_16x16x32_bf16 v[56:59], a[160:163], a[72:75], v[56:59]
    s_xor_b32 s25, s21, 128
    v_exp_f32 v5, v5
    v_mfma_f32_16x16x32_bf16 v[60:63], a[160:163], a[104:107], v[60:63]
    s_waitcnt lgkmcnt(2)
    v_exp_f32 v6, v6
    v_mfma_f32_16x16x32_bf16 v[48:51], a[144:147], a[12:15], v[48:51]
    ds_read_b128 a[160:163], v69 offset:14336
    v_cvt_pk_bf16_f32 v208, v4, v5
    v_mfma_f32_16x16x32_bf16 v[52:55], a[144:147], a[44:47], v[52:55]
    s_add_u32 m0, m0, s95
    v_exp_f32 v7, v7
    v_mfma_f32_16x16x32_bf16 v[56:59], a[144:147], a[76:79], v[56:59]
    buffer_load_dwordx4 v79, s[12:15], s25 offen sc0 sc1 lds
    v_mfma_f32_16x16x32_bf16 v[60:63], a[144:147], a[108:111], v[60:63]
    v_cvt_pk_bf16_f32 v209, v6, v7
    v_mul_f32 v12, s27, v12
    v_mfma_f32_16x16x32_bf16 v[48:51], a[148:151], a[16:19], v[48:51]
    ds_read_b64_tr_b16 a[144:145], v74 offset:16384
    v_mul_f32 v13, s27, v13
    v_mfma_f32_16x16x32_bf16 v[52:55], a[148:151], a[48:51], v[52:55]
    ds_read_b64_tr_b16 a[146:147], v74 offset:18432
    v_mul_f32 v14, s27, v14
    v_mfma_f32_16x16x32_bf16 v[56:59], a[148:151], a[80:83], v[56:59]
    s_waitcnt lgkmcnt(3)
    v_exp_f32 v8, v8
    v_mfma_f32_16x16x32_bf16 v[60:63], a[148:151], a[112:115], v[60:63]
    v_exp_f32 v9, v9
    v_mfma_f32_16x16x32_bf16 v[48:51], a[152:155], a[20:23], v[48:51]
    ds_read_b64_tr_b16 a[148:149], v74 offset:20480
    v_mul_f32 v15, s27, v15
    v_mfma_f32_16x16x32_bf16 v[52:55], a[152:155], a[52:55], v[52:55]
    ds_read_b64_tr_b16 a[150:151], v74 offset:22528
    v_cvt_pk_bf16_f32 v240, v8, v9
    v_mfma_f32_16x16x32_bf16 v[56:59], a[152:155], a[84:87], v[56:59]
    s_add_u32 s26, s25, s31
    v_exp_f32 v10, v10
    v_mfma_f32_16x16x32_bf16 v[60:63], a[152:155], a[116:119], v[60:63]
    v_exp_f32 v11, v11
    v_mfma_f32_16x16x32_bf16 v[48:51], a[156:159], a[24:27], v[48:51]
    ds_read_b64_tr_b16 a[152:153], v74 offset:24576
    v_mul_f32 v16, s27, v16
    v_mfma_f32_16x16x32_bf16 v[52:55], a[156:159], a[56:59], v[52:55]
    ds_read_b64_tr_b16 a[154:155], v74 offset:26624
    v_cvt_pk_bf16_f32 v241, v10, v11
    v_mfma_f32_16x16x32_bf16 v[56:59], a[156:159], a[88:91], v[56:59]
    s_add_u32 m0, m0, s51
    v_exp_f32 v12, v12
    v_mfma_f32_16x16x32_bf16 v[60:63], a[156:159], a[120:123], v[60:63]
    s_waitcnt lgkmcnt(4)
    v_exp_f32 v13, v13
    v_mfma_f32_16x16x32_bf16 v[48:51], a[160:163], a[28:31], v[48:51]
    ds_read_b64_tr_b16 a[156:157], v74 offset:28672
    v_mul_f32 v17, s27, v17
    v_mfma_f32_16x16x32_bf16 v[52:55], a[160:163], a[60:63], v[52:55]
    ds_read_b64_tr_b16 a[158:159], v74 offset:30720
    v_cvt_pk_bf16_f32 v248, v12, v13
    v_mfma_f32_16x16x32_bf16 v[56:59], a[160:163], a[92:95], v[56:59]
    buffer_load_dwordx4 v79, s[12:15], s26 offen sc0 sc1 lds
    v_mfma_f32_16x16x32_bf16 v[60:63], a[160:163], a[124:127], v[60:63]
    v_exp_f32 v14, v14
    v_mfma_f32_16x16x32_bf16 v[0:3], a[144:147], v[88:91], 0
    ds_read_b64_tr_b16 a[160:161], v74 offset:32768
    v_mul_f32 v18, s27, v18
    v_mfma_f32_16x16x32_bf16 v[4:7], a[144:147], v[152:155], 0
    ds_read_b64_tr_b16 a[164:165], v74 offset:36864
    v_mul_f32 v19, s27, v19
    v_mfma_f32_16x16x32_bf16 v[8:11], a[144:147], v[216:219], 0
    ds_read_b64_tr_b16 a[162:163], v74 offset:34816
    v_mul_f32 v20, s27, v20
    v_exp_f32 v15, v15
    s_nop 0
    v_cvt_pk_bf16_f32 v249, v14, v15
    v_mfma_f32_16x16x32_bf16 v[12:15], a[144:147], a[200:203], 0
    ds_read_b64_tr_b16 a[166:167], v74 offset:38912
    s_waitcnt lgkmcnt(6)
    v_mfma_f32_16x16x32_bf16 v[0:3], a[148:151], v[92:95], v[0:3]
    ds_read_b64_tr_b16 a[144:145], v74 offset:40960
    v_mul_f32 v21, s27, v21
    v_mfma_f32_16x16x32_bf16 v[4:7], a[148:151], v[156:159], v[4:7]
    ds_read_b64_tr_b16 a[146:147], v74 offset:43008
    v_mul_f32 v22, s27, v22
    v_mfma_f32_16x16x32_bf16 v[8:11], a[148:151], v[220:223], v[8:11]
    s_add_u32 s25, s26, s31
    v_exp_f32 v16, v16
    v_mfma_f32_16x16x32_bf16 v[12:15], a[148:151], a[204:207], v[12:15]
    s_add_u32 m0, m0, s51
    v_exp_f32 v17, v17
    v_mfma_f32_16x16x32_bf16 v[0:3], a[152:155], v[96:99], v[0:3]
    ds_read_b64_tr_b16 a[148:149], v74 offset:45056
    v_mul_f32 v23, s27, v23
    v_mfma_f32_16x16x32_bf16 v[4:7], a[152:155], v[160:163], v[4:7]
    ds_read_b64_tr_b16 a[150:151], v74 offset:47104
    v_cvt_pk_bf16_f32 v146, v16, v17
    v_mfma_f32_16x16x32_bf16 v[8:11], a[152:155], v[224:227], v[8:11]
    buffer_load_dwordx4 v79, s[12:15], s25 offen sc0 sc1 lds
    v_mfma_f32_16x16x32_bf16 v[12:15], a[152:155], a[208:211], v[12:15]
    s_waitcnt lgkmcnt(5)
    v_exp_f32 v18, v18
    v_mfma_f32_16x16x32_bf16 v[0:3], a[156:159], v[100:103], v[0:3]
    ds_read_b64_tr_b16 a[152:153], v75 offset:16384
    v_mul_f32 v24, s27, v24
    v_mfma_f32_16x16x32_bf16 v[4:7], a[156:159], v[164:167], v[4:7]
    ds_read_b64_tr_b16 a[154:155], v75 offset:18432
    v_mul_f32 v25, s27, v25
    v_mfma_f32_16x16x32_bf16 v[8:11], a[156:159], v[228:231], v[8:11]
    ds_read_b128 a[0:3], v70 offset:0
    v_mul_f32 v26, s27, v26
    v_mfma_f32_16x16x32_bf16 v[12:15], a[156:159], a[212:215], v[12:15]
    ds_read_b128 a[4:7], v71 offset:0
    v_mul_f32 v27, s27, v27
    v_mfma_f32_16x16x32_bf16 v[0:3], a[160:163], v[104:107], v[0:3]
    ds_read_b64_tr_b16 a[156:157], v75 offset:20480
    v_mul_f32 v28, s27, v28
    v_mfma_f32_16x16x32_bf16 v[4:7], a[160:163], v[168:171], v[4:7]
    ds_read_b64_tr_b16 a[158:159], v75 offset:22528
    v_mul_f32 v29, s27, v29
    v_mfma_f32_16x16x32_bf16 v[8:11], a[160:163], v[232:235], v[8:11]
    s_add_u32 s26, s25, s31
    v_exp_f32 v19, v19
    v_mfma_f32_16x16x32_bf16 v[12:15], a[160:163], a[216:219], v[12:15]
    s_waitcnt lgkmcnt(8)
    v_exp_f32 v20, v20
    v_mfma_f32_16x16x32_bf16 v[0:3], a[164:167], v[108:111], v[0:3]
    ds_read_b64_tr_b16 a[160:161], v75 offset:24576
    v_cvt_pk_bf16_f32 v147, v18, v19
    v_mfma_f32_16x16x32_bf16 v[4:7], a[164:167], v[172:175], v[4:7]
    ds_read_b64_tr_b16 a[162:163], v75 offset:26624
    s_add_u32 m0, m0, s51
    v_mfma_f32_16x16x32_bf16 v[8:11], a[164:167], v[236:239], v[8:11]
    buffer_load_dwordx4 v79, s[12:15], s26 offen sc0 sc1 lds
    v_mfma_f32_16x16x32_bf16 v[12:15], a[164:167], a[220:223], v[12:15]
    ds_read_b128 a[8:11], v70 offset:2048
    v_mul_f32 v30, s27, v30
    v_mfma_f32_16x16x32_bf16 v[0:3], a[144:147], v[112:115], v[0:3]
    ds_read_b64_tr_b16 a[164:165], v75 offset:28672
    v_mul_f32 v31, s27, v31
    v_mfma_f32_16x16x32_bf16 v[4:7], a[144:147], v[176:179], v[4:7]
    ds_read_b64_tr_b16 a[166:167], v75 offset:30720
    v_mul_f32 v32, s27, v32
    v_mfma_f32_16x16x32_bf16 v[8:11], a[144:147], a[168:171], v[8:11]
    ds_read_b128 a[12:15], v71 offset:2048
    v_mul_f32 v33, s27, v33
    v_mfma_f32_16x16x32_bf16 v[12:15], a[144:147], a[224:227], v[12:15]
    s_waitcnt lgkmcnt(10)
    v_exp_f32 v21, v21
    v_mfma_f32_16x16x32_bf16 v[0:3], a[148:151], v[116:119], v[0:3]
    ds_read_b64_tr_b16 a[144:145], v75 offset:32768
    v_mul_f32 v34, s27, v34
    v_mfma_f32_16x16x32_bf16 v[4:7], a[148:151], v[180:183], v[4:7]
    ds_read_b64_tr_b16 a[146:147], v75 offset:34816
    v_cvt_pk_bf16_f32 v210, v20, v21
    v_mfma_f32_16x16x32_bf16 v[8:11], a[148:151], a[172:175], v[8:11]
    s_xor_b32 s25, s21, 65664
    v_exp_f32 v22, v22
    v_mfma_f32_16x16x32_bf16 v[12:15], a[148:151], a[228:231], v[12:15]
    s_add_u32 m0, m0, s95
    v_exp_f32 v23, v23
    v_mfma_f32_16x16x32_bf16 v[16:19], a[152:155], v[88:91], 0
    ds_read_b64_tr_b16 a[148:149], v75 offset:36864
    v_mul_f32 v35, s27, v35
    v_cvt_pk_bf16_f32 v211, v22, v23
    v_mfma_f32_16x16x32_bf16 v[20:23], a[152:155], v[152:155], 0
    ds_read_b64_tr_b16 a[150:151], v75 offset:38912
    v_exp_f32 v24, v24
    v_exp_f32 v25, v25
    v_exp_f32 v26, v26
    v_exp_f32 v27, v27
    v_cvt_pk_bf16_f32 v242, v24, v25
    v_cvt_pk_bf16_f32 v243, v26, v27
    v_mfma_f32_16x16x32_bf16 v[24:27], a[152:155], v[216:219], 0
    buffer_load_dwordx4 v79, s[12:15], s25 offen sc0 sc1 lds
    v_exp_f32 v28, v28
    v_exp_f32 v29, v29
    v_exp_f32 v30, v30
    v_exp_f32 v31, v31
    v_cvt_pk_bf16_f32 v250, v28, v29
    v_cvt_pk_bf16_f32 v251, v30, v31
    v_mfma_f32_16x16x32_bf16 v[28:31], a[152:155], a[200:203], 0
    s_waitcnt lgkmcnt(8)
    s_add_u32 s43, s42, 256
    v_mul_f32 v36, s27, v36
    v_mfma_f32_16x16x32_bf16 v[16:19], a[156:159], v[92:95], v[16:19]
    ds_read_b64_tr_b16 a[152:153], v75 offset:40960
    v_mul_f32 v37, s27, v37
    v_mfma_f32_16x16x32_bf16 v[20:23], a[156:159], v[156:159], v[20:23]
    ds_read_b64_tr_b16 a[154:155], v75 offset:43008
    s_add_u32 m0, s44, 114688
    v_mfma_f32_16x16x32_bf16 v[24:27], a[156:159], v[220:223], v[24:27]
    v_exp_f32 v32, v32
    v_mfma_f32_16x16x32_bf16 v[28:31], a[156:159], a[204:207], v[28:31]
    v_exp_f32 v33, v33
    v_mfma_f32_16x16x32_bf16 v[16:19], a[160:163], v[96:99], v[16:19]
    ds_read_b64_tr_b16 a[156:157], v75 offset:45056
    v_mul_f32 v38, s27, v38
    v_mfma_f32_16x16x32_bf16 v[20:23], a[160:163], v[160:163], v[20:23]
    ds_read_b64_tr_b16 a[158:159], v75 offset:47104
    v_cvt_pk_bf16_f32 v148, v32, v33
    v_mfma_f32_16x16x32_bf16 v[24:27], a[160:163], v[224:227], v[24:27]
    s_waitcnt lgkmcnt(6)
    v_exp_f32 v34, v34
    v_mfma_f32_16x16x32_bf16 v[28:31], a[160:163], a[208:211], v[28:31]
    buffer_load_dwordx4 v78, s[4:7], s43 offen offset:0 sc0 sc1 nt lds
    v_mfma_f32_16x16x32_bf16 v[16:19], a[164:167], v[100:103], v[16:19]
    s_waitcnt vmcnt(10)
    s_barrier
    ds_read_b64_tr_b16 a[160:161], v74 offset:49152
    s_add_u32 s26, s25, s31
    v_mfma_f32_16x16x32_bf16 v[20:23], a[164:167], v[164:167], v[20:23]
    ds_read_b64_tr_b16 a[162:163], v74 offset:51200
    s_add_u32 m0, s23, 99328
    v_mfma_f32_16x16x32_bf16 v[24:27], a[164:167], v[228:231], v[24:27]
    buffer_load_dwordx4 v79, s[12:15], s26 offen sc0 sc1 lds
    v_mfma_f32_16x16x32_bf16 v[28:31], a[164:167], a[212:215], v[28:31]
    s_add_u32 m0, s45, 114688
    v_exp_f32 v35, v35
    v_mfma_f32_16x16x32_bf16 v[16:19], a[144:147], v[104:107], v[16:19]
    ds_read_b64_tr_b16 a[164:165], v74 offset:53248
    v_mul_f32 v39, s27, v39
L_w5:
    s_cbranch_execz L_w9
    v_mfma_f32_16x16x32_bf16 v[20:23], a[144:147], v[168:171], v[20:23]
    ds_read_b64_tr_b16 a[166:167], v74 offset:55296
    v_cvt_pk_bf16_f32 v149, v34, v35
    v_mfma_f32_16x16x32_bf16 v[24:27], a[144:147], v[232:235], v[24:27]
    buffer_load_dwordx4 v72, s[4:7], s43 offen offset:0 sc0 sc1 nt lds
    v_mfma_f32_16x16x32_bf16 v[28:31], a[144:147], a[216:219], v[28:31]
    s_waitcnt lgkmcnt(6)
    v_exp_f32 v36, v36
    v_mfma_f32_16x16x32_bf16 v[16:19], a[148:151], v[108:111], v[16:19]
    ds_read_b64_tr_b16 a[144:145], v74 offset:57344
    v_mul_f32 v40, s27, v40
    v_mfma_f32_16x16x32_bf16 v[20:23], a[148:151], v[172:175], v[20:23]
    ds_read_b64_tr_b16 a[146:147], v74 offset:59392
    s_add_u32 m0, s44, 116608
    v_mfma_f32_16x16x32_bf16 v[24:27], a[148:151], v[236:239], v[24:27]
    s_add_u32 s25, s26, s31
    v_exp_f32 v37, v37
    v_mfma_f32_16x16x32_bf16 v[28:31], a[148:151], a[220:223], v[28:31]
    buffer_load_dwordx4 v78, s[4:7], s43 offen offset:128 sc0 sc1 nt lds
    v_mfma_f32_16x16x32_bf16 v[16:19], a[152:155], v[112:115], v[16:19]
    ds_read_b64_tr_b16 a[148:149], v74 offset:61440
    v_cvt_pk_bf16_f32 v212, v36, v37
    v_mfma_f32_16x16x32_bf16 v[20:23], a[152:155], v[176:179], v[20:23]
    ds_read_b64_tr_b16 a[150:151], v74 offset:63488
    s_add_u32 m0, s23, 100352
    v_mfma_f32_16x16x32_bf16 v[24:27], a[152:155], a[168:171], v[24:27]
    buffer_load_dwordx4 v79, s[12:15], s25 offen sc0 sc1 lds
    v_mfma_f32_16x16x32_bf16 v[28:31], a[152:155], a[224:227], v[28:31]
    s_waitcnt lgkmcnt(6)
    v_add_u32 v74, s96, v74
    v_mul_f32 v41, s27, v41
    v_mfma_f32_16x16x32_bf16 v[16:19], a[156:159], v[116:119], v[16:19]
    ds_read_b64_tr_b16 a[152:153], v75 offset:49152
    v_mul_f32 v42, s27, v42
    v_mfma_f32_16x16x32_bf16 v[20:23], a[156:159], v[180:183], v[20:23]
    ds_read_b64_tr_b16 a[154:155], v75 offset:51200
    s_add_u32 m0, s45, 116608
    v_mfma_f32_16x16x32_bf16 v[24:27], a[156:159], a[172:175], v[24:27]
    buffer_load_dwordx4 v72, s[4:7], s43 offen offset:128 sc0 sc1 nt lds
    v_mfma_f32_16x16x32_bf16 v[28:31], a[156:159], a[228:231], v[28:31]
    s_add_u32 s26, s25, s31
    v_exp_f32 v38, v38
    v_mfma_f32_16x16x32_bf16 v[0:3], a[160:163], v[120:123], v[0:3]
    ds_read_b64_tr_b16 a[156:157], v75 offset:53248
    v_mul_f32 v43, s27, v43
    v_mfma_f32_16x16x32_bf16 v[4:7], a[160:163], v[184:187], v[4:7]
    ds_read_b64_tr_b16 a[158:159], v75 offset:55296
    v_mul_f32 v44, s27, v44
    v_mfma_f32_16x16x32_bf16 v[8:11], a[160:163], a[176:179], v[8:11]
    s_add_u32 m0, s23, 101376
    v_exp_f32 v39, v39
    v_mfma_f32_16x16x32_bf16 v[12:15], a[160:163], a[232:235], v[12:15]
    s_waitcnt lgkmcnt(6)
    v_exp_f32 v40, v40
    v_mfma_f32_16x16x32_bf16 v[0:3], a[164:167], v[124:127], v[0:3]
    ds_read_b64_tr_b16 a[160:161], v75 offset:57344
    v_cvt_pk_bf16_f32 v213, v38, v39
    v_mfma_f32_16x16x32_bf16 v[4:7], a[164:167], v[188:191], v[4:7]
    ds_read_b64_tr_b16 a[162:163], v75 offset:59392
    v_mul_f32 v45, s27, v45
    v_mfma_f32_16x16x32_bf16 v[8:11], a[164:167], a[180:183], v[8:11]
    buffer_load_dwordx4 v79, s[12:15], s26 offen sc0 sc1 lds
    v_mfma_f32_16x16x32_bf16 v[12:15], a[164:167], a[236:239], v[12:15]
    v_exp_f32 v41, v41
    v_mfma_f32_16x16x32_bf16 v[0:3], a[144:147], v[128:131], v[0:3]
    ds_read_b64_tr_b16 a[164:165], v75 offset:61440
    v_mul_f32 v46, s27, v46
    v_mfma_f32_16x16x32_bf16 v[4:7], a[144:147], v[192:195], v[4:7]
    ds_read_b64_tr_b16 a[166:167], v75 offset:63488
    v_add_u32 v75, s96, v75
    v_mfma_f32_16x16x32_bf16 v[8:11], a[144:147], a[184:187], v[8:11]
    s_xor_b32 s25, s21, 131200
    v_exp_f32 v42, v42
    v_mfma_f32_16x16x32_bf16 v[12:15], a[144:147], a[240:243], v[12:15]
    s_waitcnt lgkmcnt(6)
    v_exp_f32 v43, v43
    v_mfma_f32_16x16x32_bf16 v[0:3], a[148:151], v[132:135], v[0:3]
    ds_read_b64_tr_b16 a[144:145], v76 offset:16384
    v_cvt_pk_bf16_f32 v244, v40, v41
    v_mfma_f32_16x16x32_bf16 v[4:7], a[148:151], v[196:199], v[4:7]
    ds_read_b64_tr_b16 a[146:147], v76 offset:18432
    v_cvt_pk_bf16_f32 v245, v42, v43
    v_mfma_f32_16x16x32_bf16 v[8:11], a[148:151], a[188:191], v[8:11]
    s_add_u32 m0, s23, 0
    v_mul_f32 v47, s27, v47
    v_mul_f32 v48, s27, v48
    v_mfma_f32_16x16x32_bf16 v[12:15], a[148:151], a[244:247], v[12:15]
    buffer_load_dwordx4 v79, s[12:15], s25 offen sc0 sc1 lds
    v_mfma_f32_16x16x32_bf16 v[16:19], a[152:155], v[120:123], v[16:19]
    ds_read_b64_tr_b16 a[148:149], v76 offset:20480
    v_mul_f32 v49, s27, v49
    v_mfma_f32_16x16x32_bf16 v[20:23], a[152:155], v[184:187], v[20:23]
    ds_read_b64_tr_b16 a[150:151], v76 offset:22528
    v_mul_f32 v50, s27, v50
    v_mfma_f32_16x16x32_bf16 v[24:27], a[152:155], a[176:179], v[24:27]
    s_waitcnt lgkmcnt(6)
    v_exp_f32 v44, v44
    v_mfma_f32_16x16x32_bf16 v[28:31], a[152:155], a[232:235], v[28:31]
    v_exp_f32 v45, v45
    v_mfma_f32_16x16x32_bf16 v[16:19], a[156:159], v[124:127], v[16:19]
    ds_read_b64_tr_b16 a[152:153], v76 offset:24576
    v_mul_f32 v51, s27, v51
    v_mfma_f32_16x16x32_bf16 v[20:23], a[156:159], v[188:191], v[20:23]
    ds_read_b64_tr_b16 a[154:155], v76 offset:26624
    v_cvt_pk_bf16_f32 v252, v44, v45
    v_mfma_f32_16x16x32_bf16 v[24:27], a[156:159], a[180:183], v[24:27]
    s_add_u32 s26, s25, s31
    v_exp_f32 v46, v46
    v_mfma_f32_16x16x32_bf16 v[28:31], a[156:159], a[236:239], v[28:31]
    v_exp_f32 v47, v47
    v_mfma_f32_16x16x32_bf16 v[16:19], a[160:163], v[128:131], v[16:19]
    ds_read_b64_tr_b16 a[156:157], v76 offset:28672
    v_mul_f32 v52, s27, v52
    v_mfma_f32_16x16x32_bf16 v[20:23], a[160:163], v[192:195], v[20:23]
    ds_read_b64_tr_b16 a[158:159], v76 offset:30720
    v_cvt_pk_bf16_f32 v253, v46, v47
    v_mfma_f32_16x16x32_bf16 v[24:27], a[160:163], a[184:187], v[24:27]
    s_add_u32 m0, m0, s51
    v_exp_f32 v48, v48
    v_mfma_f32_16x16x32_bf16 v[28:31], a[160:163], a[240:243], v[28:31]
    s_waitcnt lgkmcnt(6)
    v_exp_f32 v49, v49
    v_mfma_f32_16x16x32_bf16 v[16:19], a[164:167], v[132:135], v[16:19]
    ds_read_b64_tr_b16 a[160:161], v76 offset:32768
    v_mul_f32 v53, s27, v53
    v_mfma_f32_16x16x32_bf16 v[20:23], a[164:167], v[196:199], v[20:23]
    ds_read_b64_tr_b16 a[162:163], v76 offset:34816
    v_cvt_pk_bf16_f32 v150, v48, v49
    v_mfma_f32_16x16x32_bf16 v[24:27], a[164:167], a[188:191], v[24:27]
    buffer_load_dwordx4 v79, s[12:15], s26 offen sc0 sc1 lds
    v_mfma_f32_16x16x32_bf16 v[28:31], a[164:167], a[244:247], v[28:31]
    v_exp_f32 v50, v50
    v_mfma_f32_16x16x32_bf16 v[32:35], a[144:147], v[88:91], 0
    ds_read_b64_tr_b16 a[164:165], v76 offset:36864
    v_mul_f32 v54, s27, v54
    v_mfma_f32_16x16x32_bf16 v[36:39], a[144:147], v[152:155], 0
    ds_read_b64_tr_b16 a[166:167], v76 offset:38912
    v_mul_f32 v55, s27, v55
    v_mfma_f32_16x16x32_bf16 v[40:43], a[144:147], v[216:219], 0
    s_waitcnt lgkmcnt(6)
    v_exp_f32 v51, v51
    v_mfma_f32_16x16x32_bf16 v[44:47], a[144:147], a[200:203], 0
    v_exp_f32 v52, v52
    v_mfma_f32_16x16x32_bf16 v[32:35], a[148:151], v[92:95], v[32:35]
    ds_read_b64_tr_b16 a[144:145], v76 offset:40960
    v_cvt_pk_bf16_f32 v151, v50, v51
    v_mfma_f32_16x16x32_bf16 v[36:39], a[148:151], v[156:159], v[36:39]
    ds_read_b64_tr_b16 a[146:147], v76 offset:43008
    v_mul_f32 v56, s27, v56
    v_mfma_f32_16x16x32_bf16 v[40:43], a[148:151], v[220:223], v[40:43]
    s_barrier
    v_mfma_f32_16x16x32_bf16 v[44:47], a[148:151], a[204:207], v[44:47]
    s_add_u32 s25, s26, s31
    v_exp_f32 v53, v53
    v_mfma_f32_16x16x32_bf16 v[32:35], a[152:155], v[96:99], v[32:35]
    ds_read_b64_tr_b16 a[148:149], v76 offset:45056
    v_mul_f32 v57, s27, v57
    v_mfma_f32_16x16x32_bf16 v[36:39], a[152:155], v[160:163], v[36:39]
    ds_read_b64_tr_b16 a[150:151], v76 offset:47104
    v_cvt_pk_bf16_f32 v214, v52, v53
    v_mfma_f32_16x16x32_bf16 v[40:43], a[152:155], v[224:227], v[40:43]
    s_add_u32 m0, m0, s51
    v_exp_f32 v54, v54
    v_mfma_f32_16x16x32_bf16 v[44:47], a[152:155], a[208:211], v[44:47]
    s_waitcnt lgkmcnt(6)
    v_exp_f32 v55, v55
    v_mfma_f32_16x16x32_bf16 v[32:35], a[156:159], v[100:103], v[32:35]
    ds_read_b64_tr_b16 a[152:153], v76 offset:49152
    v_mul_f32 v58, s27, v58
    v_mfma_f32_16x16x32_bf16 v[36:39], a[156:159], v[164:167], v[36:39]
    ds_read_b64_tr_b16 a[154:155], v76 offset:51200
    v_cvt_pk_bf16_f32 v215, v54, v55
    v_mfma_f32_16x16x32_bf16 v[40:43], a[156:159], v[228:231], v[40:43]
    buffer_load_dwordx4 v79, s[12:15], s25 offen sc0 sc1 lds
    v_mfma_f32_16x16x32_bf16 v[44:47], a[156:159], a[212:215], v[44:47]
    v_mul_f32 v59, s27, v59
    v_mul_f32 v60, s27, v60
    v_mfma_f32_16x16x32_bf16 v[32:35], a[160:163], v[104:107], v[32:35]
    ds_read_b64_tr_b16 a[156:157], v76 offset:53248
    v_mul_f32 v61, s27, v61
    v_mfma_f32_16x16x32_bf16 v[36:39], a[160:163], v[168:171], v[36:39]
    ds_read_b64_tr_b16 a[158:159], v76 offset:55296
    v_mul_f32 v62, s27, v62
    v_mfma_f32_16x16x32_bf16 v[40:43], a[160:163], v[232:235], v[40:43]
    s_add_u32 s26, s25, s31
    v_exp_f32 v56, v56
    v_mfma_f32_16x16x32_bf16 v[44:47], a[160:163], a[216:219], v[44:47]
    s_waitcnt lgkmcnt(6)
    v_exp_f32 v57, v57
    v_mfma_f32_16x16x32_bf16 v[32:35], a[164:167], v[108:111], v[32:35]
    ds_read_b64_tr_b16 a[160:161], v76 offset:57344
    v_mul_f32 v63, s27, v63
    v_mfma_f32_16x16x32_bf16 v[36:39], a[164:167], v[172:175], v[36:39]
    ds_read_b64_tr_b16 a[162:163], v76 offset:59392
    v_cvt_pk_bf16_f32 v246, v56, v57
    v_mfma_f32_16x16x32_bf16 v[40:43], a[164:167], v[236:239], v[40:43]
    s_add_u32 m0, m0, s51
    v_exp_f32 v58, v58
    v_mfma_f32_16x16x32_bf16 v[44:47], a[164:167], a[220:223], v[44:47]
    buffer_load_dwordx4 v79, s[12:15], s26 offen sc0 sc1 lds
    v_mfma_f32_16x16x32_bf16 v[32:35], a[144:147], v[112:115], v[32:35]
    ds_read_b64_tr_b16 a[164:165], v76 offset:61440
    v_mfma_f32_16x16x32_bf16 v[36:39], a[144:147], v[176:179], v[36:39]
    ds_read_b64_tr_b16 a[166:167], v76 offset:63488
    v_add_u32 v76, s96, v76
    v_mfma_f32_16x16x32_bf16 v[40:43], a[144:147], a[168:171], v[40:43]
    s_waitcnt lgkmcnt(6)
    v_exp_f32 v59, v59
    v_mfma_f32_16x16x32_bf16 v[44:47], a[144:147], a[224:227], v[44:47]
    v_exp_f32 v60, v60
    v_mfma_f32_16x16x32_bf16 v[32:35], a[148:151], v[116:119], v[32:35]
    ds_read_b64_tr_b16 a[144:145], v77 offset:16384
    v_cvt_pk_bf16_f32 v247, v58, v59
    v_mfma_f32_16x16x32_bf16 v[36:39], a[148:151], v[180:183], v[36:39]
    ds_read_b64_tr_b16 a[146:147], v77 offset:18432
    v_mfma_f32_16x16x32_bf16 v[40:43], a[148:151], a[172:175], v[40:43]
    v_exp_f32 v61, v61
    v_mfma_f32_16x16x32_bf16 v[44:47], a[148:151], a[228:231], v[44:47]
    v_exp_f32 v62, v62
    v_mfma_f32_16x16x32_bf16 v[32:35], a[152:155], v[120:123], v[32:35]
    ds_read_b64_tr_b16 a[148:149], v77 offset:20480
    v_cvt_pk_bf16_f32 v254, v60, v61
    v_mfma_f32_16x16x32_bf16 v[36:39], a[152:155], v[184:187], v[36:39]
    ds_read_b64_tr_b16 a[150:151], v77 offset:22528
    v_mfma_f32_16x16x32_bf16 v[40:43], a[152:155], a[176:179], v[40:43]
    s_waitcnt lgkmcnt(6)
    v_exp_f32 v63, v63
    v_mfma_f32_16x16x32_bf16 v[44:47], a[152:155], a[232:235], v[44:47]
    v_mfma_f32_16x16x32_bf16 v[32:35], a[156:159], v[124:127], v[32:35]
    ds_read_b64_tr_b16 a[152:153], v77 offset:24576
    v_cvt_pk_bf16_f32 v255, v62, v63
    v_mfma_f32_16x16x32_bf16 v[36:39], a[156:159], v[188:191], v[36:39]
    ds_read_b64_tr_b16 a[154:155], v77 offset:26624
    v_mfma_f32_16x16x32_bf16 v[40:43], a[156:159], a[180:183], v[40:43]
    v_mfma_f32_16x16x32_bf16 v[44:47], a[156:159], a[236:239], v[44:47]
    v_mfma_f32_16x16x32_bf16 v[32:35], a[160:163], v[128:131], v[32:35]
    ds_read_b64_tr_b16 a[156:157], v77 offset:28672
    v_mfma_f32_16x16x32_bf16 v[36:39], a[160:163], v[192:195], v[36:39]
    ds_read_b64_tr_b16 a[158:159], v77 offset:30720
    v_mfma_f32_16x16x32_bf16 v[40:43], a[160:163], a[184:187], v[40:43]
    s_waitcnt lgkmcnt(6)
    v_mfma_f32_16x16x32_bf16 v[44:47], a[160:163], a[240:243], v[44:47]
    v_mfma_f32_16x16x32_bf16 v[32:35], a[164:167], v[132:135], v[32:35]
    ds_read_b64_tr_b16 a[160:161], v77 offset:32768
    v_mfma_f32_16x16x32_bf16 v[36:39], a[164:167], v[196:199], v[36:39]
    ds_read_b64_tr_b16 a[162:163], v77 offset:34816
    v_mfma_f32_16x16x32_bf16 v[40:43], a[164:167], a[188:191], v[40:43]
    v_mfma_f32_16x16x32_bf16 v[44:47], a[164:167], a[244:247], v[44:47]
    v_mfma_f32_16x16x32_bf16 v[48:51], a[144:147], v[88:91], 0
    ds_read_b64_tr_b16 a[164:165], v77 offset:36864
    v_mfma_f32_16x16x32_bf16 v[52:55], a[144:147], v[152:155], 0
    ds_read_b64_tr_b16 a[166:167], v77 offset:38912
    v_mfma_f32_16x16x32_bf16 v[56:59], a[144:147], v[216:219], 0
    s_waitcnt lgkmcnt(6)
    v_mfma_f32_16x16x32_bf16 v[60:63], a[144:147], a[200:203], 0
    v_mfma_f32_16x16x32_bf16 v[48:51], a[148:151], v[92:95], v[48:51]
    ds_read_b64_tr_b16 a[144:145], v77 offset:40960
    v_mfma_f32_16x16x32_bf16 v[52:55], a[148:151], v[156:159], v[52:55]
    ds_read_b64_tr_b16 a[146:147], v77 offset:43008
    v_mfma_f32_16x16x32_bf16 v[56:59], a[148:151], v[220:223], v[56:59]
    v_mfma_f32_16x16x32_bf16 v[60:63], a[148:151], a[204:207], v[60:63]
    v_mfma_f32_16x16x32_bf16 v[48:51], a[152:155], v[96:99], v[48:51]
    ds_read_b64_tr_b16 a[148:149], v77 offset:45056
    v_mfma_f32_16x16x32_bf16 v[52:55], a[152:155], v[160:163], v[52:55]
    ds_read_b64_tr_b16 a[150:151], v77 offset:47104
    v_mfma_f32_16x16x32_bf16 v[56:59], a[152:155], v[224:227], v[56:59]
    ds_read_b128 a[32:35], v70 offset:16384
    s_waitcnt lgkmcnt(7)
    v_mfma_f32_16x16x32_bf16 v[60:63], a[152:155], a[208:211], v[60:63]
    v_mfma_f32_16x16x32_bf16 v[48:51], a[156:159], v[100:103], v[48:51]
    ds_read_b64_tr_b16 a[152:153], v77 offset:49152
    v_mfma_f32_16x16x32_bf16 v[52:55], a[156:159], v[164:167], v[52:55]
    ds_read_b64_tr_b16 a[154:155], v77 offset:51200
    v_mfma_f32_16x16x32_bf16 v[56:59], a[156:159], v[228:231], v[56:59]
    ds_read_b128 a[36:39], v71 offset:16384
    v_mfma_f32_16x16x32_bf16 v[60:63], a[156:159], a[212:215], v[60:63]
    v_smfmac_f32_16x16x64_bf16 a[136:139], a[128:131], v[144:151], v84
    v_smfmac_f32_16x16x64_bf16 a[136:139], a[132:135], v[208:215], v84
    v_smfmac_f32_16x16x64_bf16 a[140:143], a[128:131], v[240:247], v84
    v_smfmac_f32_16x16x64_bf16 a[140:143], a[132:135], v[248:255], v84
    v_mfma_f32_16x16x32_bf16 v[48:51], a[160:163], v[104:107], v[48:51]
    ds_read_b64_tr_b16 a[156:157], v77 offset:53248
    v_mfma_f32_16x16x32_bf16 v[52:55], a[160:163], v[168:171], v[52:55]
    ds_read_b64_tr_b16 a[158:159], v77 offset:55296
    v_mfma_f32_16x16x32_bf16 v[56:59], a[160:163], v[232:235], v[56:59]
    ds_read_b128 a[40:43], v70 offset:18432
    v_accvgpr_read_b32 v64, a136
    v_mfma_f32_16x16x32_bf16 v[60:63], a[160:163], a[216:219], v[60:63]
    s_waitcnt lgkmcnt(9)
    v_accvgpr_read_b32 v85, a137
    v_accvgpr_read_b32 v65, a138
    v_mfma_f32_16x16x32_bf16 v[48:51], a[164:167], v[108:111], v[48:51]
    ds_read_b64_tr_b16 a[160:161], v77 offset:57344
    v_add_f32 v64, v64, v85
    v_mfma_f32_16x16x32_bf16 v[52:55], a[164:167], v[172:175], v[52:55]
    ds_read_b64_tr_b16 a[162:163], v77 offset:59392
    v_accvgpr_read_b32 v86, a139
    v_mfma_f32_16x16x32_bf16 v[56:59], a[164:167], v[236:239], v[56:59]
    ds_read_b128 a[44:47], v71 offset:18432
    v_add_f32 v65, v65, v86
    v_mfma_f32_16x16x32_bf16 v[60:63], a[164:167], a[220:223], v[60:63]
    s_waitcnt vmcnt(16)
    v_accvgpr_read_b32 v66, a140
    v_accvgpr_read_b32 v85, a141
    v_mfma_f32_16x16x32_bf16 v[48:51], a[144:147], v[112:115], v[48:51]
    ds_read_b64_tr_b16 a[164:165], v77 offset:61440
    v_add_f32 v66, v66, v85
    v_mfma_f32_16x16x32_bf16 v[52:55], a[144:147], v[176:179], v[52:55]
    ds_read_b64_tr_b16 a[166:167], v77 offset:63488
    v_add_u32 v77, s96, v77
    v_mfma_f32_16x16x32_bf16 v[56:59], a[144:147], a[168:171], v[56:59]
    s_barrier
    v_mfma_f32_16x16x32_bf16 v[60:63], a[144:147], a[224:227], v[60:63]
    s_waitcnt lgkmcnt(9)
    v_accvgpr_read_b32 v67, a142
    v_accvgpr_read_b32 v86, a143
    v_mfma_f32_16x16x32_bf16 v[48:51], a[148:151], v[116:119], v[48:51]
    ds_read_b64_tr_b16 a[144:145], v74 offset:16384
    v_add_f32 v67, v67, v86
    v_mfma_f32_16x16x32_bf16 v[52:55], a[148:151], v[180:183], v[52:55]
    ds_read_b64_tr_b16 a[146:147], v74 offset:18432
    v_cmp_nlt_f32_e64 s[54:55], v64, s28
    v_mfma_f32_16x16x32_bf16 v[56:59], a[148:151], a[172:175], v[56:59]
    s_xor_b32 s25, s21, 196736
    v_rcp_f32 v64, v64
    v_mfma_f32_16x16x32_bf16 v[60:63], a[148:151], a[228:231], v[60:63]
    ds_read_b128 a[64:67], v70 offset:32768
    v_cmp_nlt_f32_e64 s[52:53], v65, s28
    v_mfma_f32_16x16x32_bf16 v[48:51], a[152:155], v[120:123], v[48:51]
    ds_read_b64_tr_b16 a[148:149], v74 offset:20480
    s_add_u32 m0, m0, s95
    v_mfma_f32_16x16x32_bf16 v[52:55], a[152:155], v[184:187], v[52:55]
    ds_read_b64_tr_b16 a[150:151], v74 offset:22528
    v_mfma_f32_16x16x32_bf16 v[56:59], a[152:155], a[176:179], v[56:59]
    buffer_load_dwordx4 v79, s[12:15], s25 offen sc0 sc1 lds
    v_mfma_f32_16x16x32_bf16 v[60:63], a[152:155], a[232:235], v[60:63]
    s_waitcnt lgkmcnt(8)
    v_rcp_f32 v65, v65
    v_mfma_f32_16x16x32_bf16 v[48:51], a[156:159], v[124:127], v[48:51]
    ds_read_b64_tr_b16 a[152:153], v74 offset:24576
    s_or_b64 s[54:55], s[54:55], s[52:53]
    v_mfma_f32_16x16x32_bf16 v[52:55], a[156:159], v[188:191], v[52:55]
    ds_read_b64_tr_b16 a[154:155], v74 offset:26624
    v_cmp_nlt_f32_e64 s[52:53], v66, s28
    v_mfma_f32_16x16x32_bf16 v[56:59], a[156:159], a[180:183], v[56:59]
    ds_read_b128 a[68:71], v71 offset:32768
    s_add_u32 s26, s25, s31
    v_mfma_f32_16x16x32_bf16 v[60:63], a[156:159], a[236:239], v[60:63]
    ds_read_b128 a[72:75], v70 offset:34816
    s_or_b64 s[54:55], s[54:55], s[52:53]
    v_mfma_f32_16x16x32_bf16 v[48:51], a[160:163], v[128:131], v[48:51]
    ds_read_b64_tr_b16 a[156:157], v74 offset:28672
    s_add_u32 m0, m0, s51
    v_mfma_f32_16x16x32_bf16 v[52:55], a[160:163], v[192:195], v[52:55]
    ds_read_b64_tr_b16 a[158:159], v74 offset:30720
    v_cmp_nlt_f32_e64 s[52:53], v67, s28
    v_mfma_f32_16x16x32_bf16 v[56:59], a[160:163], a[184:187], v[56:59]
    buffer_load_dwordx4 v79, s[12:15], s26 offen sc0 sc1 lds
    v_mfma_f32_16x16x32_bf16 v[60:63], a[160:163], a[240:243], v[60:63]
    s_waitcnt lgkmcnt(9)
    v_rcp_f32 v66, v66
    v_mfma_f32_16x16x32_bf16 v[48:51], a[164:167], v[132:135], v[48:51]
    ds_read_b64_tr_b16 a[160:161], v75 offset:16384
    s_or_b64 s[54:55], s[54:55], s[52:53]
    v_mfma_f32_16x16x32_bf16 v[52:55], a[164:167], v[196:199], v[52:55]
    ds_read_b64_tr_b16 a[162:163], v75 offset:18432
    v_mfma_f32_16x16x32_bf16 v[56:59], a[164:167], a[188:191], v[56:59]
    ds_read_b128 a[76:79], v71 offset:34816
    v_mfma_f32_16x16x32_bf16 v[60:63], a[164:167], a[244:247], v[60:63]
    v_rcp_f32 v67, v67
    v_mfma_f32_16x16x32_bf16 v[0:3], a[144:147], v[136:139], v[0:3]
    ds_read_b64_tr_b16 a[164:165], v75 offset:20480
    s_add_u32 s25, s26, s31
    v_mfma_f32_16x16x32_bf16 v[4:7], a[144:147], v[200:203], v[4:7]
    ds_read_b64_tr_b16 a[166:167], v75 offset:22528
    v_mfma_f32_16x16x32_bf16 v[8:11], a[144:147], a[192:195], v[8:11]
    s_waitcnt lgkmcnt(9)
    s_cmp_lg_u64 s[54:55], 0
    s_addc_u32 s30, s30, s30
    v_mfma_f32_16x16x32_bf16 v[12:15], a[144:147], a[248:251], v[12:15]
    s_add_u32 m0, m0, s51
    v_mfma_f32_16x16x32_bf16 v[0:3], a[148:151], v[140:143], v[0:3]
    ds_read_b64_tr_b16 a[144:145], v75 offset:24576
    v_mfma_f32_16x16x32_bf16 v[4:7], a[148:151], v[204:207], v[4:7]
    ds_read_b64_tr_b16 a[146:147], v75 offset:26624
    v_mfma_f32_16x16x32_bf16 v[8:11], a[148:151], a[196:199], v[8:11]
    buffer_load_dwordx4 v79, s[12:15], s25 offen sc0 sc1 lds
    v_mfma_f32_16x16x32_bf16 v[12:15], a[148:151], a[252:255], v[12:15]
    v_mfma_f32_16x16x32_bf16 v[0:3], a[152:155], v[144:147], v[0:3]
    ds_read_b64_tr_b16 a[148:149], v75 offset:28672
    v_mfma_f32_16x16x32_bf16 v[4:7], a[152:155], v[208:211], v[4:7]
    ds_read_b64_tr_b16 a[150:151], v75 offset:30720
    v_mfma_f32_16x16x32_bf16 v[8:11], a[152:155], v[240:243], v[8:11]
    s_waitcnt lgkmcnt(7)
    v_mfma_f32_16x16x32_bf16 v[12:15], a[152:155], v[248:251], v[12:15]
    v_mfma_f32_16x16x32_bf16 v[0:3], a[156:159], v[148:151], v[0:3]
    ds_read_b64_tr_b16 a[152:153], v76 offset:16384
    s_add_u32 s26, s25, s31
    v_mfma_f32_16x16x32_bf16 v[4:7], a[156:159], v[212:215], v[4:7]
    ds_read_b64_tr_b16 a[154:155], v76 offset:18432
    v_mfma_f32_16x16x32_bf16 v[8:11], a[156:159], v[244:247], v[8:11]
    v_mfma_f32_16x16x32_bf16 v[12:15], a[156:159], v[252:255], v[12:15]
    s_add_u32 m0, m0, s51
    v_mfma_f32_16x16x32_bf16 v[16:19], a[160:163], v[136:139], v[16:19]
    ds_read_b64_tr_b16 a[156:157], v76 offset:20480
    v_mul_f32 v0, v64, v0
    v_mfma_f32_16x16x32_bf16 v[20:23], a[160:163], v[200:203], v[20:23]
    ds_read_b64_tr_b16 a[158:159], v76 offset:22528
    v_mul_f32 v1, v64, v1
    v_mfma_f32_16x16x32_bf16 v[24:27], a[160:163], a[192:195], v[24:27]
    buffer_load_dwordx4 v79, s[12:15], s26 offen sc0 sc1 lds
    v_mfma_f32_16x16x32_bf16 v[28:31], a[160:163], a[248:251], v[28:31]
    s_waitcnt lgkmcnt(6)
    v_mul_f32 v2, v64, v2
    v_mul_f32 v3, v64, v3
    v_mfma_f32_16x16x32_bf16 v[16:19], a[164:167], v[140:143], v[16:19]
    ds_read_b64_tr_b16 a[160:161], v76 offset:24576
    v_cvt_pk_bf16_f32 v0, v0, v1
    v_mfma_f32_16x16x32_bf16 v[20:23], a[164:167], v[204:207], v[20:23]
    ds_read_b64_tr_b16 a[162:163], v76 offset:26624
    v_cvt_pk_bf16_f32 v1, v2, v3
    v_mfma_f32_16x16x32_bf16 v[24:27], a[164:167], a[196:199], v[24:27]
    ds_write_b64 v82, v[0:1] offset:0
    v_mfma_f32_16x16x32_bf16 v[28:31], a[164:167], a[252:255], v[28:31]
    v_mul_f32 v4, v65, v4
    v_mul_f32 v5, v65, v5
    v_mfma_f32_16x16x32_bf16 v[16:19], a[144:147], v[144:147], v[16:19]
    ds_read_b64_tr_b16 a[164:165], v76 offset:28672
    v_mul_f32 v6, v65, v6
    v_mfma_f32_16x16x32_bf16 v[20:23], a[144:147], v[208:211], v[20:23]
    ds_read_b64_tr_b16 a[166:167], v76 offset:30720
    v_mul_f32 v7, v65, v7
    v_mfma_f32_16x16x32_bf16 v[24:27], a[144:147], v[240:243], v[24:27]
    s_waitcnt lgkmcnt(7)
    v_cvt_pk_bf16_f32 v4, v4, v5
    v_cvt_pk_bf16_f32 v5, v6, v7
    v_mfma_f32_16x16x32_bf16 v[28:31], a[144:147], v[248:251], v[28:31]
    ds_write_b64 v82, v[4:5] offset:2048
    v_mfma_f32_16x16x32_bf16 v[16:19], a[148:151], v[148:151], v[16:19]
    ds_read_b64_tr_b16 a[144:145], v77 offset:16384
    v_mul_f32 v8, v66, v8
    v_mfma_f32_16x16x32_bf16 v[20:23], a[148:151], v[212:215], v[20:23]
    ds_read_b64_tr_b16 a[146:147], v77 offset:18432
    v_mul_f32 v9, v66, v9
    v_mfma_f32_16x16x32_bf16 v[24:27], a[148:151], v[244:247], v[24:27]
    s_waitcnt vmcnt(9)
    v_mul_f32 v10, v66, v10
    v_mul_f32 v11, v66, v11
    v_mfma_f32_16x16x32_bf16 v[28:31], a[148:151], v[252:255], v[28:31]
    v_cvt_pk_bf16_f32 v8, v8, v9
    v_cvt_pk_bf16_f32 v9, v10, v11
    v_mfma_f32_16x16x32_bf16 v[32:35], a[152:155], v[136:139], v[32:35]
    ds_read_b64_tr_b16 a[148:149], v77 offset:20480
    v_mul_f32 v12, v67, v12
    v_mfma_f32_16x16x32_bf16 v[36:39], a[152:155], v[200:203], v[36:39]
    ds_read_b64_tr_b16 a[150:151], v77 offset:22528
    v_mul_f32 v13, v67, v13
    v_mfma_f32_16x16x32_bf16 v[40:43], a[152:155], a[192:195], v[40:43]
    ds_write_b64 v82, v[8:9] offset:16384
    v_mfma_f32_16x16x32_bf16 v[44:47], a[152:155], a[248:251], v[44:47]
    s_waitcnt lgkmcnt(9)
    v_mul_f32 v14, v67, v14
    v_mul_f32 v15, v67, v15
    v_mfma_f32_16x16x32_bf16 v[32:35], a[156:159], v[140:143], v[32:35]
    ds_read_b64_tr_b16 a[152:153], v77 offset:24576
    v_cvt_pk_bf16_f32 v12, v12, v13
    v_mfma_f32_16x16x32_bf16 v[36:39], a[156:159], v[204:207], v[36:39]
    ds_read_b64_tr_b16 a[154:155], v77 offset:26624
    v_cvt_pk_bf16_f32 v13, v14, v15
    v_mfma_f32_16x16x32_bf16 v[40:43], a[156:159], a[196:199], v[40:43]
    ds_write_b64 v82, v[12:13] offset:18432
    v_mfma_f32_16x16x32_bf16 v[44:47], a[156:159], a[252:255], v[44:47]
    ds_read_b128 a[16:19], v70 offset:0
    v_xor_b32 v82, 32, v82
    v_mfma_f32_16x16x32_bf16 v[32:35], a[160:163], v[144:147], v[32:35]
    ds_read_b64_tr_b16 a[156:157], v77 offset:28672
    v_mul_f32 v16, v64, v16
    v_mfma_f32_16x16x32_bf16 v[36:39], a[160:163], v[208:211], v[36:39]
    ds_read_b64_tr_b16 a[158:159], v77 offset:30720
    s_waitcnt vmcnt(8)
    v_mfma_f32_16x16x32_bf16 v[40:43], a[160:163], v[240:243], v[40:43]
    s_barrier
    v_mfma_f32_16x16x32_bf16 v[44:47], a[160:163], v[248:251], v[44:47]
    s_waitcnt lgkmcnt(9)
    ds_read_b128 a[20:23], v71 offset:0
    v_mfma_f32_16x16x32_bf16 v[32:35], a[164:167], v[148:151], v[32:35]
    ds_read_b64_tr_b16 a[160:161], v74 offset:32768
    v_mul_f32 v17, v64, v17
    v_mfma_f32_16x16x32_bf16 v[36:39], a[164:167], v[212:215], v[36:39]
    ds_read_b64_tr_b16 a[162:163], v74 offset:34816
    v_mul_f32 v18, v64, v18
    v_mfma_f32_16x16x32_bf16 v[40:43], a[164:167], v[244:247], v[40:43]
    ds_read_b128 a[24:27], v70 offset:2048
    s_xor_b32 s25, s21, 256
    v_mfma_f32_16x16x32_bf16 v[44:47], a[164:167], v[252:255], v[44:47]
    ds_read_b128 a[28:31], v71 offset:2048
    v_mul_f32 v19, v64, v19
    v_mfma_f32_16x16x32_bf16 v[48:51], a[144:147], v[136:139], v[48:51]
    ds_read_b64_tr_b16 a[164:165], v74 offset:36864
    v_cvt_pk_bf16_f32 v16, v16, v17
    v_mfma_f32_16x16x32_bf16 v[52:55], a[144:147], v[200:203], v[52:55]
    s_waitcnt lgkmcnt(11)
    ds_read_b64_tr_b16 a[166:167], v74 offset:38912
    s_add_u32 m0, m0, s95
    v_mfma_f32_16x16x32_bf16 v[56:59], a[144:147], a[192:195], v[56:59]
    buffer_load_dwordx4 v79, s[12:15], s25 offen sc0 sc1 lds
    v_mfma_f32_16x16x32_bf16 v[60:63], a[144:147], a[248:251], v[60:63]
    v_cvt_pk_bf16_f32 v17, v18, v19
    v_mul_f32 v20, v65, v20
    v_mfma_f32_16x16x32_bf16 v[48:51], a[148:151], v[140:143], v[48:51]
    ds_read_b64_tr_b16 a[144:145], v74 offset:40960
    v_mul_f32 v21, v65, v21
    v_mfma_f32_16x16x32_bf16 v[52:55], a[148:151], v[204:207], v[52:55]
    ds_read_b64_tr_b16 a[146:147], v74 offset:43008
    v_mul_f32 v22, v65, v22
    v_mfma_f32_16x16x32_bf16 v[56:59], a[148:151], a[196:199], v[56:59]
    s_add_u32 s26, s25, s31
    v_mul_f32 v23, v65, v23
    v_cvt_pk_bf16_f32 v20, v20, v21
    v_mfma_f32_16x16x32_bf16 v[60:63], a[148:151], a[252:255], v[60:63]
    s_waitcnt lgkmcnt(13)
    v_cvt_pk_bf16_f32 v21, v22, v23
    v_mul_f32 v24, v66, v24
    v_mfma_f32_16x16x32_bf16 v[48:51], a[152:155], v[144:147], v[48:51]
    ds_read_b64_tr_b16 a[148:149], v74 offset:45056
    v_mul_f32 v25, v66, v25
    v_mfma_f32_16x16x32_bf16 v[52:55], a[152:155], v[208:211], v[52:55]
    ds_read_b64_tr_b16 a[150:151], v74 offset:47104
    v_mul_f32 v26, v66, v26
    v_mfma_f32_16x16x32_bf16 v[56:59], a[152:155], v[240:243], v[56:59]
    s_add_u32 m0, m0, s51
    v_mul_f32 v27, v66, v27
    v_cvt_pk_bf16_f32 v24, v24, v25
    v_mfma_f32_16x16x32_bf16 v[60:63], a[152:155], v[248:251], v[60:63]
    s_waitcnt lgkmcnt(8)
    v_cvt_pk_bf16_f32 v25, v26, v27
    v_mul_f32 v28, v67, v28
    v_mfma_f32_16x16x32_bf16 v[48:51], a[156:159], v[148:151], v[48:51]
    ds_read_b64_tr_b16 a[152:153], v74 offset:49152
    v_mul_f32 v29, v67, v29
    v_mfma_f32_16x16x32_bf16 v[52:55], a[156:159], v[212:215], v[52:55]
    ds_read_b64_tr_b16 a[154:155], v74 offset:51200
    v_mul_f32 v30, v67, v30
    v_mfma_f32_16x16x32_bf16 v[56:59], a[156:159], v[244:247], v[56:59]
    ds_write_b64 v82, v[16:17] offset:0
    v_mfma_f32_16x16x32_bf16 v[60:63], a[156:159], v[252:255], v[60:63]
    ds_write_b64 v82, v[20:21] offset:2048
    v_mfma_f32_16x16x32_bf16 v[0:3], a[160:163], v[88:91], 0
    ds_read_b64_tr_b16 a[156:157], v74 offset:53248
    v_mul_f32 v31, v67, v31
    v_mfma_f32_16x16x32_bf16 v[4:7], a[160:163], v[152:155], 0
    ds_read_b64_tr_b16 a[158:159], v74 offset:55296
    v_cvt_pk_bf16_f32 v28, v28, v29
    v_mfma_f32_16x16x32_bf16 v[8:11], a[160:163], v[216:219], 0
    buffer_load_dwordx4 v79, s[12:15], s26 offen sc0 sc1 lds
    v_mfma_f32_16x16x32_bf16 v[12:15], a[160:163], a[200:203], 0
    s_waitcnt lgkmcnt(8)
    s_add_u32 s43, s42, 8448
    v_cvt_pk_bf16_f32 v29, v30, v31
    v_mfma_f32_16x16x32_bf16 v[0:3], a[164:167], v[92:95], v[0:3]
    ds_read_b64_tr_b16 a[160:161], v74 offset:57344
    v_mul_f32 v32, v64, v32
    v_mfma_f32_16x16x32_bf16 v[4:7], a[164:167], v[156:159], v[4:7]
    ds_read_b64_tr_b16 a[162:163], v74 offset:59392
    s_add_u32 m0, s44, 114688
    v_mfma_f32_16x16x32_bf16 v[8:11], a[164:167], v[220:223], v[8:11]
    ds_write_b64 v82, v[24:25] offset:16384
    v_mfma_f32_16x16x32_bf16 v[12:15], a[164:167], a[204:207], v[12:15]
    ds_write_b64 v82, v[28:29] offset:18432
    v_mfma_f32_16x16x32_bf16 v[0:3], a[144:147], v[96:99], v[0:3]
    ds_read_b64_tr_b16 a[164:165], v74 offset:61440
    s_add_u32 s25, s26, s31
    v_mfma_f32_16x16x32_bf16 v[4:7], a[144:147], v[160:163], v[4:7]
    ds_read_b64_tr_b16 a[166:167], v74 offset:63488
    v_xor_b32 v82, 96, v82
    v_mfma_f32_16x16x32_bf16 v[8:11], a[144:147], v[224:227], v[8:11]
    buffer_load_dwordx4 v78, s[4:7], s43 offen offset:0 sc0 sc1 nt lds
    v_mfma_f32_16x16x32_bf16 v[12:15], a[144:147], a[208:211], v[12:15]
    s_waitcnt lgkmcnt(10)
    s_add_u32 m0, s23, 34816
    v_subrev_u32 v74, s96, v74
    v_mfma_f32_16x16x32_bf16 v[0:3], a[148:151], v[100:103], v[0:3]
    ds_read_b64_tr_b16 a[144:145], v75 offset:32768
    v_mul_f32 v33, v64, v33
    v_mfma_f32_16x16x32_bf16 v[4:7], a[148:151], v[164:167], v[4:7]
    ds_read_b64_tr_b16 a[146:147], v75 offset:34816
    v_mul_f32 v34, v64, v34
    v_mfma_f32_16x16x32_bf16 v[8:11], a[148:151], v[228:231], v[8:11]
    buffer_load_dwordx4 v79, s[12:15], s25 offen sc0 sc1 lds
    v_mfma_f32_16x16x32_bf16 v[12:15], a[148:151], a[212:215], v[12:15]
    s_add_u32 m0, s45, 114688
    v_mul_f32 v35, v64, v35
    v_cvt_pk_bf16_f32 v32, v32, v33
L_w6:
    s_cbranch_execz L_w10
    v_mfma_f32_16x16x32_bf16 v[0:3], a[152:155], v[104:107], v[0:3]
    ds_read_b64_tr_b16 a[148:149], v75 offset:36864
    v_cvt_pk_bf16_f32 v33, v34, v35
    v_mfma_f32_16x16x32_bf16 v[4:7], a[152:155], v[168:171], v[4:7]
    ds_read_b64_tr_b16 a[150:151], v75 offset:38912
    v_mul_f32 v36, v65, v36
    v_mfma_f32_16x16x32_bf16 v[8:11], a[152:155], v[232:235], v[8:11]
    buffer_load_dwordx4 v72, s[4:7], s43 offen offset:0 sc0 sc1 nt lds
    v_mfma_f32_16x16x32_bf16 v[12:15], a[152:155], a[216:219], v[12:15]
    s_waitcnt lgkmcnt(8)
    s_add_u32 s26, s25, s31
    v_mul_f32 v37, v65, v37
    v_mfma_f32_16x16x32_bf16 v[0:3], a[156:159], v[108:111], v[0:3]
    ds_read_b64_tr_b16 a[152:153], v75 offset:40960
    v_mul_f32 v38, v65, v38
    v_mfma_f32_16x16x32_bf16 v[4:7], a[156:159], v[172:175], v[4:7]
    ds_read_b64_tr_b16 a[154:155], v75 offset:43008
    s_add_u32 m0, s23, 35840
    v_mfma_f32_16x16x32_bf16 v[8:11], a[156:159], v[236:239], v[8:11]
    ds_write_b64 v82, v[32:33] offset:0
    v_mfma_f32_16x16x32_bf16 v[12:15], a[156:159], a[220:223], v[12:15]
    buffer_load_dwordx4 v79, s[12:15], s26 offen sc0 sc1 lds
    v_mfma_f32_16x16x32_bf16 v[0:3], a[160:163], v[112:115], v[0:3]
    ds_read_b64_tr_b16 a[156:157], v75 offset:45056
    v_mul_f32 v39, v65, v39
    v_mfma_f32_16x16x32_bf16 v[4:7], a[160:163], v[176:179], v[4:7]
    ds_read_b64_tr_b16 a[158:159], v75 offset:47104
    s_add_u32 m0, s44, 116608
    v_mfma_f32_16x16x32_bf16 v[8:11], a[160:163], a[168:171], v[8:11]
    buffer_load_dwordx4 v78, s[4:7], s43 offen offset:128 sc0 sc1 nt lds
    v_mfma_f32_16x16x32_bf16 v[12:15], a[160:163], a[224:227], v[12:15]
    s_waitcnt lgkmcnt(7)
    v_cvt_pk_bf16_f32 v36, v36, v37
    v_cvt_pk_bf16_f32 v37, v38, v39
    v_mfma_f32_16x16x32_bf16 v[0:3], a[164:167], v[116:119], v[0:3]
    ds_read_b64_tr_b16 a[160:161], v75 offset:49152
    v_mul_f32 v40, v66, v40
    v_mfma_f32_16x16x32_bf16 v[4:7], a[164:167], v[180:183], v[4:7]
    ds_read_b64_tr_b16 a[162:163], v75 offset:51200
    s_add_u32 m0, s45, 116608
    v_mfma_f32_16x16x32_bf16 v[8:11], a[164:167], a[172:175], v[8:11]
    ds_write_b64 v82, v[36:37] offset:2048
    v_mfma_f32_16x16x32_bf16 v[12:15], a[164:167], a[228:231], v[12:15]
    s_xor_b32 s25, s21, 65792
    v_mul_f32 v41, v66, v41
    v_mul_f32 v42, v66, v42
    v_mfma_f32_16x16x32_bf16 v[16:19], a[144:147], v[88:91], 0
    ds_read_b64_tr_b16 a[164:165], v75 offset:53248
    v_mul_f32 v43, v66, v43
    v_mfma_f32_16x16x32_bf16 v[20:23], a[144:147], v[152:155], 0
    ds_read_b64_tr_b16 a[166:167], v75 offset:55296
    v_cvt_pk_bf16_f32 v40, v40, v41
    v_mfma_f32_16x16x32_bf16 v[24:27], a[144:147], v[216:219], 0
    buffer_load_dwordx4 v72, s[4:7], s43 offen offset:128 sc0 sc1 nt lds
    v_mfma_f32_16x16x32_bf16 v[28:31], a[144:147], a[200:203], 0
    s_waitcnt lgkmcnt(8)
    s_add_u32 m0, s23, 49152
    v_cvt_pk_bf16_f32 v41, v42, v43
    v_mfma_f32_16x16x32_bf16 v[16:19], a[148:151], v[92:95], v[16:19]
    ds_read_b64_tr_b16 a[144:145], v75 offset:57344
    v_mul_f32 v44, v67, v44
    v_mfma_f32_16x16x32_bf16 v[20:23], a[148:151], v[156:159], v[20:23]
    ds_read_b64_tr_b16 a[146:147], v75 offset:59392
    v_mul_f32 v45, v67, v45
    v_mfma_f32_16x16x32_bf16 v[24:27], a[148:151], v[220:223], v[24:27]
    ds_write_b64 v82, v[40:41] offset:16384
    v_mfma_f32_16x16x32_bf16 v[28:31], a[148:151], a[204:207], v[28:31]
    buffer_load_dwordx4 v79, s[12:15], s25 offen sc0 sc1 lds
    v_mfma_f32_16x16x32_bf16 v[16:19], a[152:155], v[96:99], v[16:19]
    ds_read_b64_tr_b16 a[148:149], v75 offset:61440
    v_mul_f32 v46, v67, v46
    v_mfma_f32_16x16x32_bf16 v[20:23], a[152:155], v[160:163], v[20:23]
    ds_read_b64_tr_b16 a[150:151], v75 offset:63488
    v_subrev_u32 v75, s96, v75
    v_mfma_f32_16x16x32_bf16 v[24:27], a[152:155], v[224:227], v[24:27]
    s_barrier
    v_mfma_f32_16x16x32_bf16 v[28:31], a[152:155], a[208:211], v[28:31]
    s_waitcnt lgkmcnt(8)
    s_add_u32 s26, s25, s31
    v_mul_f32 v47, v67, v47
    v_mfma_f32_16x16x32_bf16 v[16:19], a[156:159], v[100:103], v[16:19]
    ds_read_b64_tr_b16 a[152:153], v76 offset:32768
    v_cvt_pk_bf16_f32 v44, v44, v45
    v_mfma_f32_16x16x32_bf16 v[20:23], a[156:159], v[164:167], v[20:23]
    ds_read_b64_tr_b16 a[154:155], v76 offset:34816
    s_add_u32 m0, m0, s51
    v_mfma_f32_16x16x32_bf16 v[24:27], a[156:159], v[228:231], v[24:27]
    buffer_load_dwordx4 v79, s[12:15], s26 offen sc0 sc1 lds
    v_mfma_f32_16x16x32_bf16 v[28:31], a[156:159], a[212:215], v[28:31]
    s_xor_b32 s3, s46, 0
    s_add_u32 s48, s3, 0
    v_cvt_pk_bf16_f32 v45, v46, v47
    v_mfma_f32_16x16x32_bf16 v[16:19], a[160:163], v[104:107], v[16:19]
    ds_read_b64_tr_b16 a[156:157], v76 offset:36864
    v_mul_f32 v48, v64, v48
    v_mfma_f32_16x16x32_bf16 v[20:23], a[160:163], v[168:171], v[20:23]
    ds_read_b64_tr_b16 a[158:159], v76 offset:38912
    v_mul_f32 v49, v64, v49
    v_mfma_f32_16x16x32_bf16 v[24:27], a[160:163], v[232:235], v[24:27]
    ds_write_b64 v82, v[44:45] offset:18432
    v_mfma_f32_16x16x32_bf16 v[28:31], a[160:163], a[216:219], v[28:31]
    s_waitcnt lgkmcnt(8)
    v_xor_b32 v82, 32, v82
    v_mul_f32 v50, v64, v50
    v_mfma_f32_16x16x32_bf16 v[16:19], a[164:167], v[108:111], v[16:19]
    ds_read_b64_tr_b16 a[160:161], v76 offset:40960
    v_mul_f32 v51, v64, v51
    v_mfma_f32_16x16x32_bf16 v[20:23], a[164:167], v[172:175], v[20:23]
    ds_read_b64_tr_b16 a[162:163], v76 offset:43008
    v_cvt_pk_bf16_f32 v48, v48, v49
    v_mfma_f32_16x16x32_bf16 v[24:27], a[164:167], v[236:239], v[24:27]
    s_add_u32 s25, s26, s31
    v_cvt_pk_bf16_f32 v49, v50, v51
    v_mul_f32 v52, v65, v52
    v_mfma_f32_16x16x32_bf16 v[28:31], a[164:167], a[220:223], v[28:31]
    ds_write_b64 v82, v[48:49] offset:0
    v_mfma_f32_16x16x32_bf16 v[16:19], a[144:147], v[112:115], v[16:19]
    ds_read_b64_tr_b16 a[164:165], v76 offset:45056
    v_mul_f32 v53, v65, v53
    v_mfma_f32_16x16x32_bf16 v[20:23], a[144:147], v[176:179], v[20:23]
    ds_read_b64_tr_b16 a[166:167], v76 offset:47104
    s_add_u32 m0, m0, s51
    v_mfma_f32_16x16x32_bf16 v[24:27], a[144:147], a[168:171], v[24:27]
    buffer_load_dwordx4 v79, s[12:15], s25 offen sc0 sc1 lds
    v_mfma_f32_16x16x32_bf16 v[28:31], a[144:147], a[224:227], v[28:31]
    s_waitcnt lgkmcnt(8)
    v_mul_f32 v54, v65, v54
    v_mul_f32 v55, v65, v55
    v_mfma_f32_16x16x32_bf16 v[16:19], a[148:151], v[116:119], v[16:19]
    ds_read_b64_tr_b16 a[144:145], v76 offset:49152
    v_cvt_pk_bf16_f32 v52, v52, v53
    v_mfma_f32_16x16x32_bf16 v[20:23], a[148:151], v[180:183], v[20:23]
    ds_read_b64_tr_b16 a[146:147], v76 offset:51200
    v_cvt_pk_bf16_f32 v53, v54, v55
    v_mfma_f32_16x16x32_bf16 v[24:27], a[148:151], a[172:175], v[24:27]
    ds_write_b64 v82, v[52:53] offset:2048
    v_mfma_f32_16x16x32_bf16 v[28:31], a[148:151], a[228:231], v[28:31]
    ds_read_b128 a[96:99], v83 offset:0
    v_mul_f32 v56, v66, v56
    v_mfma_f32_16x16x32_bf16 v[32:35], a[152:155], v[88:91], 0
    ds_read_b64_tr_b16 a[148:149], v76 offset:53248
    v_mul_f32 v57, v66, v57
    v_mfma_f32_16x16x32_bf16 v[36:39], a[152:155], v[152:155], 0
    ds_read_b64_tr_b16 a[150:151], v76 offset:55296
    v_mul_f32 v58, v66, v58
    v_mfma_f32_16x16x32_bf16 v[40:43], a[152:155], v[216:219], 0
    s_add_u32 s26, s25, s31
    v_mul_f32 v59, v66, v59
    v_cvt_pk_bf16_f32 v56, v56, v57
    v_mfma_f32_16x16x32_bf16 v[44:47], a[152:155], a[200:203], 0
    s_waitcnt lgkmcnt(9)
    v_cvt_pk_bf16_f32 v57, v58, v59
    v_mul_f32 v60, v67, v60
    v_mfma_f32_16x16x32_bf16 v[32:35], a[156:159], v[92:95], v[32:35]
    ds_read_b64_tr_b16 a[152:153], v76 offset:57344
    v_mul_f32 v61, v67, v61
    v_mfma_f32_16x16x32_bf16 v[36:39], a[156:159], v[156:159], v[36:39]
    ds_read_b64_tr_b16 a[154:155], v76 offset:59392
    s_add_u32 m0, m0, s51
    v_mfma_f32_16x16x32_bf16 v[40:43], a[156:159], v[220:223], v[40:43]
    ds_write_b64 v82, v[56:57] offset:16384
    v_mfma_f32_16x16x32_bf16 v[44:47], a[156:159], a[204:207], v[44:47]
    buffer_load_dwordx4 v79, s[12:15], s26 offen sc0 sc1 lds
    v_mfma_f32_16x16x32_bf16 v[32:35], a[160:163], v[96:99], v[32:35]
    ds_read_b64_tr_b16 a[156:157], v76 offset:61440
    v_mul_f32 v62, v67, v62
    v_mfma_f32_16x16x32_bf16 v[36:39], a[160:163], v[160:163], v[36:39]
    ds_read_b64_tr_b16 a[158:159], v76 offset:63488
    v_subrev_u32 v76, s96, v76
    v_mfma_f32_16x16x32_bf16 v[40:43], a[160:163], v[224:227], v[40:43]
    s_xor_b32 s25, s21, 131328
    v_mul_f32 v63, v67, v63
    v_cvt_pk_bf16_f32 v60, v60, v61
    v_mfma_f32_16x16x32_bf16 v[44:47], a[160:163], a[208:211], v[44:47]
    s_waitcnt lgkmcnt(9)
    ds_read_b128 a[100:103], v83 offset:1024
    v_mfma_f32_16x16x32_bf16 v[32:35], a[164:167], v[100:103], v[32:35]
    ds_read_b64_tr_b16 a[160:161], v77 offset:32768
    s_add_u32 s49, s48, s31
    v_mfma_f32_16x16x32_bf16 v[36:39], a[164:167], v[164:167], v[36:39]
    ds_read_b64_tr_b16 a[162:163], v77 offset:34816
    v_cvt_pk_bf16_f32 v61, v62, v63
    v_mfma_f32_16x16x32_bf16 v[40:43], a[164:167], v[228:231], v[40:43]
    ds_write_b64 v82, v[60:61] offset:18432
    v_mfma_f32_16x16x32_bf16 v[44:47], a[164:167], a[212:215], v[44:47]
    s_add_u32 m0, m0, s95
    v_xor_b32 v82, 96, v82
    v_mfma_f32_16x16x32_bf16 v[32:35], a[144:147], v[104:107], v[32:35]
    ds_read_b64_tr_b16 a[164:165], v77 offset:36864
    v_mfma_f32_16x16x32_bf16 v[36:39], a[144:147], v[168:171], v[36:39]
    ds_read_b64_tr_b16 a[166:167], v77 offset:38912
    v_mfma_f32_16x16x32_bf16 v[40:43], a[144:147], v[232:235], v[40:43]
    buffer_load_dwordx4 v79, s[12:15], s25 offen sc0 sc1 lds
    v_mfma_f32_16x16x32_bf16 v[44:47], a[144:147], a[216:219], v[44:47]
    s_waitcnt lgkmcnt(9)
    v_mfma_f32_16x16x32_bf16 v[32:35], a[148:151], v[108:111], v[32:35]
    ds_read_b64_tr_b16 a[144:145], v77 offset:40960
    s_add_u32 s26, s25, s31
    v_mfma_f32_16x16x32_bf16 v[36:39], a[148:151], v[172:175], v[36:39]
    ds_read_b64_tr_b16 a[146:147], v77 offset:43008
    v_mfma_f32_16x16x32_bf16 v[40:43], a[148:151], v[236:239], v[40:43]
    buffer_store_dwordx4 a[96:99], v81, s[16:19], s48 offen sc1
    v_mfma_f32_16x16x32_bf16 v[44:47], a[148:151], a[220:223], v[44:47]
    s_add_u32 m0, m0, s51
    v_mfma_f32_16x16x32_bf16 v[32:35], a[152:155], v[112:115], v[32:35]
    ds_read_b64_tr_b16 a[148:149], v77 offset:45056
    v_mfma_f32_16x16x32_bf16 v[36:39], a[152:155], v[176:179], v[36:39]
    ds_read_b64_tr_b16 a[150:151], v77 offset:47104
    v_mfma_f32_16x16x32_bf16 v[40:43], a[152:155], a[168:171], v[40:43]
    buffer_load_dwordx4 v79, s[12:15], s26 offen sc0 sc1 lds
    v_mfma_f32_16x16x32_bf16 v[44:47], a[152:155], a[224:227], v[44:47]
    s_waitcnt lgkmcnt(7)
    v_mfma_f32_16x16x32_bf16 v[32:35], a[156:159], v[116:119], v[32:35]
    ds_read_b64_tr_b16 a[152:153], v77 offset:49152
    v_mfma_f32_16x16x32_bf16 v[36:39], a[156:159], v[180:183], v[36:39]
    ds_read_b64_tr_b16 a[154:155], v77 offset:51200
    v_mfma_f32_16x16x32_bf16 v[40:43], a[156:159], a[172:175], v[40:43]
    buffer_store_dwordx4 a[100:103], v81, s[16:19], s49 offen sc1
    v_mfma_f32_16x16x32_bf16 v[44:47], a[156:159], a[228:231], v[44:47]
    v_mfma_f32_16x16x32_bf16 v[48:51], a[160:163], v[88:91], 0
    ds_read_b64_tr_b16 a[156:157], v77 offset:53248
    v_mfma_f32_16x16x32_bf16 v[52:55], a[160:163], v[152:155], 0
    ds_read_b64_tr_b16 a[158:159], v77 offset:55296
    v_mfma_f32_16x16x32_bf16 v[56:59], a[160:163], v[216:219], 0
    ds_read_b128 a[104:107], v83 offset:2048
    s_waitcnt lgkmcnt(7)
    v_mfma_f32_16x16x32_bf16 v[60:63], a[160:163], a[200:203], 0
    v_mfma_f32_16x16x32_bf16 v[48:51], a[164:167], v[92:95], v[48:51]
    ds_read_b64_tr_b16 a[160:161], v77 offset:57344
    v_mfma_f32_16x16x32_bf16 v[52:55], a[164:167], v[156:159], v[52:55]
    ds_read_b64_tr_b16 a[162:163], v77 offset:59392
    v_mfma_f32_16x16x32_bf16 v[56:59], a[164:167], v[220:223], v[56:59]
    s_waitcnt vmcnt(16)
    v_mfma_f32_16x16x32_bf16 v[60:63], a[164:167], a[204:207], v[60:63]
    s_barrier
    v_mfma_f32_16x16x32_bf16 v[48:51], a[144:147], v[96:99], v[48:51]
    ds_read_b64_tr_b16 a[164:165], v77 offset:61440
    s_add_u32 s25, s26, s31
    v_mfma_f32_16x16x32_bf16 v[52:55], a[144:147], v[160:163], v[52:55]
    ds_read_b64_tr_b16 a[166:167], v77 offset:63488
    v_subrev_u32 v77, s96, v77
    v_mfma_f32_16x16x32_bf16 v[56:59], a[144:147], v[224:227], v[56:59]
    s_add_u32 m0, m0, s51
    s_add_u32 s48, s49, s31
    s_waitcnt lgkmcnt(7)
    v_mfma_f32_16x16x32_bf16 v[60:63], a[144:147], a[208:211], v[60:63]
    buffer_load_dwordx4 v79, s[12:15], s25 offen sc0 sc1 lds
    v_mfma_f32_16x16x32_bf16 v[48:51], a[148:151], v[100:103], v[48:51]
    ds_read_b64_tr_b16 a[144:145], v74 offset:0
    v_mfma_f32_16x16x32_bf16 v[52:55], a[148:151], v[164:167], v[52:55]
    ds_read_b64_tr_b16 a[146:147], v74 offset:2048
    v_mfma_f32_16x16x32_bf16 v[56:59], a[148:151], v[228:231], v[56:59]
    v_mfma_f32_16x16x32_bf16 v[60:63], a[148:151], a[212:215], v[60:63]
    v_mfma_f32_16x16x32_bf16 v[48:51], a[152:155], v[104:107], v[48:51]
    ds_read_b64_tr_b16 a[148:149], v74 offset:4096
    s_add_u32 s26, s25, s31
    v_mfma_f32_16x16x32_bf16 v[52:55], a[152:155], v[168:171], v[52:55]
    ds_read_b64_tr_b16 a[150:151], v74 offset:6144
    v_mfma_f32_16x16x32_bf16 v[56:59], a[152:155], v[232:235], v[56:59]
    s_waitcnt lgkmcnt(6)
    v_mfma_f32_16x16x32_bf16 v[60:63], a[152:155], a[216:219], v[60:63]
    buffer_store_dwordx4 a[104:107], v81, s[16:19], s48 offen sc1
    v_mfma_f32_16x16x32_bf16 v[48:51], a[156:159], v[108:111], v[48:51]
    ds_read_b64_tr_b16 a[152:153], v74 offset:8192
    s_add_u32 m0, m0, s51
    v_mfma_f32_16x16x32_bf16 v[52:55], a[156:159], v[172:175], v[52:55]
    ds_read_b64_tr_b16 a[154:155], v74 offset:10240
    v_mfma_f32_16x16x32_bf16 v[56:59], a[156:159], v[236:239], v[56:59]
    buffer_load_dwordx4 v79, s[12:15], s26 offen sc0 sc1 lds
    v_mfma_f32_16x16x32_bf16 v[60:63], a[156:159], a[220:223], v[60:63]
    ds_read_b128 a[108:111], v83 offset:3072
    v_mfma_f32_16x16x32_bf16 v[48:51], a[160:163], v[112:115], v[48:51]
    ds_read_b64_tr_b16 a[156:157], v74 offset:12288
    v_mfma_f32_16x16x32_bf16 v[52:55], a[160:163], v[176:179], v[52:55]
    ds_read_b64_tr_b16 a[158:159], v74 offset:14336
    v_mfma_f32_16x16x32_bf16 v[56:59], a[160:163], a[168:171], v[56:59]
    ds_read_b128 a[112:115], v83 offset:16384
    s_waitcnt lgkmcnt(8)
    v_mfma_f32_16x16x32_bf16 v[60:63], a[160:163], a[224:227], v[60:63]
    v_mfma_f32_16x16x32_bf16 v[48:51], a[164:167], v[116:119], v[48:51]
    ds_read_b64_tr_b16 a[160:161], v74 offset:16384
    v_mfma_f32_16x16x32_bf16 v[52:55], a[164:167], v[180:183], v[52:55]
    ds_read_b64_tr_b16 a[162:163], v74 offset:18432
    v_mfma_f32_16x16x32_bf16 v[56:59], a[164:167], a[172:175], v[56:59]
    ds_read_b128 a[116:119], v83 offset:17408
    v_mfma_f32_16x16x32_bf16 v[60:63], a[164:167], a[228:231], v[60:63]
    v_mfma_f32_16x16x32_bf16 v[0:3], a[144:147], v[120:123], v[0:3]
    ds_read_b64_tr_b16 a[164:165], v74 offset:20480
    v_mfma_f32_16x16x32_bf16 v[4:7], a[144:147], v[184:187], v[4:7]
    ds_read_b64_tr_b16 a[166:167], v74 offset:22528
    v_mfma_f32_16x16x32_bf16 v[8:11], a[144:147], a[176:179], v[8:11]
    ds_read_b128 a[120:123], v83 offset:18432
    s_waitcnt lgkmcnt(10)
    v_mfma_f32_16x16x32_bf16 v[12:15], a[144:147], a[232:235], v[12:15]
    v_mfma_f32_16x16x32_bf16 v[0:3], a[148:151], v[124:127], v[0:3]
    ds_read_b64_tr_b16 a[144:145], v74 offset:24576
    v_mfma_f32_16x16x32_bf16 v[4:7], a[148:151], v[188:191], v[4:7]
    ds_read_b64_tr_b16 a[146:147], v74 offset:26624
    v_mfma_f32_16x16x32_bf16 v[8:11], a[148:151], a[180:183], v[8:11]
    ds_read_b128 a[124:127], v83 offset:19456
    s_add_u32 s49, s48, s31
    v_mfma_f32_16x16x32_bf16 v[12:15], a[148:151], a[236:239], v[12:15]
    v_mfma_f32_16x16x32_bf16 v[0:3], a[152:155], v[128:131], v[0:3]
    ds_read_b64_tr_b16 a[148:149], v74 offset:28672
    v_mfma_f32_16x16x32_bf16 v[4:7], a[152:155], v[192:195], v[4:7]
    ds_read_b64_tr_b16 a[150:151], v74 offset:30720
    v_mfma_f32_16x16x32_bf16 v[8:11], a[152:155], a[184:187], v[8:11]
    s_waitcnt lgkmcnt(9)
    v_mfma_f32_16x16x32_bf16 v[12:15], a[152:155], a[240:243], v[12:15]
    v_mfma_f32_16x16x32_bf16 v[0:3], a[156:159], v[132:135], v[0:3]
    ds_read_b64_tr_b16 a[152:153], v75 offset:0
    v_mfma_f32_16x16x32_bf16 v[4:7], a[156:159], v[196:199], v[4:7]
    ds_read_b64_tr_b16 a[154:155], v75 offset:2048
    v_mfma_f32_16x16x32_bf16 v[8:11], a[156:159], a[188:191], v[8:11]
    buffer_store_dwordx4 a[108:111], v81, s[16:19], s49 offen sc1
    v_mfma_f32_16x16x32_bf16 v[12:15], a[156:159], a[244:247], v[12:15]
    v_mfma_f32_16x16x32_bf16 v[0:3], a[160:163], v[136:139], v[0:3]
    ds_read_b64_tr_b16 a[156:157], v75 offset:4096
    v_mfma_f32_16x16x32_bf16 v[4:7], a[160:163], v[200:203], v[4:7]
    ds_read_b64_tr_b16 a[158:159], v75 offset:6144
    v_mfma_f32_16x16x32_bf16 v[8:11], a[160:163], a[192:195], v[8:11]
    s_waitcnt lgkmcnt(7)
    v_mfma_f32_16x16x32_bf16 v[12:15], a[160:163], a[248:251], v[12:15]
    v_mfma_f32_16x16x32_bf16 v[0:3], a[164:167], v[140:143], v[0:3]
    ds_read_b64_tr_b16 a[160:161], v75 offset:8192
    v_mfma_f32_16x16x32_bf16 v[4:7], a[164:167], v[204:207], v[4:7]
    ds_read_b64_tr_b16 a[162:163], v75 offset:10240
    v_mfma_f32_16x16x32_bf16 v[8:11], a[164:167], a[196:199], v[8:11]
    v_mfma_f32_16x16x32_bf16 v[12:15], a[164:167], a[252:255], v[12:15]
    v_mfma_f32_16x16x32_bf16 v[0:3], a[144:147], v[144:147], v[0:3]
    ds_read_b64_tr_b16 a[164:165], v75 offset:12288
    v_mfma_f32_16x16x32_bf16 v[4:7], a[144:147], v[208:211], v[4:7]
    ds_read_b64_tr_b16 a[166:167], v75 offset:14336
    v_mfma_f32_16x16x32_bf16 v[8:11], a[144:147], v[240:243], v[8:11]
    s_waitcnt lgkmcnt(6)
    v_mfma_f32_16x16x32_bf16 v[12:15], a[144:147], v[248:251], v[12:15]
    v_mfma_f32_16x16x32_bf16 v[0:3], a[148:151], v[148:151], v[0:3]
    ds_read_b64_tr_b16 a[144:145], v75 offset:16384
    v_mfma_f32_16x16x32_bf16 v[4:7], a[148:151], v[212:215], v[4:7]
    ds_read_b64_tr_b16 a[146:147], v75 offset:18432
    v_mfma_f32_16x16x32_bf16 v[8:11], a[148:151], v[244:247], v[8:11]
    v_mfma_f32_16x16x32_bf16 v[12:15], a[148:151], v[252:255], v[12:15]
    v_mfma_f32_16x16x32_bf16 v[16:19], a[152:155], v[120:123], v[16:19]
    ds_read_b64_tr_b16 a[148:149], v75 offset:20480
    v_mfma_f32_16x16x32_bf16 v[20:23], a[152:155], v[184:187], v[20:23]
    ds_read_b64_tr_b16 a[150:151], v75 offset:22528
    v_mul_f32 v0, v64, v0
    v_mfma_f32_16x16x32_bf16 v[24:27], a[152:155], a[176:179], v[24:27]
    s_waitcnt lgkmcnt(6)
    v_mul_f32 v1, v64, v1
    v_mul_f32 v2, v64, v2
    v_mfma_f32_16x16x32_bf16 v[28:31], a[152:155], a[232:235], v[28:31]
    v_mul_f32 v3, v64, v3
    v_cvt_pk_bf16_f32 v0, v0, v1
    v_mfma_f32_16x16x32_bf16 v[16:19], a[156:159], v[124:127], v[16:19]
    ds_read_b64_tr_b16 a[152:153], v75 offset:24576
    v_cvt_pk_bf16_f32 v1, v2, v3
    v_mfma_f32_16x16x32_bf16 v[20:23], a[156:159], v[188:191], v[20:23]
    ds_read_b64_tr_b16 a[154:155], v75 offset:26624
    v_mul_f32 v4, v65, v4
    v_mfma_f32_16x16x32_bf16 v[24:27], a[156:159], a[180:183], v[24:27]
    ds_write_b64 v82, v[0:1] offset:0
    v_mfma_f32_16x16x32_bf16 v[28:31], a[156:159], a[236:239], v[28:31]
    s_barrier
    v_mfma_f32_16x16x32_bf16 v[16:19], a[160:163], v[128:131], v[16:19]
    ds_read_b64_tr_b16 a[156:157], v75 offset:28672
    v_mul_f32 v5, v65, v5
    v_mfma_f32_16x16x32_bf16 v[20:23], a[160:163], v[192:195], v[20:23]
    ds_read_b64_tr_b16 a[158:159], v75 offset:30720
    v_mul_f32 v6, v65, v6
    v_mfma_f32_16x16x32_bf16 v[24:27], a[160:163], a[184:187], v[24:27]
    s_xor_b32 s25, s21, 196864
    v_mul_f32 v7, v65, v7
    v_cvt_pk_bf16_f32 v4, v4, v5
    v_mfma_f32_16x16x32_bf16 v[28:31], a[160:163], a[240:243], v[28:31]
    s_waitcnt lgkmcnt(7)
    v_cvt_pk_bf16_f32 v5, v6, v7
    v_mul_f32 v8, v66, v8
    v_mfma_f32_16x16x32_bf16 v[16:19], a[164:167], v[132:135], v[16:19]
    ds_read_b64_tr_b16 a[160:161], v76 offset:0
    s_add_u32 s48, s49, s31
    v_mfma_f32_16x16x32_bf16 v[20:23], a[164:167], v[196:199], v[20:23]
    ds_read_b64_tr_b16 a[162:163], v76 offset:2048
    v_mul_f32 v9, v66, v9
    v_mfma_f32_16x16x32_bf16 v[24:27], a[164:167], a[188:191], v[24:27]
    ds_write_b64 v82, v[4:5] offset:2048
    v_mfma_f32_16x16x32_bf16 v[28:31], a[164:167], a[244:247], v[28:31]
    buffer_store_dwordx4 a[112:115], v81, s[16:19], s48 offen sc1
    v_mfma_f32_16x16x32_bf16 v[16:19], a[144:147], v[136:139], v[16:19]
    ds_read_b64_tr_b16 a[164:165], v76 offset:4096
    v_mul_f32 v10, v66, v10
    v_mfma_f32_16x16x32_bf16 v[20:23], a[144:147], v[200:203], v[20:23]
    ds_read_b64_tr_b16 a[166:167], v76 offset:6144
    s_add_u32 m0, m0, s95
    v_mfma_f32_16x16x32_bf16 v[24:27], a[144:147], a[192:195], v[24:27]
    buffer_load_dwordx4 v79, s[12:15], s25 offen sc0 sc1 lds
    v_mfma_f32_16x16x32_bf16 v[28:31], a[144:147], a[248:251], v[28:31]
    s_waitcnt lgkmcnt(8)
    v_mul_f32 v11, v66, v11
    v_cvt_pk_bf16_f32 v8, v8, v9
    v_mfma_f32_16x16x32_bf16 v[16:19], a[148:151], v[140:143], v[16:19]
    ds_read_b64_tr_b16 a[144:145], v76 offset:8192
    v_cvt_pk_bf16_f32 v9, v10, v11
    v_mfma_f32_16x16x32_bf16 v[20:23], a[148:151], v[204:207], v[20:23]
    ds_read_b64_tr_b16 a[146:147], v76 offset:10240
    v_mul_f32 v12, v67, v12
    v_mfma_f32_16x16x32_bf16 v[24:27], a[148:151], a[196:199], v[24:27]
    ds_write_b64 v82, v[8:9] offset:16384
    v_mfma_f32_16x16x32_bf16 v[28:31], a[148:151], a[252:255], v[28:31]
    s_add_u32 s26, s25, s31
    v_mul_f32 v13, v67, v13
    v_mul_f32 v14, v67, v14
    v_mfma_f32_16x16x32_bf16 v[16:19], a[152:155], v[144:147], v[16:19]
    ds_read_b64_tr_b16 a[148:149], v76 offset:12288
    v_mul_f32 v15, v67, v15
    v_mfma_f32_16x16x32_bf16 v[20:23], a[152:155], v[208:211], v[20:23]
    ds_read_b64_tr_b16 a[150:151], v76 offset:14336
    v_cvt_pk_bf16_f32 v12, v12, v13
    v_mfma_f32_16x16x32_bf16 v[24:27], a[152:155], v[240:243], v[24:27]
    s_add_u32 m0, m0, s51
    v_cvt_pk_bf16_f32 v13, v14, v15
    s_waitcnt lgkmcnt(8)
    v_mfma_f32_16x16x32_bf16 v[28:31], a[152:155], v[248:251], v[28:31]
    ds_write_b64 v82, v[12:13] offset:18432
    v_mfma_f32_16x16x32_bf16 v[16:19], a[156:159], v[148:151], v[16:19]
    ds_read_b64_tr_b16 a[152:153], v76 offset:16384
    v_xor_b32 v82, 32, v82
    v_mfma_f32_16x16x32_bf16 v[20:23], a[156:159], v[212:215], v[20:23]
    ds_read_b64_tr_b16 a[154:155], v76 offset:18432
    v_mfma_f32_16x16x32_bf16 v[24:27], a[156:159], v[244:247], v[24:27]
    buffer_load_dwordx4 v79, s[12:15], s26 offen sc0 sc1 lds
    v_mfma_f32_16x16x32_bf16 v[28:31], a[156:159], v[252:255], v[28:31]
    v_mfma_f32_16x16x32_bf16 v[32:35], a[160:163], v[120:123], v[32:35]
    ds_read_b64_tr_b16 a[156:157], v76 offset:20480
    v_mul_f32 v16, v64, v16
    v_mfma_f32_16x16x32_bf16 v[36:39], a[160:163], v[184:187], v[36:39]
    ds_read_b64_tr_b16 a[158:159], v76 offset:22528
    v_mul_f32 v17, v64, v17
    v_mfma_f32_16x16x32_bf16 v[40:43], a[160:163], a[176:179], v[40:43]
    s_add_u32 s25, s26, s31
    v_mul_f32 v18, v64, v18
    v_mul_f32 v19, v64, v19
    v_mfma_f32_16x16x32_bf16 v[44:47], a[160:163], a[232:235], v[44:47]
    s_waitcnt lgkmcnt(8)
    v_cvt_pk_bf16_f32 v16, v16, v17
    v_cvt_pk_bf16_f32 v17, v18, v19
    v_mfma_f32_16x16x32_bf16 v[32:35], a[164:167], v[124:127], v[32:35]
    ds_read_b64_tr_b16 a[160:161], v76 offset:24576
    v_mul_f32 v20, v65, v20
    v_mfma_f32_16x16x32_bf16 v[36:39], a[164:167], v[188:191], v[36:39]
    ds_read_b64_tr_b16 a[162:163], v76 offset:26624
    v_mul_f32 v21, v65, v21
    v_mfma_f32_16x16x32_bf16 v[40:43], a[164:167], a[180:183], v[40:43]
    ds_write_b64 v82, v[16:17] offset:0
    v_mfma_f32_16x16x32_bf16 v[44:47], a[164:167], a[236:239], v[44:47]
    s_add_u32 m0, m0, s51
    v_mul_f32 v22, v65, v22
    v_mul_f32 v23, v65, v23
    v_mfma_f32_16x16x32_bf16 v[32:35], a[144:147], v[128:131], v[32:35]
    ds_read_b64_tr_b16 a[164:165], v76 offset:28672
    v_cvt_pk_bf16_f32 v20, v20, v21
    v_mfma_f32_16x16x32_bf16 v[36:39], a[144:147], v[192:195], v[36:39]
    ds_read_b64_tr_b16 a[166:167], v76 offset:30720
    v_cvt_pk_bf16_f32 v21, v22, v23
    v_mfma_f32_16x16x32_bf16 v[40:43], a[144:147], a[184:187], v[40:43]
    buffer_load_dwordx4 v79, s[12:15], s25 offen sc0 sc1 lds
    v_mfma_f32_16x16x32_bf16 v[44:47], a[144:147], a[240:243], v[44:47]
    s_waitcnt lgkmcnt(7)
    ds_write_b64 v82, v[20:21] offset:2048
    v_mfma_f32_16x16x32_bf16 v[32:35], a[148:151], v[132:135], v[32:35]
    ds_read_b64_tr_b16 a[144:145], v77 offset:0
    s_add_u32 s49, s48, s31
    v_mfma_f32_16x16x32_bf16 v[36:39], a[148:151], v[196:199], v[36:39]
    ds_read_b64_tr_b16 a[146:147], v77 offset:2048
    v_mul_f32 v24, v66, v24
    v_mfma_f32_16x16x32_bf16 v[40:43], a[148:151], a[188:191], v[40:43]
    buffer_store_dwordx4 a[116:119], v81, s[16:19], s49 offen sc1
    v_mfma_f32_16x16x32_bf16 v[44:47], a[148:151], a[244:247], v[44:47]
    s_add_u32 s26, s25, s31
    v_mul_f32 v25, v66, v25
    v_mul_f32 v26, v66, v26
    v_mfma_f32_16x16x32_bf16 v[32:35], a[152:155], v[136:139], v[32:35]
    ds_read_b64_tr_b16 a[148:149], v77 offset:4096
    v_mul_f32 v27, v66, v27
    v_mfma_f32_16x16x32_bf16 v[36:39], a[152:155], v[200:203], v[36:39]
    ds_read_b64_tr_b16 a[150:151], v77 offset:6144
    v_cvt_pk_bf16_f32 v24, v24, v25
    v_mfma_f32_16x16x32_bf16 v[40:43], a[152:155], a[192:195], v[40:43]
    s_add_u32 m0, m0, s51
    v_cvt_pk_bf16_f32 v25, v26, v27
    v_mul_f32 v28, v67, v28
    v_mfma_f32_16x16x32_bf16 v[44:47], a[152:155], a[248:251], v[44:47]
    s_waitcnt lgkmcnt(8)
    ds_write_b64 v82, v[24:25] offset:16384
    v_mfma_f32_16x16x32_bf16 v[32:35], a[156:159], v[140:143], v[32:35]
    ds_read_b64_tr_b16 a[152:153], v77 offset:8192
    v_mul_f32 v29, v67, v29
    v_mfma_f32_16x16x32_bf16 v[36:39], a[156:159], v[204:207], v[36:39]
    ds_read_b64_tr_b16 a[154:155], v77 offset:10240
    v_mul_f32 v30, v67, v30
    v_mfma_f32_16x16x32_bf16 v[40:43], a[156:159], a[196:199], v[40:43]
    buffer_load_dwordx4 v79, s[12:15], s26 offen sc0 sc1 lds
    v_mfma_f32_16x16x32_bf16 v[44:47], a[156:159], a[252:255], v[44:47]
    v_mul_f32 v31, v67, v31
    v_cvt_pk_bf16_f32 v28, v28, v29
    v_mfma_f32_16x16x32_bf16 v[32:35], a[160:163], v[144:147], v[32:35]
    ds_read_b64_tr_b16 a[156:157], v77 offset:12288
    v_cvt_pk_bf16_f32 v29, v30, v31
    v_mfma_f32_16x16x32_bf16 v[36:39], a[160:163], v[208:211], v[36:39]
    ds_read_b64_tr_b16 a[158:159], v77 offset:14336
    s_xor_b32 s25, s21, 384
    v_mfma_f32_16x16x32_bf16 v[40:43], a[160:163], v[240:243], v[40:43]
    ds_write_b64 v82, v[28:29] offset:18432
    v_mfma_f32_16x16x32_bf16 v[44:47], a[160:163], v[248:251], v[44:47]
    s_waitcnt lgkmcnt(8)
    v_xor_b32 v82, 96, v82
    s_add_u32 m0, m0, s95
    v_mfma_f32_16x16x32_bf16 v[32:35], a[164:167], v[148:151], v[32:35]
    ds_read_b64_tr_b16 a[160:161], v77 offset:16384
    v_mfma_f32_16x16x32_bf16 v[36:39], a[164:167], v[212:215], v[36:39]
    ds_read_b64_tr_b16 a[162:163], v77 offset:18432
    v_mfma_f32_16x16x32_bf16 v[40:43], a[164:167], v[244:247], v[40:43]
    buffer_load_dwordx4 v79, s[12:15], s25 offen sc0 sc1 lds
    v_mfma_f32_16x16x32_bf16 v[44:47], a[164:167], v[252:255], v[44:47]
    s_waitcnt vmcnt(19)
    v_mfma_f32_16x16x32_bf16 v[48:51], a[144:147], v[120:123], v[48:51]
    ds_read_b64_tr_b16 a[164:165], v77 offset:20480
    v_mul_f32 v32, v64, v32
    v_mfma_f32_16x16x32_bf16 v[52:55], a[144:147], v[184:187], v[52:55]
    ds_read_b64_tr_b16 a[166:167], v77 offset:22528
    v_mul_f32 v33, v64, v33
    v_mfma_f32_16x16x32_bf16 v[56:59], a[144:147], a[176:179], v[56:59]
    ds_read_b128 a[48:51], v70 offset:0
    v_mul_f32 v34, v64, v34
    v_mfma_f32_16x16x32_bf16 v[60:63], a[144:147], a[232:235], v[60:63]
    s_waitcnt lgkmcnt(8)
    v_mul_f32 v35, v64, v35
    v_cvt_pk_bf16_f32 v32, v32, v33
    v_mfma_f32_16x16x32_bf16 v[48:51], a[148:151], v[124:127], v[48:51]
    ds_read_b64_tr_b16 a[144:145], v77 offset:24576
    v_cvt_pk_bf16_f32 v33, v34, v35
    v_mfma_f32_16x16x32_bf16 v[52:55], a[148:151], v[188:191], v[52:55]
    ds_read_b64_tr_b16 a[146:147], v77 offset:26624
    v_mul_f32 v36, v65, v36
    v_mfma_f32_16x16x32_bf16 v[56:59], a[148:151], a[180:183], v[56:59]
    ds_write_b64 v82, v[32:33] offset:0
    v_mfma_f32_16x16x32_bf16 v[60:63], a[148:151], a[236:239], v[60:63]
    ds_read_b128 a[52:55], v71 offset:0
    v_mul_f32 v37, v65, v37
    v_mfma_f32_16x16x32_bf16 v[48:51], a[152:155], v[128:131], v[48:51]
    ds_read_b64_tr_b16 a[148:149], v77 offset:28672
    v_mul_f32 v38, v65, v38
    v_mfma_f32_16x16x32_bf16 v[52:55], a[152:155], v[192:195], v[52:55]
    ds_read_b64_tr_b16 a[150:151], v77 offset:30720
    s_waitcnt vmcnt(15)
    v_mfma_f32_16x16x32_bf16 v[56:59], a[152:155], a[184:187], v[56:59]
    s_barrier
    v_mfma_f32_16x16x32_bf16 v[60:63], a[152:155], a[240:243], v[60:63]
    s_waitcnt lgkmcnt(9)
    s_add_u32 s26, s25, s31
    v_mul_f32 v39, v65, v39
    v_mfma_f32_16x16x32_bf16 v[48:51], a[156:159], v[132:135], v[48:51]
    ds_read_b64_tr_b16 a[152:153], v74 offset:32768
    v_cvt_pk_bf16_f32 v36, v36, v37
    v_mfma_f32_16x16x32_bf16 v[52:55], a[156:159], v[196:199], v[52:55]
    ds_read_b64_tr_b16 a[154:155], v74 offset:34816
    s_add_u32 m0, m0, s51
    v_mfma_f32_16x16x32_bf16 v[56:59], a[156:159], a[188:191], v[56:59]
    buffer_load_dwordx4 v79, s[12:15], s26 offen sc0 sc1 lds
    v_mfma_f32_16x16x32_bf16 v[60:63], a[156:159], a[244:247], v[60:63]
    s_add_u32 s48, s49, s31
    ds_read_b128 a[56:59], v70 offset:2048
    v_mfma_f32_16x16x32_bf16 v[48:51], a[160:163], v[136:139], v[48:51]
    ds_read_b64_tr_b16 a[156:157], v74 offset:36864
    v_cvt_pk_bf16_f32 v37, v38, v39
    v_mfma_f32_16x16x32_bf16 v[52:55], a[160:163], v[200:203], v[52:55]
    ds_read_b64_tr_b16 a[158:159], v74 offset:38912
    v_mul_f32 v40, v66, v40
    v_mfma_f32_16x16x32_bf16 v[56:59], a[160:163], a[192:195], v[56:59]
    buffer_store_dwordx4 a[120:123], v81, s[16:19], s48 offen sc1
    v_mfma_f32_16x16x32_bf16 v[60:63], a[160:163], a[248:251], v[60:63]
    s_waitcnt lgkmcnt(9)
L_w7:
    s_cbranch_execz L_w11
    ds_read_b128 a[60:63], v71 offset:2048
    v_mfma_f32_16x16x32_bf16 v[48:51], a[164:167], v[140:143], v[48:51]
    ds_read_b64_tr_b16 a[160:161], v74 offset:40960
    v_mul_f32 v41, v66, v41
    v_mfma_f32_16x16x32_bf16 v[52:55], a[164:167], v[204:207], v[52:55]
    ds_read_b64_tr_b16 a[162:163], v74 offset:43008
    v_mul_f32 v42, v66, v42
    v_mfma_f32_16x16x32_bf16 v[56:59], a[164:167], a[196:199], v[56:59]
    ds_write_b64 v82, v[36:37] offset:2048
    v_mfma_f32_16x16x32_bf16 v[60:63], a[164:167], a[252:255], v[60:63]
    s_add_u32 s25, s26, s31
    v_mul_f32 v43, v66, v43
    v_cvt_pk_bf16_f32 v40, v40, v41
    v_mfma_f32_16x16x32_bf16 v[48:51], a[144:147], v[144:147], v[48:51]
    ds_read_b64_tr_b16 a[164:165], v74 offset:45056
    v_cvt_pk_bf16_f32 v41, v42, v43
    v_mfma_f32_16x16x32_bf16 v[52:55], a[144:147], v[208:211], v[52:55]
    ds_read_b64_tr_b16 a[166:167], v74 offset:47104
    s_add_u32 m0, m0, s51
    v_mfma_f32_16x16x32_bf16 v[56:59], a[144:147], v[240:243], v[56:59]
    buffer_load_dwordx4 v79, s[12:15], s25 offen sc0 sc1 lds
    v_mfma_f32_16x16x32_bf16 v[60:63], a[144:147], v[248:251], v[60:63]
    s_waitcnt lgkmcnt(9)
    v_mul_f32 v44, v67, v44
    v_mul_f32 v45, v67, v45
    v_mfma_f32_16x16x32_bf16 v[48:51], a[148:151], v[148:151], v[48:51]
    ds_read_b64_tr_b16 a[144:145], v74 offset:49152
    v_mul_f32 v46, v67, v46
    v_mfma_f32_16x16x32_bf16 v[52:55], a[148:151], v[212:215], v[52:55]
    ds_read_b64_tr_b16 a[146:147], v74 offset:51200
    v_mul_f32 v47, v67, v47
    v_mfma_f32_16x16x32_bf16 v[56:59], a[148:151], v[244:247], v[56:59]
    ds_write_b64 v82, v[40:41] offset:16384
    v_mfma_f32_16x16x32_bf16 v[60:63], a[148:151], v[252:255], v[60:63]
    s_add_u32 s26, s25, s31
    v_cvt_pk_bf16_f32 v44, v44, v45
    v_cvt_pk_bf16_f32 v45, v46, v47
    v_mfma_f32_16x16x32_bf16 v[0:3], a[152:155], v[88:91], 0
    ds_read_b64_tr_b16 a[148:149], v74 offset:53248
    v_mul_f32 v48, v64, v48
    v_mfma_f32_16x16x32_bf16 v[4:7], a[152:155], v[152:155], 0
    ds_read_b64_tr_b16 a[150:151], v74 offset:55296
    v_mul_f32 v49, v64, v49
    v_mfma_f32_16x16x32_bf16 v[8:11], a[152:155], v[216:219], 0
    s_add_u32 m0, m0, s51
    v_mul_f32 v50, v64, v50
    v_mul_f32 v51, v64, v51
    v_mfma_f32_16x16x32_bf16 v[12:15], a[152:155], a[200:203], 0
    s_waitcnt lgkmcnt(8)
    v_cvt_pk_bf16_f32 v48, v48, v49
    v_cvt_pk_bf16_f32 v49, v50, v51
    v_mfma_f32_16x16x32_bf16 v[0:3], a[156:159], v[92:95], v[0:3]
    ds_read_b64_tr_b16 a[152:153], v74 offset:57344
    v_mul_f32 v52, v65, v52
    v_mfma_f32_16x16x32_bf16 v[4:7], a[156:159], v[156:159], v[4:7]
    ds_read_b64_tr_b16 a[154:155], v74 offset:59392
    v_mul_f32 v53, v65, v53
    v_mfma_f32_16x16x32_bf16 v[8:11], a[156:159], v[220:223], v[8:11]
    ds_write_b64 v82, v[44:45] offset:18432
    v_mfma_f32_16x16x32_bf16 v[12:15], a[156:159], a[204:207], v[12:15]
    buffer_load_dwordx4 v79, s[12:15], s26 offen sc0 sc1 lds
    v_mfma_f32_16x16x32_bf16 v[0:3], a[160:163], v[96:99], v[0:3]
    ds_read_b64_tr_b16 a[156:157], v74 offset:61440
    s_add_u32 s43, s42, 16640
    v_mfma_f32_16x16x32_bf16 v[4:7], a[160:163], v[160:163], v[4:7]
    ds_read_b64_tr_b16 a[158:159], v74 offset:63488
    s_add_u32 m0, s44, 114688
    v_mfma_f32_16x16x32_bf16 v[8:11], a[160:163], v[224:227], v[8:11]
    buffer_load_dwordx4 v78, s[4:7], s43 offen offset:0 sc0 sc1 nt lds
    v_mfma_f32_16x16x32_bf16 v[12:15], a[160:163], a[208:211], v[12:15]
    s_waitcnt lgkmcnt(8)
    v_xor_b32 v82, 32, v82
    v_add_u32 v74, s96, v74
    v_mfma_f32_16x16x32_bf16 v[0:3], a[164:167], v[100:103], v[0:3]
    ds_read_b64_tr_b16 a[160:161], v75 offset:32768
    v_mul_f32 v54, v65, v54
    v_mfma_f32_16x16x32_bf16 v[4:7], a[164:167], v[164:167], v[4:7]
    ds_read_b64_tr_b16 a[162:163], v75 offset:34816
    s_add_u32 m0, s45, 114688
    v_mfma_f32_16x16x32_bf16 v[8:11], a[164:167], v[228:231], v[8:11]
    ds_write_b64 v82, v[48:49] offset:0
    v_mfma_f32_16x16x32_bf16 v[12:15], a[164:167], a[212:215], v[12:15]
    buffer_load_dwordx4 v72, s[4:7], s43 offen offset:0 sc0 sc1 nt lds
    v_mfma_f32_16x16x32_bf16 v[0:3], a[144:147], v[104:107], v[0:3]
    ds_read_b64_tr_b16 a[164:165], v75 offset:36864
    s_add_u32 s49, s48, s31
    v_mfma_f32_16x16x32_bf16 v[4:7], a[144:147], v[168:171], v[4:7]
    ds_read_b64_tr_b16 a[166:167], v75 offset:38912
    v_mul_f32 v55, v65, v55
    v_mfma_f32_16x16x32_bf16 v[8:11], a[144:147], v[232:235], v[8:11]
    buffer_store_dwordx4 a[124:127], v81, s[16:19], s49 offen sc1
    v_mfma_f32_16x16x32_bf16 v[12:15], a[144:147], a[216:219], v[12:15]
    s_waitcnt lgkmcnt(8)
    v_cvt_pk_bf16_f32 v52, v52, v53
    v_cvt_pk_bf16_f32 v53, v54, v55
    v_mfma_f32_16x16x32_bf16 v[0:3], a[148:151], v[108:111], v[0:3]
    ds_read_b64_tr_b16 a[144:145], v75 offset:40960
    v_mul_f32 v56, v66, v56
    v_mfma_f32_16x16x32_bf16 v[4:7], a[148:151], v[172:175], v[4:7]
    ds_read_b64_tr_b16 a[146:147], v75 offset:43008
    s_add_u32 m0, s44, 116608
    v_mfma_f32_16x16x32_bf16 v[8:11], a[148:151], v[236:239], v[8:11]
    ds_write_b64 v82, v[52:53] offset:2048
    v_mfma_f32_16x16x32_bf16 v[12:15], a[148:151], a[220:223], v[12:15]
    buffer_load_dwordx4 v78, s[4:7], s43 offen offset:128 sc0 sc1 nt lds
    v_mfma_f32_16x16x32_bf16 v[0:3], a[152:155], v[112:115], v[0:3]
    ds_read_b64_tr_b16 a[148:149], v75 offset:45056
    v_mul_f32 v57, v66, v57
    v_mfma_f32_16x16x32_bf16 v[4:7], a[152:155], v[176:179], v[4:7]
    ds_read_b64_tr_b16 a[150:151], v75 offset:47104
    v_mul_f32 v58, v66, v58
    v_mfma_f32_16x16x32_bf16 v[8:11], a[152:155], a[168:171], v[8:11]
    s_add_u32 m0, s45, 116608
    v_mul_f32 v59, v66, v59
    v_cvt_pk_bf16_f32 v56, v56, v57
    v_mfma_f32_16x16x32_bf16 v[12:15], a[152:155], a[224:227], v[12:15]
    s_waitcnt lgkmcnt(8)
    v_cvt_pk_bf16_f32 v57, v58, v59
    v_mul_f32 v60, v67, v60
    v_mfma_f32_16x16x32_bf16 v[0:3], a[156:159], v[116:119], v[0:3]
    ds_read_b64_tr_b16 a[152:153], v75 offset:49152
    v_mul_f32 v61, v67, v61
    v_mfma_f32_16x16x32_bf16 v[4:7], a[156:159], v[180:183], v[4:7]
    ds_read_b64_tr_b16 a[154:155], v75 offset:51200
    v_mul_f32 v62, v67, v62
    v_mfma_f32_16x16x32_bf16 v[8:11], a[156:159], a[172:175], v[8:11]
    ds_write_b64 v82, v[56:57] offset:16384
    v_mfma_f32_16x16x32_bf16 v[12:15], a[156:159], a[228:231], v[12:15]
    buffer_load_dwordx4 v72, s[4:7], s43 offen offset:128 sc0 sc1 nt lds
    v_mfma_f32_16x16x32_bf16 v[16:19], a[160:163], v[88:91], 0
    ds_read_b64_tr_b16 a[156:157], v75 offset:53248
    v_mul_f32 v63, v67, v63
    v_mfma_f32_16x16x32_bf16 v[20:23], a[160:163], v[152:155], 0
    ds_read_b64_tr_b16 a[158:159], v75 offset:55296
    v_cvt_pk_bf16_f32 v60, v60, v61
    v_mfma_f32_16x16x32_bf16 v[24:27], a[160:163], v[216:219], 0
    ds_read_b128 a[96:99], v83 offset:0
    v_cvt_pk_bf16_f32 v61, v62, v63
    v_mfma_f32_16x16x32_bf16 v[28:31], a[160:163], a[200:203], 0
    s_waitcnt lgkmcnt(9)
    v_mfma_f32_16x16x32_bf16 v[16:19], a[164:167], v[92:95], v[16:19]
    ds_read_b64_tr_b16 a[160:161], v75 offset:57344
    v_mfma_f32_16x16x32_bf16 v[20:23], a[164:167], v[156:159], v[20:23]
    ds_read_b64_tr_b16 a[162:163], v75 offset:59392
    v_mfma_f32_16x16x32_bf16 v[24:27], a[164:167], v[220:223], v[24:27]
    ds_write_b64 v82, v[60:61] offset:18432
    v_mfma_f32_16x16x32_bf16 v[28:31], a[164:167], a[204:207], v[28:31]
    s_barrier
    v_mfma_f32_16x16x32_bf16 v[16:19], a[144:147], v[96:99], v[16:19]
    ds_read_b64_tr_b16 a[164:165], v75 offset:61440
    v_xor_b32 v82, 96, v82
    v_mfma_f32_16x16x32_bf16 v[20:23], a[144:147], v[160:163], v[20:23]
    ds_read_b64_tr_b16 a[166:167], v75 offset:63488
    v_add_u32 v75, s96, v75
    v_mfma_f32_16x16x32_bf16 v[24:27], a[144:147], v[224:227], v[24:27]
    s_xor_b32 s25, s21, 65920
    s_xor_b32 s3, s46, 128
    s_add_u32 s48, s3, 0
    v_mfma_f32_16x16x32_bf16 v[28:31], a[144:147], a[208:211], v[28:31]
    s_waitcnt lgkmcnt(9)
    s_add_u32 m0, s23, 0
    v_mfma_f32_16x16x32_bf16 v[16:19], a[148:151], v[100:103], v[16:19]
    ds_read_b64_tr_b16 a[144:145], v76 offset:32768
    v_mfma_f32_16x16x32_bf16 v[20:23], a[148:151], v[164:167], v[20:23]
    ds_read_b64_tr_b16 a[146:147], v76 offset:34816
    v_mfma_f32_16x16x32_bf16 v[24:27], a[148:151], v[228:231], v[24:27]
    buffer_load_dwordx4 v79, s[12:15], s25 offen sc0 sc1 lds
    v_mfma_f32_16x16x32_bf16 v[28:31], a[148:151], a[212:215], v[28:31]
    v_mfma_f32_16x16x32_bf16 v[16:19], a[152:155], v[104:107], v[16:19]
    ds_read_b64_tr_b16 a[148:149], v76 offset:36864
    v_mfma_f32_16x16x32_bf16 v[20:23], a[152:155], v[168:171], v[20:23]
    ds_read_b64_tr_b16 a[150:151], v76 offset:38912
    v_mfma_f32_16x16x32_bf16 v[24:27], a[152:155], v[232:235], v[24:27]
    s_waitcnt lgkmcnt(7)
    v_mfma_f32_16x16x32_bf16 v[28:31], a[152:155], a[216:219], v[28:31]
    buffer_store_dwordx4 a[96:99], v81, s[16:19], s48 offen sc1
    v_mfma_f32_16x16x32_bf16 v[16:19], a[156:159], v[108:111], v[16:19]
    ds_read_b64_tr_b16 a[152:153], v76 offset:40960
    s_add_u32 s26, s25, s31
    v_mfma_f32_16x16x32_bf16 v[20:23], a[156:159], v[172:175], v[20:23]
    ds_read_b64_tr_b16 a[154:155], v76 offset:43008
    v_mfma_f32_16x16x32_bf16 v[24:27], a[156:159], v[236:239], v[24:27]
    v_mfma_f32_16x16x32_bf16 v[28:31], a[156:159], a[220:223], v[28:31]
    s_add_u32 m0, m0, s51
    v_mfma_f32_16x16x32_bf16 v[16:19], a[160:163], v[112:115], v[16:19]
    ds_read_b64_tr_b16 a[156:157], v76 offset:45056
    v_mfma_f32_16x16x32_bf16 v[20:23], a[160:163], v[176:179], v[20:23]
    ds_read_b64_tr_b16 a[158:159], v76 offset:47104
    v_mfma_f32_16x16x32_bf16 v[24:27], a[160:163], a[168:171], v[24:27]
    buffer_load_dwordx4 v79, s[12:15], s26 offen sc0 sc1 lds
    v_mfma_f32_16x16x32_bf16 v[28:31], a[160:163], a[224:227], v[28:31]
    s_waitcnt lgkmcnt(6)
    v_mfma_f32_16x16x32_bf16 v[16:19], a[164:167], v[116:119], v[16:19]
    ds_read_b64_tr_b16 a[160:161], v76 offset:49152
    v_mfma_f32_16x16x32_bf16 v[20:23], a[164:167], v[180:183], v[20:23]
    ds_read_b64_tr_b16 a[162:163], v76 offset:51200
    v_mfma_f32_16x16x32_bf16 v[24:27], a[164:167], a[172:175], v[24:27]
    v_mfma_f32_16x16x32_bf16 v[28:31], a[164:167], a[228:231], v[28:31]
    v_mfma_f32_16x16x32_bf16 v[32:35], a[144:147], v[88:91], 0
    ds_read_b64_tr_b16 a[164:165], v76 offset:53248
    s_add_u32 s25, s26, s31
    v_mfma_f32_16x16x32_bf16 v[36:39], a[144:147], v[152:155], 0
    ds_read_b64_tr_b16 a[166:167], v76 offset:55296
    v_mfma_f32_16x16x32_bf16 v[40:43], a[144:147], v[216:219], 0
    ds_read_b128 a[100:103], v83 offset:1024
    s_waitcnt lgkmcnt(7)
    v_mfma_f32_16x16x32_bf16 v[44:47], a[144:147], a[200:203], 0
    s_add_u32 m0, m0, s51
    v_mfma_f32_16x16x32_bf16 v[32:35], a[148:151], v[92:95], v[32:35]
    ds_read_b64_tr_b16 a[144:145], v76 offset:57344
    v_mfma_f32_16x16x32_bf16 v[36:39], a[148:151], v[156:159], v[36:39]
    ds_read_b64_tr_b16 a[146:147], v76 offset:59392
    v_mfma_f32_16x16x32_bf16 v[40:43], a[148:151], v[220:223], v[40:43]
    buffer_load_dwordx4 v79, s[12:15], s25 offen sc0 sc1 lds
    v_mfma_f32_16x16x32_bf16 v[44:47], a[148:151], a[204:207], v[44:47]
    s_add_u32 s49, s48, s31
    v_mfma_f32_16x16x32_bf16 v[32:35], a[152:155], v[96:99], v[32:35]
    ds_read_b64_tr_b16 a[148:149], v76 offset:61440
    v_mfma_f32_16x16x32_bf16 v[36:39], a[152:155], v[160:163], v[36:39]
    ds_read_b64_tr_b16 a[150:151], v76 offset:63488
    v_add_u32 v76, s96, v76
    v_mfma_f32_16x16x32_bf16 v[40:43], a[152:155], v[224:227], v[40:43]
    s_waitcnt lgkmcnt(7)
    v_mfma_f32_16x16x32_bf16 v[44:47], a[152:155], a[208:211], v[44:47]
    v_mfma_f32_16x16x32_bf16 v[32:35], a[156:159], v[100:103], v[32:35]
    ds_read_b64_tr_b16 a[152:153], v77 offset:32768
    s_add_u32 s26, s25, s31
    v_mfma_f32_16x16x32_bf16 v[36:39], a[156:159], v[164:167], v[36:39]
    ds_read_b64_tr_b16 a[154:155], v77 offset:34816
    v_mfma_f32_16x16x32_bf16 v[40:43], a[156:159], v[228:231], v[40:43]
    v_mfma_f32_16x16x32_bf16 v[44:47], a[156:159], a[212:215], v[44:47]
    s_add_u32 m0, m0, s51
    v_mfma_f32_16x16x32_bf16 v[32:35], a[160:163], v[104:107], v[32:35]
    ds_read_b64_tr_b16 a[156:157], v77 offset:36864
    v_mfma_f32_16x16x32_bf16 v[36:39], a[160:163], v[168:171], v[36:39]
    ds_read_b64_tr_b16 a[158:159], v77 offset:38912
    v_mfma_f32_16x16x32_bf16 v[40:43], a[160:163], v[232:235], v[40:43]
    buffer_load_dwordx4 v79, s[12:15], s26 offen sc0 sc1 lds
    v_mfma_f32_16x16x32_bf16 v[44:47], a[160:163], a[216:219], v[44:47]
    s_waitcnt lgkmcnt(6)
    v_mfma_f32_16x16x32_bf16 v[32:35], a[164:167], v[108:111], v[32:35]
    ds_read_b64_tr_b16 a[160:161], v77 offset:40960
    v_mfma_f32_16x16x32_bf16 v[36:39], a[164:167], v[172:175], v[36:39]
    ds_read_b64_tr_b16 a[162:163], v77 offset:43008
    v_mfma_f32_16x16x32_bf16 v[40:43], a[164:167], v[236:239], v[40:43]
    buffer_store_dwordx4 a[100:103], v81, s[16:19], s49 offen sc1
    v_mfma_f32_16x16x32_bf16 v[44:47], a[164:167], a[220:223], v[44:47]
    v_mfma_f32_16x16x32_bf16 v[32:35], a[144:147], v[112:115], v[32:35]
    ds_read_b64_tr_b16 a[164:165], v77 offset:45056
    s_xor_b32 s25, s21, 131456
    v_mfma_f32_16x16x32_bf16 v[36:39], a[144:147], v[176:179], v[36:39]
    ds_read_b64_tr_b16 a[166:167], v77 offset:47104
    v_mfma_f32_16x16x32_bf16 v[40:43], a[144:147], a[168:171], v[40:43]
    s_waitcnt lgkmcnt(6)
    v_mfma_f32_16x16x32_bf16 v[44:47], a[144:147], a[224:227], v[44:47]
    s_add_u32 m0, m0, s95
    v_mfma_f32_16x16x32_bf16 v[32:35], a[148:151], v[116:119], v[32:35]
    ds_read_b64_tr_b16 a[144:145], v77 offset:49152
    v_mfma_f32_16x16x32_bf16 v[36:39], a[148:151], v[180:183], v[36:39]
    ds_read_b64_tr_b16 a[146:147], v77 offset:51200
    v_mfma_f32_16x16x32_bf16 v[40:43], a[148:151], a[172:175], v[40:43]
    buffer_load_dwordx4 v79, s[12:15], s25 offen sc0 sc1 lds
    v_mfma_f32_16x16x32_bf16 v[44:47], a[148:151], a[228:231], v[44:47]
    v_mfma_f32_16x16x32_bf16 v[48:51], a[152:155], v[88:91], 0
    ds_read_b64_tr_b16 a[148:149], v77 offset:53248
    v_mfma_f32_16x16x32_bf16 v[52:55], a[152:155], v[152:155], 0
    ds_read_b64_tr_b16 a[150:151], v77 offset:55296
    v_mfma_f32_16x16x32_bf16 v[56:59], a[152:155], v[216:219], 0
    ds_read_b128 a[104:107], v83 offset:2048
    s_waitcnt lgkmcnt(7)
    v_mfma_f32_16x16x32_bf16 v[60:63], a[152:155], a[200:203], 0
    v_mfma_f32_16x16x32_bf16 v[48:51], a[156:159], v[92:95], v[48:51]
    ds_read_b64_tr_b16 a[152:153], v77 offset:57344
    v_mfma_f32_16x16x32_bf16 v[52:55], a[156:159], v[156:159], v[52:55]
    ds_read_b64_tr_b16 a[154:155], v77 offset:59392
    v_mfma_f32_16x16x32_bf16 v[56:59], a[156:159], v[220:223], v[56:59]
    s_waitcnt vmcnt(17)
    v_mfma_f32_16x16x32_bf16 v[60:63], a[156:159], a[204:207], v[60:63]
    s_barrier
    v_mfma_f32_16x16x32_bf16 v[48:51], a[160:163], v[96:99], v[48:51]
    ds_read_b64_tr_b16 a[156:157], v77 offset:61440
    s_add_u32 s26, s25, s31
    v_mfma_f32_16x16x32_bf16 v[52:55], a[160:163], v[160:163], v[52:55]
    ds_read_b64_tr_b16 a[158:159], v77 offset:63488
    v_add_u32 v77, s96, v77
    v_mfma_f32_16x16x32_bf16 v[56:59], a[160:163], v[224:227], v[56:59]
    s_add_u32 m0, m0, s51
    s_add_u32 s48, s49, s31
    s_waitcnt lgkmcnt(7)
    v_mfma_f32_16x16x32_bf16 v[60:63], a[160:163], a[208:211], v[60:63]
    buffer_load_dwordx4 v79, s[12:15], s26 offen sc0 sc1 lds
    v_mfma_f32_16x16x32_bf16 v[48:51], a[164:167], v[100:103], v[48:51]
    ds_read_b64_tr_b16 a[160:161], v74 offset:16384
    v_mfma_f32_16x16x32_bf16 v[52:55], a[164:167], v[164:167], v[52:55]
    ds_read_b64_tr_b16 a[162:163], v74 offset:18432
    v_mfma_f32_16x16x32_bf16 v[56:59], a[164:167], v[228:231], v[56:59]
    v_mfma_f32_16x16x32_bf16 v[60:63], a[164:167], a[212:215], v[60:63]
    v_mfma_f32_16x16x32_bf16 v[48:51], a[144:147], v[104:107], v[48:51]
    ds_read_b64_tr_b16 a[164:165], v74 offset:20480
    s_add_u32 s25, s26, s31
    v_mfma_f32_16x16x32_bf16 v[52:55], a[144:147], v[168:171], v[52:55]
    ds_read_b64_tr_b16 a[166:167], v74 offset:22528
    v_mfma_f32_16x16x32_bf16 v[56:59], a[144:147], v[232:235], v[56:59]
    s_waitcnt lgkmcnt(6)
    v_mfma_f32_16x16x32_bf16 v[60:63], a[144:147], a[216:219], v[60:63]
    buffer_store_dwordx4 a[104:107], v81, s[16:19], s48 offen sc1
    v_mfma_f32_16x16x32_bf16 v[48:51], a[148:151], v[108:111], v[48:51]
    ds_read_b64_tr_b16 a[144:145], v74 offset:24576
    s_add_u32 m0, m0, s51
    v_mfma_f32_16x16x32_bf16 v[52:55], a[148:151], v[172:175], v[52:55]
    ds_read_b64_tr_b16 a[146:147], v74 offset:26624
    v_mfma_f32_16x16x32_bf16 v[56:59], a[148:151], v[236:239], v[56:59]
    buffer_load_dwordx4 v79, s[12:15], s25 offen sc0 sc1 lds
    v_mfma_f32_16x16x32_bf16 v[60:63], a[148:151], a[220:223], v[60:63]
    ds_read_b128 a[108:111], v83 offset:3072
    v_mfma_f32_16x16x32_bf16 v[48:51], a[152:155], v[112:115], v[48:51]
    ds_read_b64_tr_b16 a[148:149], v74 offset:28672
    v_mfma_f32_16x16x32_bf16 v[52:55], a[152:155], v[176:179], v[52:55]
    ds_read_b64_tr_b16 a[150:151], v74 offset:30720
    v_mfma_f32_16x16x32_bf16 v[56:59], a[152:155], a[168:171], v[56:59]
    ds_read_b128 a[112:115], v83 offset:16384
    s_waitcnt lgkmcnt(8)
    v_mfma_f32_16x16x32_bf16 v[60:63], a[152:155], a[224:227], v[60:63]
    v_mfma_f32_16x16x32_bf16 v[48:51], a[156:159], v[116:119], v[48:51]
    ds_read_b64_tr_b16 a[152:153], v74 offset:32768
    s_add_u32 s26, s25, s31
    v_mfma_f32_16x16x32_bf16 v[52:55], a[156:159], v[180:183], v[52:55]
    ds_read_b64_tr_b16 a[154:155], v74 offset:34816
    v_mfma_f32_16x16x32_bf16 v[56:59], a[156:159], a[172:175], v[56:59]
    ds_read_b128 a[116:119], v83 offset:17408
    v_mfma_f32_16x16x32_bf16 v[60:63], a[156:159], a[228:231], v[60:63]
    s_add_u32 m0, m0, s51
    v_mfma_f32_16x16x32_bf16 v[0:3], a[160:163], v[120:123], v[0:3]
    ds_read_b64_tr_b16 a[156:157], v74 offset:36864
    v_mfma_f32_16x16x32_bf16 v[4:7], a[160:163], v[184:187], v[4:7]
    ds_read_b64_tr_b16 a[158:159], v74 offset:38912
    v_mfma_f32_16x16x32_bf16 v[8:11], a[160:163], a[176:179], v[8:11]
    buffer_load_dwordx4 v79, s[12:15], s26 offen sc0 sc1 lds
    v_mfma_f32_16x16x32_bf16 v[12:15], a[160:163], a[232:235], v[12:15]
    s_waitcnt lgkmcnt(9)
    ds_read_b128 a[120:123], v83 offset:18432
    v_mfma_f32_16x16x32_bf16 v[0:3], a[164:167], v[124:127], v[0:3]
    ds_read_b64_tr_b16 a[160:161], v74 offset:40960
    v_mfma_f32_16x16x32_bf16 v[4:7], a[164:167], v[188:191], v[4:7]
    ds_read_b64_tr_b16 a[162:163], v74 offset:43008
    v_mfma_f32_16x16x32_bf16 v[8:11], a[164:167], a[180:183], v[8:11]
    ds_read_b128 a[124:127], v83 offset:19456
    s_add_u32 s49, s48, s31
    v_mfma_f32_16x16x32_bf16 v[12:15], a[164:167], a[236:239], v[12:15]
    v_mfma_f32_16x16x32_bf16 v[0:3], a[144:147], v[128:131], v[0:3]
    ds_read_b64_tr_b16 a[164:165], v74 offset:45056
    v_mfma_f32_16x16x32_bf16 v[4:7], a[144:147], v[192:195], v[4:7]
    ds_read_b64_tr_b16 a[166:167], v74 offset:47104
    v_mfma_f32_16x16x32_bf16 v[8:11], a[144:147], a[184:187], v[8:11]
    s_waitcnt lgkmcnt(9)
    v_mfma_f32_16x16x32_bf16 v[12:15], a[144:147], a[240:243], v[12:15]
    v_mfma_f32_16x16x32_bf16 v[0:3], a[148:151], v[132:135], v[0:3]
    ds_read_b64_tr_b16 a[144:145], v75 offset:16384
    v_mfma_f32_16x16x32_bf16 v[4:7], a[148:151], v[196:199], v[4:7]
    ds_read_b64_tr_b16 a[146:147], v75 offset:18432
    v_mfma_f32_16x16x32_bf16 v[8:11], a[148:151], a[188:191], v[8:11]
    buffer_store_dwordx4 a[108:111], v81, s[16:19], s49 offen sc1
    v_mfma_f32_16x16x32_bf16 v[12:15], a[148:151], a[244:247], v[12:15]
    v_mfma_f32_16x16x32_bf16 v[0:3], a[152:155], v[136:139], v[0:3]
    ds_read_b64_tr_b16 a[148:149], v75 offset:20480
    v_mfma_f32_16x16x32_bf16 v[4:7], a[152:155], v[200:203], v[4:7]
    ds_read_b64_tr_b16 a[150:151], v75 offset:22528
    v_mfma_f32_16x16x32_bf16 v[8:11], a[152:155], a[192:195], v[8:11]
    s_waitcnt lgkmcnt(7)
    v_mfma_f32_16x16x32_bf16 v[12:15], a[152:155], a[248:251], v[12:15]
    v_mfma_f32_16x16x32_bf16 v[0:3], a[156:159], v[140:143], v[0:3]
    ds_read_b64_tr_b16 a[152:153], v75 offset:24576
    v_mfma_f32_16x16x32_bf16 v[4:7], a[156:159], v[204:207], v[4:7]
    ds_read_b64_tr_b16 a[154:155], v75 offset:26624
    v_mfma_f32_16x16x32_bf16 v[8:11], a[156:159], a[196:199], v[8:11]
    v_mfma_f32_16x16x32_bf16 v[12:15], a[156:159], a[252:255], v[12:15]
    v_mfma_f32_16x16x32_bf16 v[0:3], a[160:163], v[144:147], v[0:3]
    ds_read_b64_tr_b16 a[156:157], v75 offset:28672
    v_mfma_f32_16x16x32_bf16 v[4:7], a[160:163], v[208:211], v[4:7]
    ds_read_b64_tr_b16 a[158:159], v75 offset:30720
    v_mfma_f32_16x16x32_bf16 v[8:11], a[160:163], v[240:243], v[8:11]
    s_waitcnt lgkmcnt(6)
    v_mfma_f32_16x16x32_bf16 v[12:15], a[160:163], v[248:251], v[12:15]
    v_mfma_f32_16x16x32_bf16 v[0:3], a[164:167], v[148:151], v[0:3]
    ds_read_b64_tr_b16 a[160:161], v75 offset:32768
    v_mfma_f32_16x16x32_bf16 v[4:7], a[164:167], v[212:215], v[4:7]
    ds_read_b64_tr_b16 a[162:163], v75 offset:34816
    v_mfma_f32_16x16x32_bf16 v[8:11], a[164:167], v[244:247], v[8:11]
    v_mfma_f32_16x16x32_bf16 v[12:15], a[164:167], v[252:255], v[12:15]
    v_mfma_f32_16x16x32_bf16 v[16:19], a[144:147], v[120:123], v[16:19]
    ds_read_b64_tr_b16 a[164:165], v75 offset:36864
    v_mfma_f32_16x16x32_bf16 v[20:23], a[144:147], v[184:187], v[20:23]
    ds_read_b64_tr_b16 a[166:167], v75 offset:38912
    v_mul_f32 v0, v64, v0
    v_mfma_f32_16x16x32_bf16 v[24:27], a[144:147], a[176:179], v[24:27]
    s_waitcnt lgkmcnt(6)
    v_mul_f32 v1, v64, v1
    v_mul_f32 v2, v64, v2
    v_mfma_f32_16x16x32_bf16 v[28:31], a[144:147], a[232:235], v[28:31]
    v_mul_f32 v3, v64, v3
    v_cvt_pk_bf16_f32 v0, v0, v1
    v_mfma_f32_16x16x32_bf16 v[16:19], a[148:151], v[124:127], v[16:19]
    ds_read_b64_tr_b16 a[144:145], v75 offset:40960
    v_cvt_pk_bf16_f32 v1, v2, v3
    v_mfma_f32_16x16x32_bf16 v[20:23], a[148:151], v[188:191], v[20:23]
    ds_read_b64_tr_b16 a[146:147], v75 offset:43008
    v_mul_f32 v4, v65, v4
    v_mfma_f32_16x16x32_bf16 v[24:27], a[148:151], a[180:183], v[24:27]
    ds_write_b64 v82, v[0:1] offset:0
    v_mfma_f32_16x16x32_bf16 v[28:31], a[148:151], a[236:239], v[28:31]
    s_barrier
    v_mfma_f32_16x16x32_bf16 v[16:19], a[152:155], v[128:131], v[16:19]
    ds_read_b64_tr_b16 a[148:149], v75 offset:45056
    v_mul_f32 v5, v65, v5
    v_mfma_f32_16x16x32_bf16 v[20:23], a[152:155], v[192:195], v[20:23]
    ds_read_b64_tr_b16 a[150:151], v75 offset:47104
    v_mul_f32 v6, v65, v6
    v_mfma_f32_16x16x32_bf16 v[24:27], a[152:155], a[184:187], v[24:27]
    s_xor_b32 s25, s21, 196992
    v_mul_f32 v7, v65, v7
    v_cvt_pk_bf16_f32 v4, v4, v5
    v_mfma_f32_16x16x32_bf16 v[28:31], a[152:155], a[240:243], v[28:31]
    s_waitcnt lgkmcnt(7)
    v_cvt_pk_bf16_f32 v5, v6, v7
    v_mul_f32 v8, v66, v8
    v_mfma_f32_16x16x32_bf16 v[16:19], a[156:159], v[132:135], v[16:19]
    ds_read_b64_tr_b16 a[152:153], v76 offset:16384
    s_add_u32 s48, s49, s31
    v_mfma_f32_16x16x32_bf16 v[20:23], a[156:159], v[196:199], v[20:23]
    ds_read_b64_tr_b16 a[154:155], v76 offset:18432
    v_mul_f32 v9, v66, v9
    v_mfma_f32_16x16x32_bf16 v[24:27], a[156:159], a[188:191], v[24:27]
    ds_write_b64 v82, v[4:5] offset:2048
    v_mfma_f32_16x16x32_bf16 v[28:31], a[156:159], a[244:247], v[28:31]
    buffer_store_dwordx4 a[112:115], v81, s[16:19], s48 offen sc1
    v_mfma_f32_16x16x32_bf16 v[16:19], a[160:163], v[136:139], v[16:19]
    ds_read_b64_tr_b16 a[156:157], v76 offset:20480
    v_mul_f32 v10, v66, v10
    v_mfma_f32_16x16x32_bf16 v[20:23], a[160:163], v[200:203], v[20:23]
    ds_read_b64_tr_b16 a[158:159], v76 offset:22528
    s_add_u32 m0, m0, s95
    v_mfma_f32_16x16x32_bf16 v[24:27], a[160:163], a[192:195], v[24:27]
    buffer_load_dwordx4 v79, s[12:15], s25 offen sc0 sc1 lds
    v_mfma_f32_16x16x32_bf16 v[28:31], a[160:163], a[248:251], v[28:31]
    s_waitcnt lgkmcnt(8)
    v_mul_f32 v11, v66, v11
    v_cvt_pk_bf16_f32 v8, v8, v9
    v_mfma_f32_16x16x32_bf16 v[16:19], a[164:167], v[140:143], v[16:19]
    ds_read_b64_tr_b16 a[160:161], v76 offset:24576
    v_cvt_pk_bf16_f32 v9, v10, v11
    v_mfma_f32_16x16x32_bf16 v[20:23], a[164:167], v[204:207], v[20:23]
    ds_read_b64_tr_b16 a[162:163], v76 offset:26624
    v_mul_f32 v12, v67, v12
    v_mfma_f32_16x16x32_bf16 v[24:27], a[164:167], a[196:199], v[24:27]
    ds_write_b64 v82, v[8:9] offset:16384
    v_mfma_f32_16x16x32_bf16 v[28:31], a[164:167], a[252:255], v[28:31]
    s_add_u32 s26, s25, s31
    v_mul_f32 v13, v67, v13
    v_mul_f32 v14, v67, v14
    v_mfma_f32_16x16x32_bf16 v[16:19], a[144:147], v[144:147], v[16:19]
    ds_read_b64_tr_b16 a[164:165], v76 offset:28672
    v_mul_f32 v15, v67, v15
    v_mfma_f32_16x16x32_bf16 v[20:23], a[144:147], v[208:211], v[20:23]
    ds_read_b64_tr_b16 a[166:167], v76 offset:30720
    v_cvt_pk_bf16_f32 v12, v12, v13
    v_mfma_f32_16x16x32_bf16 v[24:27], a[144:147], v[240:243], v[24:27]
    s_add_u32 m0, m0, s51
    v_cvt_pk_bf16_f32 v13, v14, v15
    s_waitcnt lgkmcnt(8)
    v_mfma_f32_16x16x32_bf16 v[28:31], a[144:147], v[248:251], v[28:31]
    ds_write_b64 v82, v[12:13] offset:18432
    v_mfma_f32_16x16x32_bf16 v[16:19], a[148:151], v[148:151], v[16:19]
    ds_read_b64_tr_b16 a[144:145], v76 offset:32768
    v_xor_b32 v82, 32, v82
    v_mfma_f32_16x16x32_bf16 v[20:23], a[148:151], v[212:215], v[20:23]
    ds_read_b64_tr_b16 a[146:147], v76 offset:34816
    v_mfma_f32_16x16x32_bf16 v[24:27], a[148:151], v[244:247], v[24:27]
    buffer_load_dwordx4 v79, s[12:15], s26 offen sc0 sc1 lds
    v_mfma_f32_16x16x32_bf16 v[28:31], a[148:151], v[252:255], v[28:31]
    v_mfma_f32_16x16x32_bf16 v[32:35], a[152:155], v[120:123], v[32:35]
    ds_read_b64_tr_b16 a[148:149], v76 offset:36864
    v_mul_f32 v16, v64, v16
    v_mfma_f32_16x16x32_bf16 v[36:39], a[152:155], v[184:187], v[36:39]
    ds_read_b64_tr_b16 a[150:151], v76 offset:38912
    v_mul_f32 v17, v64, v17
    v_mfma_f32_16x16x32_bf16 v[40:43], a[152:155], a[176:179], v[40:43]
    s_add_u32 s25, s26, s31
    v_mul_f32 v18, v64, v18
    v_mul_f32 v19, v64, v19
    v_mfma_f32_16x16x32_bf16 v[44:47], a[152:155], a[232:235], v[44:47]
    s_waitcnt lgkmcnt(8)
    v_cvt_pk_bf16_f32 v16, v16, v17
    v_cvt_pk_bf16_f32 v17, v18, v19
    v_mfma_f32_16x16x32_bf16 v[32:35], a[156:159], v[124:127], v[32:35]
    ds_read_b64_tr_b16 a[152:153], v76 offset:40960
    v_mul_f32 v20, v65, v20
    v_mfma_f32_16x16x32_bf16 v[36:39], a[156:159], v[188:191], v[36:39]
    ds_read_b64_tr_b16 a[154:155], v76 offset:43008
    v_mul_f32 v21, v65, v21
    v_mfma_f32_16x16x32_bf16 v[40:43], a[156:159], a[180:183], v[40:43]
    ds_write_b64 v82, v[16:17] offset:0
    v_mfma_f32_16x16x32_bf16 v[44:47], a[156:159], a[236:239], v[44:47]
    s_add_u32 m0, m0, s51
    v_mul_f32 v22, v65, v22
    v_mul_f32 v23, v65, v23
    v_mfma_f32_16x16x32_bf16 v[32:35], a[160:163], v[128:131], v[32:35]
    ds_read_b64_tr_b16 a[156:157], v76 offset:45056
    v_cvt_pk_bf16_f32 v20, v20, v21
    v_mfma_f32_16x16x32_bf16 v[36:39], a[160:163], v[192:195], v[36:39]
    ds_read_b64_tr_b16 a[158:159], v76 offset:47104
    v_cvt_pk_bf16_f32 v21, v22, v23
    v_mfma_f32_16x16x32_bf16 v[40:43], a[160:163], a[184:187], v[40:43]
    buffer_load_dwordx4 v79, s[12:15], s25 offen sc0 sc1 lds
    v_mfma_f32_16x16x32_bf16 v[44:47], a[160:163], a[240:243], v[44:47]
    s_waitcnt lgkmcnt(7)
    ds_write_b64 v82, v[20:21] offset:2048
    v_mfma_f32_16x16x32_bf16 v[32:35], a[164:167], v[132:135], v[32:35]
    ds_read_b64_tr_b16 a[160:161], v77 offset:16384
    s_add_u32 s49, s48, s31
    v_mfma_f32_16x16x32_bf16 v[36:39], a[164:167], v[196:199], v[36:39]
    ds_read_b64_tr_b16 a[162:163], v77 offset:18432
    v_mul_f32 v24, v66, v24
    v_mfma_f32_16x16x32_bf16 v[40:43], a[164:167], a[188:191], v[40:43]
    buffer_store_dwordx4 a[116:119], v81, s[16:19], s49 offen sc1
    v_mfma_f32_16x16x32_bf16 v[44:47], a[164:167], a[244:247], v[44:47]
    s_add_u32 s26, s25, s31
    v_mul_f32 v25, v66, v25
    v_mul_f32 v26, v66, v26
    v_mfma_f32_16x16x32_bf16 v[32:35], a[144:147], v[136:139], v[32:35]
    ds_read_b64_tr_b16 a[164:165], v77 offset:20480
    v_mul_f32 v27, v66, v27
    v_mfma_f32_16x16x32_bf16 v[36:39], a[144:147], v[200:203], v[36:39]
    ds_read_b64_tr_b16 a[166:167], v77 offset:22528
    v_cvt_pk_bf16_f32 v24, v24, v25
    v_mfma_f32_16x16x32_bf16 v[40:43], a[144:147], a[192:195], v[40:43]
    s_add_u32 m0, m0, s51
    v_cvt_pk_bf16_f32 v25, v26, v27
    v_mul_f32 v28, v67, v28
    v_mfma_f32_16x16x32_bf16 v[44:47], a[144:147], a[248:251], v[44:47]
    s_waitcnt lgkmcnt(8)
    ds_write_b64 v82, v[24:25] offset:16384
    v_mfma_f32_16x16x32_bf16 v[32:35], a[148:151], v[140:143], v[32:35]
    ds_read_b64_tr_b16 a[144:145], v77 offset:24576
    v_mul_f32 v29, v67, v29
    v_mfma_f32_16x16x32_bf16 v[36:39], a[148:151], v[204:207], v[36:39]
    ds_read_b64_tr_b16 a[146:147], v77 offset:26624
    v_mul_f32 v30, v67, v30
    v_mfma_f32_16x16x32_bf16 v[40:43], a[148:151], a[196:199], v[40:43]
    buffer_load_dwordx4 v79, s[12:15], s26 offen sc0 sc1 lds
    v_mfma_f32_16x16x32_bf16 v[44:47], a[148:151], a[252:255], v[44:47]
    v_mul_f32 v31, v67, v31
    v_cvt_pk_bf16_f32 v28, v28, v29
    v_mfma_f32_16x16x32_bf16 v[32:35], a[152:155], v[144:147], v[32:35]
    ds_read_b64_tr_b16 a[148:149], v77 offset:28672
    v_cvt_pk_bf16_f32 v29, v30, v31
    v_mfma_f32_16x16x32_bf16 v[36:39], a[152:155], v[208:211], v[36:39]
    ds_read_b64_tr_b16 a[150:151], v77 offset:30720
    v_mfma_f32_16x16x32_bf16 v[40:43], a[152:155], v[240:243], v[40:43]
    ds_write_b64 v82, v[28:29] offset:18432
    v_mfma_f32_16x16x32_bf16 v[44:47], a[152:155], v[248:251], v[44:47]
    s_waitcnt lgkmcnt(8)
    v_xor_b32 v82, 96, v82
    v_mfma_f32_16x16x32_bf16 v[32:35], a[156:159], v[148:151], v[32:35]
    ds_read_b64_tr_b16 a[152:153], v77 offset:32768
    v_mfma_f32_16x16x32_bf16 v[36:39], a[156:159], v[212:215], v[36:39]
    ds_read_b64_tr_b16 a[154:155], v77 offset:34816
    v_mfma_f32_16x16x32_bf16 v[40:43], a[156:159], v[244:247], v[40:43]
    s_add_u32 s20, s20, 0x40000
    s_or_b32 s20, s20, s79
    v_mfma_f32_16x16x32_bf16 v[44:47], a[156:159], v[252:255], v[44:47]
    s_cmp_lt_u32 s29, 3
    s_cselect_b32 s10, s14, 0
    s_xor_b32 s24, s20, 0
    v_mfma_f32_16x16x32_bf16 v[48:51], a[160:163], v[120:123], v[48:51]
    ds_read_b64_tr_b16 a[156:157], v77 offset:36864
    v_mul_f32 v32, v64, v32
    v_mfma_f32_16x16x32_bf16 v[52:55], a[160:163], v[184:187], v[52:55]
L_w8:
    s_cbranch_execz L_w12
    ds_read_b64_tr_b16 a[158:159], v77 offset:38912
    s_add_u32 m0, s22, 49152
    v_mfma_f32_16x16x32_bf16 v[56:59], a[160:163], a[176:179], v[56:59]
    buffer_load_dwordx4 v78, s[8:11], s24 offen offset:0 sc0 sc1 lds
    v_mfma_f32_16x16x32_bf16 v[60:63], a[160:163], a[232:235], v[60:63]
    s_waitcnt lgkmcnt(7)
    s_waitcnt vmcnt(19)
    v_mul_f32 v33, v64, v33
    v_mfma_f32_16x16x32_bf16 v[48:51], a[164:167], v[124:127], v[48:51]
    ds_read_b64_tr_b16 a[160:161], v77 offset:40960
    v_mul_f32 v34, v64, v34
    v_mfma_f32_16x16x32_bf16 v[52:55], a[164:167], v[188:191], v[52:55]
    ds_read_b64_tr_b16 a[162:163], v77 offset:43008
    v_mul_f32 v35, v64, v35
    v_mfma_f32_16x16x32_bf16 v[56:59], a[164:167], a[180:183], v[56:59]
    ds_read_b128 a[80:83], v70 offset:0
    v_cvt_pk_bf16_f32 v32, v32, v33
    v_mfma_f32_16x16x32_bf16 v[60:63], a[164:167], a[236:239], v[60:63]
    ds_read_b128 a[84:87], v71 offset:0
    v_cvt_pk_bf16_f32 v33, v34, v35
    v_mfma_f32_16x16x32_bf16 v[48:51], a[144:147], v[128:131], v[48:51]
    ds_read_b64_tr_b16 a[164:165], v77 offset:45056
    v_mul_f32 v36, v65, v36
    v_mfma_f32_16x16x32_bf16 v[52:55], a[144:147], v[192:195], v[52:55]
    ds_read_b64_tr_b16 a[166:167], v77 offset:47104
    s_waitcnt vmcnt(14)
    v_mfma_f32_16x16x32_bf16 v[56:59], a[144:147], a[184:187], v[56:59]
    ds_write_b64 v82, v[32:33] offset:0
    v_mfma_f32_16x16x32_bf16 v[60:63], a[144:147], a[240:243], v[60:63]
    s_waitcnt lgkmcnt(9)
    v_mul_f32 v37, v65, v37
    v_mul_f32 v38, v65, v38
    v_mfma_f32_16x16x32_bf16 v[48:51], a[148:151], v[132:135], v[48:51]
    s_barrier
    ds_read_b64_tr_b16 a[144:145], v74 offset:49152
    v_mul_f32 v39, v65, v39
    v_mfma_f32_16x16x32_bf16 v[52:55], a[148:151], v[196:199], v[52:55]
    ds_read_b64_tr_b16 a[146:147], v74 offset:51200
    s_add_u32 m0, m0, s50
    v_mfma_f32_16x16x32_bf16 v[56:59], a[148:151], a[188:191], v[56:59]
    buffer_load_dwordx4 v78, s[8:11], s24 offen offset:128 sc0 sc1 lds
    v_mfma_f32_16x16x32_bf16 v[60:63], a[148:151], a[244:247], v[60:63]
    s_add_u32 s48, s49, s31
    ds_read_b128 a[88:91], v70 offset:2048
    v_mfma_f32_16x16x32_bf16 v[48:51], a[152:155], v[136:139], v[48:51]
    ds_read_b64_tr_b16 a[148:149], v74 offset:53248
    v_cvt_pk_bf16_f32 v36, v36, v37
    v_mfma_f32_16x16x32_bf16 v[52:55], a[152:155], v[200:203], v[52:55]
    ds_read_b64_tr_b16 a[150:151], v74 offset:55296
    v_cvt_pk_bf16_f32 v37, v38, v39
    v_mfma_f32_16x16x32_bf16 v[56:59], a[152:155], a[192:195], v[56:59]
    buffer_store_dwordx4 a[120:123], v81, s[16:19], s48 offen sc1
    v_mfma_f32_16x16x32_bf16 v[60:63], a[152:155], a[248:251], v[60:63]
    s_waitcnt lgkmcnt(10)
    ds_read_b128 a[92:95], v71 offset:2048
    v_mfma_f32_16x16x32_bf16 v[48:51], a[156:159], v[140:143], v[48:51]
    ds_read_b64_tr_b16 a[152:153], v74 offset:57344
    v_mul_f32 v40, v66, v40
    v_mfma_f32_16x16x32_bf16 v[52:55], a[156:159], v[204:207], v[52:55]
    ds_read_b64_tr_b16 a[154:155], v74 offset:59392
    v_mul_f32 v41, v66, v41
    v_mfma_f32_16x16x32_bf16 v[56:59], a[156:159], a[196:199], v[56:59]
    ds_write_b64 v82, v[36:37] offset:2048
    v_mfma_f32_16x16x32_bf16 v[60:63], a[156:159], a[252:255], v[60:63]
    s_add_u32 m0, m0, s50
    v_mul_f32 v42, v66, v42
    v_mul_f32 v43, v66, v43
    v_mfma_f32_16x16x32_bf16 v[48:51], a[160:163], v[144:147], v[48:51]
    ds_read_b64_tr_b16 a[156:157], v74 offset:61440
    v_cvt_pk_bf16_f32 v40, v40, v41
    v_mfma_f32_16x16x32_bf16 v[52:55], a[160:163], v[208:211], v[52:55]
    s_waitcnt lgkmcnt(11)
    ds_read_b64_tr_b16 a[158:159], v74 offset:63488
    v_subrev_u32 v74, s96, v74
    v_mfma_f32_16x16x32_bf16 v[56:59], a[160:163], v[240:243], v[56:59]
    buffer_load_dwordx4 v78, s[8:11], s24 offen offset:256 sc0 sc1 lds
    v_mfma_f32_16x16x32_bf16 v[60:63], a[160:163], v[248:251], v[60:63]
    v_cvt_pk_bf16_f32 v41, v42, v43
    v_mul_f32 v44, v67, v44
    v_mfma_f32_16x16x32_bf16 v[48:51], a[164:167], v[148:151], v[48:51]
    ds_read_b64_tr_b16 a[160:161], v74 offset:0
    v_mul_f32 v45, v67, v45
    v_mfma_f32_16x16x32_bf16 v[52:55], a[164:167], v[212:215], v[52:55]
    ds_read_b64_tr_b16 a[162:163], v74 offset:2048
    v_mul_f32 v46, v67, v46
    v_mfma_f32_16x16x32_bf16 v[56:59], a[164:167], v[244:247], v[56:59]
    s_waitcnt lgkmcnt(11)
    v_mul_f32 v47, v67, v47
    v_cvt_pk_bf16_f32 v44, v44, v45
    v_mfma_f32_16x16x32_bf16 v[60:63], a[164:167], v[252:255], v[60:63]
    ds_write_b64 v82, v[40:41] offset:16384
    v_mfma_f32_16x16x32_bf16 v[0:3], a[144:147], v[88:91], 0
    ds_read_b64_tr_b16 a[164:165], v74 offset:4096
    v_cvt_pk_bf16_f32 v45, v46, v47
    v_mfma_f32_16x16x32_bf16 v[4:7], a[144:147], v[152:155], 0
    ds_read_b64_tr_b16 a[166:167], v74 offset:6144
    v_mul_f32 v48, v64, v48
    v_mfma_f32_16x16x32_bf16 v[8:11], a[144:147], v[216:219], 0
    s_add_u32 m0, m0, s50
    v_mul_f32 v49, v64, v49
    v_mul_f32 v50, v64, v50
    v_mfma_f32_16x16x32_bf16 v[12:15], a[144:147], a[200:203], 0
    s_waitcnt lgkmcnt(8)
    v_mul_f32 v51, v64, v51
    v_cvt_pk_bf16_f32 v48, v48, v49
    v_mfma_f32_16x16x32_bf16 v[0:3], a[148:151], v[92:95], v[0:3]
    ds_read_b64_tr_b16 a[144:145], v74 offset:8192
    v_cvt_pk_bf16_f32 v49, v50, v51
    v_mfma_f32_16x16x32_bf16 v[4:7], a[148:151], v[156:159], v[4:7]
    ds_read_b64_tr_b16 a[146:147], v74 offset:10240
    v_mul_f32 v52, v65, v52
    v_mfma_f32_16x16x32_bf16 v[8:11], a[148:151], v[220:223], v[8:11]
    ds_write_b64 v82, v[44:45] offset:18432
    v_mfma_f32_16x16x32_bf16 v[12:15], a[148:151], a[204:207], v[12:15]
    buffer_load_dwordx4 v78, s[8:11], s24 offen offset:384 sc0 sc1 lds
    v_mfma_f32_16x16x32_bf16 v[0:3], a[152:155], v[96:99], v[0:3]
    ds_read_b64_tr_b16 a[148:149], v74 offset:12288
    v_xor_b32 v82, 32, v82
    v_mfma_f32_16x16x32_bf16 v[4:7], a[152:155], v[160:163], v[4:7]
    ds_read_b64_tr_b16 a[150:151], v74 offset:14336
    v_mul_f32 v53, v65, v53
    v_mfma_f32_16x16x32_bf16 v[8:11], a[152:155], v[224:227], v[8:11]
    ds_write_b64 v82, v[48:49] offset:0
    v_mfma_f32_16x16x32_bf16 v[12:15], a[152:155], a[208:211], v[12:15]
    s_waitcnt lgkmcnt(9)
    v_mul_f32 v54, v65, v54
    v_mul_f32 v55, v65, v55
    v_mfma_f32_16x16x32_bf16 v[0:3], a[156:159], v[100:103], v[0:3]
    ds_read_b64_tr_b16 a[152:153], v75 offset:49152
    s_add_u32 s49, s48, s31
    v_mfma_f32_16x16x32_bf16 v[4:7], a[156:159], v[164:167], v[4:7]
    ds_read_b64_tr_b16 a[154:155], v75 offset:51200
    v_cvt_pk_bf16_f32 v52, v52, v53
    v_mfma_f32_16x16x32_bf16 v[8:11], a[156:159], v[228:231], v[8:11]
    buffer_store_dwordx4 a[124:127], v81, s[16:19], s49 offen sc1
    v_mfma_f32_16x16x32_bf16 v[12:15], a[156:159], a[212:215], v[12:15]
    v_cvt_pk_bf16_f32 v53, v54, v55
    v_mul_f32 v56, v66, v56
    v_mfma_f32_16x16x32_bf16 v[0:3], a[160:163], v[104:107], v[0:3]
    ds_read_b64_tr_b16 a[156:157], v75 offset:53248
    v_mul_f32 v57, v66, v57
    v_mfma_f32_16x16x32_bf16 v[4:7], a[160:163], v[168:171], v[4:7]
    ds_read_b64_tr_b16 a[158:159], v75 offset:55296
    v_mul_f32 v58, v66, v58
    v_mfma_f32_16x16x32_bf16 v[8:11], a[160:163], v[232:235], v[8:11]
    ds_write_b64 v82, v[52:53] offset:2048
    v_mfma_f32_16x16x32_bf16 v[12:15], a[160:163], a[216:219], v[12:15]
    s_waitcnt lgkmcnt(9)
    v_mul_f32 v59, v66, v59
    v_cvt_pk_bf16_f32 v56, v56, v57
    v_mfma_f32_16x16x32_bf16 v[0:3], a[164:167], v[108:111], v[0:3]
    ds_read_b64_tr_b16 a[160:161], v75 offset:57344
    v_cvt_pk_bf16_f32 v57, v58, v59
    v_mfma_f32_16x16x32_bf16 v[4:7], a[164:167], v[172:175], v[4:7]
    ds_read_b64_tr_b16 a[162:163], v75 offset:59392
    v_mul_f32 v60, v67, v60
    v_mfma_f32_16x16x32_bf16 v[8:11], a[164:167], v[236:239], v[8:11]
    ds_write_b64 v82, v[56:57] offset:16384
    v_mfma_f32_16x16x32_bf16 v[12:15], a[164:167], a[220:223], v[12:15]
    v_mul_f32 v61, v67, v61
    v_mul_f32 v62, v67, v62
    v_mfma_f32_16x16x32_bf16 v[0:3], a[144:147], v[112:115], v[0:3]
    ds_read_b64_tr_b16 a[164:165], v75 offset:61440
    v_mul_f32 v63, v67, v63
    v_mfma_f32_16x16x32_bf16 v[4:7], a[144:147], v[176:179], v[4:7]
    ds_read_b64_tr_b16 a[166:167], v75 offset:63488
    v_subrev_u32 v75, s96, v75
    v_mfma_f32_16x16x32_bf16 v[8:11], a[144:147], a[168:171], v[8:11]
    s_waitcnt lgkmcnt(8)
    v_cvt_pk_bf16_f32 v60, v60, v61
    v_cvt_pk_bf16_f32 v61, v62, v63
    v_mfma_f32_16x16x32_bf16 v[12:15], a[144:147], a[224:227], v[12:15]
    ds_write_b64 v82, v[60:61] offset:18432
    v_mfma_f32_16x16x32_bf16 v[0:3], a[148:151], v[116:119], v[0:3]
    ds_read_b64_tr_b16 a[144:145], v75 offset:0
    v_xor_b32 v82, 96, v82
    v_mfma_f32_16x16x32_bf16 v[4:7], a[148:151], v[180:183], v[4:7]
    ds_read_b64_tr_b16 a[146:147], v75 offset:2048
    v_mfma_f32_16x16x32_bf16 v[8:11], a[148:151], a[172:175], v[8:11]
    v_mfma_f32_16x16x32_bf16 v[12:15], a[148:151], a[228:231], v[12:15]
    v_mfma_f32_16x16x32_bf16 v[16:19], a[152:155], v[88:91], 0
    ds_read_b64_tr_b16 a[148:149], v75 offset:4096
    v_mfma_f32_16x16x32_bf16 v[20:23], a[152:155], v[152:155], 0
    ds_read_b64_tr_b16 a[150:151], v75 offset:6144
    v_mfma_f32_16x16x32_bf16 v[24:27], a[152:155], v[216:219], 0
    ds_read_b128 a[96:99], v83 offset:0
    s_waitcnt lgkmcnt(9)
    v_mfma_f32_16x16x32_bf16 v[28:31], a[152:155], a[200:203], 0
    v_mfma_f32_16x16x32_bf16 v[16:19], a[156:159], v[92:95], v[16:19]
    ds_read_b64_tr_b16 a[152:153], v75 offset:8192
    v_mfma_f32_16x16x32_bf16 v[20:23], a[156:159], v[156:159], v[20:23]
    ds_read_b64_tr_b16 a[154:155], v75 offset:10240
    v_mfma_f32_16x16x32_bf16 v[24:27], a[156:159], v[220:223], v[24:27]
    s_barrier
    v_mfma_f32_16x16x32_bf16 v[28:31], a[156:159], a[204:207], v[28:31]
    s_xor_b32 s3, s46, 256
    s_add_u32 s48, s3, 0
    v_mfma_f32_16x16x32_bf16 v[16:19], a[160:163], v[96:99], v[16:19]
    ds_read_b64_tr_b16 a[156:157], v75 offset:12288
    s_add_u32 s24, s24, s59
    v_mfma_f32_16x16x32_bf16 v[20:23], a[160:163], v[160:163], v[20:23]
    ds_read_b64_tr_b16 a[158:159], v75 offset:14336
    v_mfma_f32_16x16x32_bf16 v[24:27], a[160:163], v[224:227], v[24:27]
    s_waitcnt lgkmcnt(7)
    v_mfma_f32_16x16x32_bf16 v[28:31], a[160:163], a[208:211], v[28:31]
    s_add_u32 m0, m0, s94
    v_mfma_f32_16x16x32_bf16 v[16:19], a[164:167], v[100:103], v[16:19]
    ds_read_b64_tr_b16 a[160:161], v76 offset:49152
    v_mfma_f32_16x16x32_bf16 v[20:23], a[164:167], v[164:167], v[20:23]
    ds_read_b64_tr_b16 a[162:163], v76 offset:51200
    v_mfma_f32_16x16x32_bf16 v[24:27], a[164:167], v[228:231], v[24:27]
    buffer_load_dwordx4 v78, s[8:11], s24 offen offset:0 sc0 sc1 lds
    v_mfma_f32_16x16x32_bf16 v[28:31], a[164:167], a[212:215], v[28:31]
    v_mfma_f32_16x16x32_bf16 v[16:19], a[144:147], v[104:107], v[16:19]
    ds_read_b64_tr_b16 a[164:165], v76 offset:53248
    v_mfma_f32_16x16x32_bf16 v[20:23], a[144:147], v[168:171], v[20:23]
    ds_read_b64_tr_b16 a[166:167], v76 offset:55296
    v_mfma_f32_16x16x32_bf16 v[24:27], a[144:147], v[232:235], v[24:27]
    s_waitcnt lgkmcnt(6)
    v_mfma_f32_16x16x32_bf16 v[28:31], a[144:147], a[216:219], v[28:31]
    buffer_store_dwordx4 a[96:99], v81, s[16:19], s48 offen sc1
    v_mfma_f32_16x16x32_bf16 v[16:19], a[148:151], v[108:111], v[16:19]
    ds_read_b64_tr_b16 a[144:145], v76 offset:57344
    v_mfma_f32_16x16x32_bf16 v[20:23], a[148:151], v[172:175], v[20:23]
    ds_read_b64_tr_b16 a[146:147], v76 offset:59392
    v_mfma_f32_16x16x32_bf16 v[24:27], a[148:151], v[236:239], v[24:27]
    v_mfma_f32_16x16x32_bf16 v[28:31], a[148:151], a[220:223], v[28:31]
    s_add_u32 m0, m0, s50
    v_mfma_f32_16x16x32_bf16 v[16:19], a[152:155], v[112:115], v[16:19]
    ds_read_b64_tr_b16 a[148:149], v76 offset:61440
    v_mfma_f32_16x16x32_bf16 v[20:23], a[152:155], v[176:179], v[20:23]
    ds_read_b64_tr_b16 a[150:151], v76 offset:63488
    v_subrev_u32 v76, s96, v76
    v_mfma_f32_16x16x32_bf16 v[24:27], a[152:155], a[168:171], v[24:27]
    buffer_load_dwordx4 v78, s[8:11], s24 offen offset:128 sc0 sc1 lds
    v_mfma_f32_16x16x32_bf16 v[28:31], a[152:155], a[224:227], v[28:31]
    s_waitcnt lgkmcnt(6)
    v_mfma_f32_16x16x32_bf16 v[16:19], a[156:159], v[116:119], v[16:19]
    ds_read_b64_tr_b16 a[152:153], v76 offset:0
    v_mfma_f32_16x16x32_bf16 v[20:23], a[156:159], v[180:183], v[20:23]
    ds_read_b64_tr_b16 a[154:155], v76 offset:2048
    v_mfma_f32_16x16x32_bf16 v[24:27], a[156:159], a[172:175], v[24:27]
    v_mfma_f32_16x16x32_bf16 v[28:31], a[156:159], a[228:231], v[28:31]
    v_mfma_f32_16x16x32_bf16 v[32:35], a[160:163], v[88:91], 0
    ds_read_b64_tr_b16 a[156:157], v76 offset:4096
    v_mfma_f32_16x16x32_bf16 v[36:39], a[160:163], v[152:155], 0
    ds_read_b64_tr_b16 a[158:159], v76 offset:6144
    v_mfma_f32_16x16x32_bf16 v[40:43], a[160:163], v[216:219], 0
    ds_read_b128 a[100:103], v83 offset:1024
    s_waitcnt lgkmcnt(7)
    v_mfma_f32_16x16x32_bf16 v[44:47], a[160:163], a[200:203], 0
    s_add_u32 m0, m0, s50
    v_mfma_f32_16x16x32_bf16 v[32:35], a[164:167], v[92:95], v[32:35]
    ds_read_b64_tr_b16 a[160:161], v76 offset:8192
    v_mfma_f32_16x16x32_bf16 v[36:39], a[164:167], v[156:159], v[36:39]
    ds_read_b64_tr_b16 a[162:163], v76 offset:10240
    v_mfma_f32_16x16x32_bf16 v[40:43], a[164:167], v[220:223], v[40:43]
    buffer_load_dwordx4 v78, s[8:11], s24 offen offset:256 sc0 sc1 lds
    v_mfma_f32_16x16x32_bf16 v[44:47], a[164:167], a[204:207], v[44:47]
    s_add_u32 s49, s48, s31
    v_mfma_f32_16x16x32_bf16 v[32:35], a[144:147], v[96:99], v[32:35]
    ds_read_b64_tr_b16 a[164:165], v76 offset:12288
    v_mfma_f32_16x16x32_bf16 v[36:39], a[144:147], v[160:163], v[36:39]
    ds_read_b64_tr_b16 a[166:167], v76 offset:14336
    v_mfma_f32_16x16x32_bf16 v[40:43], a[144:147], v[224:227], v[40:43]
    s_waitcnt lgkmcnt(7)
    v_mfma_f32_16x16x32_bf16 v[44:47], a[144:147], a[208:211], v[44:47]
    v_mfma_f32_16x16x32_bf16 v[32:35], a[148:151], v[100:103], v[32:35]
    ds_read_b64_tr_b16 a[144:145], v77 offset:49152
    v_mfma_f32_16x16x32_bf16 v[36:39], a[148:151], v[164:167], v[36:39]
    ds_read_b64_tr_b16 a[146:147], v77 offset:51200
    v_mfma_f32_16x16x32_bf16 v[40:43], a[148:151], v[228:231], v[40:43]
    v_mfma_f32_16x16x32_bf16 v[44:47], a[148:151], a[212:215], v[44:47]
    s_add_u32 m0, m0, s50
    v_mfma_f32_16x16x32_bf16 v[32:35], a[152:155], v[104:107], v[32:35]
    ds_read_b64_tr_b16 a[148:149], v77 offset:53248
    v_mfma_f32_16x16x32_bf16 v[36:39], a[152:155], v[168:171], v[36:39]
    ds_read_b64_tr_b16 a[150:151], v77 offset:55296
    v_mfma_f32_16x16x32_bf16 v[40:43], a[152:155], v[232:235], v[40:43]
    buffer_load_dwordx4 v78, s[8:11], s24 offen offset:384 sc0 sc1 lds
    v_mfma_f32_16x16x32_bf16 v[44:47], a[152:155], a[216:219], v[44:47]
    s_waitcnt lgkmcnt(6)
    v_mfma_f32_16x16x32_bf16 v[32:35], a[156:159], v[108:111], v[32:35]
    ds_read_b64_tr_b16 a[152:153], v77 offset:57344
    v_mfma_f32_16x16x32_bf16 v[36:39], a[156:159], v[172:175], v[36:39]
    ds_read_b64_tr_b16 a[154:155], v77 offset:59392
    v_mfma_f32_16x16x32_bf16 v[40:43], a[156:159], v[236:239], v[40:43]
    buffer_store_dwordx4 a[100:103], v81, s[16:19], s49 offen sc1
    v_mfma_f32_16x16x32_bf16 v[44:47], a[156:159], a[220:223], v[44:47]
    v_mfma_f32_16x16x32_bf16 v[32:35], a[160:163], v[112:115], v[32:35]
    ds_read_b64_tr_b16 a[156:157], v77 offset:61440
    s_add_u32 s24, s24, s59
    v_mfma_f32_16x16x32_bf16 v[36:39], a[160:163], v[176:179], v[36:39]
    ds_read_b64_tr_b16 a[158:159], v77 offset:63488
    v_subrev_u32 v77, s96, v77
    v_mfma_f32_16x16x32_bf16 v[40:43], a[160:163], a[168:171], v[40:43]
    s_waitcnt lgkmcnt(6)
    v_mfma_f32_16x16x32_bf16 v[44:47], a[160:163], a[224:227], v[44:47]
    s_add_u32 m0, m0, s94
    v_mfma_f32_16x16x32_bf16 v[32:35], a[164:167], v[116:119], v[32:35]
    ds_read_b64_tr_b16 a[160:161], v77 offset:0
    v_mfma_f32_16x16x32_bf16 v[36:39], a[164:167], v[180:183], v[36:39]
    ds_read_b64_tr_b16 a[162:163], v77 offset:2048
    v_mfma_f32_16x16x32_bf16 v[40:43], a[164:167], a[172:175], v[40:43]
    buffer_load_dwordx4 v78, s[8:11], s24 offen offset:0 sc0 sc1 lds
    v_mfma_f32_16x16x32_bf16 v[44:47], a[164:167], a[228:231], v[44:47]
    v_mfma_f32_16x16x32_bf16 v[48:51], a[144:147], v[88:91], 0
    ds_read_b64_tr_b16 a[164:165], v77 offset:4096
    v_mfma_f32_16x16x32_bf16 v[52:55], a[144:147], v[152:155], 0
    ds_read_b64_tr_b16 a[166:167], v77 offset:6144
    v_mfma_f32_16x16x32_bf16 v[56:59], a[144:147], v[216:219], 0
    ds_read_b128 a[104:107], v83 offset:2048
    s_waitcnt lgkmcnt(7)
    v_mfma_f32_16x16x32_bf16 v[60:63], a[144:147], a[200:203], 0
    v_mfma_f32_16x16x32_bf16 v[48:51], a[148:151], v[92:95], v[48:51]
    ds_read_b64_tr_b16 a[144:145], v77 offset:8192
    v_mfma_f32_16x16x32_bf16 v[52:55], a[148:151], v[156:159], v[52:55]
    ds_read_b64_tr_b16 a[146:147], v77 offset:10240
    v_mfma_f32_16x16x32_bf16 v[56:59], a[148:151], v[220:223], v[56:59]
    s_waitcnt vmcnt(13)
    v_mfma_f32_16x16x32_bf16 v[60:63], a[148:151], a[204:207], v[60:63]
    s_barrier
    v_mfma_f32_16x16x32_bf16 v[48:51], a[152:155], v[96:99], v[48:51]
    ds_read_b64_tr_b16 a[148:149], v77 offset:12288
    s_add_u32 m0, m0, s50
    v_mfma_f32_16x16x32_bf16 v[52:55], a[152:155], v[160:163], v[52:55]
    ds_read_b64_tr_b16 a[150:151], v77 offset:14336
    s_add_u32 s48, s49, s31
    v_mfma_f32_16x16x32_bf16 v[56:59], a[152:155], v[224:227], v[56:59]
    buffer_load_dwordx4 v78, s[8:11], s24 offen offset:128 sc0 sc1 lds
    v_mfma_f32_16x16x32_bf16 v[60:63], a[152:155], a[208:211], v[60:63]
    s_waitcnt lgkmcnt(7)
    v_mfma_f32_16x16x32_bf16 v[48:51], a[156:159], v[100:103], v[48:51]
    ds_read_b64_tr_b16 a[152:153], v74 offset:16384
    v_mfma_f32_16x16x32_bf16 v[52:55], a[156:159], v[164:167], v[52:55]
    ds_read_b64_tr_b16 a[154:155], v74 offset:18432
    v_mfma_f32_16x16x32_bf16 v[56:59], a[156:159], v[228:231], v[56:59]
    v_mfma_f32_16x16x32_bf16 v[60:63], a[156:159], a[212:215], v[60:63]
    v_mfma_f32_16x16x32_bf16 v[48:51], a[160:163], v[104:107], v[48:51]
    ds_read_b64_tr_b16 a[156:157], v74 offset:20480
    v_mfma_f32_16x16x32_bf16 v[52:55], a[160:163], v[168:171], v[52:55]
    ds_read_b64_tr_b16 a[158:159], v74 offset:22528
    v_mfma_f32_16x16x32_bf16 v[56:59], a[160:163], v[232:235], v[56:59]
    s_waitcnt lgkmcnt(6)
    v_mfma_f32_16x16x32_bf16 v[60:63], a[160:163], a[216:219], v[60:63]
    buffer_store_dwordx4 a[104:107], v81, s[16:19], s48 offen sc1
    v_mfma_f32_16x16x32_bf16 v[48:51], a[164:167], v[108:111], v[48:51]
    ds_read_b64_tr_b16 a[160:161], v74 offset:24576
    s_add_u32 m0, m0, s50
    v_mfma_f32_16x16x32_bf16 v[52:55], a[164:167], v[172:175], v[52:55]
    ds_read_b64_tr_b16 a[162:163], v74 offset:26624
    v_mfma_f32_16x16x32_bf16 v[56:59], a[164:167], v[236:239], v[56:59]
    buffer_load_dwordx4 v78, s[8:11], s24 offen offset:256 sc0 sc1 lds
    v_mfma_f32_16x16x32_bf16 v[60:63], a[164:167], a[220:223], v[60:63]
    ds_read_b128 a[108:111], v83 offset:3072
    v_mfma_f32_16x16x32_bf16 v[48:51], a[144:147], v[112:115], v[48:51]
    ds_read_b64_tr_b16 a[164:165], v74 offset:28672
    v_mfma_f32_16x16x32_bf16 v[52:55], a[144:147], v[176:179], v[52:55]
    ds_read_b64_tr_b16 a[166:167], v74 offset:30720
    v_mfma_f32_16x16x32_bf16 v[56:59], a[144:147], a[168:171], v[56:59]
    ds_read_b128 a[112:115], v83 offset:16384
    s_waitcnt lgkmcnt(8)
    v_mfma_f32_16x16x32_bf16 v[60:63], a[144:147], a[224:227], v[60:63]
    v_mfma_f32_16x16x32_bf16 v[48:51], a[148:151], v[116:119], v[48:51]
    ds_read_b64_tr_b16 a[144:145], v74 offset:32768
    v_mfma_f32_16x16x32_bf16 v[52:55], a[148:151], v[180:183], v[52:55]
    ds_read_b64_tr_b16 a[146:147], v74 offset:34816
    v_mfma_f32_16x16x32_bf16 v[56:59], a[148:151], a[172:175], v[56:59]
    ds_read_b128 a[116:119], v83 offset:17408
    v_mfma_f32_16x16x32_bf16 v[60:63], a[148:151], a[228:231], v[60:63]
    s_add_u32 m0, m0, s50
    v_mfma_f32_16x16x32_bf16 v[0:3], a[152:155], v[120:123], v[0:3]
    ds_read_b64_tr_b16 a[148:149], v74 offset:36864
    v_mfma_f32_16x16x32_bf16 v[4:7], a[152:155], v[184:187], v[4:7]
    ds_read_b64_tr_b16 a[150:151], v74 offset:38912
    v_mfma_f32_16x16x32_bf16 v[8:11], a[152:155], a[176:179], v[8:11]
    buffer_load_dwordx4 v78, s[8:11], s24 offen offset:384 sc0 sc1 lds
    v_mfma_f32_16x16x32_bf16 v[12:15], a[152:155], a[232:235], v[12:15]
    s_waitcnt lgkmcnt(9)
    ds_read_b128 a[120:123], v83 offset:18432
    v_mfma_f32_16x16x32_bf16 v[0:3], a[156:159], v[124:127], v[0:3]
    ds_read_b64_tr_b16 a[152:153], v74 offset:40960
    v_mfma_f32_16x16x32_bf16 v[4:7], a[156:159], v[188:191], v[4:7]
    ds_read_b64_tr_b16 a[154:155], v74 offset:43008
    v_mfma_f32_16x16x32_bf16 v[8:11], a[156:159], a[180:183], v[8:11]
    ds_read_b128 a[124:127], v83 offset:19456
    s_add_u32 s49, s48, s31
    v_mfma_f32_16x16x32_bf16 v[12:15], a[156:159], a[236:239], v[12:15]
    v_mfma_f32_16x16x32_bf16 v[0:3], a[160:163], v[128:131], v[0:3]
    ds_read_b64_tr_b16 a[156:157], v74 offset:45056
    v_mfma_f32_16x16x32_bf16 v[4:7], a[160:163], v[192:195], v[4:7]
    ds_read_b64_tr_b16 a[158:159], v74 offset:47104
    v_mfma_f32_16x16x32_bf16 v[8:11], a[160:163], a[184:187], v[8:11]
    s_waitcnt lgkmcnt(9)
    v_mfma_f32_16x16x32_bf16 v[12:15], a[160:163], a[240:243], v[12:15]
    v_mfma_f32_16x16x32_bf16 v[0:3], a[164:167], v[132:135], v[0:3]
    ds_read_b64_tr_b16 a[160:161], v75 offset:16384
    v_mfma_f32_16x16x32_bf16 v[4:7], a[164:167], v[196:199], v[4:7]
    ds_read_b64_tr_b16 a[162:163], v75 offset:18432
    v_mfma_f32_16x16x32_bf16 v[8:11], a[164:167], a[188:191], v[8:11]
    buffer_store_dwordx4 a[108:111], v81, s[16:19], s49 offen sc1
    v_mfma_f32_16x16x32_bf16 v[12:15], a[164:167], a[244:247], v[12:15]
    v_mfma_f32_16x16x32_bf16 v[0:3], a[144:147], v[136:139], v[0:3]
    ds_read_b64_tr_b16 a[164:165], v75 offset:20480
    v_mfma_f32_16x16x32_bf16 v[4:7], a[144:147], v[200:203], v[4:7]
    ds_read_b64_tr_b16 a[166:167], v75 offset:22528
    v_mfma_f32_16x16x32_bf16 v[8:11], a[144:147], a[192:195], v[8:11]
    s_waitcnt lgkmcnt(7)
    v_mfma_f32_16x16x32_bf16 v[12:15], a[144:147], a[248:251], v[12:15]
    v_mfma_f32_16x16x32_bf16 v[0:3], a[148:151], v[140:143], v[0:3]
    ds_read_b64_tr_b16 a[144:145], v75 offset:24576
    v_mfma_f32_16x16x32_bf16 v[4:7], a[148:151], v[204:207], v[4:7]
    ds_read_b64_tr_b16 a[146:147], v75 offset:26624
    v_mfma_f32_16x16x32_bf16 v[8:11], a[148:151], a[196:199], v[8:11]
    v_mfma_f32_16x16x32_bf16 v[12:15], a[148:151], a[252:255], v[12:15]
    v_mfma_f32_16x16x32_bf16 v[0:3], a[152:155], v[144:147], v[0:3]
    ds_read_b64_tr_b16 a[148:149], v75 offset:28672
    v_mfma_f32_16x16x32_bf16 v[4:7], a[152:155], v[208:211], v[4:7]
    ds_read_b64_tr_b16 a[150:151], v75 offset:30720
    v_mfma_f32_16x16x32_bf16 v[8:11], a[152:155], v[240:243], v[8:11]
    s_waitcnt lgkmcnt(6)
    v_mfma_f32_16x16x32_bf16 v[12:15], a[152:155], v[248:251], v[12:15]
    v_mfma_f32_16x16x32_bf16 v[0:3], a[156:159], v[148:151], v[0:3]
    ds_read_b64_tr_b16 a[152:153], v75 offset:32768
    v_mfma_f32_16x16x32_bf16 v[4:7], a[156:159], v[212:215], v[4:7]
    ds_read_b64_tr_b16 a[154:155], v75 offset:34816
    v_mfma_f32_16x16x32_bf16 v[8:11], a[156:159], v[244:247], v[8:11]
    v_mfma_f32_16x16x32_bf16 v[12:15], a[156:159], v[252:255], v[12:15]
    v_mfma_f32_16x16x32_bf16 v[16:19], a[160:163], v[120:123], v[16:19]
    ds_read_b64_tr_b16 a[156:157], v75 offset:36864
    v_mfma_f32_16x16x32_bf16 v[20:23], a[160:163], v[184:187], v[20:23]
    ds_read_b64_tr_b16 a[158:159], v75 offset:38912
    v_mul_f32 v0, v64, v0
    v_mfma_f32_16x16x32_bf16 v[24:27], a[160:163], a[176:179], v[24:27]
    s_waitcnt lgkmcnt(6)
    v_mul_f32 v1, v64, v1
    v_mul_f32 v2, v64, v2
    v_mfma_f32_16x16x32_bf16 v[28:31], a[160:163], a[232:235], v[28:31]
    v_mul_f32 v3, v64, v3
    v_cvt_pk_bf16_f32 v0, v0, v1
    v_mfma_f32_16x16x32_bf16 v[16:19], a[164:167], v[124:127], v[16:19]
    ds_read_b64_tr_b16 a[160:161], v75 offset:40960
    v_cvt_pk_bf16_f32 v1, v2, v3
    v_mfma_f32_16x16x32_bf16 v[20:23], a[164:167], v[188:191], v[20:23]
    ds_read_b64_tr_b16 a[162:163], v75 offset:43008
    v_mul_f32 v4, v65, v4
    v_mfma_f32_16x16x32_bf16 v[24:27], a[164:167], a[180:183], v[24:27]
    ds_write_b64 v82, v[0:1] offset:0
    v_mfma_f32_16x16x32_bf16 v[28:31], a[164:167], a[236:239], v[28:31]
    s_barrier
    v_mfma_f32_16x16x32_bf16 v[16:19], a[144:147], v[128:131], v[16:19]
    ds_read_b64_tr_b16 a[164:165], v75 offset:45056
    v_mul_f32 v5, v65, v5
    v_mfma_f32_16x16x32_bf16 v[20:23], a[144:147], v[192:195], v[20:23]
    ds_read_b64_tr_b16 a[166:167], v75 offset:47104
    v_mul_f32 v6, v65, v6
    v_mfma_f32_16x16x32_bf16 v[24:27], a[144:147], a[184:187], v[24:27]
    s_add_u32 s24, s24, s59
    v_mul_f32 v7, v65, v7
    v_cvt_pk_bf16_f32 v4, v4, v5
    v_mfma_f32_16x16x32_bf16 v[28:31], a[144:147], a[240:243], v[28:31]
    s_waitcnt lgkmcnt(7)
    v_cvt_pk_bf16_f32 v5, v6, v7
    v_mul_f32 v8, v66, v8
    v_mfma_f32_16x16x32_bf16 v[16:19], a[148:151], v[132:135], v[16:19]
    ds_read_b64_tr_b16 a[144:145], v76 offset:16384
    s_add_u32 s48, s49, s31
    v_mfma_f32_16x16x32_bf16 v[20:23], a[148:151], v[196:199], v[20:23]
    ds_read_b64_tr_b16 a[146:147], v76 offset:18432
    v_mul_f32 v9, v66, v9
    v_mfma_f32_16x16x32_bf16 v[24:27], a[148:151], a[188:191], v[24:27]
    ds_write_b64 v82, v[4:5] offset:2048
    v_mfma_f32_16x16x32_bf16 v[28:31], a[148:151], a[244:247], v[28:31]
    buffer_store_dwordx4 a[112:115], v81, s[16:19], s48 offen sc1
    v_mfma_f32_16x16x32_bf16 v[16:19], a[152:155], v[136:139], v[16:19]
    ds_read_b64_tr_b16 a[148:149], v76 offset:20480
    v_mul_f32 v10, v66, v10
    v_mfma_f32_16x16x32_bf16 v[20:23], a[152:155], v[200:203], v[20:23]
    ds_read_b64_tr_b16 a[150:151], v76 offset:22528
    s_add_u32 m0, s22, 0
    v_mfma_f32_16x16x32_bf16 v[24:27], a[152:155], a[192:195], v[24:27]
    buffer_load_dwordx4 v78, s[8:11], s24 offen offset:0 sc0 sc1 lds
    v_mfma_f32_16x16x32_bf16 v[28:31], a[152:155], a[248:251], v[28:31]
    s_waitcnt lgkmcnt(8)
    v_mul_f32 v11, v66, v11
    v_cvt_pk_bf16_f32 v8, v8, v9
    v_mfma_f32_16x16x32_bf16 v[16:19], a[156:159], v[140:143], v[16:19]
    ds_read_b64_tr_b16 a[152:153], v76 offset:24576
    v_cvt_pk_bf16_f32 v9, v10, v11
    v_mfma_f32_16x16x32_bf16 v[20:23], a[156:159], v[204:207], v[20:23]
    ds_read_b64_tr_b16 a[154:155], v76 offset:26624
    v_mul_f32 v12, v67, v12
    v_mfma_f32_16x16x32_bf16 v[24:27], a[156:159], a[196:199], v[24:27]
    ds_write_b64 v82, v[8:9] offset:16384
    v_mfma_f32_16x16x32_bf16 v[28:31], a[156:159], a[252:255], v[28:31]
    v_mul_f32 v13, v67, v13
    v_mul_f32 v14, v67, v14
    v_mfma_f32_16x16x32_bf16 v[16:19], a[160:163], v[144:147], v[16:19]
    ds_read_b64_tr_b16 a[156:157], v76 offset:28672
    v_mul_f32 v15, v67, v15
    v_mfma_f32_16x16x32_bf16 v[20:23], a[160:163], v[208:211], v[20:23]
    ds_read_b64_tr_b16 a[158:159], v76 offset:30720
    v_cvt_pk_bf16_f32 v12, v12, v13
    v_mfma_f32_16x16x32_bf16 v[24:27], a[160:163], v[240:243], v[24:27]
    s_add_u32 m0, m0, s50
    v_cvt_pk_bf16_f32 v13, v14, v15
    s_waitcnt lgkmcnt(8)
    v_mfma_f32_16x16x32_bf16 v[28:31], a[160:163], v[248:251], v[28:31]
    ds_write_b64 v82, v[12:13] offset:18432
    v_mfma_f32_16x16x32_bf16 v[16:19], a[164:167], v[148:151], v[16:19]
    ds_read_b64_tr_b16 a[160:161], v76 offset:32768
    v_xor_b32 v82, 32, v82
    v_mfma_f32_16x16x32_bf16 v[20:23], a[164:167], v[212:215], v[20:23]
    ds_read_b64_tr_b16 a[162:163], v76 offset:34816
    v_mfma_f32_16x16x32_bf16 v[24:27], a[164:167], v[244:247], v[24:27]
    buffer_load_dwordx4 v78, s[8:11], s24 offen offset:128 sc0 sc1 lds
    v_mfma_f32_16x16x32_bf16 v[28:31], a[164:167], v[252:255], v[28:31]
    v_mfma_f32_16x16x32_bf16 v[32:35], a[144:147], v[120:123], v[32:35]
    ds_read_b64_tr_b16 a[164:165], v76 offset:36864
    v_mul_f32 v16, v64, v16
    v_mfma_f32_16x16x32_bf16 v[36:39], a[144:147], v[184:187], v[36:39]
    ds_read_b64_tr_b16 a[166:167], v76 offset:38912
    v_mul_f32 v17, v64, v17
    v_mfma_f32_16x16x32_bf16 v[40:43], a[144:147], a[176:179], v[40:43]
    s_waitcnt lgkmcnt(8)
    v_mul_f32 v18, v64, v18
    v_mul_f32 v19, v64, v19
    v_mfma_f32_16x16x32_bf16 v[44:47], a[144:147], a[232:235], v[44:47]
    v_cvt_pk_bf16_f32 v16, v16, v17
    v_cvt_pk_bf16_f32 v17, v18, v19
    v_mfma_f32_16x16x32_bf16 v[32:35], a[148:151], v[124:127], v[32:35]
    ds_read_b64_tr_b16 a[144:145], v76 offset:40960
    v_mul_f32 v20, v65, v20
    v_mfma_f32_16x16x32_bf16 v[36:39], a[148:151], v[188:191], v[36:39]
    ds_read_b64_tr_b16 a[146:147], v76 offset:43008
    v_mul_f32 v21, v65, v21
    v_mfma_f32_16x16x32_bf16 v[40:43], a[148:151], a[180:183], v[40:43]
    ds_write_b64 v82, v[16:17] offset:0
    v_mfma_f32_16x16x32_bf16 v[44:47], a[148:151], a[236:239], v[44:47]
    s_add_u32 m0, m0, s50
    v_mul_f32 v22, v65, v22
    v_mul_f32 v23, v65, v23
    v_mfma_f32_16x16x32_bf16 v[32:35], a[152:155], v[128:131], v[32:35]
    ds_read_b64_tr_b16 a[148:149], v76 offset:45056
    v_cvt_pk_bf16_f32 v20, v20, v21
    v_mfma_f32_16x16x32_bf16 v[36:39], a[152:155], v[192:195], v[36:39]
    ds_read_b64_tr_b16 a[150:151], v76 offset:47104
    v_cvt_pk_bf16_f32 v21, v22, v23
    v_mfma_f32_16x16x32_bf16 v[40:43], a[152:155], a[184:187], v[40:43]
    buffer_load_dwordx4 v78, s[8:11], s24 offen offset:256 sc0 sc1 lds
    v_mfma_f32_16x16x32_bf16 v[44:47], a[152:155], a[240:243], v[44:47]
    s_waitcnt lgkmcnt(7)
    ds_write_b64 v82, v[20:21] offset:2048
    v_mfma_f32_16x16x32_bf16 v[32:35], a[156:159], v[132:135], v[32:35]
    ds_read_b64_tr_b16 a[152:153], v77 offset:16384
    s_add_u32 s49, s48, s31
    v_mfma_f32_16x16x32_bf16 v[36:39], a[156:159], v[196:199], v[36:39]
    ds_read_b64_tr_b16 a[154:155], v77 offset:18432
    v_mul_f32 v24, v66, v24
    v_mfma_f32_16x16x32_bf16 v[40:43], a[156:159], a[188:191], v[40:43]
    buffer_store_dwordx4 a[116:119], v81, s[16:19], s49 offen sc1
    v_mfma_f32_16x16x32_bf16 v[44:47], a[156:159], a[244:247], v[44:47]
    v_mul_f32 v25, v66, v25
    v_mul_f32 v26, v66, v26
    v_mfma_f32_16x16x32_bf16 v[32:35], a[160:163], v[136:139], v[32:35]
    ds_read_b64_tr_b16 a[156:157], v77 offset:20480
    v_mul_f32 v27, v66, v27
    v_mfma_f32_16x16x32_bf16 v[36:39], a[160:163], v[200:203], v[36:39]
    ds_read_b64_tr_b16 a[158:159], v77 offset:22528
    v_cvt_pk_bf16_f32 v24, v24, v25
    v_mfma_f32_16x16x32_bf16 v[40:43], a[160:163], a[192:195], v[40:43]
    s_add_u32 m0, m0, s50
    v_cvt_pk_bf16_f32 v25, v26, v27
    v_mul_f32 v28, v67, v28
    v_mfma_f32_16x16x32_bf16 v[44:47], a[160:163], a[248:251], v[44:47]
    s_waitcnt lgkmcnt(8)
    ds_write_b64 v82, v[24:25] offset:16384
L_w9:
    s_cbranch_execz L_w13
    v_mfma_f32_16x16x32_bf16 v[32:35], a[164:167], v[140:143], v[32:35]
    ds_read_b64_tr_b16 a[160:161], v77 offset:24576
    v_mul_f32 v29, v67, v29
    v_mfma_f32_16x16x32_bf16 v[36:39], a[164:167], v[204:207], v[36:39]
    ds_read_b64_tr_b16 a[162:163], v77 offset:26624
    v_mul_f32 v30, v67, v30
    v_mfma_f32_16x16x32_bf16 v[40:43], a[164:167], a[196:199], v[40:43]
    buffer_load_dwordx4 v78, s[8:11], s24 offen offset:384 sc0 sc1 lds
    v_mfma_f32_16x16x32_bf16 v[44:47], a[164:167], a[252:255], v[44:47]
    v_mul_f32 v31, v67, v31
    v_cvt_pk_bf16_f32 v28, v28, v29
    v_mfma_f32_16x16x32_bf16 v[32:35], a[144:147], v[144:147], v[32:35]
    v_cvt_pk_bf16_f32 v29, v30, v31
    v_mfma_f32_16x16x32_bf16 v[36:39], a[144:147], v[208:211], v[36:39]
    ds_write_b64 v82, v[28:29] offset:18432
    v_mfma_f32_16x16x32_bf16 v[40:43], a[144:147], v[240:243], v[40:43]
    s_waitcnt lgkmcnt(6)
    v_xor_b32 v82, 96, v82
    v_mfma_f32_16x16x32_bf16 v[44:47], a[144:147], v[248:251], v[44:47]
    v_mfma_f32_16x16x32_bf16 v[32:35], a[148:151], v[148:151], v[32:35]
    ds_read_b64_tr_b16 a[144:145], v77 offset:28672
    v_mfma_f32_16x16x32_bf16 v[36:39], a[148:151], v[212:215], v[36:39]
    ds_read_b64_tr_b16 a[146:147], v77 offset:30720
    v_mfma_f32_16x16x32_bf16 v[40:43], a[148:151], v[244:247], v[40:43]
    v_mfma_f32_16x16x32_bf16 v[44:47], a[148:151], v[252:255], v[44:47]
    v_mfma_f32_16x16x32_bf16 v[48:51], a[152:155], v[120:123], v[48:51]
    ds_read_b64_tr_b16 a[148:149], v77 offset:32768
    v_mfma_f32_16x16x32_bf16 v[52:55], a[152:155], v[184:187], v[52:55]
    ds_read_b64_tr_b16 a[150:151], v77 offset:34816
    v_mul_f32 v32, v64, v32
    v_mfma_f32_16x16x32_bf16 v[56:59], a[152:155], a[176:179], v[56:59]
    s_waitcnt lgkmcnt(5)
    v_mul_f32 v33, v64, v33
    v_mul_f32 v34, v64, v34
    v_mfma_f32_16x16x32_bf16 v[60:63], a[152:155], a[232:235], v[60:63]
    v_mul_f32 v35, v64, v35
    v_cvt_pk_bf16_f32 v32, v32, v33
    v_mfma_f32_16x16x32_bf16 v[48:51], a[156:159], v[124:127], v[48:51]
    ds_read_b64_tr_b16 a[152:153], v77 offset:36864
    v_cvt_pk_bf16_f32 v33, v34, v35
    v_mfma_f32_16x16x32_bf16 v[52:55], a[156:159], v[188:191], v[52:55]
    ds_read_b64_tr_b16 a[154:155], v77 offset:38912
    v_mul_f32 v36, v65, v36
    v_mfma_f32_16x16x32_bf16 v[56:59], a[156:159], a[180:183], v[56:59]
    ds_write_b64 v82, v[32:33] offset:0
    v_mfma_f32_16x16x32_bf16 v[60:63], a[156:159], a[236:239], v[60:63]
    s_waitcnt vmcnt(19)
    v_mul_f32 v37, v65, v37
    v_mul_f32 v38, v65, v38
    v_mfma_f32_16x16x32_bf16 v[48:51], a[160:163], v[128:131], v[48:51]
    ds_read_b64_tr_b16 a[156:157], v77 offset:40960
    v_mul_f32 v39, v65, v39
    v_mfma_f32_16x16x32_bf16 v[52:55], a[160:163], v[192:195], v[52:55]
    ds_read_b64_tr_b16 a[158:159], v77 offset:43008
    v_cvt_pk_bf16_f32 v36, v36, v37
    v_mfma_f32_16x16x32_bf16 v[56:59], a[160:163], a[184:187], v[56:59]
    s_barrier
    v_mfma_f32_16x16x32_bf16 v[60:63], a[160:163], a[240:243], v[60:63]
    s_waitcnt lgkmcnt(5)
    v_cvt_pk_bf16_f32 v37, v38, v39
    v_mul_f32 v40, v66, v40
    v_mfma_f32_16x16x32_bf16 v[48:51], a[144:147], v[132:135], v[48:51]
    ds_read_b64_tr_b16 a[160:161], v77 offset:45056
    s_add_u32 s48, s49, s31
    v_mfma_f32_16x16x32_bf16 v[52:55], a[144:147], v[196:199], v[52:55]
    ds_read_b64_tr_b16 a[162:163], v77 offset:47104
    v_mul_f32 v41, v66, v41
    v_mfma_f32_16x16x32_bf16 v[56:59], a[144:147], a[188:191], v[56:59]
    ds_write_b64 v82, v[36:37] offset:2048
    v_mfma_f32_16x16x32_bf16 v[60:63], a[144:147], a[244:247], v[60:63]
    buffer_store_dwordx4 a[120:123], v81, s[16:19], s48 offen sc1
    v_mfma_f32_16x16x32_bf16 v[48:51], a[148:151], v[136:139], v[48:51]
    ds_read_b128 a[144:147], v68 offset:49152
    v_mul_f32 v42, v66, v42
    v_mfma_f32_16x16x32_bf16 v[52:55], a[148:151], v[200:203], v[52:55]
    v_mul_f32 v43, v66, v43
    v_cvt_pk_bf16_f32 v40, v40, v41
    v_mfma_f32_16x16x32_bf16 v[56:59], a[148:151], a[192:195], v[56:59]
    s_waitcnt lgkmcnt(4)
    v_cvt_pk_bf16_f32 v41, v42, v43
    v_mul_f32 v44, v67, v44
    v_mfma_f32_16x16x32_bf16 v[60:63], a[148:151], a[248:251], v[60:63]
    ds_write_b64 v82, v[40:41] offset:16384
    v_mfma_f32_16x16x32_bf16 v[48:51], a[152:155], v[140:143], v[48:51]
    ds_read_b128 a[148:151], v69 offset:49152
    v_mul_f32 v45, v67, v45
    v_mfma_f32_16x16x32_bf16 v[52:55], a[152:155], v[204:207], v[52:55]
    v_mul_f32 v46, v67, v46
    v_mul_f32 v47, v67, v47
    v_mfma_f32_16x16x32_bf16 v[56:59], a[152:155], a[196:199], v[56:59]
    v_cvt_pk_bf16_f32 v44, v44, v45
    v_cvt_pk_bf16_f32 v45, v46, v47
    v_mfma_f32_16x16x32_bf16 v[60:63], a[152:155], a[252:255], v[60:63]
    ds_write_b64 v82, v[44:45] offset:18432
    v_mfma_f32_16x16x32_bf16 v[48:51], a[156:159], v[144:147], v[48:51]
    ds_read_b128 a[152:155], v68 offset:53248
    v_xor_b32 v82, 32, v82
    v_mfma_f32_16x16x32_bf16 v[52:55], a[156:159], v[208:211], v[52:55]
    v_mfma_f32_16x16x32_bf16 v[56:59], a[156:159], v[240:243], v[56:59]
    s_waitcnt lgkmcnt(4)
    v_mfma_f32_16x16x32_bf16 v[60:63], a[156:159], v[248:251], v[60:63]
    v_mfma_f32_16x16x32_bf16 v[48:51], a[160:163], v[148:151], v[48:51]
    ds_read_b128 a[156:159], v69 offset:53248
    v_mfma_f32_16x16x32_bf16 v[52:55], a[160:163], v[212:215], v[52:55]
    v_mfma_f32_16x16x32_bf16 v[56:59], a[160:163], v[244:247], v[56:59]
    v_mfma_f32_16x16x32_bf16 v[60:63], a[160:163], v[252:255], v[60:63]
    s_add_u32 s29, s29, 1
    s_cmp_lg_u32 s29, 4
    s_cbranch_scc1 L_segB
L_tailA:
    s_waitcnt lgkmcnt(0)
    s_nop 7
    s_nop 1
    s_xor_b32 s3, s46, 384
    s_xor_b32 s49, s46, 256
    s_add_u32 s49, s49, 28672
    buffer_store_dwordx4 a[124:127], v81, s[16:19], s49 offen sc1
    v_mul_f32 v48, v64, v48
    v_mul_f32 v49, v64, v49
    v_mul_f32 v50, v64, v50
    v_mul_f32 v51, v64, v51
    v_cvt_pk_bf16_f32 v48, v48, v49
    v_cvt_pk_bf16_f32 v49, v50, v51
    ds_write_b64 v82, v[48:49] offset:0
    ds_read_b128 a[0:3], v83 offset:0
    ds_read_b128 a[4:7], v83 offset:1024
    v_mul_f32 v52, v65, v52
    v_mul_f32 v53, v65, v53
    v_mul_f32 v54, v65, v54
    v_mul_f32 v55, v65, v55
    v_cvt_pk_bf16_f32 v52, v52, v53
    v_cvt_pk_bf16_f32 v53, v54, v55
    ds_write_b64 v82, v[52:53] offset:2048
    ds_read_b128 a[8:11], v83 offset:2048
    ds_read_b128 a[12:15], v83 offset:3072
    s_add_u32 s48, s3, 0
    s_waitcnt lgkmcnt(4)
    buffer_store_dwordx4 a[0:3], v81, s[16:19], s48 offen sc1
    s_add_u32 s49, s48, s31
    s_waitcnt lgkmcnt(3)
    buffer_store_dwordx4 a[4:7], v81, s[16:19], s49 offen sc1
    v_mul_f32 v56, v66, v56
    v_mul_f32 v57, v66, v57
    v_mul_f32 v58, v66, v58
    v_mul_f32 v59, v66, v59
    v_cvt_pk_bf16_f32 v56, v56, v57
    v_cvt_pk_bf16_f32 v57, v58, v59
    ds_write_b64 v82, v[56:57] offset:16384
    ds_read_b128 a[16:19], v83 offset:16384
    ds_read_b128 a[20:23], v83 offset:17408
    s_add_u32 s48, s49, s31
    s_waitcnt lgkmcnt(4)
    buffer_store_dwordx4 a[8:11], v81, s[16:19], s48 offen sc1
    s_add_u32 s49, s48, s31
    s_waitcnt lgkmcnt(3)
    buffer_store_dwordx4 a[12:15], v81, s[16:19], s49 offen sc1
    v_mul_f32 v60, v67, v60
    v_mul_f32 v61, v67, v61
    v_mul_f32 v62, v67, v62
    v_mul_f32 v63, v67, v63
    v_cvt_pk_bf16_f32 v60, v60, v61
    v_cvt_pk_bf16_f32 v61, v62, v63
    ds_write_b64 v82, v[60:61] offset:18432
    ds_read_b128 a[24:27], v83 offset:18432
    ds_read_b128 a[28:31], v83 offset:19456
    s_add_u32 s48, s49, s31
    s_waitcnt lgkmcnt(4)
    buffer_store_dwordx4 a[16:19], v81, s[16:19], s48 offen sc1
    s_add_u32 s49, s48, s31
    s_waitcnt lgkmcnt(3)
    buffer_store_dwordx4 a[20:23], v81, s[16:19], s49 offen sc1
    v_xor_b32 v82, 96, v82
    s_add_u32 s48, s49, s31
    s_waitcnt lgkmcnt(1)
    buffer_store_dwordx4 a[24:27], v81, s[16:19], s48 offen sc1
    s_add_u32 s49, s48, s31
    s_waitcnt lgkmcnt(0)
    buffer_store_dwordx4 a[28:31], v81, s[16:19], s49 offen sc1
    s_cmp_lg_u32 s30, 0
    s_cbranch_scc1 L_fin
    s_endpgm
L_segB:
L_w10:
    s_cbranch_execz L_w14
    v_mfma_f32_16x16x32_bf16 v[0:3], a[144:147], a[0:3], 0
    ds_read_b128 a[160:163], v68 offset:57344
    v_mfma_f32_16x16x32_bf16 v[4:7], a[144:147], a[32:35], 0
    ds_read_b128 a[164:167], v69 offset:57344
    v_mul_f32 v48, v64, v48
    v_mfma_f32_16x16x32_bf16 v[8:11], a[144:147], a[64:67], 0
    s_waitcnt lgkmcnt(3)
    v_mul_f32 v49, v64, v49
    v_mul_f32 v50, v64, v50
    v_mfma_f32_16x16x32_bf16 v[0:3], a[148:151], a[4:7], v[0:3]
    ds_read_b128 a[144:147], v68 offset:61440
    v_mul_f32 v51, v64, v51
    v_mfma_f32_16x16x32_bf16 v[4:7], a[148:151], a[36:39], v[4:7]
    v_cvt_pk_bf16_f32 v48, v48, v49
    v_cvt_pk_bf16_f32 v49, v50, v51
    v_mfma_f32_16x16x32_bf16 v[8:11], a[148:151], a[68:71], v[8:11]
    ds_write_b64 v82, v[48:49] offset:0
    v_mfma_f32_16x16x32_bf16 v[0:3], a[152:155], a[8:11], v[0:3]
    ds_read_b128 a[148:151], v69 offset:61440
    v_mul_f32 v52, v65, v52
    v_mfma_f32_16x16x32_bf16 v[4:7], a[152:155], a[40:43], v[4:7]
    s_add_u32 s49, s3, 28672
    v_mul_f32 v53, v65, v53
    v_mul_f32 v54, v65, v54
    v_mfma_f32_16x16x32_bf16 v[8:11], a[152:155], a[72:75], v[8:11]
    s_waitcnt lgkmcnt(4)
    v_mul_f32 v55, v65, v55
    v_cvt_pk_bf16_f32 v52, v52, v53
    v_mfma_f32_16x16x32_bf16 v[0:3], a[156:159], a[12:15], v[0:3]
    ds_read_b128 a[152:155], v68 offset:51200
    v_cvt_pk_bf16_f32 v53, v54, v55
    v_mfma_f32_16x16x32_bf16 v[4:7], a[156:159], a[44:47], v[4:7]
    ds_write_b64 v82, v[52:53] offset:2048
    v_mfma_f32_16x16x32_bf16 v[8:11], a[156:159], a[76:79], v[8:11]
    buffer_store_dwordx4 a[124:127], v81, s[16:19], s49 offen sc1
    v_mfma_f32_16x16x32_bf16 v[0:3], a[160:163], a[16:19], v[0:3]
    ds_read_b128 a[156:159], v69 offset:51200
    v_mul_f32 v56, v66, v56
    v_mfma_f32_16x16x32_bf16 v[4:7], a[160:163], a[48:51], v[4:7]
    s_waitcnt lgkmcnt(5)
    v_mul_f32 v57, v66, v57
    v_mul_f32 v58, v66, v58
    v_mfma_f32_16x16x32_bf16 v[8:11], a[160:163], a[80:83], v[8:11]
    v_mul_f32 v59, v66, v59
    v_cvt_pk_bf16_f32 v56, v56, v57
    v_mfma_f32_16x16x32_bf16 v[0:3], a[164:167], a[20:23], v[0:3]
    ds_read_b128 a[160:163], v68 offset:55296
    v_cvt_pk_bf16_f32 v57, v58, v59
    v_mfma_f32_16x16x32_bf16 v[4:7], a[164:167], a[52:55], v[4:7]
    ds_write_b64 v82, v[56:57] offset:16384
    v_mfma_f32_16x16x32_bf16 v[8:11], a[164:167], a[84:87], v[8:11]
    v_mul_f32 v60, v67, v60
    v_mul_f32 v61, v67, v61
    v_mfma_f32_16x16x32_bf16 v[0:3], a[144:147], a[24:27], v[0:3]
    ds_read_b128 a[164:167], v69 offset:55296
    v_mul_f32 v62, v67, v62
    v_mfma_f32_16x16x32_bf16 v[4:7], a[144:147], a[56:59], v[4:7]
    s_waitcnt lgkmcnt(5)
    v_mul_f32 v63, v67, v63
    v_cvt_pk_bf16_f32 v60, v60, v61
    v_mfma_f32_16x16x32_bf16 v[8:11], a[144:147], a[88:91], v[8:11]
    v_cvt_pk_bf16_f32 v61, v62, v63
    v_accvgpr_write_b32 a136, 0
    v_mfma_f32_16x16x32_bf16 v[0:3], a[148:151], a[28:31], v[0:3]
    ds_read_b128 a[144:147], v68 offset:59392
    v_accvgpr_write_b32 a137, 0
    v_mfma_f32_16x16x32_bf16 v[4:7], a[148:151], a[60:63], v[4:7]
    ds_write_b64 v82, v[60:61] offset:18432
    v_mfma_f32_16x16x32_bf16 v[8:11], a[148:151], a[92:95], v[8:11]
    v_xor_b32 v82, 96, v82
    v_accvgpr_write_b32 a138, 0
    v_mfma_f32_16x16x32_bf16 v[16:19], a[152:155], a[0:3], 0
    ds_read_b128 a[148:151], v69 offset:59392
    v_accvgpr_write_b32 a139, 0
    v_mfma_f32_16x16x32_bf16 v[20:23], a[152:155], a[32:35], 0
    ds_read_b128 a[96:99], v83 offset:0
    v_accvgpr_write_b32 a140, 0
    v_mfma_f32_16x16x32_bf16 v[24:27], a[152:155], a[64:67], 0
    s_waitcnt lgkmcnt(6)
    v_accvgpr_write_b32 a141, 0
    v_accvgpr_write_b32 a142, 0
    v_mfma_f32_16x16x32_bf16 v[16:19], a[156:159], a[4:7], v[16:19]
    ds_read_b128 a[152:155], v68 offset:63488
    v_add_u32 v68, s96, v68
    v_mfma_f32_16x16x32_bf16 v[20:23], a[156:159], a[36:39], v[20:23]
    s_waitcnt vmcnt(15)
    v_accvgpr_write_b32 a143, 0
    v_max3_f32 v64, v0, v1, v2
    v_mfma_f32_16x16x32_bf16 v[24:27], a[156:159], a[68:71], v[24:27]
    s_barrier
    v_mfma_f32_16x16x32_bf16 v[16:19], a[160:163], a[8:11], v[16:19]
    ds_read_b128 a[156:159], v69 offset:63488
    v_add_u32 v69, s96, v69
    v_mfma_f32_16x16x32_bf16 v[20:23], a[160:163], a[40:43], v[20:23]
    s_xor_b32 s24, s20, 65536
    v_max3_f32 v65, v4, v5, v6
    v_max3_f32 v66, v8, v9, v10
    v_mfma_f32_16x16x32_bf16 v[24:27], a[160:163], a[72:75], v[24:27]
    s_waitcnt lgkmcnt(5)
    v_max_f32 v64, v64, v3
    v_max_f32 v65, v65, v7
    v_mfma_f32_16x16x32_bf16 v[16:19], a[164:167], a[12:15], v[16:19]
    ds_read_b128 a[160:163], v68 offset:16384
    s_xor_b32 s3, s46, 384
    v_mfma_f32_16x16x32_bf16 v[20:23], a[164:167], a[44:47], v[20:23]
    s_add_u32 m0, s22, 16384
    s_add_u32 s48, s3, 0
    v_max_f32 v66, v66, v11
    v_mfma_f32_16x16x32_bf16 v[24:27], a[164:167], a[76:79], v[24:27]
    buffer_load_dwordx4 v78, s[8:11], s24 offen offset:0 sc0 sc1 lds
    v_mfma_f32_16x16x32_bf16 v[16:19], a[144:147], a[16:19], v[16:19]
    ds_read_b128 a[164:167], v69 offset:16384
    v_mov_b32 v144, v64
    v_mfma_f32_16x16x32_bf16 v[20:23], a[144:147], a[48:51], v[20:23]
    s_waitcnt lgkmcnt(3)
    v_mov_b32 v145, v65
    v_mov_b32 v146, v66
    v_mfma_f32_16x16x32_bf16 v[24:27], a[144:147], a[80:83], v[24:27]
    buffer_store_dwordx4 a[96:99], v81, s[16:19], s48 offen sc1
    v_mfma_f32_16x16x32_bf16 v[16:19], a[148:151], a[20:23], v[16:19]
    ds_read_b128 a[144:147], v68 offset:20480
    v_mfma_f32_16x16x32_bf16 v[20:23], a[148:151], a[52:55], v[20:23]
    v_permlane32_swap_b32 v64, v144
    v_mfma_f32_16x16x32_bf16 v[24:27], a[148:151], a[84:87], v[24:27]
    v_permlane32_swap_b32 v65, v145
    v_mfma_f32_16x16x32_bf16 v[16:19], a[152:155], a[24:27], v[16:19]
    ds_read_b128 a[148:151], v69 offset:20480
    v_max_f32 v64, v64, v144
    v_mfma_f32_16x16x32_bf16 v[20:23], a[152:155], a[56:59], v[20:23]
    s_add_u32 m0, m0, s50
    v_permlane32_swap_b32 v66, v146
    v_mfma_f32_16x16x32_bf16 v[24:27], a[152:155], a[88:91], v[24:27]
    s_waitcnt lgkmcnt(3)
    v_max_f32 v65, v65, v145
    v_max_f32 v66, v66, v146
    v_mfma_f32_16x16x32_bf16 v[16:19], a[156:159], a[28:31], v[16:19]
    ds_read_b128 a[152:155], v68 offset:24576
    v_mov_b32 v144, v64
    v_mfma_f32_16x16x32_bf16 v[20:23], a[156:159], a[60:63], v[20:23]
    buffer_load_dwordx4 v78, s[8:11], s24 offen offset:128 sc0 sc1 lds
    v_mfma_f32_16x16x32_bf16 v[24:27], a[156:159], a[92:95], v[24:27]
    v_mov_b32 v145, v65
    v_mov_b32 v146, v66
    v_mfma_f32_16x16x32_bf16 v[32:35], a[160:163], a[0:3], 0
    ds_read_b128 a[156:159], v69 offset:24576
    v_mfma_f32_16x16x32_bf16 v[36:39], a[160:163], a[32:35], 0
    ds_read_b128 a[100:103], v83 offset:1024
    s_waitcnt lgkmcnt(4)
    v_mfma_f32_16x16x32_bf16 v[40:43], a[160:163], a[64:67], 0
    v_permlane16_swap_b32 v64, v144
    v_mfma_f32_16x16x32_bf16 v[32:35], a[164:167], a[4:7], v[32:35]
    ds_read_b128 a[160:163], v68 offset:28672
    s_add_u32 m0, m0, s50
    v_mfma_f32_16x16x32_bf16 v[36:39], a[164:167], a[36:39], v[36:39]
    v_permlane16_swap_b32 v65, v145
    v_mfma_f32_16x16x32_bf16 v[40:43], a[164:167], a[68:71], v[40:43]
    buffer_load_dwordx4 v78, s[8:11], s24 offen offset:256 sc0 sc1 lds
    v_mfma_f32_16x16x32_bf16 v[32:35], a[144:147], a[8:11], v[32:35]
    ds_read_b128 a[164:167], v69 offset:28672
    v_max_f32 v64, v64, v144
    v_mfma_f32_16x16x32_bf16 v[36:39], a[144:147], a[40:43], v[36:39]
    s_add_u32 s49, s48, s31
    v_permlane16_swap_b32 v66, v146
    v_mfma_f32_16x16x32_bf16 v[40:43], a[144:147], a[72:75], v[40:43]
    s_waitcnt lgkmcnt(4)
    v_max_f32 v65, v65, v145
    v_max_f32 v66, v66, v146
    v_mfma_f32_16x16x32_bf16 v[32:35], a[148:151], a[12:15], v[32:35]
    ds_read_b128 a[144:147], v68 offset:18432
    v_sub_f32 v148, s71, v64
    v_mfma_f32_16x16x32_bf16 v[36:39], a[148:151], a[44:47], v[36:39]
    s_mov_b32 s6, s38
    v_sub_f32 v212, s71, v65
    v_sub_f32 v244, s71, v66
    v_mfma_f32_16x16x32_bf16 v[40:43], a[148:151], a[76:79], v[40:43]
    s_sub_u32 s42, s33, s47
    v_mul_f32 v64, s27, v148
    v_mul_f32 v65, s27, v212
    v_mfma_f32_16x16x32_bf16 v[32:35], a[152:155], a[16:19], v[32:35]
    ds_read_b128 a[148:151], v69 offset:18432
    v_mul_f32 v66, s27, v244
    v_mfma_f32_16x16x32_bf16 v[36:39], a[152:155], a[48:51], v[36:39]
    s_add_u32 m0, m0, s50
    v_mov_b32 v149, v148
    v_mov_b32 v150, v148
    v_mfma_f32_16x16x32_bf16 v[40:43], a[152:155], a[80:83], v[40:43]
    s_waitcnt lgkmcnt(3)
    v_mov_b32 v151, v148
    v_mov_b32 v213, v212
    v_mfma_f32_16x16x32_bf16 v[32:35], a[156:159], a[20:23], v[32:35]
    ds_read_b128 a[152:155], v68 offset:22528
    v_mov_b32 v214, v212
    v_mfma_f32_16x16x32_bf16 v[36:39], a[156:159], a[52:55], v[36:39]
    buffer_load_dwordx4 v78, s[8:11], s24 offen offset:384 sc0 sc1 lds
    v_mfma_f32_16x16x32_bf16 v[40:43], a[156:159], a[84:87], v[40:43]
    buffer_store_dwordx4 a[100:103], v81, s[16:19], s49 offen sc1
    v_mfma_f32_16x16x32_bf16 v[32:35], a[160:163], a[24:27], v[32:35]
    ds_read_b128 a[156:159], v69 offset:22528
    v_mov_b32 v215, v212
    v_mfma_f32_16x16x32_bf16 v[36:39], a[160:163], a[56:59], v[36:39]
    s_add_u32 s24, s24, s59
    v_mov_b32 v245, v244
    v_mov_b32 v246, v244
    v_mfma_f32_16x16x32_bf16 v[40:43], a[160:163], a[88:91], v[40:43]
    s_waitcnt lgkmcnt(3)
    v_mov_b32 v247, v244
    v_fma_f32 v0, v0, s27, v64
    v_mfma_f32_16x16x32_bf16 v[32:35], a[164:167], a[28:31], v[32:35]
    ds_read_b128 a[160:163], v68 offset:26624
    v_fma_f32 v1, v1, s27, v64
    v_mfma_f32_16x16x32_bf16 v[36:39], a[164:167], a[60:63], v[36:39]
    s_add_u32 m0, m0, s94
    v_fma_f32 v2, v2, s27, v64
    v_fma_f32 v3, v3, s27, v64
    v_mfma_f32_16x16x32_bf16 v[40:43], a[164:167], a[92:95], v[40:43]
    buffer_load_dwordx4 v78, s[8:11], s24 offen offset:0 sc0 sc1 lds
    v_mfma_f32_16x16x32_bf16 v[48:51], a[144:147], a[0:3], v[148:151]
    ds_read_b128 a[164:167], v69 offset:26624
    v_fma_f32 v4, v4, s27, v65
    v_mfma_f32_16x16x32_bf16 v[52:55], a[144:147], a[32:35], v[212:215]
    ds_read_b128 a[104:107], v83 offset:2048
    v_fma_f32 v5, v5, s27, v65
    v_mfma_f32_16x16x32_bf16 v[56:59], a[144:147], a[64:67], v[244:247]
    s_waitcnt lgkmcnt(4)
    v_exp_f32 v0, v0
    v_mfma_f32_16x16x32_bf16 v[48:51], a[148:151], a[4:7], v[48:51]
    ds_read_b128 a[144:147], v68 offset:30720
    v_fma_f32 v6, v6, s27, v65
    v_mfma_f32_16x16x32_bf16 v[52:55], a[148:151], a[36:39], v[52:55]
    s_waitcnt vmcnt(16)
    v_exp_f32 v1, v1
    v_mfma_f32_16x16x32_bf16 v[56:59], a[148:151], a[68:71], v[56:59]
    s_barrier
    v_mfma_f32_16x16x32_bf16 v[48:51], a[152:155], a[8:11], v[48:51]
    ds_read_b128 a[148:151], v69 offset:30720
    v_cvt_pk_bf16_f32 v88, v0, v1
    v_mfma_f32_16x16x32_bf16 v[52:55], a[152:155], a[40:43], v[52:55]
    s_add_u32 m0, m0, s50
    v_exp_f32 v2, v2
    v_mfma_f32_16x16x32_bf16 v[56:59], a[152:155], a[72:75], v[56:59]
    s_waitcnt lgkmcnt(4)
    v_exp_f32 v3, v3
    v_mfma_f32_16x16x32_bf16 v[48:51], a[156:159], a[12:15], v[48:51]
    ds_read_b128 a[152:155], v68 offset:32768
    v_fma_f32 v7, v7, s27, v65
    v_mfma_f32_16x16x32_bf16 v[52:55], a[156:159], a[44:47], v[52:55]
    buffer_load_dwordx4 v78, s[8:11], s24 offen offset:128 sc0 sc1 lds
    v_mfma_f32_16x16x32_bf16 v[56:59], a[156:159], a[76:79], v[56:59]
    s_add_u32 s48, s49, s31
    v_cvt_pk_bf16_f32 v89, v2, v3
    v_fma_f32 v8, v8, s27, v66
    v_mfma_f32_16x16x32_bf16 v[48:51], a[160:163], a[16:19], v[48:51]
    ds_read_b128 a[156:159], v69 offset:32768
    v_fma_f32 v9, v9, s27, v66
    v_mfma_f32_16x16x32_bf16 v[52:55], a[160:163], a[48:51], v[52:55]
    s_waitcnt lgkmcnt(3)
    v_exp_f32 v4, v4
    v_mfma_f32_16x16x32_bf16 v[56:59], a[160:163], a[80:83], v[56:59]
    buffer_store_dwordx4 a[104:107], v81, s[16:19], s48 offen sc1
    v_mfma_f32_16x16x32_bf16 v[48:51], a[164:167], a[20:23], v[48:51]
    ds_read_b128 a[160:163], v68 offset:36864
    v_fma_f32 v10, v10, s27, v66
    v_mfma_f32_16x16x32_bf16 v[52:55], a[164:167], a[52:55], v[52:55]
    s_add_u32 m0, m0, s50
    v_exp_f32 v5, v5
    v_mfma_f32_16x16x32_bf16 v[56:59], a[164:167], a[84:87], v[56:59]
    buffer_load_dwordx4 v78, s[8:11], s24 offen offset:256 sc0 sc1 lds
    v_mfma_f32_16x16x32_bf16 v[48:51], a[144:147], a[24:27], v[48:51]
    ds_read_b128 a[164:167], v69 offset:36864
    v_cvt_pk_bf16_f32 v152, v4, v5
    v_mfma_f32_16x16x32_bf16 v[52:55], a[144:147], a[56:59], v[52:55]
    s_waitcnt lgkmcnt(3)
    v_exp_f32 v6, v6
    v_mfma_f32_16x16x32_bf16 v[56:59], a[144:147], a[88:91], v[56:59]
    v_exp_f32 v7, v7
    v_mfma_f32_16x16x32_bf16 v[48:51], a[148:151], a[28:31], v[48:51]
    ds_read_b128 a[144:147], v68 offset:40960
    v_fma_f32 v11, v11, s27, v66
    v_mfma_f32_16x16x32_bf16 v[52:55], a[148:151], a[60:63], v[52:55]
    v_cvt_pk_bf16_f32 v153, v6, v7
    v_fma_f32 v16, v16, s27, v64
    v_mfma_f32_16x16x32_bf16 v[56:59], a[148:151], a[92:95], v[56:59]
    v_exp_f32 v8, v8
    v_mfma_f32_16x16x32_bf16 v[0:3], a[152:155], a[0:3], v[148:151]
    ds_read_b128 a[148:151], v69 offset:40960
    v_fma_f32 v17, v17, s27, v64
    v_mfma_f32_16x16x32_bf16 v[4:7], a[152:155], a[32:35], v[212:215]
    s_add_u32 m0, m0, s50
    v_exp_f32 v9, v9
    v_exp_f32 v10, v10
    v_fma_f32 v18, v18, s27, v64
    v_pk_mul_f32 v[48:49], v[48:49], s[92:93]
    v_pk_mul_f32 v[50:51], v[50:51], s[92:93]
    v_pk_mul_f32 v[52:53], v[52:53], s[92:93]
    v_pk_mul_f32 v[54:55], v[54:55], s[92:93]
    v_pk_mul_f32 v[56:57], v[56:57], s[92:93]
    v_pk_mul_f32 v[58:59], v[58:59], s[92:93]
    v_exp_f32 v11, v11
    v_cvt_pk_bf16_f32 v216, v8, v9
    v_cvt_pk_bf16_f32 v217, v10, v11
    v_mfma_f32_16x16x32_bf16 v[8:11], a[152:155], a[64:67], v[244:247]
    s_waitcnt lgkmcnt(3)
    v_fma_f32 v19, v19, s27, v64
    v_fma_f32 v20, v20, s27, v65
    v_mfma_f32_16x16x32_bf16 v[0:3], a[156:159], a[4:7], v[0:3]
    ds_read_b128 a[152:155], v68 offset:45056
    v_fma_f32 v21, v21, s27, v65
    v_mfma_f32_16x16x32_bf16 v[4:7], a[156:159], a[36:39], v[4:7]
    buffer_load_dwordx4 v78, s[8:11], s24 offen offset:384 sc0 sc1 lds
    v_mfma_f32_16x16x32_bf16 v[8:11], a[156:159], a[68:71], v[8:11]
    ds_read_b128 a[108:111], v83 offset:3072
    v_fma_f32 v22, v22, s27, v65
    v_mfma_f32_16x16x32_bf16 v[0:3], a[160:163], a[8:11], v[0:3]
    ds_read_b128 a[156:159], v69 offset:45056
    v_fma_f32 v23, v23, s27, v65
    v_mfma_f32_16x16x32_bf16 v[4:7], a[160:163], a[40:43], v[4:7]
    s_add_u32 s24, s24, s59
    v_exp_f32 v16, v16
    v_mfma_f32_16x16x32_bf16 v[8:11], a[160:163], a[72:75], v[8:11]
    s_waitcnt lgkmcnt(4)
    v_exp_f32 v17, v17
    v_mfma_f32_16x16x32_bf16 v[0:3], a[164:167], a[12:15], v[0:3]
    ds_read_b128 a[160:163], v68 offset:34816
    v_fma_f32 v24, v24, s27, v66
    v_mfma_f32_16x16x32_bf16 v[4:7], a[164:167], a[44:47], v[4:7]
    s_add_u32 m0, m0, s94
    s_add_u32 s49, s48, s31
    v_cvt_pk_bf16_f32 v90, v16, v17
    v_mfma_f32_16x16x32_bf16 v[8:11], a[164:167], a[76:79], v[8:11]
    buffer_load_dwordx4 v78, s[8:11], s24 offen offset:0 sc0 sc1 lds
    v_mfma_f32_16x16x32_bf16 v[0:3], a[144:147], a[16:19], v[0:3]
    ds_read_b128 a[164:167], v69 offset:34816
    v_fma_f32 v25, v25, s27, v66
    v_mfma_f32_16x16x32_bf16 v[4:7], a[144:147], a[48:51], v[4:7]
    s_waitcnt lgkmcnt(4)
    v_exp_f32 v18, v18
    v_mfma_f32_16x16x32_bf16 v[8:11], a[144:147], a[80:83], v[8:11]
    v_exp_f32 v19, v19
    v_mfma_f32_16x16x32_bf16 v[0:3], a[148:151], a[20:23], v[0:3]
    ds_read_b128 a[144:147], v68 offset:38912
    v_fma_f32 v26, v26, s27, v66
    v_mfma_f32_16x16x32_bf16 v[4:7], a[148:151], a[52:55], v[4:7]
    v_cvt_pk_bf16_f32 v91, v18, v19
    v_fma_f32 v27, v27, s27, v66
    v_mfma_f32_16x16x32_bf16 v[8:11], a[148:151], a[84:87], v[8:11]
    v_exp_f32 v20, v20
    v_mfma_f32_16x16x32_bf16 v[0:3], a[152:155], a[24:27], v[0:3]
    ds_read_b128 a[148:151], v69 offset:38912
    v_fma_f32 v32, v32, s27, v64
    v_mfma_f32_16x16x32_bf16 v[4:7], a[152:155], a[56:59], v[4:7]
    s_add_u32 m0, m0, s50
    v_exp_f32 v21, v21
    v_mfma_f32_16x16x32_bf16 v[8:11], a[152:155], a[88:91], v[8:11]
    s_waitcnt lgkmcnt(3)
    v_exp_f32 v22, v22
    v_mfma_f32_16x16x32_bf16 v[0:3], a[156:159], a[28:31], v[0:3]
    ds_read_b128 a[152:155], v68 offset:43008
    v_cvt_pk_bf16_f32 v154, v20, v21
    v_mfma_f32_16x16x32_bf16 v[4:7], a[156:159], a[60:63], v[4:7]
    buffer_store_dwordx4 a[108:111], v81, s[16:19], s49 offen sc1
    v_mfma_f32_16x16x32_bf16 v[8:11], a[156:159], a[92:95], v[8:11]
    buffer_load_dwordx4 v78, s[8:11], s24 offen offset:128 sc0 sc1 lds
    v_mfma_f32_16x16x32_bf16 v[16:19], a[160:163], a[0:3], v[148:151]
    ds_read_b128 a[156:159], v69 offset:43008
    v_fma_f32 v33, v33, s27, v64
    v_exp_f32 v23, v23
    s_nop 0
    v_cvt_pk_bf16_f32 v155, v22, v23
    v_mfma_f32_16x16x32_bf16 v[20:23], a[160:163], a[32:35], v[212:215]
    v_exp_f32 v24, v24
    v_exp_f32 v25, v25
    v_fma_f32 v34, v34, s27, v64
    v_pk_mul_f32 v[0:1], v[0:1], s[92:93]
    v_pk_mul_f32 v[2:3], v[2:3], s[92:93]
    v_pk_mul_f32 v[4:5], v[4:5], s[92:93]
    v_pk_mul_f32 v[6:7], v[6:7], s[92:93]
    v_pk_mul_f32 v[8:9], v[8:9], s[92:93]
    v_pk_mul_f32 v[10:11], v[10:11], s[92:93]
    v_exp_f32 v26, v26
    v_exp_f32 v27, v27
    v_cvt_pk_bf16_f32 v218, v24, v25
    v_cvt_pk_bf16_f32 v219, v26, v27
    v_mfma_f32_16x16x32_bf16 v[24:27], a[160:163], a[64:67], v[244:247]
    s_waitcnt lgkmcnt(3)
    v_fma_f32 v35, v35, s27, v64
    v_fma_f32 v36, v36, s27, v65
    v_mfma_f32_16x16x32_bf16 v[16:19], a[164:167], a[4:7], v[16:19]
    ds_read_b128 a[160:163], v68 offset:47104
    v_subrev_u32 v68, s96, v68
    v_mfma_f32_16x16x32_bf16 v[20:23], a[164:167], a[36:39], v[20:23]
    ds_read_b128 a[112:115], v83 offset:16384
    v_fma_f32 v37, v37, s27, v65
    v_mfma_f32_16x16x32_bf16 v[24:27], a[164:167], a[68:71], v[24:27]
    s_waitcnt vmcnt(16)
    v_exp_f32 v32, v32
    v_mfma_f32_16x16x32_bf16 v[16:19], a[144:147], a[8:11], v[16:19]
    ds_read_b128 a[164:167], v69 offset:47104
    v_subrev_u32 v69, s96, v69
    v_mfma_f32_16x16x32_bf16 v[20:23], a[144:147], a[40:43], v[20:23]
    s_barrier
    v_mfma_f32_16x16x32_bf16 v[24:27], a[144:147], a[72:75], v[24:27]
    s_waitcnt lgkmcnt(4)
    v_exp_f32 v33, v33
    v_mfma_f32_16x16x32_bf16 v[16:19], a[148:151], a[12:15], v[16:19]
    ds_read_b128 a[144:147], v68 offset:0
    v_fma_f32 v38, v38, s27, v65
    v_mfma_f32_16x16x32_bf16 v[20:23], a[148:151], a[44:47], v[20:23]
    s_add_u32 m0, m0, s50
    s_add_u32 s48, s49, s31
    v_cvt_pk_bf16_f32 v92, v32, v33
    v_mfma_f32_16x16x32_bf16 v[24:27], a[148:151], a[76:79], v[24:27]
    buffer_load_dwordx4 v78, s[8:11], s24 offen offset:256 sc0 sc1 lds
    v_mfma_f32_16x16x32_bf16 v[16:19], a[152:155], a[16:19], v[16:19]
    ds_read_b128 a[148:151], v69 offset:0
    v_fma_f32 v39, v39, s27, v65
    v_mfma_f32_16x16x32_bf16 v[20:23], a[152:155], a[48:51], v[20:23]
    s_waitcnt lgkmcnt(4)
    v_exp_f32 v34, v34
    v_mfma_f32_16x16x32_bf16 v[24:27], a[152:155], a[80:83], v[24:27]
    v_exp_f32 v35, v35
    v_mfma_f32_16x16x32_bf16 v[16:19], a[156:159], a[20:23], v[16:19]
    ds_read_b128 a[152:155], v68 offset:4096
    v_fma_f32 v40, v40, s27, v66
    v_mfma_f32_16x16x32_bf16 v[20:23], a[156:159], a[52:55], v[20:23]
    s_add_u32 m0, m0, s50
    v_cvt_pk_bf16_f32 v93, v34, v35
    v_fma_f32 v41, v41, s27, v66
    v_mfma_f32_16x16x32_bf16 v[24:27], a[156:159], a[84:87], v[24:27]
    buffer_load_dwordx4 v78, s[8:11], s24 offen offset:384 sc0 sc1 lds
    v_mfma_f32_16x16x32_bf16 v[16:19], a[160:163], a[24:27], v[16:19]
    ds_read_b128 a[156:159], v69 offset:4096
    v_fma_f32 v42, v42, s27, v66
    v_mfma_f32_16x16x32_bf16 v[20:23], a[160:163], a[56:59], v[20:23]
L_w11:
    s_cbranch_execz L_w15
    s_waitcnt lgkmcnt(3)
    v_exp_f32 v36, v36
    v_mfma_f32_16x16x32_bf16 v[24:27], a[160:163], a[88:91], v[24:27]
    buffer_store_dwordx4 a[112:115], v81, s[16:19], s48 offen sc1
    v_mfma_f32_16x16x32_bf16 v[16:19], a[164:167], a[28:31], v[16:19]
    ds_read_b128 a[160:163], v68 offset:8192
    v_fma_f32 v43, v43, s27, v66
    v_mfma_f32_16x16x32_bf16 v[20:23], a[164:167], a[60:63], v[20:23]
    s_add_u32 s24, s24, s59
    v_exp_f32 v37, v37
    v_mfma_f32_16x16x32_bf16 v[24:27], a[164:167], a[92:95], v[24:27]
    v_exp_f32 v38, v38
    v_mfma_f32_16x16x32_bf16 v[32:35], a[144:147], a[0:3], v[148:151]
    ds_read_b128 a[164:167], v69 offset:8192
    v_cvt_pk_bf16_f32 v156, v36, v37
    v_exp_f32 v39, v39
    s_nop 0
    v_cvt_pk_bf16_f32 v157, v38, v39
    v_mfma_f32_16x16x32_bf16 v[36:39], a[144:147], a[32:35], v[212:215]
    s_add_u32 m0, m0, s94
    v_exp_f32 v40, v40
    v_exp_f32 v41, v41
    v_pk_mul_f32 v[16:17], v[16:17], s[92:93]
    v_pk_mul_f32 v[18:19], v[18:19], s[92:93]
    v_pk_mul_f32 v[20:21], v[20:21], s[92:93]
    v_pk_mul_f32 v[22:23], v[22:23], s[92:93]
    v_pk_mul_f32 v[24:25], v[24:25], s[92:93]
    v_pk_mul_f32 v[26:27], v[26:27], s[92:93]
    v_exp_f32 v42, v42
    v_exp_f32 v43, v43
    v_cvt_pk_bf16_f32 v220, v40, v41
    v_cvt_pk_bf16_f32 v221, v42, v43
    v_mfma_f32_16x16x32_bf16 v[40:43], a[144:147], a[64:67], v[244:247]
    s_waitcnt lgkmcnt(3)
    v_exp_f32 v48, v48
    v_mfma_f32_16x16x32_bf16 v[32:35], a[148:151], a[4:7], v[32:35]
    ds_read_b128 a[144:147], v68 offset:12288
    v_mfma_f32_16x16x32_bf16 v[36:39], a[148:151], a[36:39], v[36:39]
    buffer_load_dwordx4 v78, s[8:11], s24 offen offset:0 sc0 sc1 lds
    v_mfma_f32_16x16x32_bf16 v[40:43], a[148:151], a[68:71], v[40:43]
    ds_read_b128 a[116:119], v83 offset:17408
    s_add_u32 s49, s48, s31
    v_mfma_f32_16x16x32_bf16 v[32:35], a[152:155], a[8:11], v[32:35]
    ds_read_b128 a[148:151], v69 offset:12288
    v_mfma_f32_16x16x32_bf16 v[36:39], a[152:155], a[40:43], v[36:39]
    s_waitcnt lgkmcnt(4)
    v_exp_f32 v49, v49
    v_mfma_f32_16x16x32_bf16 v[40:43], a[152:155], a[72:75], v[40:43]
    v_exp_f32 v50, v50
    v_mfma_f32_16x16x32_bf16 v[32:35], a[156:159], a[12:15], v[32:35]
    ds_read_b128 a[152:155], v68 offset:2048
    v_cvt_pk_bf16_f32 v94, v48, v49
    v_mfma_f32_16x16x32_bf16 v[36:39], a[156:159], a[44:47], v[36:39]
    s_add_u32 m0, m0, s50
    v_exp_f32 v51, v51
    v_mfma_f32_16x16x32_bf16 v[40:43], a[156:159], a[76:79], v[40:43]
    buffer_load_dwordx4 v78, s[8:11], s24 offen offset:128 sc0 sc1 lds
    v_mfma_f32_16x16x32_bf16 v[32:35], a[160:163], a[16:19], v[32:35]
    ds_read_b128 a[156:159], v69 offset:2048
    v_cvt_pk_bf16_f32 v95, v50, v51
    v_mfma_f32_16x16x32_bf16 v[36:39], a[160:163], a[48:51], v[36:39]
    s_waitcnt lgkmcnt(4)
    v_exp_f32 v52, v52
    v_mfma_f32_16x16x32_bf16 v[40:43], a[160:163], a[80:83], v[40:43]
    v_exp_f32 v53, v53
    v_mfma_f32_16x16x32_bf16 v[32:35], a[164:167], a[20:23], v[32:35]
    ds_read_b128 a[160:163], v68 offset:6144
    v_mfma_f32_16x16x32_bf16 v[36:39], a[164:167], a[52:55], v[36:39]
    v_exp_f32 v54, v54
    v_mfma_f32_16x16x32_bf16 v[40:43], a[164:167], a[84:87], v[40:43]
    v_exp_f32 v55, v55
    v_mfma_f32_16x16x32_bf16 v[32:35], a[144:147], a[24:27], v[32:35]
    ds_read_b128 a[164:167], v69 offset:6144
    v_cvt_pk_bf16_f32 v158, v52, v53
    v_mfma_f32_16x16x32_bf16 v[36:39], a[144:147], a[56:59], v[36:39]
    s_add_u32 m0, m0, s50
    v_exp_f32 v56, v56
    v_mfma_f32_16x16x32_bf16 v[40:43], a[144:147], a[88:91], v[40:43]
    s_waitcnt lgkmcnt(3)
    v_exp_f32 v57, v57
    v_mfma_f32_16x16x32_bf16 v[32:35], a[148:151], a[28:31], v[32:35]
    ds_read_b128 a[144:147], v68 offset:10240
    v_cvt_pk_bf16_f32 v159, v54, v55
    v_mfma_f32_16x16x32_bf16 v[36:39], a[148:151], a[60:63], v[36:39]
    buffer_store_dwordx4 a[116:119], v81, s[16:19], s49 offen sc1
    v_mfma_f32_16x16x32_bf16 v[40:43], a[148:151], a[92:95], v[40:43]
    buffer_load_dwordx4 v78, s[8:11], s24 offen offset:256 sc0 sc1 lds
    v_smfmac_f32_16x16x64_bf16 a[136:139], a[128:131], v[88:95], v84
    v_cvt_pk_bf16_f32 v222, v56, v57
    v_smfmac_f32_16x16x64_bf16 a[136:139], a[132:135], v[152:159], v84
    v_exp_f32 v58, v58
    v_exp_f32 v59, v59
    s_nop 0
    v_cvt_pk_bf16_f32 v223, v58, v59
    s_nop 1
    v_smfmac_f32_16x16x64_bf16 a[140:143], a[128:131], v[216:223], v84
    v_exp_f32 v0, v0
    v_exp_f32 v1, v1
    v_pk_mul_f32 v[32:33], v[32:33], s[92:93]
    v_pk_mul_f32 v[34:35], v[34:35], s[92:93]
    v_pk_mul_f32 v[36:37], v[36:37], s[92:93]
    v_pk_mul_f32 v[38:39], v[38:39], s[92:93]
    v_pk_mul_f32 v[40:41], v[40:41], s[92:93]
    v_pk_mul_f32 v[42:43], v[42:43], s[92:93]
    v_mfma_f32_16x16x32_bf16 v[48:51], a[152:155], a[0:3], v[148:151]
    ds_read_b128 a[148:151], v69 offset:10240
    v_cvt_pk_bf16_f32 v96, v0, v1
    v_mfma_f32_16x16x32_bf16 v[52:55], a[152:155], a[32:35], v[212:215]
    ds_read_b128 a[120:123], v83 offset:18432
    s_waitcnt lgkmcnt(4)
    v_mfma_f32_16x16x32_bf16 v[56:59], a[152:155], a[64:67], v[244:247]
    v_exp_f32 v2, v2
    v_mfma_f32_16x16x32_bf16 v[48:51], a[156:159], a[4:7], v[48:51]
    ds_read_b128 a[152:155], v68 offset:14336
    v_mfma_f32_16x16x32_bf16 v[52:55], a[156:159], a[36:39], v[52:55]
    s_waitcnt vmcnt(16)
    v_exp_f32 v3, v3
    v_mfma_f32_16x16x32_bf16 v[56:59], a[156:159], a[68:71], v[56:59]
    s_barrier
    v_mfma_f32_16x16x32_bf16 v[48:51], a[160:163], a[8:11], v[48:51]
    ds_read_b128 a[156:159], v69 offset:14336
    v_cvt_pk_bf16_f32 v97, v2, v3
    v_mfma_f32_16x16x32_bf16 v[52:55], a[160:163], a[40:43], v[52:55]
    s_add_u32 m0, m0, s50
    v_exp_f32 v4, v4
    v_mfma_f32_16x16x32_bf16 v[56:59], a[160:163], a[72:75], v[56:59]
    s_waitcnt lgkmcnt(4)
    v_exp_f32 v5, v5
    v_mfma_f32_16x16x32_bf16 v[48:51], a[164:167], a[12:15], v[48:51]
    ds_read_b128 a[160:163], v68 offset:16384
    s_add_u32 s48, s49, s31
    v_mfma_f32_16x16x32_bf16 v[52:55], a[164:167], a[44:47], v[52:55]
    buffer_load_dwordx4 v78, s[8:11], s24 offen offset:384 sc0 sc1 lds
    v_mfma_f32_16x16x32_bf16 v[56:59], a[164:167], a[76:79], v[56:59]
    v_exp_f32 v6, v6
    v_mfma_f32_16x16x32_bf16 v[48:51], a[144:147], a[16:19], v[48:51]
    ds_read_b128 a[164:167], v69 offset:16384
    v_cvt_pk_bf16_f32 v160, v4, v5
    v_mfma_f32_16x16x32_bf16 v[52:55], a[144:147], a[48:51], v[52:55]
    s_xor_b32 s24, s20, 131072
    v_exp_f32 v7, v7
    v_mfma_f32_16x16x32_bf16 v[56:59], a[144:147], a[80:83], v[56:59]
    s_waitcnt lgkmcnt(3)
    v_exp_f32 v8, v8
    v_mfma_f32_16x16x32_bf16 v[48:51], a[148:151], a[20:23], v[48:51]
    ds_read_b128 a[144:147], v68 offset:20480
    v_cvt_pk_bf16_f32 v161, v6, v7
    v_mfma_f32_16x16x32_bf16 v[52:55], a[148:151], a[52:55], v[52:55]
    buffer_store_dwordx4 a[120:123], v81, s[16:19], s48 offen sc1
    v_mfma_f32_16x16x32_bf16 v[56:59], a[148:151], a[84:87], v[56:59]
    s_add_u32 m0, m0, s94
    v_exp_f32 v9, v9
    v_mfma_f32_16x16x32_bf16 v[48:51], a[152:155], a[24:27], v[48:51]
    ds_read_b128 a[148:151], v69 offset:20480
    v_mfma_f32_16x16x32_bf16 v[52:55], a[152:155], a[56:59], v[52:55]
    buffer_load_dwordx4 v78, s[8:11], s24 offen offset:0 sc0 sc1 lds
    v_mfma_f32_16x16x32_bf16 v[56:59], a[152:155], a[88:91], v[56:59]
    s_waitcnt lgkmcnt(3)
    v_exp_f32 v10, v10
    v_mfma_f32_16x16x32_bf16 v[48:51], a[156:159], a[28:31], v[48:51]
    ds_read_b128 a[152:155], v68 offset:24576
    v_cvt_pk_bf16_f32 v224, v8, v9
    v_mfma_f32_16x16x32_bf16 v[52:55], a[156:159], a[60:63], v[52:55]
    v_exp_f32 v11, v11
    v_mfma_f32_16x16x32_bf16 v[56:59], a[156:159], a[92:95], v[56:59]
    v_exp_f32 v16, v16
    v_mfma_f32_16x16x32_bf16 v[0:3], a[160:163], a[0:3], v[148:151]
    ds_read_b128 a[156:159], v69 offset:24576
    v_cvt_pk_bf16_f32 v225, v10, v11
    v_mfma_f32_16x16x32_bf16 v[4:7], a[160:163], a[32:35], v[212:215]
    s_add_u32 m0, m0, s50
    v_exp_f32 v17, v17
    v_exp_f32 v18, v18
    v_pk_mul_f32 v[48:49], v[48:49], s[92:93]
    v_pk_mul_f32 v[50:51], v[50:51], s[92:93]
    v_pk_mul_f32 v[52:53], v[52:53], s[92:93]
    v_pk_mul_f32 v[54:55], v[54:55], s[92:93]
    v_pk_mul_f32 v[56:57], v[56:57], s[92:93]
    v_pk_mul_f32 v[58:59], v[58:59], s[92:93]
    v_mfma_f32_16x16x32_bf16 v[8:11], a[160:163], a[64:67], v[244:247]
    s_waitcnt lgkmcnt(3)
    v_exp_f32 v19, v19
    v_mfma_f32_16x16x32_bf16 v[0:3], a[164:167], a[4:7], v[0:3]
    ds_read_b128 a[160:163], v68 offset:28672
    v_cvt_pk_bf16_f32 v98, v16, v17
    v_mfma_f32_16x16x32_bf16 v[4:7], a[164:167], a[36:39], v[4:7]
    buffer_load_dwordx4 v78, s[8:11], s24 offen offset:128 sc0 sc1 lds
    v_mfma_f32_16x16x32_bf16 v[8:11], a[164:167], a[68:71], v[8:11]
    ds_read_b128 a[124:127], v83 offset:19456
    v_cvt_pk_bf16_f32 v99, v18, v19
    v_mfma_f32_16x16x32_bf16 v[0:3], a[144:147], a[8:11], v[0:3]
    ds_read_b128 a[164:167], v69 offset:28672
    s_add_u32 s49, s48, s31
    v_mfma_f32_16x16x32_bf16 v[4:7], a[144:147], a[40:43], v[4:7]
    s_waitcnt lgkmcnt(4)
    v_exp_f32 v20, v20
    v_mfma_f32_16x16x32_bf16 v[8:11], a[144:147], a[72:75], v[8:11]
    v_exp_f32 v21, v21
    v_mfma_f32_16x16x32_bf16 v[0:3], a[148:151], a[12:15], v[0:3]
    ds_read_b128 a[144:147], v68 offset:18432
    s_add_u32 m0, m0, s50
    v_mfma_f32_16x16x32_bf16 v[4:7], a[148:151], a[44:47], v[4:7]
    v_exp_f32 v22, v22
    v_mfma_f32_16x16x32_bf16 v[8:11], a[148:151], a[76:79], v[8:11]
    buffer_load_dwordx4 v78, s[8:11], s24 offen offset:256 sc0 sc1 lds
    v_mfma_f32_16x16x32_bf16 v[0:3], a[152:155], a[16:19], v[0:3]
    ds_read_b128 a[148:151], v69 offset:18432
    v_cvt_pk_bf16_f32 v162, v20, v21
    v_mfma_f32_16x16x32_bf16 v[4:7], a[152:155], a[48:51], v[4:7]
    s_waitcnt lgkmcnt(4)
    v_exp_f32 v23, v23
    v_mfma_f32_16x16x32_bf16 v[8:11], a[152:155], a[80:83], v[8:11]
    v_exp_f32 v24, v24
    v_mfma_f32_16x16x32_bf16 v[0:3], a[156:159], a[20:23], v[0:3]
    ds_read_b128 a[152:155], v68 offset:22528
    v_cvt_pk_bf16_f32 v163, v22, v23
    v_mfma_f32_16x16x32_bf16 v[4:7], a[156:159], a[52:55], v[4:7]
    v_exp_f32 v25, v25
    v_mfma_f32_16x16x32_bf16 v[8:11], a[156:159], a[84:87], v[8:11]
    v_exp_f32 v26, v26
    v_mfma_f32_16x16x32_bf16 v[0:3], a[160:163], a[24:27], v[0:3]
    ds_read_b128 a[156:159], v69 offset:22528
    v_cvt_pk_bf16_f32 v226, v24, v25
    v_mfma_f32_16x16x32_bf16 v[4:7], a[160:163], a[56:59], v[4:7]
    s_add_u32 m0, m0, s50
    v_exp_f32 v27, v27
    v_mfma_f32_16x16x32_bf16 v[8:11], a[160:163], a[88:91], v[8:11]
    s_waitcnt lgkmcnt(3)
    v_exp_f32 v32, v32
    v_mfma_f32_16x16x32_bf16 v[0:3], a[164:167], a[28:31], v[0:3]
    ds_read_b128 a[160:163], v68 offset:26624
    v_cvt_pk_bf16_f32 v227, v26, v27
    v_mfma_f32_16x16x32_bf16 v[4:7], a[164:167], a[60:63], v[4:7]
    buffer_store_dwordx4 a[124:127], v81, s[16:19], s49 offen sc1
    v_mfma_f32_16x16x32_bf16 v[8:11], a[164:167], a[92:95], v[8:11]
    buffer_load_dwordx4 v78, s[8:11], s24 offen offset:384 sc0 sc1 lds
    v_mfma_f32_16x16x32_bf16 v[16:19], a[144:147], a[0:3], v[148:151]
    ds_read_b128 a[164:167], v69 offset:26624
    v_mfma_f32_16x16x32_bf16 v[20:23], a[144:147], a[32:35], v[212:215]
    s_waitcnt lgkmcnt(3)
    v_exp_f32 v33, v33
    v_mfma_f32_16x16x32_bf16 v[24:27], a[144:147], a[64:67], v[244:247]
    v_exp_f32 v34, v34
    v_exp_f32 v35, v35
    v_cvt_pk_bf16_f32 v100, v32, v33
    v_pk_mul_f32 v[0:1], v[0:1], s[92:93]
    v_pk_mul_f32 v[2:3], v[2:3], s[92:93]
    v_pk_mul_f32 v[4:5], v[4:5], s[92:93]
    v_pk_mul_f32 v[6:7], v[6:7], s[92:93]
    v_pk_mul_f32 v[8:9], v[8:9], s[92:93]
    v_pk_mul_f32 v[10:11], v[10:11], s[92:93]
    v_mfma_f32_16x16x32_bf16 v[16:19], a[148:151], a[4:7], v[16:19]
    ds_read_b128 a[144:147], v68 offset:30720
    v_cvt_pk_bf16_f32 v101, v34, v35
    v_mfma_f32_16x16x32_bf16 v[20:23], a[148:151], a[36:39], v[20:23]
    s_waitcnt vmcnt(17)
    v_exp_f32 v36, v36
    v_mfma_f32_16x16x32_bf16 v[24:27], a[148:151], a[68:71], v[24:27]
    s_barrier
    v_mfma_f32_16x16x32_bf16 v[16:19], a[152:155], a[8:11], v[16:19]
    ds_read_b128 a[148:151], v69 offset:30720
    s_add_u32 s24, s24, s59
    v_mfma_f32_16x16x32_bf16 v[20:23], a[152:155], a[40:43], v[20:23]
    s_waitcnt lgkmcnt(3)
    v_exp_f32 v37, v37
    v_mfma_f32_16x16x32_bf16 v[24:27], a[152:155], a[72:75], v[24:27]
    v_exp_f32 v38, v38
    v_mfma_f32_16x16x32_bf16 v[16:19], a[156:159], a[12:15], v[16:19]
    ds_read_b128 a[152:155], v68 offset:32768
    v_cvt_pk_bf16_f32 v164, v36, v37
    v_mfma_f32_16x16x32_bf16 v[20:23], a[156:159], a[44:47], v[20:23]
    s_add_u32 m0, s22, 0
    v_exp_f32 v39, v39
    v_mfma_f32_16x16x32_bf16 v[24:27], a[156:159], a[76:79], v[24:27]
    buffer_load_dwordx4 v78, s[8:11], s24 offen offset:0 sc0 sc1 lds
    v_mfma_f32_16x16x32_bf16 v[16:19], a[160:163], a[16:19], v[16:19]
    ds_read_b128 a[156:159], v69 offset:32768
    v_cvt_pk_bf16_f32 v165, v38, v39
    v_mfma_f32_16x16x32_bf16 v[20:23], a[160:163], a[48:51], v[20:23]
    s_waitcnt lgkmcnt(3)
    v_exp_f32 v40, v40
    v_mfma_f32_16x16x32_bf16 v[24:27], a[160:163], a[80:83], v[24:27]
    v_exp_f32 v41, v41
    v_mfma_f32_16x16x32_bf16 v[16:19], a[164:167], a[20:23], v[16:19]
    ds_read_b128 a[160:163], v68 offset:36864
    v_mfma_f32_16x16x32_bf16 v[20:23], a[164:167], a[52:55], v[20:23]
    v_exp_f32 v42, v42
    v_mfma_f32_16x16x32_bf16 v[24:27], a[164:167], a[84:87], v[24:27]
    v_exp_f32 v43, v43
    v_mfma_f32_16x16x32_bf16 v[16:19], a[144:147], a[24:27], v[16:19]
    ds_read_b128 a[164:167], v69 offset:36864
    v_cvt_pk_bf16_f32 v228, v40, v41
    v_mfma_f32_16x16x32_bf16 v[20:23], a[144:147], a[56:59], v[20:23]
    s_add_u32 m0, m0, s50
    v_exp_f32 v48, v48
    v_mfma_f32_16x16x32_bf16 v[24:27], a[144:147], a[88:91], v[24:27]
    s_waitcnt lgkmcnt(3)
    v_exp_f32 v49, v49
    v_mfma_f32_16x16x32_bf16 v[16:19], a[148:151], a[28:31], v[16:19]
    ds_read_b128 a[144:147], v68 offset:40960
    v_cvt_pk_bf16_f32 v229, v42, v43
    v_mfma_f32_16x16x32_bf16 v[20:23], a[148:151], a[60:63], v[20:23]
    buffer_load_dwordx4 v78, s[8:11], s24 offen offset:128 sc0 sc1 lds
    v_mfma_f32_16x16x32_bf16 v[24:27], a[148:151], a[92:95], v[24:27]
    s_add_u32 s43, s42, 24576
    v_exp_f32 v50, v50
    v_mfma_f32_16x16x32_bf16 v[32:35], a[152:155], a[0:3], v[148:151]
    ds_read_b128 a[148:151], v69 offset:40960
    v_cvt_pk_bf16_f32 v102, v48, v49
    v_mfma_f32_16x16x32_bf16 v[36:39], a[152:155], a[32:35], v[212:215]
    s_add_u32 m0, s44, 114688
    v_exp_f32 v51, v51
    v_exp_f32 v52, v52
    v_pk_mul_f32 v[16:17], v[16:17], s[92:93]
    v_pk_mul_f32 v[18:19], v[18:19], s[92:93]
    v_pk_mul_f32 v[20:21], v[20:21], s[92:93]
    v_pk_mul_f32 v[22:23], v[22:23], s[92:93]
    v_pk_mul_f32 v[24:25], v[24:25], s[92:93]
    v_pk_mul_f32 v[26:27], v[26:27], s[92:93]
    v_mfma_f32_16x16x32_bf16 v[40:43], a[152:155], a[64:67], v[244:247]
    s_waitcnt lgkmcnt(3)
    v_exp_f32 v53, v53
    v_mfma_f32_16x16x32_bf16 v[32:35], a[156:159], a[4:7], v[32:35]
    ds_read_b128 a[152:155], v68 offset:45056
    v_cvt_pk_bf16_f32 v103, v50, v51
    v_mfma_f32_16x16x32_bf16 v[36:39], a[156:159], a[36:39], v[36:39]
    buffer_load_dwordx4 v78, s[4:7], s43 offen offset:0 sc0 sc1 nt lds
    v_mfma_f32_16x16x32_bf16 v[40:43], a[156:159], a[68:71], v[40:43]
    s_add_u32 m0, s22, 7936
    v_exp_f32 v54, v54
    v_mfma_f32_16x16x32_bf16 v[32:35], a[160:163], a[8:11], v[32:35]
    ds_read_b128 a[156:159], v69 offset:45056
    v_cvt_pk_bf16_f32 v166, v52, v53
    v_mfma_f32_16x16x32_bf16 v[36:39], a[160:163], a[40:43], v[36:39]
    buffer_load_dwordx4 v78, s[8:11], s24 offen offset:256 sc0 sc1 lds
    v_mfma_f32_16x16x32_bf16 v[40:43], a[160:163], a[72:75], v[40:43]
    s_waitcnt lgkmcnt(3)
    v_exp_f32 v55, v55
    v_mfma_f32_16x16x32_bf16 v[32:35], a[164:167], a[12:15], v[32:35]
    ds_read_b128 a[160:163], v68 offset:34816
    s_add_u32 m0, s45, 114688
    v_mfma_f32_16x16x32_bf16 v[36:39], a[164:167], a[44:47], v[36:39]
    buffer_load_dwordx4 v72, s[4:7], s43 offen offset:0 sc0 sc1 nt lds
    v_mfma_f32_16x16x32_bf16 v[40:43], a[164:167], a[76:79], v[40:43]
    v_exp_f32 v56, v56
    v_mfma_f32_16x16x32_bf16 v[32:35], a[144:147], a[16:19], v[32:35]
    ds_read_b128 a[164:167], v69 offset:34816
    v_cvt_pk_bf16_f32 v167, v54, v55
    v_mfma_f32_16x16x32_bf16 v[36:39], a[144:147], a[48:51], v[36:39]
    s_add_u32 m0, s22, 11904
    v_exp_f32 v57, v57
    v_mfma_f32_16x16x32_bf16 v[40:43], a[144:147], a[80:83], v[40:43]
    s_waitcnt lgkmcnt(3)
    v_exp_f32 v58, v58
    v_mfma_f32_16x16x32_bf16 v[32:35], a[148:151], a[20:23], v[32:35]
    ds_read_b128 a[144:147], v68 offset:38912
    v_cvt_pk_bf16_f32 v230, v56, v57
    v_mfma_f32_16x16x32_bf16 v[36:39], a[148:151], a[52:55], v[36:39]
    buffer_load_dwordx4 v78, s[8:11], s24 offen offset:384 sc0 sc1 lds
    v_mfma_f32_16x16x32_bf16 v[40:43], a[148:151], a[84:87], v[40:43]
    s_add_u32 m0, s44, 116608
    v_exp_f32 v59, v59
    v_mfma_f32_16x16x32_bf16 v[32:35], a[152:155], a[24:27], v[32:35]
    ds_read_b128 a[148:151], v69 offset:38912
    v_mfma_f32_16x16x32_bf16 v[36:39], a[152:155], a[56:59], v[36:39]
    buffer_load_dwordx4 v78, s[4:7], s43 offen offset:128 sc0 sc1 nt lds
    v_mfma_f32_16x16x32_bf16 v[40:43], a[152:155], a[88:91], v[40:43]
    s_waitcnt lgkmcnt(3)
    v_exp_f32 v0, v0
    v_mfma_f32_16x16x32_bf16 v[32:35], a[156:159], a[28:31], v[32:35]
    ds_read_b128 a[152:155], v68 offset:43008
    v_cvt_pk_bf16_f32 v231, v58, v59
    v_mfma_f32_16x16x32_bf16 v[36:39], a[156:159], a[60:63], v[36:39]
    s_add_u32 m0, s45, 116608
    v_exp_f32 v1, v1
    v_mfma_f32_16x16x32_bf16 v[40:43], a[156:159], a[92:95], v[40:43]
    buffer_load_dwordx4 v72, s[4:7], s43 offen offset:128 sc0 sc1 nt lds
    v_smfmac_f32_16x16x64_bf16 a[136:139], a[128:131], v[96:103], v84
    v_cvt_pk_bf16_f32 v104, v0, v1
    v_smfmac_f32_16x16x64_bf16 a[136:139], a[132:135], v[160:167], v84
    v_smfmac_f32_16x16x64_bf16 a[140:143], a[128:131], v[224:231], v84
    v_exp_f32 v2, v2
    v_exp_f32 v3, v3
    v_pk_mul_f32 v[32:33], v[32:33], s[92:93]
    v_pk_mul_f32 v[34:35], v[34:35], s[92:93]
    v_pk_mul_f32 v[36:37], v[36:37], s[92:93]
    v_pk_mul_f32 v[38:39], v[38:39], s[92:93]
    v_pk_mul_f32 v[40:41], v[40:41], s[92:93]
    v_pk_mul_f32 v[42:43], v[42:43], s[92:93]
    v_mfma_f32_16x16x32_bf16 v[48:51], a[160:163], a[0:3], v[148:151]
    ds_read_b128 a[156:159], v69 offset:43008
    v_cvt_pk_bf16_f32 v105, v2, v3
    v_mfma_f32_16x16x32_bf16 v[52:55], a[160:163], a[32:35], v[212:215]
    s_waitcnt lgkmcnt(3)
    v_exp_f32 v4, v4
    v_mfma_f32_16x16x32_bf16 v[56:59], a[160:163], a[64:67], v[244:247]
    v_exp_f32 v5, v5
    v_mfma_f32_16x16x32_bf16 v[48:51], a[164:167], a[4:7], v[48:51]
    ds_read_b128 a[160:163], v68 offset:47104
    v_mfma_f32_16x16x32_bf16 v[52:55], a[164:167], a[36:39], v[52:55]
    s_waitcnt vmcnt(20)
    v_exp_f32 v6, v6
    v_mfma_f32_16x16x32_bf16 v[56:59], a[164:167], a[68:71], v[56:59]
    s_barrier
    v_mfma_f32_16x16x32_bf16 v[48:51], a[144:147], a[8:11], v[48:51]
    ds_read_b128 a[164:167], v69 offset:47104
    v_cvt_pk_bf16_f32 v168, v4, v5
    v_mfma_f32_16x16x32_bf16 v[52:55], a[144:147], a[40:43], v[52:55]
    s_add_u32 s24, s24, s59
    v_exp_f32 v7, v7
    v_mfma_f32_16x16x32_bf16 v[56:59], a[144:147], a[72:75], v[56:59]
    s_waitcnt lgkmcnt(3)
    v_exp_f32 v8, v8
    v_mfma_f32_16x16x32_bf16 v[48:51], a[148:151], a[12:15], v[48:51]
    ds_read_b128 a[144:147], v68 offset:49152
    v_cvt_pk_bf16_f32 v169, v6, v7
    v_mfma_f32_16x16x32_bf16 v[52:55], a[148:151], a[44:47], v[52:55]
    s_add_u32 m0, s22, 16384
    v_exp_f32 v9, v9
    v_mfma_f32_16x16x32_bf16 v[56:59], a[148:151], a[76:79], v[56:59]
    buffer_load_dwordx4 v78, s[8:11], s24 offen offset:0 sc0 sc1 lds
    v_mfma_f32_16x16x32_bf16 v[48:51], a[152:155], a[16:19], v[48:51]
    ds_read_b128 a[148:151], v69 offset:49152
    v_cvt_pk_bf16_f32 v232, v8, v9
    v_mfma_f32_16x16x32_bf16 v[52:55], a[152:155], a[48:51], v[52:55]
    s_waitcnt lgkmcnt(3)
    v_exp_f32 v10, v10
    v_mfma_f32_16x16x32_bf16 v[56:59], a[152:155], a[80:83], v[56:59]
    v_exp_f32 v11, v11
    v_mfma_f32_16x16x32_bf16 v[48:51], a[156:159], a[20:23], v[48:51]
    ds_read_b128 a[152:155], v68 offset:53248
    v_mfma_f32_16x16x32_bf16 v[52:55], a[156:159], a[52:55], v[52:55]
    v_exp_f32 v16, v16
    v_mfma_f32_16x16x32_bf16 v[56:59], a[156:159], a[84:87], v[56:59]
    v_exp_f32 v17, v17
    v_mfma_f32_16x16x32_bf16 v[48:51], a[160:163], a[24:27], v[48:51]
    ds_read_b128 a[156:159], v69 offset:53248
    v_cvt_pk_bf16_f32 v233, v10, v11
    v_mfma_f32_16x16x32_bf16 v[52:55], a[160:163], a[56:59], v[52:55]
    s_add_u32 m0, m0, s50
    v_exp_f32 v18, v18
    v_mfma_f32_16x16x32_bf16 v[56:59], a[160:163], a[88:91], v[56:59]
    s_waitcnt lgkmcnt(3)
    v_exp_f32 v19, v19
    v_mfma_f32_16x16x32_bf16 v[48:51], a[164:167], a[28:31], v[48:51]
    ds_read_b128 a[160:163], v68 offset:57344
    v_cvt_pk_bf16_f32 v106, v16, v17
    v_mfma_f32_16x16x32_bf16 v[52:55], a[164:167], a[60:63], v[52:55]
    buffer_load_dwordx4 v78, s[8:11], s24 offen offset:128 sc0 sc1 lds
    v_mfma_f32_16x16x32_bf16 v[56:59], a[164:167], a[92:95], v[56:59]
    v_exp_f32 v20, v20
    v_mfma_f32_16x16x32_bf16 v[0:3], a[144:147], a[0:3], v[148:151]
    ds_read_b128 a[164:167], v69 offset:57344
    v_cvt_pk_bf16_f32 v107, v18, v19
    v_mfma_f32_16x16x32_bf16 v[4:7], a[144:147], a[32:35], v[212:215]
    v_exp_f32 v21, v21
    v_exp_f32 v22, v22
    v_pk_mul_f32 v[48:49], v[48:49], s[92:93]
    v_pk_mul_f32 v[50:51], v[50:51], s[92:93]
    v_pk_mul_f32 v[52:53], v[52:53], s[92:93]
    v_pk_mul_f32 v[54:55], v[54:55], s[92:93]
    v_pk_mul_f32 v[56:57], v[56:57], s[92:93]
    v_pk_mul_f32 v[58:59], v[58:59], s[92:93]
    v_mfma_f32_16x16x32_bf16 v[8:11], a[144:147], a[64:67], v[244:247]
    s_waitcnt lgkmcnt(3)
    v_exp_f32 v23, v23
    v_mfma_f32_16x16x32_bf16 v[0:3], a[148:151], a[4:7], v[0:3]
    ds_read_b128 a[144:147], v68 offset:61440
    v_cvt_pk_bf16_f32 v170, v20, v21
    v_mfma_f32_16x16x32_bf16 v[4:7], a[148:151], a[36:39], v[4:7]
    s_add_u32 m0, m0, s50
    v_exp_f32 v24, v24
    v_mfma_f32_16x16x32_bf16 v[8:11], a[148:151], a[68:71], v[8:11]
    buffer_load_dwordx4 v78, s[8:11], s24 offen offset:256 sc0 sc1 lds
    v_mfma_f32_16x16x32_bf16 v[0:3], a[152:155], a[8:11], v[0:3]
    ds_read_b128 a[148:151], v69 offset:61440
    v_cvt_pk_bf16_f32 v171, v22, v23
    v_mfma_f32_16x16x32_bf16 v[4:7], a[152:155], a[40:43], v[4:7]
    s_waitcnt lgkmcnt(3)
    v_exp_f32 v25, v25
    v_mfma_f32_16x16x32_bf16 v[8:11], a[152:155], a[72:75], v[8:11]
    v_exp_f32 v26, v26
    v_mfma_f32_16x16x32_bf16 v[0:3], a[156:159], a[12:15], v[0:3]
    ds_read_b128 a[152:155], v68 offset:51200
    v_cvt_pk_bf16_f32 v234, v24, v25
    v_mfma_f32_16x16x32_bf16 v[4:7], a[156:159], a[44:47], v[4:7]
    v_exp_f32 v27, v27
    v_mfma_f32_16x16x32_bf16 v[8:11], a[156:159], a[76:79], v[8:11]
    v_exp_f32 v32, v32
    v_mfma_f32_16x16x32_bf16 v[0:3], a[160:163], a[16:19], v[0:3]
    ds_read_b128 a[156:159], v69 offset:51200
    v_cvt_pk_bf16_f32 v235, v26, v27
    v_mfma_f32_16x16x32_bf16 v[4:7], a[160:163], a[48:51], v[4:7]
    s_add_u32 m0, m0, s50
    v_exp_f32 v33, v33
    v_mfma_f32_16x16x32_bf16 v[8:11], a[160:163], a[80:83], v[8:11]
    s_waitcnt lgkmcnt(3)
    v_exp_f32 v34, v34
    v_mfma_f32_16x16x32_bf16 v[0:3], a[164:167], a[20:23], v[0:3]
    ds_read_b128 a[160:163], v68 offset:55296
    v_cvt_pk_bf16_f32 v108, v32, v33
    v_mfma_f32_16x16x32_bf16 v[4:7], a[164:167], a[52:55], v[4:7]
    buffer_load_dwordx4 v78, s[8:11], s24 offen offset:384 sc0 sc1 lds
    v_mfma_f32_16x16x32_bf16 v[8:11], a[164:167], a[84:87], v[8:11]
    v_exp_f32 v35, v35
    v_mfma_f32_16x16x32_bf16 v[0:3], a[144:147], a[24:27], v[0:3]
    ds_read_b128 a[164:167], v69 offset:55296
    v_mfma_f32_16x16x32_bf16 v[4:7], a[144:147], a[56:59], v[4:7]
    s_waitcnt lgkmcnt(3)
    v_exp_f32 v36, v36
    v_mfma_f32_16x16x32_bf16 v[8:11], a[144:147], a[88:91], v[8:11]
    v_exp_f32 v37, v37
    v_mfma_f32_16x16x32_bf16 v[0:3], a[148:151], a[28:31], v[0:3]
    ds_read_b128 a[144:147], v68 offset:59392
    v_cvt_pk_bf16_f32 v109, v34, v35
    v_mfma_f32_16x16x32_bf16 v[4:7], a[148:151], a[60:63], v[4:7]
    v_exp_f32 v38, v38
    v_mfma_f32_16x16x32_bf16 v[8:11], a[148:151], a[92:95], v[8:11]
    v_exp_f32 v39, v39
    v_mfma_f32_16x16x32_bf16 v[16:19], a[152:155], a[0:3], v[148:151]
    ds_read_b128 a[148:151], v69 offset:59392
    v_cvt_pk_bf16_f32 v172, v36, v37
    v_mfma_f32_16x16x32_bf16 v[20:23], a[152:155], a[32:35], v[212:215]
    v_exp_f32 v40, v40
    v_exp_f32 v41, v41
    v_cvt_pk_bf16_f32 v173, v38, v39
    v_pk_mul_f32 v[0:1], v[0:1], s[92:93]
    v_pk_mul_f32 v[2:3], v[2:3], s[92:93]
    v_pk_mul_f32 v[4:5], v[4:5], s[92:93]
    v_pk_mul_f32 v[6:7], v[6:7], s[92:93]
    v_pk_mul_f32 v[8:9], v[8:9], s[92:93]
    v_pk_mul_f32 v[10:11], v[10:11], s[92:93]
    v_mfma_f32_16x16x32_bf16 v[24:27], a[152:155], a[64:67], v[244:247]
    s_waitcnt lgkmcnt(3)
    v_exp_f32 v42, v42
    v_mfma_f32_16x16x32_bf16 v[16:19], a[156:159], a[4:7], v[16:19]
    ds_read_b128 a[152:155], v68 offset:63488
    v_add_u32 v68, s96, v68
    v_mfma_f32_16x16x32_bf16 v[20:23], a[156:159], a[36:39], v[20:23]
    s_waitcnt vmcnt(18)
    v_exp_f32 v43, v43
    v_mfma_f32_16x16x32_bf16 v[24:27], a[156:159], a[68:71], v[24:27]
    s_barrier
    v_mfma_f32_16x16x32_bf16 v[16:19], a[160:163], a[8:11], v[16:19]
    ds_read_b128 a[156:159], v69 offset:63488
    v_add_u32 v69, s96, v69
    v_mfma_f32_16x16x32_bf16 v[20:23], a[160:163], a[40:43], v[20:23]
    s_add_u32 s24, s24, s59
    v_cvt_pk_bf16_f32 v236, v40, v41
    v_cvt_pk_bf16_f32 v237, v42, v43
    v_mfma_f32_16x16x32_bf16 v[24:27], a[160:163], a[72:75], v[24:27]
    s_waitcnt lgkmcnt(3)
    v_exp_f32 v48, v48
    v_mfma_f32_16x16x32_bf16 v[16:19], a[164:167], a[12:15], v[16:19]
    ds_read_b128 a[160:163], v68 offset:16384
    s_add_u32 m0, m0, s94
    v_mfma_f32_16x16x32_bf16 v[20:23], a[164:167], a[44:47], v[20:23]
    v_exp_f32 v49, v49
    v_mfma_f32_16x16x32_bf16 v[24:27], a[164:167], a[76:79], v[24:27]
    buffer_load_dwordx4 v78, s[8:11], s24 offen offset:0 sc0 sc1 lds
    v_mfma_f32_16x16x32_bf16 v[16:19], a[144:147], a[16:19], v[16:19]
    ds_read_b128 a[164:167], v69 offset:16384
    v_cvt_pk_bf16_f32 v110, v48, v49
    v_mfma_f32_16x16x32_bf16 v[20:23], a[144:147], a[48:51], v[20:23]
    s_add_u32 s43, s42, 24832
    v_exp_f32 v50, v50
    v_mfma_f32_16x16x32_bf16 v[24:27], a[144:147], a[80:83], v[24:27]
    s_waitcnt lgkmcnt(3)
    v_exp_f32 v51, v51
    v_mfma_f32_16x16x32_bf16 v[16:19], a[148:151], a[20:23], v[16:19]
    ds_read_b128 a[144:147], v68 offset:20480
    s_add_u32 m0, s44, 131072
    v_mfma_f32_16x16x32_bf16 v[20:23], a[148:151], a[52:55], v[20:23]
    buffer_load_dwordx4 v78, s[4:7], s43 offen offset:0 sc0 sc1 nt lds
    v_mfma_f32_16x16x32_bf16 v[24:27], a[148:151], a[84:87], v[24:27]
    v_exp_f32 v52, v52
    v_mfma_f32_16x16x32_bf16 v[16:19], a[152:155], a[24:27], v[16:19]
    ds_read_b128 a[148:151], v69 offset:20480
    v_cvt_pk_bf16_f32 v111, v50, v51
    v_mfma_f32_16x16x32_bf16 v[20:23], a[152:155], a[56:59], v[20:23]
    s_add_u32 m0, s22, 36736
    v_exp_f32 v53, v53
    v_mfma_f32_16x16x32_bf16 v[24:27], a[152:155], a[88:91], v[24:27]
    s_waitcnt lgkmcnt(3)
    v_exp_f32 v54, v54
    v_mfma_f32_16x16x32_bf16 v[16:19], a[156:159], a[28:31], v[16:19]
    ds_read_b128 a[152:155], v68 offset:24576
    v_cvt_pk_bf16_f32 v174, v52, v53
    v_mfma_f32_16x16x32_bf16 v[20:23], a[156:159], a[60:63], v[20:23]
    buffer_load_dwordx4 v78, s[8:11], s24 offen offset:128 sc0 sc1 lds
    v_mfma_f32_16x16x32_bf16 v[24:27], a[156:159], a[92:95], v[24:27]
    s_add_u32 m0, s45, 131072
    v_exp_f32 v55, v55
    v_mfma_f32_16x16x32_bf16 v[32:35], a[160:163], a[0:3], v[148:151]
    ds_read_b128 a[156:159], v69 offset:24576
    v_mfma_f32_16x16x32_bf16 v[36:39], a[160:163], a[32:35], v[212:215]
    buffer_load_dwordx4 v72, s[4:7], s43 offen offset:0 sc0 sc1 nt lds
    v_exp_f32 v56, v56
    v_cvt_pk_bf16_f32 v175, v54, v55
    v_pk_mul_f32 v[16:17], v[16:17], s[92:93]
    v_pk_mul_f32 v[18:19], v[18:19], s[92:93]
L_w12:
    s_cbranch_execz L_w16
    v_pk_mul_f32 v[20:21], v[20:21], s[92:93]
    v_pk_mul_f32 v[22:23], v[22:23], s[92:93]
    v_pk_mul_f32 v[24:25], v[24:25], s[92:93]
    v_pk_mul_f32 v[26:27], v[26:27], s[92:93]
    v_mfma_f32_16x16x32_bf16 v[40:43], a[160:163], a[64:67], v[244:247]
    s_waitcnt lgkmcnt(3)
    v_exp_f32 v57, v57
    v_mfma_f32_16x16x32_bf16 v[32:35], a[164:167], a[4:7], v[32:35]
    ds_read_b128 a[160:163], v68 offset:28672
    s_add_u32 m0, s44, 132992
    v_mfma_f32_16x16x32_bf16 v[36:39], a[164:167], a[36:39], v[36:39]
    buffer_load_dwordx4 v78, s[4:7], s43 offen offset:128 sc0 sc1 nt lds
    v_mfma_f32_16x16x32_bf16 v[40:43], a[164:167], a[68:71], v[40:43]
    s_add_u32 m0, s22, 40704
    v_exp_f32 v58, v58
    v_mfma_f32_16x16x32_bf16 v[32:35], a[144:147], a[8:11], v[32:35]
    ds_read_b128 a[164:167], v69 offset:28672
    v_cvt_pk_bf16_f32 v238, v56, v57
    v_mfma_f32_16x16x32_bf16 v[36:39], a[144:147], a[40:43], v[36:39]
    buffer_load_dwordx4 v78, s[8:11], s24 offen offset:256 sc0 sc1 lds
    v_mfma_f32_16x16x32_bf16 v[40:43], a[144:147], a[72:75], v[40:43]
    s_waitcnt lgkmcnt(3)
    v_exp_f32 v59, v59
    v_mfma_f32_16x16x32_bf16 v[32:35], a[148:151], a[12:15], v[32:35]
    ds_read_b128 a[144:147], v68 offset:18432
    s_add_u32 m0, s45, 132992
    v_mfma_f32_16x16x32_bf16 v[36:39], a[148:151], a[44:47], v[36:39]
    buffer_load_dwordx4 v72, s[4:7], s43 offen offset:128 sc0 sc1 nt lds
    v_mfma_f32_16x16x32_bf16 v[40:43], a[148:151], a[76:79], v[40:43]
    v_exp_f32 v0, v0
    v_mfma_f32_16x16x32_bf16 v[32:35], a[152:155], a[16:19], v[32:35]
    ds_read_b128 a[148:151], v69 offset:18432
    v_cvt_pk_bf16_f32 v239, v58, v59
    v_mfma_f32_16x16x32_bf16 v[36:39], a[152:155], a[48:51], v[36:39]
    s_add_u32 m0, s22, 44672
    v_exp_f32 v1, v1
    v_mfma_f32_16x16x32_bf16 v[40:43], a[152:155], a[80:83], v[40:43]
    s_waitcnt lgkmcnt(3)
    v_exp_f32 v2, v2
    v_mfma_f32_16x16x32_bf16 v[32:35], a[156:159], a[20:23], v[32:35]
    ds_read_b128 a[152:155], v68 offset:22528
    v_cvt_pk_bf16_f32 v112, v0, v1
    v_mfma_f32_16x16x32_bf16 v[36:39], a[156:159], a[52:55], v[36:39]
    buffer_load_dwordx4 v78, s[8:11], s24 offen offset:384 sc0 sc1 lds
    v_mfma_f32_16x16x32_bf16 v[40:43], a[156:159], a[84:87], v[40:43]
    v_exp_f32 v3, v3
    v_mfma_f32_16x16x32_bf16 v[32:35], a[160:163], a[24:27], v[32:35]
    ds_read_b128 a[156:159], v69 offset:22528
    v_mfma_f32_16x16x32_bf16 v[36:39], a[160:163], a[56:59], v[36:39]
    s_waitcnt lgkmcnt(3)
    v_exp_f32 v4, v4
    v_mfma_f32_16x16x32_bf16 v[40:43], a[160:163], a[88:91], v[40:43]
    v_exp_f32 v5, v5
    v_mfma_f32_16x16x32_bf16 v[32:35], a[164:167], a[28:31], v[32:35]
    ds_read_b128 a[160:163], v68 offset:26624
    v_cvt_pk_bf16_f32 v113, v2, v3
    v_mfma_f32_16x16x32_bf16 v[36:39], a[164:167], a[60:63], v[36:39]
    v_exp_f32 v6, v6
    v_mfma_f32_16x16x32_bf16 v[40:43], a[164:167], a[92:95], v[40:43]
    v_exp_f32 v7, v7
    v_smfmac_f32_16x16x64_bf16 a[136:139], a[128:131], v[104:111], v84
    v_cvt_pk_bf16_f32 v176, v4, v5
    v_smfmac_f32_16x16x64_bf16 a[136:139], a[132:135], v[168:175], v84
    v_cvt_pk_bf16_f32 v177, v6, v7
    v_smfmac_f32_16x16x64_bf16 a[140:143], a[128:131], v[232:239], v84
    v_exp_f32 v8, v8
    v_exp_f32 v9, v9
    v_pk_mul_f32 v[32:33], v[32:33], s[92:93]
    v_pk_mul_f32 v[34:35], v[34:35], s[92:93]
    v_pk_mul_f32 v[36:37], v[36:37], s[92:93]
    v_pk_mul_f32 v[38:39], v[38:39], s[92:93]
    v_pk_mul_f32 v[40:41], v[40:41], s[92:93]
    v_pk_mul_f32 v[42:43], v[42:43], s[92:93]
    v_mfma_f32_16x16x32_bf16 v[48:51], a[144:147], a[0:3], v[148:151]
    ds_read_b128 a[164:167], v69 offset:26624
    v_cvt_pk_bf16_f32 v8, v8, v9
    v_mfma_f32_16x16x32_bf16 v[52:55], a[144:147], a[32:35], v[212:215]
    s_waitcnt lgkmcnt(3)
    v_exp_f32 v10, v10
    v_mfma_f32_16x16x32_bf16 v[56:59], a[144:147], a[64:67], v[244:247]
    v_exp_f32 v11, v11
    v_mfma_f32_16x16x32_bf16 v[48:51], a[148:151], a[4:7], v[48:51]
    ds_read_b128 a[144:147], v68 offset:30720
    v_accvgpr_write_b32 a168, v8
    v_mfma_f32_16x16x32_bf16 v[52:55], a[148:151], a[36:39], v[52:55]
    s_waitcnt vmcnt(20)
    v_exp_f32 v16, v16
    v_mfma_f32_16x16x32_bf16 v[56:59], a[148:151], a[68:71], v[56:59]
    s_barrier
    v_mfma_f32_16x16x32_bf16 v[48:51], a[152:155], a[8:11], v[48:51]
    ds_read_b128 a[148:151], v69 offset:30720
    v_cvt_pk_bf16_f32 v10, v10, v11
    v_mfma_f32_16x16x32_bf16 v[52:55], a[152:155], a[40:43], v[52:55]
    s_xor_b32 s24, s20, 196608
    v_exp_f32 v17, v17
    v_mfma_f32_16x16x32_bf16 v[56:59], a[152:155], a[72:75], v[56:59]
    s_waitcnt lgkmcnt(3)
    v_exp_f32 v18, v18
    v_mfma_f32_16x16x32_bf16 v[48:51], a[156:159], a[12:15], v[48:51]
    ds_read_b128 a[152:155], v68 offset:32768
    v_accvgpr_write_b32 a169, v10
    v_mfma_f32_16x16x32_bf16 v[52:55], a[156:159], a[44:47], v[52:55]
    s_add_u32 m0, m0, s94
    v_exp_f32 v19, v19
    v_mfma_f32_16x16x32_bf16 v[56:59], a[156:159], a[76:79], v[56:59]
    buffer_load_dwordx4 v78, s[8:11], s24 offen offset:0 sc0 sc1 lds
    v_mfma_f32_16x16x32_bf16 v[48:51], a[160:163], a[16:19], v[48:51]
    ds_read_b128 a[156:159], v69 offset:32768
    v_cvt_pk_bf16_f32 v114, v16, v17
    v_mfma_f32_16x16x32_bf16 v[52:55], a[160:163], a[48:51], v[52:55]
    s_waitcnt lgkmcnt(3)
    v_exp_f32 v20, v20
    v_mfma_f32_16x16x32_bf16 v[56:59], a[160:163], a[80:83], v[56:59]
    v_exp_f32 v21, v21
    v_mfma_f32_16x16x32_bf16 v[48:51], a[164:167], a[20:23], v[48:51]
    ds_read_b128 a[160:163], v68 offset:36864
    v_cvt_pk_bf16_f32 v115, v18, v19
    v_mfma_f32_16x16x32_bf16 v[52:55], a[164:167], a[52:55], v[52:55]
    v_exp_f32 v22, v22
    v_mfma_f32_16x16x32_bf16 v[56:59], a[164:167], a[84:87], v[56:59]
    v_exp_f32 v23, v23
    v_mfma_f32_16x16x32_bf16 v[48:51], a[144:147], a[24:27], v[48:51]
    ds_read_b128 a[164:167], v69 offset:36864
    v_cvt_pk_bf16_f32 v178, v20, v21
    v_mfma_f32_16x16x32_bf16 v[52:55], a[144:147], a[56:59], v[52:55]
    s_add_u32 m0, m0, s50
    v_exp_f32 v24, v24
    v_mfma_f32_16x16x32_bf16 v[56:59], a[144:147], a[88:91], v[56:59]
    s_waitcnt lgkmcnt(3)
    v_exp_f32 v25, v25
    v_mfma_f32_16x16x32_bf16 v[48:51], a[148:151], a[28:31], v[48:51]
    ds_read_b128 a[144:147], v68 offset:40960
    v_cvt_pk_bf16_f32 v179, v22, v23
    v_mfma_f32_16x16x32_bf16 v[52:55], a[148:151], a[60:63], v[52:55]
    buffer_load_dwordx4 v78, s[8:11], s24 offen offset:128 sc0 sc1 lds
    v_mfma_f32_16x16x32_bf16 v[56:59], a[148:151], a[92:95], v[56:59]
    v_exp_f32 v26, v26
    v_mfma_f32_16x16x32_bf16 v[0:3], a[152:155], a[0:3], v[148:151]
    ds_read_b128 a[148:151], v69 offset:40960
    v_cvt_pk_bf16_f32 v24, v24, v25
    v_mfma_f32_16x16x32_bf16 v[4:7], a[152:155], a[32:35], v[212:215]
    v_exp_f32 v27, v27
    v_exp_f32 v32, v32
    v_accvgpr_write_b32 a170, v24
    v_pk_mul_f32 v[48:49], v[48:49], s[92:93]
    v_pk_mul_f32 v[50:51], v[50:51], s[92:93]
    v_pk_mul_f32 v[52:53], v[52:53], s[92:93]
    v_pk_mul_f32 v[54:55], v[54:55], s[92:93]
    v_pk_mul_f32 v[56:57], v[56:57], s[92:93]
    v_pk_mul_f32 v[58:59], v[58:59], s[92:93]
    v_mfma_f32_16x16x32_bf16 v[8:11], a[152:155], a[64:67], v[244:247]
    s_waitcnt lgkmcnt(3)
    v_exp_f32 v33, v33
    v_mfma_f32_16x16x32_bf16 v[0:3], a[156:159], a[4:7], v[0:3]
    ds_read_b128 a[152:155], v68 offset:45056
    v_cvt_pk_bf16_f32 v26, v26, v27
    v_mfma_f32_16x16x32_bf16 v[4:7], a[156:159], a[36:39], v[4:7]
    s_add_u32 m0, m0, s50
    v_accvgpr_write_b32 a171, v26
    v_cvt_pk_bf16_f32 v116, v32, v33
    v_mfma_f32_16x16x32_bf16 v[8:11], a[156:159], a[68:71], v[8:11]
    buffer_load_dwordx4 v78, s[8:11], s24 offen offset:256 sc0 sc1 lds
    v_mfma_f32_16x16x32_bf16 v[0:3], a[160:163], a[8:11], v[0:3]
    ds_read_b128 a[156:159], v69 offset:45056
    v_mfma_f32_16x16x32_bf16 v[4:7], a[160:163], a[40:43], v[4:7]
    s_waitcnt lgkmcnt(3)
    v_exp_f32 v34, v34
    v_mfma_f32_16x16x32_bf16 v[8:11], a[160:163], a[72:75], v[8:11]
    v_exp_f32 v35, v35
    v_mfma_f32_16x16x32_bf16 v[0:3], a[164:167], a[12:15], v[0:3]
    ds_read_b128 a[160:163], v68 offset:34816
    v_mfma_f32_16x16x32_bf16 v[4:7], a[164:167], a[44:47], v[4:7]
    v_exp_f32 v36, v36
    v_mfma_f32_16x16x32_bf16 v[8:11], a[164:167], a[76:79], v[8:11]
    v_exp_f32 v37, v37
    v_mfma_f32_16x16x32_bf16 v[0:3], a[144:147], a[16:19], v[0:3]
    ds_read_b128 a[164:167], v69 offset:34816
    v_cvt_pk_bf16_f32 v117, v34, v35
    v_mfma_f32_16x16x32_bf16 v[4:7], a[144:147], a[48:51], v[4:7]
    s_add_u32 m0, m0, s50
    v_exp_f32 v38, v38
    v_mfma_f32_16x16x32_bf16 v[8:11], a[144:147], a[80:83], v[8:11]
    s_waitcnt lgkmcnt(3)
    v_exp_f32 v39, v39
    v_mfma_f32_16x16x32_bf16 v[0:3], a[148:151], a[20:23], v[0:3]
    ds_read_b128 a[144:147], v68 offset:38912
    v_cvt_pk_bf16_f32 v180, v36, v37
    v_mfma_f32_16x16x32_bf16 v[4:7], a[148:151], a[52:55], v[4:7]
    buffer_load_dwordx4 v78, s[8:11], s24 offen offset:384 sc0 sc1 lds
    v_mfma_f32_16x16x32_bf16 v[8:11], a[148:151], a[84:87], v[8:11]
    v_exp_f32 v40, v40
    v_mfma_f32_16x16x32_bf16 v[0:3], a[152:155], a[24:27], v[0:3]
    ds_read_b128 a[148:151], v69 offset:38912
    v_cvt_pk_bf16_f32 v181, v38, v39
    v_mfma_f32_16x16x32_bf16 v[4:7], a[152:155], a[56:59], v[4:7]
    s_waitcnt lgkmcnt(3)
    v_exp_f32 v41, v41
    v_mfma_f32_16x16x32_bf16 v[8:11], a[152:155], a[88:91], v[8:11]
    v_exp_f32 v42, v42
    v_mfma_f32_16x16x32_bf16 v[0:3], a[156:159], a[28:31], v[0:3]
    ds_read_b128 a[152:155], v68 offset:43008
    v_cvt_pk_bf16_f32 v40, v40, v41
    v_mfma_f32_16x16x32_bf16 v[4:7], a[156:159], a[60:63], v[4:7]
    v_exp_f32 v43, v43
    v_mfma_f32_16x16x32_bf16 v[8:11], a[156:159], a[92:95], v[8:11]
    s_add_u32 s43, s42, 0
    v_exp_f32 v48, v48
    v_mfma_f32_16x16x32_bf16 v[16:19], a[160:163], a[0:3], v[148:151]
    ds_read_b128 a[156:159], v69 offset:43008
    v_cvt_pk_bf16_f32 v42, v42, v43
    v_mfma_f32_16x16x32_bf16 v[20:23], a[160:163], a[32:35], v[212:215]
    s_add_u32 m0, s44, 147456
    v_accvgpr_write_b32 a172, v40
    v_exp_f32 v49, v49
    v_exp_f32 v50, v50
    v_pk_mul_f32 v[0:1], v[0:1], s[92:93]
    v_pk_mul_f32 v[2:3], v[2:3], s[92:93]
    v_pk_mul_f32 v[4:5], v[4:5], s[92:93]
    v_pk_mul_f32 v[6:7], v[6:7], s[92:93]
    v_pk_mul_f32 v[8:9], v[8:9], s[92:93]
    v_pk_mul_f32 v[10:11], v[10:11], s[92:93]
    v_mfma_f32_16x16x32_bf16 v[24:27], a[160:163], a[64:67], v[244:247]
    s_waitcnt lgkmcnt(3)
    v_accvgpr_write_b32 a173, v42
    v_cvt_pk_bf16_f32 v118, v48, v49
    v_mfma_f32_16x16x32_bf16 v[16:19], a[164:167], a[4:7], v[16:19]
    ds_read_b128 a[160:163], v68 offset:47104
    v_subrev_u32 v68, s96, v68
    v_mfma_f32_16x16x32_bf16 v[20:23], a[164:167], a[36:39], v[20:23]
    buffer_load_dwordx4 v78, s[4:7], s43 offen offset:0 sc0 sc1 nt lds
    v_mfma_f32_16x16x32_bf16 v[24:27], a[164:167], a[68:71], v[24:27]
    s_waitcnt vmcnt(19)
    v_exp_f32 v51, v51
    v_mfma_f32_16x16x32_bf16 v[16:19], a[144:147], a[8:11], v[16:19]
    ds_read_b128 a[164:167], v69 offset:47104
    v_subrev_u32 v69, s96, v69
    v_mfma_f32_16x16x32_bf16 v[20:23], a[144:147], a[40:43], v[20:23]
    s_barrier
    v_mfma_f32_16x16x32_bf16 v[24:27], a[144:147], a[72:75], v[24:27]
    s_waitcnt lgkmcnt(3)
    v_exp_f32 v52, v52
    v_mfma_f32_16x16x32_bf16 v[16:19], a[148:151], a[12:15], v[16:19]
    ds_read_b128 a[144:147], v68 offset:0
    v_cvt_pk_bf16_f32 v119, v50, v51
    v_mfma_f32_16x16x32_bf16 v[20:23], a[148:151], a[44:47], v[20:23]
    s_add_u32 s24, s24, s59
    v_exp_f32 v53, v53
    v_mfma_f32_16x16x32_bf16 v[24:27], a[148:151], a[76:79], v[24:27]
    s_add_u32 m0, s45, 147456
    v_exp_f32 v54, v54
    v_mfma_f32_16x16x32_bf16 v[16:19], a[152:155], a[16:19], v[16:19]
    ds_read_b128 a[148:151], v69 offset:0
    v_cvt_pk_bf16_f32 v182, v52, v53
    v_mfma_f32_16x16x32_bf16 v[20:23], a[152:155], a[48:51], v[20:23]
    buffer_load_dwordx4 v72, s[4:7], s43 offen offset:0 sc0 sc1 nt lds
    v_mfma_f32_16x16x32_bf16 v[24:27], a[152:155], a[80:83], v[24:27]
    s_waitcnt lgkmcnt(3)
    s_add_u32 m0, s22, 65536
    v_mfma_f32_16x16x32_bf16 v[16:19], a[156:159], a[20:23], v[16:19]
    ds_read_b128 a[152:155], v68 offset:4096
    v_mfma_f32_16x16x32_bf16 v[20:23], a[156:159], a[52:55], v[20:23]
    buffer_load_dwordx4 v78, s[8:11], s24 offen offset:0 sc0 sc1 lds
    v_mfma_f32_16x16x32_bf16 v[24:27], a[156:159], a[84:87], v[24:27]
    s_add_u32 m0, s44, 149376
    v_exp_f32 v55, v55
    v_mfma_f32_16x16x32_bf16 v[16:19], a[160:163], a[24:27], v[16:19]
    ds_read_b128 a[156:159], v69 offset:4096
    v_mfma_f32_16x16x32_bf16 v[20:23], a[160:163], a[56:59], v[20:23]
    buffer_load_dwordx4 v78, s[4:7], s43 offen offset:128 sc0 sc1 nt lds
    v_mfma_f32_16x16x32_bf16 v[24:27], a[160:163], a[88:91], v[24:27]
    s_waitcnt lgkmcnt(3)
    v_exp_f32 v56, v56
    v_mfma_f32_16x16x32_bf16 v[16:19], a[164:167], a[28:31], v[16:19]
    ds_read_b128 a[160:163], v68 offset:8192
    v_cvt_pk_bf16_f32 v183, v54, v55
    v_mfma_f32_16x16x32_bf16 v[20:23], a[164:167], a[60:63], v[20:23]
    s_add_u32 m0, s22, 69504
    v_exp_f32 v57, v57
    v_mfma_f32_16x16x32_bf16 v[24:27], a[164:167], a[92:95], v[24:27]
    buffer_load_dwordx4 v78, s[8:11], s24 offen offset:128 sc0 sc1 lds
    v_mfma_f32_16x16x32_bf16 v[32:35], a[144:147], a[0:3], v[148:151]
    ds_read_b128 a[164:167], v69 offset:8192
    v_cvt_pk_bf16_f32 v56, v56, v57
    v_mfma_f32_16x16x32_bf16 v[36:39], a[144:147], a[32:35], v[212:215]
    s_add_u32 m0, s45, 149376
    v_exp_f32 v58, v58
    v_exp_f32 v59, v59
    v_accvgpr_write_b32 a174, v56
    v_pk_mul_f32 v[16:17], v[16:17], s[92:93]
    v_pk_mul_f32 v[18:19], v[18:19], s[92:93]
    v_pk_mul_f32 v[20:21], v[20:21], s[92:93]
    v_pk_mul_f32 v[22:23], v[22:23], s[92:93]
    v_pk_mul_f32 v[24:25], v[24:25], s[92:93]
    v_pk_mul_f32 v[26:27], v[26:27], s[92:93]
    v_mfma_f32_16x16x32_bf16 v[40:43], a[144:147], a[64:67], v[244:247]
    s_waitcnt lgkmcnt(3)
    v_exp_f32 v0, v0
    v_mfma_f32_16x16x32_bf16 v[32:35], a[148:151], a[4:7], v[32:35]
    ds_read_b128 a[144:147], v68 offset:12288
    v_cvt_pk_bf16_f32 v58, v58, v59
    v_mfma_f32_16x16x32_bf16 v[36:39], a[148:151], a[36:39], v[36:39]
    buffer_load_dwordx4 v72, s[4:7], s43 offen offset:128 sc0 sc1 nt lds
    v_mfma_f32_16x16x32_bf16 v[40:43], a[148:151], a[68:71], v[40:43]
    s_waitcnt vmcnt(22)
    v_exp_f32 v1, v1
    v_mfma_f32_16x16x32_bf16 v[32:35], a[152:155], a[8:11], v[32:35]
    ds_read_b128 a[148:151], v69 offset:12288
    v_accvgpr_write_b32 a175, v58
    v_mfma_f32_16x16x32_bf16 v[36:39], a[152:155], a[40:43], v[36:39]
    ds_read_b128 a[96:99], v70 offset:0
    v_cvt_pk_bf16_f32 v120, v0, v1
    v_mfma_f32_16x16x32_bf16 v[40:43], a[152:155], a[72:75], v[40:43]
    s_waitcnt lgkmcnt(4)
    s_add_u32 m0, s22, 73472
    v_mfma_f32_16x16x32_bf16 v[32:35], a[156:159], a[12:15], v[32:35]
    ds_read_b128 a[152:155], v68 offset:2048
    v_mfma_f32_16x16x32_bf16 v[36:39], a[156:159], a[44:47], v[36:39]
    buffer_load_dwordx4 v78, s[8:11], s24 offen offset:256 sc0 sc1 lds
    v_mfma_f32_16x16x32_bf16 v[40:43], a[156:159], a[76:79], v[40:43]
    ds_read_b128 a[100:103], v71 offset:0
    s_add_u32 m0, m0, s50
    v_mfma_f32_16x16x32_bf16 v[32:35], a[160:163], a[16:19], v[32:35]
    ds_read_b128 a[156:159], v69 offset:2048
    v_mfma_f32_16x16x32_bf16 v[36:39], a[160:163], a[48:51], v[36:39]
    ds_read_b128 a[104:107], v70 offset:2048
    s_waitcnt lgkmcnt(6)
    v_mfma_f32_16x16x32_bf16 v[40:43], a[160:163], a[80:83], v[40:43]
    buffer_load_dwordx4 v78, s[8:11], s24 offen offset:384 sc0 sc1 lds
    v_mfma_f32_16x16x32_bf16 v[32:35], a[164:167], a[20:23], v[32:35]
    ds_read_b128 a[160:163], v68 offset:6144
    v_mfma_f32_16x16x32_bf16 v[36:39], a[164:167], a[52:55], v[36:39]
    ds_read_b128 a[108:111], v71 offset:2048
    v_mfma_f32_16x16x32_bf16 v[40:43], a[164:167], a[84:87], v[40:43]
    v_exp_f32 v2, v2
    v_mfma_f32_16x16x32_bf16 v[32:35], a[144:147], a[24:27], v[32:35]
    ds_read_b128 a[164:167], v69 offset:6144
    v_mfma_f32_16x16x32_bf16 v[36:39], a[144:147], a[56:59], v[36:39]
    s_waitcnt lgkmcnt(6)
    v_exp_f32 v3, v3
    v_mfma_f32_16x16x32_bf16 v[40:43], a[144:147], a[88:91], v[40:43]
    v_exp_f32 v4, v4
    v_mfma_f32_16x16x32_bf16 v[32:35], a[148:151], a[28:31], v[32:35]
    ds_read_b128 a[144:147], v68 offset:10240
    v_cvt_pk_bf16_f32 v121, v2, v3
    v_mfma_f32_16x16x32_bf16 v[36:39], a[148:151], a[60:63], v[36:39]
    v_exp_f32 v5, v5
    v_mfma_f32_16x16x32_bf16 v[40:43], a[148:151], a[92:95], v[40:43]
    v_exp_f32 v6, v6
    v_smfmac_f32_16x16x64_bf16 a[136:139], a[128:131], v[112:119], v84
    v_cvt_pk_bf16_f32 v184, v4, v5
    v_smfmac_f32_16x16x64_bf16 a[136:139], a[132:135], v[176:183], v84
    v_smfmac_f32_16x16x64_bf16 a[140:143], a[128:131], a[168:175], v84
    v_exp_f32 v7, v7
    v_exp_f32 v8, v8
    v_pk_mul_f32 v[32:33], v[32:33], s[92:93]
    v_pk_mul_f32 v[34:35], v[34:35], s[92:93]
    v_pk_mul_f32 v[36:37], v[36:37], s[92:93]
    v_pk_mul_f32 v[38:39], v[38:39], s[92:93]
    v_pk_mul_f32 v[40:41], v[40:41], s[92:93]
    v_pk_mul_f32 v[42:43], v[42:43], s[92:93]
    v_mfma_f32_16x16x32_bf16 v[48:51], a[152:155], a[0:3], v[148:151]
    ds_read_b128 a[148:151], v69 offset:10240
    v_cvt_pk_bf16_f32 v185, v6, v7
    v_mfma_f32_16x16x32_bf16 v[52:55], a[152:155], a[32:35], v[212:215]
    s_waitcnt lgkmcnt(4)
    v_exp_f32 v9, v9
    v_mfma_f32_16x16x32_bf16 v[56:59], a[152:155], a[64:67], v[244:247]
    v_exp_f32 v10, v10
    v_mfma_f32_16x16x32_bf16 v[48:51], a[156:159], a[4:7], v[48:51]
    ds_read_b128 a[152:155], v68 offset:14336
    v_cvt_pk_bf16_f32 v8, v8, v9
    v_mfma_f32_16x16x32_bf16 v[52:55], a[156:159], a[36:39], v[52:55]
    s_waitcnt vmcnt(20)
    v_exp_f32 v11, v11
    v_mfma_f32_16x16x32_bf16 v[56:59], a[156:159], a[68:71], v[56:59]
    s_barrier
    v_mfma_f32_16x16x32_bf16 v[48:51], a[160:163], a[8:11], v[48:51]
    ds_read_b128 a[156:159], v69 offset:14336
    v_cvt_pk_bf16_f32 v10, v10, v11
    v_mfma_f32_16x16x32_bf16 v[52:55], a[160:163], a[40:43], v[52:55]
    s_add_u32 s24, s24, s59
    v_accvgpr_write_b32 a176, v8
    v_accvgpr_write_b32 a177, v10
    v_mfma_f32_16x16x32_bf16 v[56:59], a[160:163], a[72:75], v[56:59]
    s_waitcnt lgkmcnt(3)
    v_exp_f32 v16, v16
    v_mfma_f32_16x16x32_bf16 v[48:51], a[164:167], a[12:15], v[48:51]
    ds_read_b128 a[160:163], v68 offset:16384
    s_add_u32 m0, m0, s94
    v_mfma_f32_16x16x32_bf16 v[52:55], a[164:167], a[44:47], v[52:55]
    v_exp_f32 v17, v17
    v_mfma_f32_16x16x32_bf16 v[56:59], a[164:167], a[76:79], v[56:59]
    buffer_load_dwordx4 v78, s[8:11], s24 offen offset:0 sc0 sc1 lds
    v_mfma_f32_16x16x32_bf16 v[48:51], a[144:147], a[16:19], v[48:51]
    ds_read_b128 a[164:167], v69 offset:16384
    v_cvt_pk_bf16_f32 v122, v16, v17
    v_mfma_f32_16x16x32_bf16 v[52:55], a[144:147], a[48:51], v[52:55]
    s_waitcnt lgkmcnt(3)
    v_exp_f32 v18, v18
    v_mfma_f32_16x16x32_bf16 v[56:59], a[144:147], a[80:83], v[56:59]
    v_exp_f32 v19, v19
    v_mfma_f32_16x16x32_bf16 v[48:51], a[148:151], a[20:23], v[48:51]
    ds_read_b128 a[144:147], v68 offset:20480
    v_mfma_f32_16x16x32_bf16 v[52:55], a[148:151], a[52:55], v[52:55]
    v_exp_f32 v20, v20
    v_mfma_f32_16x16x32_bf16 v[56:59], a[148:151], a[84:87], v[56:59]
    v_exp_f32 v21, v21
    v_mfma_f32_16x16x32_bf16 v[48:51], a[152:155], a[24:27], v[48:51]
    ds_read_b128 a[148:151], v69 offset:20480
    v_cvt_pk_bf16_f32 v123, v18, v19
    v_mfma_f32_16x16x32_bf16 v[52:55], a[152:155], a[56:59], v[52:55]
    s_add_u32 m0, m0, s50
    v_exp_f32 v22, v22
    v_mfma_f32_16x16x32_bf16 v[56:59], a[152:155], a[88:91], v[56:59]
    s_waitcnt lgkmcnt(3)
    v_exp_f32 v23, v23
    v_mfma_f32_16x16x32_bf16 v[48:51], a[156:159], a[28:31], v[48:51]
    ds_read_b128 a[152:155], v68 offset:24576
    v_cvt_pk_bf16_f32 v186, v20, v21
    v_mfma_f32_16x16x32_bf16 v[52:55], a[156:159], a[60:63], v[52:55]
    buffer_load_dwordx4 v78, s[8:11], s24 offen offset:128 sc0 sc1 lds
    v_mfma_f32_16x16x32_bf16 v[56:59], a[156:159], a[92:95], v[56:59]
    v_exp_f32 v24, v24
    v_mfma_f32_16x16x32_bf16 v[0:3], a[160:163], a[0:3], v[148:151]
    ds_read_b128 a[156:159], v69 offset:24576
    v_cvt_pk_bf16_f32 v187, v22, v23
    v_mfma_f32_16x16x32_bf16 v[4:7], a[160:163], a[32:35], v[212:215]
    v_exp_f32 v25, v25
    v_exp_f32 v26, v26
    v_pk_mul_f32 v[48:49], v[48:49], s[92:93]
    v_pk_mul_f32 v[50:51], v[50:51], s[92:93]
    v_pk_mul_f32 v[52:53], v[52:53], s[92:93]
    v_pk_mul_f32 v[54:55], v[54:55], s[92:93]
    v_pk_mul_f32 v[56:57], v[56:57], s[92:93]
    v_pk_mul_f32 v[58:59], v[58:59], s[92:93]
    v_mfma_f32_16x16x32_bf16 v[8:11], a[160:163], a[64:67], v[244:247]
    s_waitcnt lgkmcnt(3)
    v_exp_f32 v27, v27
    v_mfma_f32_16x16x32_bf16 v[0:3], a[164:167], a[4:7], v[0:3]
    ds_read_b128 a[160:163], v68 offset:28672
    v_cvt_pk_bf16_f32 v24, v24, v25
    v_mfma_f32_16x16x32_bf16 v[4:7], a[164:167], a[36:39], v[4:7]
    s_add_u32 m0, m0, s50
    v_cvt_pk_bf16_f32 v26, v26, v27
    v_accvgpr_write_b32 a178, v24
    v_mfma_f32_16x16x32_bf16 v[8:11], a[164:167], a[68:71], v[8:11]
    buffer_load_dwordx4 v78, s[8:11], s24 offen offset:256 sc0 sc1 lds
    v_mfma_f32_16x16x32_bf16 v[0:3], a[144:147], a[8:11], v[0:3]
    ds_read_b128 a[164:167], v69 offset:28672
    v_accvgpr_write_b32 a179, v26
    v_mfma_f32_16x16x32_bf16 v[4:7], a[144:147], a[40:43], v[4:7]
    s_waitcnt lgkmcnt(3)
    v_exp_f32 v32, v32
    v_mfma_f32_16x16x32_bf16 v[8:11], a[144:147], a[72:75], v[8:11]
    v_exp_f32 v33, v33
    v_mfma_f32_16x16x32_bf16 v[0:3], a[148:151], a[12:15], v[0:3]
    ds_read_b128 a[144:147], v68 offset:18432
    v_mfma_f32_16x16x32_bf16 v[4:7], a[148:151], a[44:47], v[4:7]
    v_exp_f32 v34, v34
    v_mfma_f32_16x16x32_bf16 v[8:11], a[148:151], a[76:79], v[8:11]
    v_exp_f32 v35, v35
    v_mfma_f32_16x16x32_bf16 v[0:3], a[152:155], a[16:19], v[0:3]
    ds_read_b128 a[148:151], v69 offset:18432
    v_cvt_pk_bf16_f32 v124, v32, v33
    v_mfma_f32_16x16x32_bf16 v[4:7], a[152:155], a[48:51], v[4:7]
    s_add_u32 m0, m0, s50
    v_exp_f32 v36, v36
    v_mfma_f32_16x16x32_bf16 v[8:11], a[152:155], a[80:83], v[8:11]
    s_waitcnt lgkmcnt(3)
    v_exp_f32 v37, v37
    v_mfma_f32_16x16x32_bf16 v[0:3], a[156:159], a[20:23], v[0:3]
    ds_read_b128 a[152:155], v68 offset:22528
    v_cvt_pk_bf16_f32 v125, v34, v35
    v_mfma_f32_16x16x32_bf16 v[4:7], a[156:159], a[52:55], v[4:7]
    buffer_load_dwordx4 v78, s[8:11], s24 offen offset:384 sc0 sc1 lds
    v_mfma_f32_16x16x32_bf16 v[8:11], a[156:159], a[84:87], v[8:11]
    s_add_u32 s43, s42, 8192
    v_exp_f32 v38, v38
    v_mfma_f32_16x16x32_bf16 v[0:3], a[160:163], a[24:27], v[0:3]
    ds_read_b128 a[156:159], v69 offset:22528
    v_cvt_pk_bf16_f32 v188, v36, v37
    v_mfma_f32_16x16x32_bf16 v[4:7], a[160:163], a[56:59], v[4:7]
    s_add_u32 m0, s44, 114688
    v_exp_f32 v39, v39
    v_mfma_f32_16x16x32_bf16 v[8:11], a[160:163], a[88:91], v[8:11]
    s_waitcnt lgkmcnt(3)
    v_exp_f32 v40, v40
    v_mfma_f32_16x16x32_bf16 v[0:3], a[164:167], a[28:31], v[0:3]
    ds_read_b128 a[160:163], v68 offset:26624
    v_cvt_pk_bf16_f32 v189, v38, v39
    v_mfma_f32_16x16x32_bf16 v[4:7], a[164:167], a[60:63], v[4:7]
    buffer_load_dwordx4 v78, s[4:7], s43 offen offset:0 sc0 sc1 nt lds
    v_mfma_f32_16x16x32_bf16 v[8:11], a[164:167], a[92:95], v[8:11]
    s_add_u32 m0, s45, 114688
    v_exp_f32 v41, v41
    v_mfma_f32_16x16x32_bf16 v[16:19], a[144:147], a[0:3], v[148:151]
    ds_read_b128 a[164:167], v69 offset:26624
    v_mfma_f32_16x16x32_bf16 v[20:23], a[144:147], a[32:35], v[212:215]
    buffer_load_dwordx4 v72, s[4:7], s43 offen offset:0 sc0 sc1 nt lds
    v_exp_f32 v42, v42
    v_cvt_pk_bf16_f32 v40, v40, v41
    v_pk_mul_f32 v[0:1], v[0:1], s[92:93]
    v_pk_mul_f32 v[2:3], v[2:3], s[92:93]
    v_pk_mul_f32 v[4:5], v[4:5], s[92:93]
    v_pk_mul_f32 v[6:7], v[6:7], s[92:93]
    v_pk_mul_f32 v[8:9], v[8:9], s[92:93]
    v_pk_mul_f32 v[10:11], v[10:11], s[92:93]
    v_mfma_f32_16x16x32_bf16 v[24:27], a[144:147], a[64:67], v[244:247]
    s_waitcnt lgkmcnt(3)
    v_exp_f32 v43, v43
    v_mfma_f32_16x16x32_bf16 v[16:19], a[148:151], a[4:7], v[16:19]
    ds_read_b128 a[144:147], v68 offset:30720
    v_accvgpr_write_b32 a180, v40
    v_mfma_f32_16x16x32_bf16 v[20:23], a[148:151], a[36:39], v[20:23]
    s_add_u32 m0, s44, 116608
    v_exp_f32 v48, v48
    v_mfma_f32_16x16x32_bf16 v[24:27], a[148:151], a[68:71], v[24:27]
    buffer_load_dwordx4 v78, s[4:7], s43 offen offset:128 sc0 sc1 nt lds
    v_mfma_f32_16x16x32_bf16 v[16:19], a[152:155], a[8:11], v[16:19]
    ds_read_b128 a[148:151], v69 offset:30720
    v_cvt_pk_bf16_f32 v42, v42, v43
    v_mfma_f32_16x16x32_bf16 v[20:23], a[152:155], a[40:43], v[20:23]
    s_waitcnt vmcnt(19)
    v_exp_f32 v49, v49
    v_mfma_f32_16x16x32_bf16 v[24:27], a[152:155], a[72:75], v[24:27]
    s_waitcnt lgkmcnt(3)
    v_exp_f32 v50, v50
    v_mfma_f32_16x16x32_bf16 v[16:19], a[156:159], a[12:15], v[16:19]
    s_barrier
    ds_read_b128 a[152:155], v68 offset:32768
    v_accvgpr_write_b32 a181, v42
    v_mfma_f32_16x16x32_bf16 v[20:23], a[156:159], a[44:47], v[20:23]
    s_add_u32 s24, s24, s59
    v_exp_f32 v51, v51
    v_mfma_f32_16x16x32_bf16 v[24:27], a[156:159], a[76:79], v[24:27]
    s_add_u32 m0, s45, 116608
    v_exp_f32 v52, v52
    v_mfma_f32_16x16x32_bf16 v[16:19], a[160:163], a[16:19], v[16:19]
    ds_read_b128 a[156:159], v69 offset:32768
    v_cvt_pk_bf16_f32 v126, v48, v49
    v_mfma_f32_16x16x32_bf16 v[20:23], a[160:163], a[48:51], v[20:23]
    buffer_load_dwordx4 v72, s[4:7], s43 offen offset:128 sc0 sc1 nt lds
    v_mfma_f32_16x16x32_bf16 v[24:27], a[160:163], a[80:83], v[24:27]
    s_waitcnt lgkmcnt(3)
    s_add_u32 m0, s22, 0
    v_cvt_pk_bf16_f32 v127, v50, v51
    v_mfma_f32_16x16x32_bf16 v[16:19], a[164:167], a[20:23], v[16:19]
    ds_read_b128 a[160:163], v68 offset:36864
    v_mfma_f32_16x16x32_bf16 v[20:23], a[164:167], a[52:55], v[20:23]
    buffer_load_dwordx4 v78, s[8:11], s24 offen offset:0 sc0 sc1 lds
    v_mfma_f32_16x16x32_bf16 v[24:27], a[164:167], a[84:87], v[24:27]
    ds_read_b128 a[112:115], v70 offset:16384
    s_add_u32 m0, m0, s50
    v_mfma_f32_16x16x32_bf16 v[16:19], a[144:147], a[24:27], v[16:19]
    ds_read_b128 a[164:167], v69 offset:36864
    v_mfma_f32_16x16x32_bf16 v[20:23], a[144:147], a[56:59], v[20:23]
    ds_read_b128 a[116:119], v71 offset:16384
    s_waitcnt lgkmcnt(5)
    v_mfma_f32_16x16x32_bf16 v[24:27], a[144:147], a[88:91], v[24:27]
    buffer_load_dwordx4 v78, s[8:11], s24 offen offset:128 sc0 sc1 lds
    v_mfma_f32_16x16x32_bf16 v[16:19], a[148:151], a[28:31], v[16:19]
    ds_read_b128 a[144:147], v68 offset:40960
    v_mfma_f32_16x16x32_bf16 v[20:23], a[148:151], a[60:63], v[20:23]
    ds_read_b128 a[120:123], v70 offset:18432
    v_mfma_f32_16x16x32_bf16 v[24:27], a[148:151], a[92:95], v[24:27]
    ds_read_b128 a[124:127], v71 offset:18432
    v_mfma_f32_16x16x32_bf16 v[32:35], a[152:155], a[0:3], v[148:151]
    ds_read_b128 a[148:151], v69 offset:40960
    v_mfma_f32_16x16x32_bf16 v[36:39], a[152:155], a[32:35], v[212:215]
    s_waitcnt lgkmcnt(7)
    v_exp_f32 v53, v53
    v_mfma_f32_16x16x32_bf16 v[40:43], a[152:155], a[64:67], v[244:247]
    v_exp_f32 v54, v54
    v_exp_f32 v55, v55
    v_cvt_pk_bf16_f32 v190, v52, v53
    v_pk_mul_f32 v[16:17], v[16:17], s[92:93]
    v_pk_mul_f32 v[18:19], v[18:19], s[92:93]
    v_pk_mul_f32 v[20:21], v[20:21], s[92:93]
    v_pk_mul_f32 v[22:23], v[22:23], s[92:93]
    v_pk_mul_f32 v[24:25], v[24:25], s[92:93]
    v_pk_mul_f32 v[26:27], v[26:27], s[92:93]
    v_mfma_f32_16x16x32_bf16 v[32:35], a[156:159], a[4:7], v[32:35]
    ds_read_b128 a[152:155], v68 offset:45056
    v_cvt_pk_bf16_f32 v191, v54, v55
    v_mfma_f32_16x16x32_bf16 v[36:39], a[156:159], a[36:39], v[36:39]
    s_add_u32 m0, m0, s50
    v_exp_f32 v56, v56
    v_mfma_f32_16x16x32_bf16 v[40:43], a[156:159], a[68:71], v[40:43]
    buffer_load_dwordx4 v78, s[8:11], s24 offen offset:256 sc0 sc1 lds
    v_mfma_f32_16x16x32_bf16 v[32:35], a[160:163], a[8:11], v[32:35]
L_w13:
    s_cbranch_execz L_w17
    ds_read_b128 a[156:159], v69 offset:45056
    v_mfma_f32_16x16x32_bf16 v[36:39], a[160:163], a[40:43], v[36:39]
    s_waitcnt lgkmcnt(5)
    v_exp_f32 v57, v57
    v_mfma_f32_16x16x32_bf16 v[40:43], a[160:163], a[72:75], v[40:43]
    v_exp_f32 v58, v58
    v_mfma_f32_16x16x32_bf16 v[32:35], a[164:167], a[12:15], v[32:35]
    ds_read_b128 a[160:163], v68 offset:34816
    v_cvt_pk_bf16_f32 v56, v56, v57
    v_mfma_f32_16x16x32_bf16 v[36:39], a[164:167], a[44:47], v[36:39]
    v_exp_f32 v59, v59
    v_mfma_f32_16x16x32_bf16 v[40:43], a[164:167], a[76:79], v[40:43]
    v_exp_f32 v0, v0
    v_mfma_f32_16x16x32_bf16 v[32:35], a[144:147], a[16:19], v[32:35]
    ds_read_b128 a[164:167], v69 offset:34816
    v_cvt_pk_bf16_f32 v58, v58, v59
    v_mfma_f32_16x16x32_bf16 v[36:39], a[144:147], a[48:51], v[36:39]
    s_add_u32 m0, m0, s50
    v_accvgpr_write_b32 a182, v56
    v_accvgpr_write_b32 a183, v58
    v_mfma_f32_16x16x32_bf16 v[40:43], a[144:147], a[80:83], v[40:43]
    s_waitcnt lgkmcnt(3)
    v_exp_f32 v1, v1
    v_mfma_f32_16x16x32_bf16 v[32:35], a[148:151], a[20:23], v[32:35]
    ds_read_b128 a[144:147], v68 offset:38912
    v_mfma_f32_16x16x32_bf16 v[36:39], a[148:151], a[52:55], v[36:39]
    buffer_load_dwordx4 v78, s[8:11], s24 offen offset:384 sc0 sc1 lds
    v_mfma_f32_16x16x32_bf16 v[40:43], a[148:151], a[84:87], v[40:43]
    v_exp_f32 v2, v2
    v_mfma_f32_16x16x32_bf16 v[32:35], a[152:155], a[24:27], v[32:35]
    ds_read_b128 a[148:151], v69 offset:38912
    v_cvt_pk_bf16_f32 v128, v0, v1
    v_mfma_f32_16x16x32_bf16 v[36:39], a[152:155], a[56:59], v[36:39]
    s_waitcnt lgkmcnt(3)
    v_exp_f32 v3, v3
    v_mfma_f32_16x16x32_bf16 v[40:43], a[152:155], a[88:91], v[40:43]
    v_exp_f32 v4, v4
    v_mfma_f32_16x16x32_bf16 v[32:35], a[156:159], a[28:31], v[32:35]
    ds_read_b128 a[152:155], v68 offset:43008
    v_cvt_pk_bf16_f32 v129, v2, v3
    v_mfma_f32_16x16x32_bf16 v[36:39], a[156:159], a[60:63], v[36:39]
    v_exp_f32 v5, v5
    v_mfma_f32_16x16x32_bf16 v[40:43], a[156:159], a[92:95], v[40:43]
    v_exp_f32 v6, v6
    v_smfmac_f32_16x16x64_bf16 a[136:139], a[128:131], v[120:127], v84
    v_cvt_pk_bf16_f32 v192, v4, v5
    v_smfmac_f32_16x16x64_bf16 a[136:139], a[132:135], v[184:191], v84
    v_smfmac_f32_16x16x64_bf16 a[140:143], a[128:131], a[176:183], v84
    v_exp_f32 v7, v7
    v_exp_f32 v8, v8
    v_pk_mul_f32 v[32:33], v[32:33], s[92:93]
    v_pk_mul_f32 v[34:35], v[34:35], s[92:93]
    v_pk_mul_f32 v[36:37], v[36:37], s[92:93]
    v_pk_mul_f32 v[38:39], v[38:39], s[92:93]
    v_pk_mul_f32 v[40:41], v[40:41], s[92:93]
    v_pk_mul_f32 v[42:43], v[42:43], s[92:93]
    v_mfma_f32_16x16x32_bf16 v[48:51], a[160:163], a[0:3], v[148:151]
    ds_read_b128 a[156:159], v69 offset:43008
    v_cvt_pk_bf16_f32 v193, v6, v7
    v_mfma_f32_16x16x32_bf16 v[52:55], a[160:163], a[32:35], v[212:215]
    s_waitcnt lgkmcnt(3)
    v_exp_f32 v9, v9
    v_mfma_f32_16x16x32_bf16 v[56:59], a[160:163], a[64:67], v[244:247]
    v_exp_f32 v10, v10
    v_mfma_f32_16x16x32_bf16 v[48:51], a[164:167], a[4:7], v[48:51]
    ds_read_b128 a[160:163], v68 offset:47104
    v_cvt_pk_bf16_f32 v8, v8, v9
    v_mfma_f32_16x16x32_bf16 v[52:55], a[164:167], a[36:39], v[52:55]
    s_waitcnt vmcnt(20)
    v_exp_f32 v11, v11
    v_mfma_f32_16x16x32_bf16 v[56:59], a[164:167], a[68:71], v[56:59]
    s_barrier
    v_mfma_f32_16x16x32_bf16 v[48:51], a[144:147], a[8:11], v[48:51]
    ds_read_b128 a[164:167], v69 offset:47104
    v_cvt_pk_bf16_f32 v10, v10, v11
    v_mfma_f32_16x16x32_bf16 v[52:55], a[144:147], a[40:43], v[52:55]
    s_or_b32 s21, s20, s97
    v_accvgpr_write_b32 a184, v8
    v_accvgpr_write_b32 a185, v10
    v_mfma_f32_16x16x32_bf16 v[56:59], a[144:147], a[72:75], v[56:59]
    s_waitcnt lgkmcnt(3)
    v_exp_f32 v16, v16
    v_mfma_f32_16x16x32_bf16 v[48:51], a[148:151], a[12:15], v[48:51]
    ds_read_b128 a[144:147], v68 offset:49152
    s_xor_b32 s25, s21, 0
    v_mfma_f32_16x16x32_bf16 v[52:55], a[148:151], a[44:47], v[52:55]
    s_add_u32 m0, s23, 16384
    v_exp_f32 v17, v17
    v_mfma_f32_16x16x32_bf16 v[56:59], a[148:151], a[76:79], v[56:59]
    buffer_load_dwordx4 v79, s[12:15], s25 offen sc0 sc1 lds
    v_mfma_f32_16x16x32_bf16 v[48:51], a[152:155], a[16:19], v[48:51]
    ds_read_b128 a[148:151], v69 offset:49152
    v_cvt_pk_bf16_f32 v130, v16, v17
    v_mfma_f32_16x16x32_bf16 v[52:55], a[152:155], a[48:51], v[52:55]
    s_waitcnt lgkmcnt(3)
    v_exp_f32 v18, v18
    v_mfma_f32_16x16x32_bf16 v[56:59], a[152:155], a[80:83], v[56:59]
    v_exp_f32 v19, v19
    v_mfma_f32_16x16x32_bf16 v[48:51], a[156:159], a[20:23], v[48:51]
    ds_read_b128 a[152:155], v68 offset:53248
    s_add_u32 s26, s25, s31
    v_mfma_f32_16x16x32_bf16 v[52:55], a[156:159], a[52:55], v[52:55]
    v_exp_f32 v20, v20
    v_mfma_f32_16x16x32_bf16 v[56:59], a[156:159], a[84:87], v[56:59]
    v_exp_f32 v21, v21
    v_mfma_f32_16x16x32_bf16 v[48:51], a[160:163], a[24:27], v[48:51]
    ds_read_b128 a[156:159], v69 offset:53248
    v_cvt_pk_bf16_f32 v131, v18, v19
    v_mfma_f32_16x16x32_bf16 v[52:55], a[160:163], a[56:59], v[52:55]
    s_add_u32 m0, m0, s51
    v_exp_f32 v22, v22
    v_mfma_f32_16x16x32_bf16 v[56:59], a[160:163], a[88:91], v[56:59]
    s_waitcnt lgkmcnt(3)
    v_exp_f32 v23, v23
    v_mfma_f32_16x16x32_bf16 v[48:51], a[164:167], a[28:31], v[48:51]
    ds_read_b128 a[160:163], v68 offset:57344
    v_cvt_pk_bf16_f32 v194, v20, v21
    v_mfma_f32_16x16x32_bf16 v[52:55], a[164:167], a[60:63], v[52:55]
    buffer_load_dwordx4 v79, s[12:15], s26 offen sc0 sc1 lds
    v_mfma_f32_16x16x32_bf16 v[56:59], a[164:167], a[92:95], v[56:59]
    s_add_u32 s43, s42, 16384
    v_exp_f32 v24, v24
    v_mfma_f32_16x16x32_bf16 v[0:3], a[144:147], a[0:3], v[148:151]
    ds_read_b128 a[164:167], v69 offset:57344
    v_cvt_pk_bf16_f32 v195, v22, v23
    v_mfma_f32_16x16x32_bf16 v[4:7], a[144:147], a[32:35], v[212:215]
    s_add_u32 s25, s26, s31
    v_exp_f32 v25, v25
    v_exp_f32 v26, v26
    v_pk_mul_f32 v[48:49], v[48:49], s[92:93]
    v_pk_mul_f32 v[50:51], v[50:51], s[92:93]
    v_pk_mul_f32 v[52:53], v[52:53], s[92:93]
    v_pk_mul_f32 v[54:55], v[54:55], s[92:93]
    v_pk_mul_f32 v[56:57], v[56:57], s[92:93]
    v_pk_mul_f32 v[58:59], v[58:59], s[92:93]
    v_mfma_f32_16x16x32_bf16 v[8:11], a[144:147], a[64:67], v[244:247]
    s_waitcnt lgkmcnt(3)
    v_exp_f32 v27, v27
    v_mfma_f32_16x16x32_bf16 v[0:3], a[148:151], a[4:7], v[0:3]
    ds_read_b128 a[144:147], v68 offset:61440
    v_cvt_pk_bf16_f32 v24, v24, v25
    v_mfma_f32_16x16x32_bf16 v[4:7], a[148:151], a[36:39], v[4:7]
    s_add_u32 m0, s44, 131072
    v_cvt_pk_bf16_f32 v26, v26, v27
    v_accvgpr_write_b32 a186, v24
    v_mfma_f32_16x16x32_bf16 v[8:11], a[148:151], a[68:71], v[8:11]
    buffer_load_dwordx4 v78, s[4:7], s43 offen offset:0 sc0 sc1 nt lds
    v_mfma_f32_16x16x32_bf16 v[0:3], a[152:155], a[8:11], v[0:3]
    ds_read_b128 a[148:151], v69 offset:61440
    v_accvgpr_write_b32 a187, v26
    v_mfma_f32_16x16x32_bf16 v[4:7], a[152:155], a[40:43], v[4:7]
    s_add_u32 m0, s23, 18432
    v_exp_f32 v32, v32
    v_mfma_f32_16x16x32_bf16 v[8:11], a[152:155], a[72:75], v[8:11]
    s_waitcnt lgkmcnt(3)
    v_exp_f32 v33, v33
    v_mfma_f32_16x16x32_bf16 v[0:3], a[156:159], a[12:15], v[0:3]
    ds_read_b128 a[152:155], v68 offset:51200
    v_mfma_f32_16x16x32_bf16 v[4:7], a[156:159], a[44:47], v[4:7]
    buffer_load_dwordx4 v79, s[12:15], s25 offen sc0 sc1 lds
    v_mfma_f32_16x16x32_bf16 v[8:11], a[156:159], a[76:79], v[8:11]
    s_add_u32 m0, s45, 131072
    v_exp_f32 v34, v34
    v_mfma_f32_16x16x32_bf16 v[0:3], a[160:163], a[16:19], v[0:3]
    ds_read_b128 a[156:159], v69 offset:51200
    v_cvt_pk_bf16_f32 v132, v32, v33
    v_mfma_f32_16x16x32_bf16 v[4:7], a[160:163], a[48:51], v[4:7]
    buffer_load_dwordx4 v72, s[4:7], s43 offen offset:0 sc0 sc1 nt lds
    v_mfma_f32_16x16x32_bf16 v[8:11], a[160:163], a[80:83], v[8:11]
    s_waitcnt lgkmcnt(3)
    s_add_u32 s26, s25, s31
    s_add_u32 m0, s23, 19456
    v_mfma_f32_16x16x32_bf16 v[0:3], a[164:167], a[20:23], v[0:3]
    ds_read_b128 a[160:163], v68 offset:55296
    v_mfma_f32_16x16x32_bf16 v[4:7], a[164:167], a[52:55], v[4:7]
    buffer_load_dwordx4 v79, s[12:15], s26 offen sc0 sc1 lds
    v_mfma_f32_16x16x32_bf16 v[8:11], a[164:167], a[84:87], v[8:11]
    s_add_u32 m0, s44, 132992
    v_exp_f32 v35, v35
    v_mfma_f32_16x16x32_bf16 v[0:3], a[144:147], a[24:27], v[0:3]
    ds_read_b128 a[164:167], v69 offset:55296
    v_mfma_f32_16x16x32_bf16 v[4:7], a[144:147], a[56:59], v[4:7]
    buffer_load_dwordx4 v78, s[4:7], s43 offen offset:128 sc0 sc1 nt lds
    v_mfma_f32_16x16x32_bf16 v[8:11], a[144:147], a[88:91], v[8:11]
    s_waitcnt lgkmcnt(3)
    v_exp_f32 v36, v36
    v_mfma_f32_16x16x32_bf16 v[0:3], a[148:151], a[28:31], v[0:3]
    ds_read_b128 a[144:147], v68 offset:59392
    v_cvt_pk_bf16_f32 v133, v34, v35
    v_mfma_f32_16x16x32_bf16 v[4:7], a[148:151], a[60:63], v[4:7]
    s_add_u32 m0, s45, 132992
    v_exp_f32 v37, v37
    v_mfma_f32_16x16x32_bf16 v[8:11], a[148:151], a[92:95], v[8:11]
    buffer_load_dwordx4 v72, s[4:7], s43 offen offset:128 sc0 sc1 nt lds
    v_mfma_f32_16x16x32_bf16 v[16:19], a[152:155], a[0:3], v[148:151]
    ds_read_b128 a[148:151], v69 offset:59392
    v_cvt_pk_bf16_f32 v196, v36, v37
    v_mfma_f32_16x16x32_bf16 v[20:23], a[152:155], a[32:35], v[212:215]
    v_exp_f32 v38, v38
    v_exp_f32 v39, v39
    v_pk_mul_f32 v[0:1], v[0:1], s[92:93]
    v_pk_mul_f32 v[2:3], v[2:3], s[92:93]
    v_pk_mul_f32 v[4:5], v[4:5], s[92:93]
    v_pk_mul_f32 v[6:7], v[6:7], s[92:93]
    v_pk_mul_f32 v[8:9], v[8:9], s[92:93]
    v_pk_mul_f32 v[10:11], v[10:11], s[92:93]
    v_mfma_f32_16x16x32_bf16 v[24:27], a[152:155], a[64:67], v[244:247]
    s_waitcnt lgkmcnt(3)
    v_exp_f32 v40, v40
    v_mfma_f32_16x16x32_bf16 v[16:19], a[156:159], a[4:7], v[16:19]
    ds_read_b128 a[152:155], v68 offset:63488
    v_add_u32 v68, s96, v68
    v_mfma_f32_16x16x32_bf16 v[20:23], a[156:159], a[36:39], v[20:23]
    s_waitcnt vmcnt(20)
    v_exp_f32 v41, v41
    v_mfma_f32_16x16x32_bf16 v[24:27], a[156:159], a[68:71], v[24:27]
    s_barrier
    v_mfma_f32_16x16x32_bf16 v[16:19], a[160:163], a[8:11], v[16:19]
    ds_read_b128 a[156:159], v69 offset:63488
    v_add_u32 v69, s96, v69
    v_mfma_f32_16x16x32_bf16 v[20:23], a[160:163], a[40:43], v[20:23]
    s_xor_b32 s25, s21, 65536
    v_cvt_pk_bf16_f32 v197, v38, v39
    v_cvt_pk_bf16_f32 v40, v40, v41
    v_mfma_f32_16x16x32_bf16 v[24:27], a[160:163], a[72:75], v[24:27]
    s_waitcnt lgkmcnt(3)
    v_exp_f32 v42, v42
    v_mfma_f32_16x16x32_bf16 v[16:19], a[164:167], a[12:15], v[16:19]
    ds_read_b128 a[160:163], v68 offset:16384
    v_accvgpr_write_b32 a188, v40
    v_mfma_f32_16x16x32_bf16 v[20:23], a[164:167], a[44:47], v[20:23]
    s_add_u32 m0, s23, 32768
    v_exp_f32 v43, v43
    v_mfma_f32_16x16x32_bf16 v[24:27], a[164:167], a[76:79], v[24:27]
    buffer_load_dwordx4 v79, s[12:15], s25 offen sc0 sc1 lds
    v_mfma_f32_16x16x32_bf16 v[16:19], a[144:147], a[16:19], v[16:19]
    ds_read_b128 a[164:167], v69 offset:16384
    v_cvt_pk_bf16_f32 v42, v42, v43
    v_mfma_f32_16x16x32_bf16 v[20:23], a[144:147], a[48:51], v[20:23]
    s_waitcnt lgkmcnt(3)
    v_exp_f32 v48, v48
    v_mfma_f32_16x16x32_bf16 v[24:27], a[144:147], a[80:83], v[24:27]
    v_exp_f32 v49, v49
    v_mfma_f32_16x16x32_bf16 v[16:19], a[148:151], a[20:23], v[16:19]
    ds_read_b128 a[144:147], v68 offset:20480
    v_accvgpr_write_b32 a189, v42
    v_mfma_f32_16x16x32_bf16 v[20:23], a[148:151], a[52:55], v[20:23]
    s_add_u32 s26, s25, s31
    v_exp_f32 v50, v50
    v_mfma_f32_16x16x32_bf16 v[24:27], a[148:151], a[84:87], v[24:27]
    v_exp_f32 v51, v51
    v_mfma_f32_16x16x32_bf16 v[16:19], a[152:155], a[24:27], v[16:19]
    ds_read_b128 a[148:151], v69 offset:20480
    v_cvt_pk_bf16_f32 v134, v48, v49
    v_mfma_f32_16x16x32_bf16 v[20:23], a[152:155], a[56:59], v[20:23]
    s_add_u32 m0, m0, s51
    v_exp_f32 v52, v52
    v_mfma_f32_16x16x32_bf16 v[24:27], a[152:155], a[88:91], v[24:27]
    s_waitcnt lgkmcnt(3)
    v_exp_f32 v53, v53
    v_mfma_f32_16x16x32_bf16 v[16:19], a[156:159], a[28:31], v[16:19]
    ds_read_b128 a[152:155], v68 offset:24576
    v_cvt_pk_bf16_f32 v135, v50, v51
    v_mfma_f32_16x16x32_bf16 v[20:23], a[156:159], a[60:63], v[20:23]
    buffer_load_dwordx4 v79, s[12:15], s26 offen sc0 sc1 lds
    v_mfma_f32_16x16x32_bf16 v[24:27], a[156:159], a[92:95], v[24:27]
    v_exp_f32 v54, v54
    v_mfma_f32_16x16x32_bf16 v[32:35], a[160:163], a[0:3], v[148:151]
    ds_read_b128 a[156:159], v69 offset:24576
    v_cvt_pk_bf16_f32 v198, v52, v53
    v_mfma_f32_16x16x32_bf16 v[36:39], a[160:163], a[32:35], v[212:215]
    s_add_u32 s25, s26, s31
    v_exp_f32 v55, v55
    v_exp_f32 v56, v56
    v_pk_mul_f32 v[16:17], v[16:17], s[92:93]
    v_pk_mul_f32 v[18:19], v[18:19], s[92:93]
    v_pk_mul_f32 v[20:21], v[20:21], s[92:93]
    v_pk_mul_f32 v[22:23], v[22:23], s[92:93]
    v_pk_mul_f32 v[24:25], v[24:25], s[92:93]
    v_pk_mul_f32 v[26:27], v[26:27], s[92:93]
    v_mfma_f32_16x16x32_bf16 v[40:43], a[160:163], a[64:67], v[244:247]
    s_waitcnt lgkmcnt(3)
    v_exp_f32 v57, v57
    v_mfma_f32_16x16x32_bf16 v[32:35], a[164:167], a[4:7], v[32:35]
    ds_read_b128 a[160:163], v68 offset:28672
    v_cvt_pk_bf16_f32 v199, v54, v55
    v_mfma_f32_16x16x32_bf16 v[36:39], a[164:167], a[36:39], v[36:39]
    s_add_u32 m0, m0, s51
    v_exp_f32 v58, v58
    v_mfma_f32_16x16x32_bf16 v[40:43], a[164:167], a[68:71], v[40:43]
    buffer_load_dwordx4 v79, s[12:15], s25 offen sc0 sc1 lds
    v_mfma_f32_16x16x32_bf16 v[32:35], a[144:147], a[8:11], v[32:35]
    ds_read_b128 a[164:167], v69 offset:28672
    v_cvt_pk_bf16_f32 v56, v56, v57
    v_mfma_f32_16x16x32_bf16 v[36:39], a[144:147], a[40:43], v[36:39]
    s_waitcnt lgkmcnt(3)
    v_exp_f32 v59, v59
    v_mfma_f32_16x16x32_bf16 v[40:43], a[144:147], a[72:75], v[40:43]
    v_exp_f32 v0, v0
    v_mfma_f32_16x16x32_bf16 v[32:35], a[148:151], a[12:15], v[32:35]
    ds_read_b128 a[144:147], v68 offset:18432
    v_cvt_pk_bf16_f32 v58, v58, v59
    v_mfma_f32_16x16x32_bf16 v[36:39], a[148:151], a[44:47], v[36:39]
    s_add_u32 s26, s25, s31
    v_accvgpr_write_b32 a190, v56
    v_accvgpr_write_b32 a191, v58
    v_mfma_f32_16x16x32_bf16 v[40:43], a[148:151], a[76:79], v[40:43]
    v_exp_f32 v1, v1
    v_mfma_f32_16x16x32_bf16 v[32:35], a[152:155], a[16:19], v[32:35]
    ds_read_b128 a[148:151], v69 offset:18432
    s_add_u32 m0, m0, s51
    v_mfma_f32_16x16x32_bf16 v[36:39], a[152:155], a[48:51], v[36:39]
    s_waitcnt lgkmcnt(3)
    v_exp_f32 v2, v2
    v_mfma_f32_16x16x32_bf16 v[40:43], a[152:155], a[80:83], v[40:43]
    buffer_load_dwordx4 v79, s[12:15], s26 offen sc0 sc1 lds
    v_mfma_f32_16x16x32_bf16 v[32:35], a[156:159], a[20:23], v[32:35]
    ds_read_b128 a[152:155], v68 offset:22528
    v_cvt_pk_bf16_f32 v136, v0, v1
    v_mfma_f32_16x16x32_bf16 v[36:39], a[156:159], a[52:55], v[36:39]
    v_exp_f32 v3, v3
    v_mfma_f32_16x16x32_bf16 v[40:43], a[156:159], a[84:87], v[40:43]
    v_exp_f32 v4, v4
    v_mfma_f32_16x16x32_bf16 v[32:35], a[160:163], a[24:27], v[32:35]
    ds_read_b128 a[156:159], v69 offset:22528
    v_cvt_pk_bf16_f32 v137, v2, v3
    v_mfma_f32_16x16x32_bf16 v[36:39], a[160:163], a[56:59], v[36:39]
    s_waitcnt lgkmcnt(3)
    v_exp_f32 v5, v5
    v_mfma_f32_16x16x32_bf16 v[40:43], a[160:163], a[88:91], v[40:43]
    v_exp_f32 v6, v6
    v_mfma_f32_16x16x32_bf16 v[32:35], a[164:167], a[28:31], v[32:35]
    ds_read_b128 a[160:163], v68 offset:26624
    v_cvt_pk_bf16_f32 v200, v4, v5
    v_mfma_f32_16x16x32_bf16 v[36:39], a[164:167], a[60:63], v[36:39]
    v_exp_f32 v7, v7
    v_mfma_f32_16x16x32_bf16 v[40:43], a[164:167], a[92:95], v[40:43]
    v_exp_f32 v8, v8
    v_smfmac_f32_16x16x64_bf16 a[136:139], a[128:131], v[128:135], v84
    v_cvt_pk_bf16_f32 v201, v6, v7
    v_smfmac_f32_16x16x64_bf16 a[136:139], a[132:135], v[192:199], v84
    v_smfmac_f32_16x16x64_bf16 a[140:143], a[128:131], a[184:191], v84
    v_exp_f32 v9, v9
    v_exp_f32 v10, v10
    v_pk_mul_f32 v[32:33], v[32:33], s[92:93]
    v_pk_mul_f32 v[34:35], v[34:35], s[92:93]
    v_pk_mul_f32 v[36:37], v[36:37], s[92:93]
    v_pk_mul_f32 v[38:39], v[38:39], s[92:93]
    v_pk_mul_f32 v[40:41], v[40:41], s[92:93]
    v_pk_mul_f32 v[42:43], v[42:43], s[92:93]
    v_mfma_f32_16x16x32_bf16 v[48:51], a[144:147], a[0:3], v[148:151]
    ds_read_b128 a[164:167], v69 offset:26624
    v_cvt_pk_bf16_f32 v8, v8, v9
    v_mfma_f32_16x16x32_bf16 v[52:55], a[144:147], a[32:35], v[212:215]
    s_waitcnt lgkmcnt(3)
    v_exp_f32 v11, v11
    v_mfma_f32_16x16x32_bf16 v[56:59], a[144:147], a[64:67], v[244:247]
    v_exp_f32 v16, v16
    v_mfma_f32_16x16x32_bf16 v[48:51], a[148:151], a[4:7], v[48:51]
    ds_read_b128 a[144:147], v68 offset:30720
    v_cvt_pk_bf16_f32 v10, v10, v11
    v_mfma_f32_16x16x32_bf16 v[52:55], a[148:151], a[36:39], v[52:55]
    s_waitcnt vmcnt(20)
    v_accvgpr_write_b32 a192, v8
    v_accvgpr_write_b32 a193, v10
    v_mfma_f32_16x16x32_bf16 v[56:59], a[148:151], a[68:71], v[56:59]
    s_barrier
    v_mfma_f32_16x16x32_bf16 v[48:51], a[152:155], a[8:11], v[48:51]
    ds_read_b128 a[148:151], v69 offset:30720
    s_xor_b32 s25, s21, 131072
    v_mfma_f32_16x16x32_bf16 v[52:55], a[152:155], a[40:43], v[52:55]
    s_waitcnt lgkmcnt(3)
    v_exp_f32 v17, v17
    v_mfma_f32_16x16x32_bf16 v[56:59], a[152:155], a[72:75], v[56:59]
    v_exp_f32 v18, v18
    v_mfma_f32_16x16x32_bf16 v[48:51], a[156:159], a[12:15], v[48:51]
    ds_read_b128 a[152:155], v68 offset:32768
    v_cvt_pk_bf16_f32 v138, v16, v17
    v_mfma_f32_16x16x32_bf16 v[52:55], a[156:159], a[44:47], v[52:55]
    s_add_u32 m0, m0, s95
    v_exp_f32 v19, v19
    v_mfma_f32_16x16x32_bf16 v[56:59], a[156:159], a[76:79], v[56:59]
    buffer_load_dwordx4 v79, s[12:15], s25 offen sc0 sc1 lds
    v_mfma_f32_16x16x32_bf16 v[48:51], a[160:163], a[16:19], v[48:51]
    ds_read_b128 a[156:159], v69 offset:32768
    v_cvt_pk_bf16_f32 v139, v18, v19
    v_mfma_f32_16x16x32_bf16 v[52:55], a[160:163], a[48:51], v[52:55]
    s_waitcnt lgkmcnt(3)
    v_exp_f32 v20, v20
    v_mfma_f32_16x16x32_bf16 v[56:59], a[160:163], a[80:83], v[56:59]
    v_exp_f32 v21, v21
    v_mfma_f32_16x16x32_bf16 v[48:51], a[164:167], a[20:23], v[48:51]
    ds_read_b128 a[160:163], v68 offset:36864
    s_add_u32 s26, s25, s31
    v_mfma_f32_16x16x32_bf16 v[52:55], a[164:167], a[52:55], v[52:55]
    v_exp_f32 v22, v22
    v_mfma_f32_16x16x32_bf16 v[56:59], a[164:167], a[84:87], v[56:59]
    v_exp_f32 v23, v23
    v_mfma_f32_16x16x32_bf16 v[48:51], a[144:147], a[24:27], v[48:51]
    ds_read_b128 a[164:167], v69 offset:36864
    v_cvt_pk_bf16_f32 v202, v20, v21
    v_mfma_f32_16x16x32_bf16 v[52:55], a[144:147], a[56:59], v[52:55]
    s_add_u32 m0, m0, s51
    v_exp_f32 v24, v24
    v_mfma_f32_16x16x32_bf16 v[56:59], a[144:147], a[88:91], v[56:59]
    s_waitcnt lgkmcnt(3)
    v_exp_f32 v25, v25
    v_mfma_f32_16x16x32_bf16 v[48:51], a[148:151], a[28:31], v[48:51]
    ds_read_b128 a[144:147], v68 offset:40960
    v_cvt_pk_bf16_f32 v203, v22, v23
    v_mfma_f32_16x16x32_bf16 v[52:55], a[148:151], a[60:63], v[52:55]
    buffer_load_dwordx4 v79, s[12:15], s26 offen sc0 sc1 lds
    v_mfma_f32_16x16x32_bf16 v[56:59], a[148:151], a[92:95], v[56:59]
    v_exp_f32 v26, v26
    v_mfma_f32_16x16x32_bf16 v[0:3], a[152:155], a[0:3], v[148:151]
    ds_read_b128 a[148:151], v69 offset:40960
    v_cvt_pk_bf16_f32 v24, v24, v25
    v_mfma_f32_16x16x32_bf16 v[4:7], a[152:155], a[32:35], v[212:215]
    s_add_u32 s25, s26, s31
    v_exp_f32 v27, v27
    v_exp_f32 v32, v32
    v_accvgpr_write_b32 a194, v24
    v_pk_mul_f32 v[48:49], v[48:49], s[92:93]
    v_pk_mul_f32 v[50:51], v[50:51], s[92:93]
    v_pk_mul_f32 v[52:53], v[52:53], s[92:93]
    v_pk_mul_f32 v[54:55], v[54:55], s[92:93]
    v_pk_mul_f32 v[56:57], v[56:57], s[92:93]
    v_pk_mul_f32 v[58:59], v[58:59], s[92:93]
    v_mfma_f32_16x16x32_bf16 v[8:11], a[152:155], a[64:67], v[244:247]
    s_waitcnt lgkmcnt(3)
    v_exp_f32 v33, v33
    v_mfma_f32_16x16x32_bf16 v[0:3], a[156:159], a[4:7], v[0:3]
    ds_read_b128 a[152:155], v68 offset:45056
    v_cvt_pk_bf16_f32 v26, v26, v27
    v_mfma_f32_16x16x32_bf16 v[4:7], a[156:159], a[36:39], v[4:7]
    s_add_u32 m0, m0, s51
    v_accvgpr_write_b32 a195, v26
    v_cvt_pk_bf16_f32 v140, v32, v33
    v_mfma_f32_16x16x32_bf16 v[8:11], a[156:159], a[68:71], v[8:11]
    buffer_load_dwordx4 v79, s[12:15], s25 offen sc0 sc1 lds
    v_mfma_f32_16x16x32_bf16 v[0:3], a[160:163], a[8:11], v[0:3]
    ds_read_b128 a[156:159], v69 offset:45056
    s_or_b32 s46, s32, s97
    v_mfma_f32_16x16x32_bf16 v[4:7], a[160:163], a[40:43], v[4:7]
    s_mov_b32 s18, s37
    v_exp_f32 v34, v34
    v_mfma_f32_16x16x32_bf16 v[8:11], a[160:163], a[72:75], v[8:11]
    s_waitcnt lgkmcnt(3)
    v_exp_f32 v35, v35
    v_mfma_f32_16x16x32_bf16 v[0:3], a[164:167], a[12:15], v[0:3]
    ds_read_b128 a[160:163], v68 offset:34816
    s_add_u32 s26, s25, s31
    v_mfma_f32_16x16x32_bf16 v[4:7], a[164:167], a[44:47], v[4:7]
    s_mov_b32 s32, s33
    v_exp_f32 v36, v36
    v_mfma_f32_16x16x32_bf16 v[8:11], a[164:167], a[76:79], v[8:11]
    s_mov_b32 s37, s38
    v_exp_f32 v37, v37
    v_mfma_f32_16x16x32_bf16 v[0:3], a[144:147], a[16:19], v[0:3]
    ds_read_b128 a[164:167], v69 offset:34816
    v_cvt_pk_bf16_f32 v141, v34, v35
    v_mfma_f32_16x16x32_bf16 v[4:7], a[144:147], a[48:51], v[4:7]
    s_add_u32 m0, m0, s51
    v_exp_f32 v38, v38
    v_mfma_f32_16x16x32_bf16 v[8:11], a[144:147], a[80:83], v[8:11]
    s_waitcnt lgkmcnt(3)
    s_mov_b32 s33, s34
    v_cvt_pk_bf16_f32 v204, v36, v37
    v_mfma_f32_16x16x32_bf16 v[0:3], a[148:151], a[20:23], v[0:3]
    ds_read_b128 a[144:147], v68 offset:38912
    s_mov_b32 s38, s39
    v_mfma_f32_16x16x32_bf16 v[4:7], a[148:151], a[52:55], v[4:7]
    buffer_load_dwordx4 v79, s[12:15], s26 offen sc0 sc1 lds
    v_mfma_f32_16x16x32_bf16 v[8:11], a[148:151], a[84:87], v[8:11]
    s_mov_b32 s34, s35
    s_mov_b32 s39, s40
    s_mov_b32 s35, s36
    v_mfma_f32_16x16x32_bf16 v[0:3], a[152:155], a[24:27], v[0:3]
    ds_read_b128 a[148:151], v69 offset:38912
    s_mov_b32 s40, s41
    v_mfma_f32_16x16x32_bf16 v[4:7], a[152:155], a[56:59], v[4:7]
    s_cmp_eq_u32 s37, 0
    s_cselect_b32 s71, 0xc7000000, 0
    s_waitcnt lgkmcnt(3)
    v_mfma_f32_16x16x32_bf16 v[8:11], a[152:155], a[88:91], v[8:11]
    v_exp_f32 v39, v39
    v_mfma_f32_16x16x32_bf16 v[0:3], a[156:159], a[28:31], v[0:3]
    ds_read_b128 a[152:155], v68 offset:43008
    v_mfma_f32_16x16x32_bf16 v[4:7], a[156:159], a[60:63], v[4:7]
    v_exp_f32 v40, v40
    v_mfma_f32_16x16x32_bf16 v[8:11], a[156:159], a[92:95], v[8:11]
    v_exp_f32 v41, v41
    v_mfma_f32_16x16x32_bf16 v[16:19], a[160:163], a[0:3], v[148:151]
    ds_read_b128 a[156:159], v69 offset:43008
    v_cvt_pk_bf16_f32 v205, v38, v39
    v_mfma_f32_16x16x32_bf16 v[20:23], a[160:163], a[32:35], v[212:215]
    s_waitcnt lgkmcnt(3)
    v_exp_f32 v42, v42
    v_mfma_f32_16x16x32_bf16 v[24:27], a[160:163], a[64:67], v[244:247]
    v_exp_f32 v43, v43
    v_mfma_f32_16x16x32_bf16 v[16:19], a[164:167], a[4:7], v[16:19]
    ds_read_b128 a[160:163], v68 offset:47104
    v_subrev_u32 v68, s96, v68
    v_mfma_f32_16x16x32_bf16 v[20:23], a[164:167], a[36:39], v[20:23]
    s_waitcnt vmcnt(16)
    v_cvt_pk_bf16_f32 v40, v40, v41
    v_cvt_pk_bf16_f32 v42, v42, v43
    v_mfma_f32_16x16x32_bf16 v[24:27], a[164:167], a[68:71], v[24:27]
    s_barrier
    v_mfma_f32_16x16x32_bf16 v[16:19], a[144:147], a[8:11], v[16:19]
    ds_read_b128 a[164:167], v69 offset:47104
    v_subrev_u32 v69, s96, v69
    v_mfma_f32_16x16x32_bf16 v[20:23], a[144:147], a[40:43], v[20:23]
    s_xor_b32 s25, s21, 196608
    v_accvgpr_write_b32 a196, v40
    v_accvgpr_write_b32 a197, v42
    v_mfma_f32_16x16x32_bf16 v[24:27], a[144:147], a[72:75], v[24:27]
    s_waitcnt lgkmcnt(3)
    v_exp_f32 v48, v48
    v_mfma_f32_16x16x32_bf16 v[16:19], a[148:151], a[12:15], v[16:19]
    ds_read_b128 a[144:147], v68 offset:0
    v_mul_f32 v0, s27, v0
    v_mfma_f32_16x16x32_bf16 v[20:23], a[148:151], a[44:47], v[20:23]
    s_add_u32 m0, m0, s95
    v_exp_f32 v49, v49
    v_mfma_f32_16x16x32_bf16 v[24:27], a[148:151], a[76:79], v[24:27]
    buffer_load_dwordx4 v79, s[12:15], s25 offen sc0 sc1 lds
    v_mfma_f32_16x16x32_bf16 v[16:19], a[152:155], a[16:19], v[16:19]
    ds_read_b128 a[148:151], v69 offset:0
    v_cvt_pk_bf16_f32 v142, v48, v49
    v_mfma_f32_16x16x32_bf16 v[20:23], a[152:155], a[48:51], v[20:23]
    s_waitcnt lgkmcnt(3)
    v_exp_f32 v50, v50
    v_mfma_f32_16x16x32_bf16 v[24:27], a[152:155], a[80:83], v[24:27]
    v_exp_f32 v51, v51
    v_mfma_f32_16x16x32_bf16 v[16:19], a[156:159], a[20:23], v[16:19]
    ds_read_b128 a[152:155], v68 offset:4096
    v_mul_f32 v1, s27, v1
    v_mfma_f32_16x16x32_bf16 v[20:23], a[156:159], a[52:55], v[20:23]
    s_add_u32 s26, s25, s31
    v_cvt_pk_bf16_f32 v143, v50, v51
    v_mul_f32 v2, s27, v2
    v_mfma_f32_16x16x32_bf16 v[24:27], a[156:159], a[84:87], v[24:27]
    v_exp_f32 v52, v52
    v_mfma_f32_16x16x32_bf16 v[16:19], a[160:163], a[24:27], v[16:19]
    ds_read_b128 a[156:159], v69 offset:4096
    v_mul_f32 v3, s27, v3
    v_mfma_f32_16x16x32_bf16 v[20:23], a[160:163], a[56:59], v[20:23]
    s_add_u32 m0, m0, s51
    v_exp_f32 v53, v53
    v_mfma_f32_16x16x32_bf16 v[24:27], a[160:163], a[88:91], v[24:27]
    s_waitcnt lgkmcnt(3)
    v_exp_f32 v54, v54
    v_mfma_f32_16x16x32_bf16 v[16:19], a[164:167], a[28:31], v[16:19]
    ds_read_b128 a[160:163], v68 offset:8192
    v_cvt_pk_bf16_f32 v206, v52, v53
    v_mfma_f32_16x16x32_bf16 v[20:23], a[164:167], a[60:63], v[20:23]
    buffer_load_dwordx4 v79, s[12:15], s26 offen sc0 sc1 lds
    v_mfma_f32_16x16x32_bf16 v[24:27], a[164:167], a[92:95], v[24:27]
    v_exp_f32 v55, v55
    v_mfma_f32_16x16x32_bf16 v[32:35], a[144:147], a[0:3], v[148:151]
    ds_read_b128 a[164:167], v69 offset:8192
    v_mul_f32 v4, s27, v4
    v_mfma_f32_16x16x32_bf16 v[36:39], a[144:147], a[32:35], v[212:215]
    s_add_u32 s25, s26, s31
    v_cvt_pk_bf16_f32 v207, v54, v55
    v_mul_f32 v5, s27, v5
    v_mfma_f32_16x16x32_bf16 v[40:43], a[144:147], a[64:67], v[244:247]
    s_waitcnt lgkmcnt(3)
    v_exp_f32 v56, v56
    v_mfma_f32_16x16x32_bf16 v[32:35], a[148:151], a[4:7], v[32:35]
    ds_read_b128 a[144:147], v68 offset:12288
    v_mul_f32 v6, s27, v6
    v_mfma_f32_16x16x32_bf16 v[36:39], a[148:151], a[36:39], v[36:39]
    s_add_u32 m0, m0, s51
    v_exp_f32 v57, v57
    v_mfma_f32_16x16x32_bf16 v[40:43], a[148:151], a[68:71], v[40:43]
    buffer_load_dwordx4 v79, s[12:15], s25 offen sc0 sc1 lds
    v_mfma_f32_16x16x32_bf16 v[32:35], a[152:155], a[8:11], v[32:35]
    ds_read_b128 a[148:151], v69 offset:12288
    v_cvt_pk_bf16_f32 v56, v56, v57
    v_mfma_f32_16x16x32_bf16 v[36:39], a[152:155], a[40:43], v[36:39]
    s_waitcnt lgkmcnt(3)
    v_exp_f32 v58, v58
    v_mfma_f32_16x16x32_bf16 v[40:43], a[152:155], a[72:75], v[40:43]
    v_exp_f32 v59, v59
    v_mfma_f32_16x16x32_bf16 v[32:35], a[156:159], a[12:15], v[32:35]
    ds_read_b128 a[152:155], v68 offset:2048
    v_accvgpr_write_b32 a198, v56
    v_mfma_f32_16x16x32_bf16 v[36:39], a[156:159], a[44:47], v[36:39]
    s_add_u32 s26, s25, s31
    v_cvt_pk_bf16_f32 v58, v58, v59
    v_mul_f32 v7, s27, v7
    v_mfma_f32_16x16x32_bf16 v[40:43], a[156:159], a[76:79], v[40:43]
    v_accvgpr_write_b32 a199, v58
    v_mul_f32 v8, s27, v8
    v_mfma_f32_16x16x32_bf16 v[32:35], a[160:163], a[16:19], v[32:35]
    ds_read_b128 a[156:159], v69 offset:2048
    v_mul_f32 v9, s27, v9
    v_mfma_f32_16x16x32_bf16 v[36:39], a[160:163], a[48:51], v[36:39]
    s_add_u32 m0, m0, s51
    v_exp_f32 v0, v0
    v_mfma_f32_16x16x32_bf16 v[40:43], a[160:163], a[80:83], v[40:43]
    s_waitcnt lgkmcnt(3)
    v_exp_f32 v1, v1
    v_mfma_f32_16x16x32_bf16 v[32:35], a[164:167], a[20:23], v[32:35]
    ds_read_b128 a[160:163], v68 offset:6144
    v_mul_f32 v10, s27, v10
    v_mfma_f32_16x16x32_bf16 v[36:39], a[164:167], a[52:55], v[36:39]
L_w14:
    s_cbranch_execz L_w18
    buffer_load_dwordx4 v79, s[12:15], s26 offen sc0 sc1 lds
    v_mfma_f32_16x16x32_bf16 v[40:43], a[164:167], a[84:87], v[40:43]
    v_exp_f32 v2, v2
    v_mfma_f32_16x16x32_bf16 v[32:35], a[144:147], a[24:27], v[32:35]
    v_exp_f32 v3, v3
    v_mfma_f32_16x16x32_bf16 v[36:39], a[144:147], a[56:59], v[36:39]
    s_waitcnt lgkmcnt(2)
    v_cvt_pk_bf16_f32 v144, v0, v1
    v_cvt_pk_bf16_f32 v145, v2, v3
    v_mfma_f32_16x16x32_bf16 v[40:43], a[144:147], a[88:91], v[40:43]
    v_exp_f32 v4, v4
    v_mfma_f32_16x16x32_bf16 v[32:35], a[148:151], a[28:31], v[32:35]
    ds_read_b128 a[144:147], v69 offset:6144
    v_mul_f32 v11, s27, v11
    v_mfma_f32_16x16x32_bf16 v[36:39], a[148:151], a[60:63], v[36:39]
    v_exp_f32 v5, v5
    v_mfma_f32_16x16x32_bf16 v[40:43], a[148:151], a[92:95], v[40:43]
    v_exp_f32 v6, v6
    v_smfmac_f32_16x16x64_bf16 a[136:139], a[128:131], v[136:143], v84
    v_cvt_pk_bf16_f32 v208, v4, v5
    v_smfmac_f32_16x16x64_bf16 a[136:139], a[132:135], v[200:207], v84
    v_mul_f32 v16, s27, v16
    v_smfmac_f32_16x16x64_bf16 a[140:143], a[128:131], a[192:199], v84
    v_mul_f32 v17, s27, v17
    v_mfma_f32_16x16x32_bf16 v[48:51], a[152:155], a[0:3], v[148:151]
    ds_read_b128 a[148:151], v68 offset:10240
    v_mul_f32 v18, s27, v18
    v_mfma_f32_16x16x32_bf16 v[52:55], a[152:155], a[32:35], v[212:215]
    s_waitcnt lgkmcnt(2)
    v_exp_f32 v7, v7
    v_mfma_f32_16x16x32_bf16 v[56:59], a[152:155], a[64:67], v[244:247]
    v_exp_f32 v8, v8
    v_mfma_f32_16x16x32_bf16 v[48:51], a[156:159], a[4:7], v[48:51]
    ds_read_b128 a[152:155], v69 offset:10240
    v_cvt_pk_bf16_f32 v209, v6, v7
    v_mfma_f32_16x16x32_bf16 v[52:55], a[156:159], a[36:39], v[52:55]
    s_waitcnt vmcnt(8)
    v_exp_f32 v9, v9
    v_mfma_f32_16x16x32_bf16 v[56:59], a[156:159], a[68:71], v[56:59]
    s_barrier
    v_mfma_f32_16x16x32_bf16 v[48:51], a[160:163], a[8:11], v[48:51]
    ds_read_b128 a[156:159], v68 offset:14336
    v_cvt_pk_bf16_f32 v240, v8, v9
    v_mfma_f32_16x16x32_bf16 v[52:55], a[160:163], a[40:43], v[52:55]
    s_xor_b32 s25, s21, 128
    v_exp_f32 v10, v10
    v_mfma_f32_16x16x32_bf16 v[56:59], a[160:163], a[72:75], v[56:59]
    s_waitcnt lgkmcnt(2)
    v_exp_f32 v11, v11
    v_mfma_f32_16x16x32_bf16 v[48:51], a[144:147], a[12:15], v[48:51]
    ds_read_b128 a[160:163], v69 offset:14336
    v_mul_f32 v19, s27, v19
    v_mfma_f32_16x16x32_bf16 v[52:55], a[144:147], a[44:47], v[52:55]
    s_add_u32 m0, m0, s95
    v_cvt_pk_bf16_f32 v241, v10, v11
    v_mul_f32 v20, s27, v20
    v_mfma_f32_16x16x32_bf16 v[56:59], a[144:147], a[76:79], v[56:59]
    buffer_load_dwordx4 v79, s[12:15], s25 offen sc0 sc1 lds
    v_mfma_f32_16x16x32_bf16 v[48:51], a[148:151], a[16:19], v[48:51]
    ds_read_b64_tr_b16 a[144:145], v74 offset:16384
    v_mul_f32 v21, s27, v21
    v_mfma_f32_16x16x32_bf16 v[52:55], a[148:151], a[48:51], v[52:55]
    ds_read_b64_tr_b16 a[146:147], v74 offset:18432
    v_mul_f32 v22, s27, v22
    v_mfma_f32_16x16x32_bf16 v[56:59], a[148:151], a[80:83], v[56:59]
    s_waitcnt lgkmcnt(3)
    v_exp_f32 v16, v16
    v_mfma_f32_16x16x32_bf16 v[48:51], a[152:155], a[20:23], v[48:51]
    ds_read_b64_tr_b16 a[148:149], v74 offset:20480
    v_mul_f32 v23, s27, v23
    v_mfma_f32_16x16x32_bf16 v[52:55], a[152:155], a[52:55], v[52:55]
    ds_read_b64_tr_b16 a[150:151], v74 offset:22528
    v_mul_f32 v24, s27, v24
    v_mfma_f32_16x16x32_bf16 v[56:59], a[152:155], a[84:87], v[56:59]
    s_add_u32 s26, s25, s31
    v_exp_f32 v17, v17
    v_mfma_f32_16x16x32_bf16 v[48:51], a[156:159], a[24:27], v[48:51]
    ds_read_b64_tr_b16 a[152:153], v74 offset:24576
    v_mul_f32 v25, s27, v25
    v_mfma_f32_16x16x32_bf16 v[52:55], a[156:159], a[56:59], v[52:55]
    ds_read_b64_tr_b16 a[154:155], v74 offset:26624
    v_cvt_pk_bf16_f32 v146, v16, v17
    v_mfma_f32_16x16x32_bf16 v[56:59], a[156:159], a[88:91], v[56:59]
    s_waitcnt lgkmcnt(4)
    v_exp_f32 v18, v18
    v_mfma_f32_16x16x32_bf16 v[48:51], a[160:163], a[28:31], v[48:51]
    ds_read_b64_tr_b16 a[156:157], v74 offset:28672
    v_mul_f32 v26, s27, v26
    v_mfma_f32_16x16x32_bf16 v[52:55], a[160:163], a[60:63], v[52:55]
    ds_read_b64_tr_b16 a[158:159], v74 offset:30720
    v_mul_f32 v27, s27, v27
    v_mfma_f32_16x16x32_bf16 v[56:59], a[160:163], a[92:95], v[56:59]
    s_add_u32 m0, m0, s51
    v_exp_f32 v19, v19
    v_mfma_f32_16x16x32_bf16 v[0:3], a[144:147], v[88:91], 0
    ds_read_b64_tr_b16 a[160:161], v74 offset:32768
    v_mul_f32 v32, s27, v32
    v_mfma_f32_16x16x32_bf16 v[4:7], a[144:147], v[152:155], 0
    ds_read_b64_tr_b16 a[164:165], v74 offset:36864
    s_waitcnt lgkmcnt(4)
    v_mfma_f32_16x16x32_bf16 v[8:11], a[144:147], v[216:219], 0
    ds_read_b64_tr_b16 a[162:163], v74 offset:34816
    v_cvt_pk_bf16_f32 v147, v18, v19
    v_mfma_f32_16x16x32_bf16 v[0:3], a[148:151], v[92:95], v[0:3]
    ds_read_b64_tr_b16 a[166:167], v74 offset:38912
    v_mul_f32 v33, s27, v33
    v_mfma_f32_16x16x32_bf16 v[4:7], a[148:151], v[156:159], v[4:7]
    ds_read_b64_tr_b16 a[144:145], v74 offset:40960
    v_mul_f32 v34, s27, v34
    v_mfma_f32_16x16x32_bf16 v[8:11], a[148:151], v[220:223], v[8:11]
    ds_read_b64_tr_b16 a[146:147], v74 offset:43008
    v_mul_f32 v35, s27, v35
    v_mfma_f32_16x16x32_bf16 v[0:3], a[152:155], v[96:99], v[0:3]
    ds_read_b64_tr_b16 a[148:149], v74 offset:45056
    v_mfma_f32_16x16x32_bf16 v[4:7], a[152:155], v[160:163], v[4:7]
    ds_read_b64_tr_b16 a[150:151], v74 offset:47104
    s_waitcnt lgkmcnt(5)
    v_mfma_f32_16x16x32_bf16 v[8:11], a[152:155], v[224:227], v[8:11]
    buffer_load_dwordx4 v79, s[12:15], s26 offen sc0 sc1 lds
    v_mfma_f32_16x16x32_bf16 v[0:3], a[156:159], v[100:103], v[0:3]
    ds_read_b64_tr_b16 a[152:153], v75 offset:16384
    s_add_u32 s25, s26, s31
    v_mfma_f32_16x16x32_bf16 v[4:7], a[156:159], v[164:167], v[4:7]
    ds_read_b64_tr_b16 a[154:155], v75 offset:18432
    s_add_u32 m0, m0, s51
    v_mfma_f32_16x16x32_bf16 v[8:11], a[156:159], v[228:231], v[8:11]
    buffer_load_dwordx4 v79, s[12:15], s25 offen sc0 sc1 lds
    v_mfma_f32_16x16x32_bf16 v[0:3], a[160:163], v[104:107], v[0:3]
    ds_read_b64_tr_b16 a[156:157], v75 offset:20480
    s_add_u32 s26, s25, s31
    v_mfma_f32_16x16x32_bf16 v[4:7], a[160:163], v[168:171], v[4:7]
    ds_read_b64_tr_b16 a[158:159], v75 offset:22528
    s_add_u32 m0, m0, s51
    v_mfma_f32_16x16x32_bf16 v[8:11], a[160:163], v[232:235], v[8:11]
    s_waitcnt lgkmcnt(6)
    ds_read_b128 a[32:35], v70 offset:0
    v_mfma_f32_16x16x32_bf16 v[0:3], a[164:167], v[108:111], v[0:3]
    ds_read_b64_tr_b16 a[160:161], v75 offset:24576
    v_mfma_f32_16x16x32_bf16 v[4:7], a[164:167], v[172:175], v[4:7]
    ds_read_b64_tr_b16 a[162:163], v75 offset:26624
    v_mfma_f32_16x16x32_bf16 v[8:11], a[164:167], v[236:239], v[8:11]
    buffer_load_dwordx4 v79, s[12:15], s26 offen sc0 sc1 lds
    v_mfma_f32_16x16x32_bf16 v[0:3], a[144:147], v[112:115], v[0:3]
    ds_read_b64_tr_b16 a[164:165], v75 offset:28672
    s_xor_b32 s25, s21, 65664
    v_mfma_f32_16x16x32_bf16 v[4:7], a[144:147], v[176:179], v[4:7]
    ds_read_b64_tr_b16 a[166:167], v75 offset:30720
    s_waitcnt lgkmcnt(7)
    v_mfma_f32_16x16x32_bf16 v[8:11], a[144:147], a[168:171], v[8:11]
    ds_read_b128 a[36:39], v71 offset:0
    s_add_u32 m0, m0, s95
    v_mfma_f32_16x16x32_bf16 v[0:3], a[148:151], v[116:119], v[0:3]
    ds_read_b64_tr_b16 a[144:145], v75 offset:32768
    v_mfma_f32_16x16x32_bf16 v[4:7], a[148:151], v[180:183], v[4:7]
    ds_read_b64_tr_b16 a[146:147], v75 offset:34816
    v_mfma_f32_16x16x32_bf16 v[8:11], a[148:151], a[172:175], v[8:11]
    buffer_load_dwordx4 v79, s[12:15], s25 offen sc0 sc1 lds
    v_mfma_f32_16x16x32_bf16 v[16:19], a[152:155], v[88:91], 0
    ds_read_b64_tr_b16 a[148:149], v75 offset:36864
    s_add_u32 s43, s42, 256
    v_exp_f32 v20, v20
    v_exp_f32 v21, v21
    v_exp_f32 v22, v22
    v_exp_f32 v23, v23
    v_cvt_pk_bf16_f32 v210, v20, v21
    v_cvt_pk_bf16_f32 v211, v22, v23
    v_mfma_f32_16x16x32_bf16 v[20:23], a[152:155], v[152:155], 0
    ds_read_b64_tr_b16 a[150:151], v75 offset:38912
    v_mul_f32 v36, s27, v36
    v_exp_f32 v24, v24
    v_exp_f32 v25, v25
    v_exp_f32 v26, v26
    v_exp_f32 v27, v27
    v_cvt_pk_bf16_f32 v242, v24, v25
    v_cvt_pk_bf16_f32 v243, v26, v27
    v_mfma_f32_16x16x32_bf16 v[24:27], a[152:155], v[216:219], 0
    s_waitcnt lgkmcnt(7)
    ds_read_b128 a[40:43], v70 offset:2048
    v_mfma_f32_16x16x32_bf16 v[16:19], a[156:159], v[92:95], v[16:19]
    ds_read_b64_tr_b16 a[152:153], v75 offset:40960
    v_mul_f32 v37, s27, v37
    v_mfma_f32_16x16x32_bf16 v[20:23], a[156:159], v[156:159], v[20:23]
    ds_read_b64_tr_b16 a[154:155], v75 offset:43008
    v_mul_f32 v38, s27, v38
    v_mfma_f32_16x16x32_bf16 v[24:27], a[156:159], v[220:223], v[24:27]
    ds_read_b128 a[44:47], v71 offset:2048
    s_add_u32 m0, s44, 114688
    v_mfma_f32_16x16x32_bf16 v[16:19], a[160:163], v[96:99], v[16:19]
    ds_read_b64_tr_b16 a[156:157], v75 offset:45056
    v_mul_f32 v39, s27, v39
    v_mfma_f32_16x16x32_bf16 v[20:23], a[160:163], v[160:163], v[20:23]
    ds_read_b64_tr_b16 a[158:159], v75 offset:47104
    v_mul_f32 v40, s27, v40
    v_mfma_f32_16x16x32_bf16 v[24:27], a[160:163], v[224:227], v[24:27]
    s_waitcnt lgkmcnt(8)
    v_exp_f32 v32, v32
    v_mfma_f32_16x16x32_bf16 v[16:19], a[164:167], v[100:103], v[16:19]
    s_waitcnt lgkmcnt(2)
    buffer_load_dwordx4 v78, s[4:7], s43 offen offset:0 sc0 sc1 nt lds
    s_waitcnt vmcnt(10)
    s_add_u32 s26, s25, s31
    s_barrier
    ds_read_b64_tr_b16 a[160:161], v74 offset:49152
    v_mul_f32 v41, s27, v41
    v_mfma_f32_16x16x32_bf16 v[20:23], a[164:167], v[164:167], v[20:23]
    ds_read_b64_tr_b16 a[162:163], v74 offset:51200
    v_mul_f32 v42, s27, v42
    v_mfma_f32_16x16x32_bf16 v[24:27], a[164:167], v[228:231], v[24:27]
    s_add_u32 m0, s23, 99328
    v_exp_f32 v33, v33
    v_mfma_f32_16x16x32_bf16 v[16:19], a[144:147], v[104:107], v[16:19]
    ds_read_b64_tr_b16 a[164:165], v74 offset:53248
    v_mul_f32 v43, s27, v43
    v_mfma_f32_16x16x32_bf16 v[20:23], a[144:147], v[168:171], v[20:23]
    ds_read_b64_tr_b16 a[166:167], v74 offset:55296
    v_cvt_pk_bf16_f32 v148, v32, v33
    v_mfma_f32_16x16x32_bf16 v[24:27], a[144:147], v[232:235], v[24:27]
    buffer_load_dwordx4 v79, s[12:15], s26 offen sc0 sc1 lds
    v_mfma_f32_16x16x32_bf16 v[16:19], a[148:151], v[108:111], v[16:19]
    ds_read_b64_tr_b16 a[144:145], v74 offset:57344
    s_add_u32 m0, s45, 114688
    v_mfma_f32_16x16x32_bf16 v[20:23], a[148:151], v[172:175], v[20:23]
    ds_read_b64_tr_b16 a[146:147], v74 offset:59392
    v_mul_f32 v48, s27, v48
    v_mfma_f32_16x16x32_bf16 v[24:27], a[148:151], v[236:239], v[24:27]
    buffer_load_dwordx4 v72, s[4:7], s43 offen offset:0 sc0 sc1 nt lds
    v_mfma_f32_16x16x32_bf16 v[16:19], a[152:155], v[112:115], v[16:19]
    ds_read_b64_tr_b16 a[148:149], v74 offset:61440
    s_add_u32 s25, s26, s31
    v_mfma_f32_16x16x32_bf16 v[20:23], a[152:155], v[176:179], v[20:23]
    ds_read_b64_tr_b16 a[150:151], v74 offset:63488
    s_add_u32 m0, s44, 116608
    v_mfma_f32_16x16x32_bf16 v[24:27], a[152:155], a[168:171], v[24:27]
    s_waitcnt lgkmcnt(6)
    v_add_u32 v74, s96, v74
    v_mul_f32 v49, s27, v49
    v_mfma_f32_16x16x32_bf16 v[16:19], a[156:159], v[116:119], v[16:19]
    ds_read_b64_tr_b16 a[152:153], v75 offset:49152
    v_mul_f32 v50, s27, v50
    v_mfma_f32_16x16x32_bf16 v[20:23], a[156:159], v[180:183], v[20:23]
    ds_read_b64_tr_b16 a[154:155], v75 offset:51200
    v_mul_f32 v51, s27, v51
    v_mfma_f32_16x16x32_bf16 v[24:27], a[156:159], a[172:175], v[24:27]
    buffer_load_dwordx4 v78, s[4:7], s43 offen offset:128 sc0 sc1 nt lds
    v_mfma_f32_16x16x32_bf16 v[0:3], a[160:163], v[120:123], v[0:3]
    ds_read_b64_tr_b16 a[156:157], v75 offset:53248
    s_add_u32 m0, s23, 100352
    v_mfma_f32_16x16x32_bf16 v[4:7], a[160:163], v[184:187], v[4:7]
    ds_read_b64_tr_b16 a[158:159], v75 offset:55296
    s_waitcnt lgkmcnt(6)
    v_mfma_f32_16x16x32_bf16 v[8:11], a[160:163], a[176:179], v[8:11]
    buffer_load_dwordx4 v79, s[12:15], s25 offen sc0 sc1 lds
    v_mfma_f32_16x16x32_bf16 v[0:3], a[164:167], v[124:127], v[0:3]
    ds_read_b64_tr_b16 a[160:161], v75 offset:57344
    s_add_u32 m0, s45, 116608
    v_mfma_f32_16x16x32_bf16 v[4:7], a[164:167], v[188:191], v[4:7]
    ds_read_b64_tr_b16 a[162:163], v75 offset:59392
    v_mfma_f32_16x16x32_bf16 v[8:11], a[164:167], a[180:183], v[8:11]
    buffer_load_dwordx4 v72, s[4:7], s43 offen offset:128 sc0 sc1 nt lds
    v_mfma_f32_16x16x32_bf16 v[0:3], a[144:147], v[128:131], v[0:3]
    ds_read_b64_tr_b16 a[164:165], v75 offset:61440
    s_add_u32 s26, s25, s31
    v_mfma_f32_16x16x32_bf16 v[4:7], a[144:147], v[192:195], v[4:7]
    ds_read_b64_tr_b16 a[166:167], v75 offset:63488
    s_add_u32 m0, s23, 101376
    v_mfma_f32_16x16x32_bf16 v[8:11], a[144:147], a[184:187], v[8:11]
    s_waitcnt lgkmcnt(6)
    v_add_u32 v75, s96, v75
    v_mfma_f32_16x16x32_bf16 v[0:3], a[148:151], v[132:135], v[0:3]
    ds_read_b64_tr_b16 a[144:145], v76 offset:16384
    v_mfma_f32_16x16x32_bf16 v[4:7], a[148:151], v[196:199], v[4:7]
    ds_read_b64_tr_b16 a[146:147], v76 offset:18432
    v_mfma_f32_16x16x32_bf16 v[8:11], a[148:151], a[188:191], v[8:11]
    buffer_load_dwordx4 v79, s[12:15], s26 offen sc0 sc1 lds
    v_mfma_f32_16x16x32_bf16 v[16:19], a[152:155], v[120:123], v[16:19]
    ds_read_b64_tr_b16 a[148:149], v76 offset:20480
    s_xor_b32 s25, s21, 131200
    v_mfma_f32_16x16x32_bf16 v[20:23], a[152:155], v[184:187], v[20:23]
    ds_read_b64_tr_b16 a[150:151], v76 offset:22528
    s_add_u32 m0, s23, 0
    v_mfma_f32_16x16x32_bf16 v[24:27], a[152:155], a[176:179], v[24:27]
    s_waitcnt lgkmcnt(6)
    v_exp_f32 v34, v34
    v_mfma_f32_16x16x32_bf16 v[16:19], a[156:159], v[124:127], v[16:19]
    ds_read_b64_tr_b16 a[152:153], v76 offset:24576
    v_mfma_f32_16x16x32_bf16 v[20:23], a[156:159], v[188:191], v[20:23]
    ds_read_b64_tr_b16 a[154:155], v76 offset:26624
    v_mfma_f32_16x16x32_bf16 v[24:27], a[156:159], a[180:183], v[24:27]
    buffer_load_dwordx4 v79, s[12:15], s25 offen sc0 sc1 lds
    v_mfma_f32_16x16x32_bf16 v[16:19], a[160:163], v[128:131], v[16:19]
    ds_read_b64_tr_b16 a[156:157], v76 offset:28672
    s_add_u32 s26, s25, s31
    v_mfma_f32_16x16x32_bf16 v[20:23], a[160:163], v[192:195], v[20:23]
    ds_read_b64_tr_b16 a[158:159], v76 offset:30720
    s_add_u32 m0, m0, s51
    v_mfma_f32_16x16x32_bf16 v[24:27], a[160:163], a[184:187], v[24:27]
    s_waitcnt lgkmcnt(6)
    v_exp_f32 v35, v35
    v_mfma_f32_16x16x32_bf16 v[16:19], a[164:167], v[132:135], v[16:19]
    ds_read_b64_tr_b16 a[160:161], v76 offset:32768
    v_mfma_f32_16x16x32_bf16 v[20:23], a[164:167], v[196:199], v[20:23]
    ds_read_b64_tr_b16 a[162:163], v76 offset:34816
    v_cvt_pk_bf16_f32 v149, v34, v35
    v_mfma_f32_16x16x32_bf16 v[24:27], a[164:167], a[188:191], v[24:27]
    buffer_load_dwordx4 v79, s[12:15], s26 offen sc0 sc1 lds
    v_mfma_f32_16x16x32_bf16 v[32:35], a[144:147], v[88:91], 0
    ds_read_b64_tr_b16 a[164:165], v76 offset:36864
    v_exp_f32 v36, v36
    v_exp_f32 v37, v37
    v_exp_f32 v38, v38
    v_exp_f32 v39, v39
    v_cvt_pk_bf16_f32 v212, v36, v37
    v_cvt_pk_bf16_f32 v213, v38, v39
    v_mfma_f32_16x16x32_bf16 v[36:39], a[144:147], v[152:155], 0
    ds_read_b64_tr_b16 a[166:167], v76 offset:38912
    v_mul_f32 v52, s27, v52
    v_exp_f32 v40, v40
    v_exp_f32 v41, v41
    v_exp_f32 v42, v42
    v_exp_f32 v43, v43
    v_cvt_pk_bf16_f32 v244, v40, v41
    v_cvt_pk_bf16_f32 v245, v42, v43
    v_mfma_f32_16x16x32_bf16 v[40:43], a[144:147], v[216:219], 0
    s_waitcnt lgkmcnt(6)
    v_exp_f32 v48, v48
    v_mfma_f32_16x16x32_bf16 v[32:35], a[148:151], v[92:95], v[32:35]
    ds_read_b64_tr_b16 a[144:145], v76 offset:40960
    v_mul_f32 v53, s27, v53
    v_mfma_f32_16x16x32_bf16 v[36:39], a[148:151], v[156:159], v[36:39]
    ds_read_b64_tr_b16 a[146:147], v76 offset:43008
    v_mul_f32 v54, s27, v54
    v_mfma_f32_16x16x32_bf16 v[40:43], a[148:151], v[220:223], v[40:43]
    s_add_u32 s25, s26, s31
    v_exp_f32 v49, v49
    v_mfma_f32_16x16x32_bf16 v[32:35], a[152:155], v[96:99], v[32:35]
    ds_read_b64_tr_b16 a[148:149], v76 offset:45056
    v_mul_f32 v55, s27, v55
    v_mfma_f32_16x16x32_bf16 v[36:39], a[152:155], v[160:163], v[36:39]
    ds_read_b64_tr_b16 a[150:151], v76 offset:47104
    v_cvt_pk_bf16_f32 v150, v48, v49
    v_mfma_f32_16x16x32_bf16 v[40:43], a[152:155], v[224:227], v[40:43]
    s_waitcnt lgkmcnt(6)
    v_exp_f32 v50, v50
    v_mfma_f32_16x16x32_bf16 v[32:35], a[156:159], v[100:103], v[32:35]
    ds_read_b64_tr_b16 a[152:153], v76 offset:49152
    v_mul_f32 v56, s27, v56
    v_mfma_f32_16x16x32_bf16 v[36:39], a[156:159], v[164:167], v[36:39]
    ds_read_b64_tr_b16 a[154:155], v76 offset:51200
    v_mul_f32 v57, s27, v57
    v_mfma_f32_16x16x32_bf16 v[40:43], a[156:159], v[228:231], v[40:43]
    s_barrier
    v_mfma_f32_16x16x32_bf16 v[32:35], a[160:163], v[104:107], v[32:35]
    ds_read_b64_tr_b16 a[156:157], v76 offset:53248
    s_add_u32 m0, m0, s51
    v_mfma_f32_16x16x32_bf16 v[36:39], a[160:163], v[168:171], v[36:39]
    ds_read_b64_tr_b16 a[158:159], v76 offset:55296
    s_waitcnt lgkmcnt(6)
    v_mfma_f32_16x16x32_bf16 v[40:43], a[160:163], v[232:235], v[40:43]
    buffer_load_dwordx4 v79, s[12:15], s25 offen sc0 sc1 lds
    v_mfma_f32_16x16x32_bf16 v[32:35], a[164:167], v[108:111], v[32:35]
    ds_read_b64_tr_b16 a[160:161], v76 offset:57344
    v_mul_f32 v58, s27, v58
    v_mfma_f32_16x16x32_bf16 v[36:39], a[164:167], v[172:175], v[36:39]
    ds_read_b64_tr_b16 a[162:163], v76 offset:59392
    v_mul_f32 v59, s27, v59
    v_mfma_f32_16x16x32_bf16 v[40:43], a[164:167], v[236:239], v[40:43]
    s_add_u32 s26, s25, s31
    v_exp_f32 v51, v51
    v_mfma_f32_16x16x32_bf16 v[32:35], a[144:147], v[112:115], v[32:35]
    ds_read_b64_tr_b16 a[164:165], v76 offset:61440
    s_add_u32 m0, m0, s51
    v_mfma_f32_16x16x32_bf16 v[36:39], a[144:147], v[176:179], v[36:39]
    ds_read_b64_tr_b16 a[166:167], v76 offset:63488
    s_waitcnt lgkmcnt(6)
    v_mfma_f32_16x16x32_bf16 v[40:43], a[144:147], a[168:171], v[40:43]
    buffer_load_dwordx4 v79, s[12:15], s26 offen sc0 sc1 lds
    v_mfma_f32_16x16x32_bf16 v[32:35], a[148:151], v[116:119], v[32:35]
    ds_read_b64_tr_b16 a[144:145], v77 offset:16384
    v_add_u32 v76, s96, v76
    v_mfma_f32_16x16x32_bf16 v[36:39], a[148:151], v[180:183], v[36:39]
    ds_read_b64_tr_b16 a[146:147], v77 offset:18432
    v_cvt_pk_bf16_f32 v151, v50, v51
    v_mfma_f32_16x16x32_bf16 v[40:43], a[148:151], a[172:175], v[40:43]
    v_exp_f32 v52, v52
    v_mfma_f32_16x16x32_bf16 v[32:35], a[152:155], v[120:123], v[32:35]
    ds_read_b64_tr_b16 a[148:149], v77 offset:20480
    v_mfma_f32_16x16x32_bf16 v[36:39], a[152:155], v[184:187], v[36:39]
    ds_read_b64_tr_b16 a[150:151], v77 offset:22528
    s_waitcnt lgkmcnt(6)
    v_mfma_f32_16x16x32_bf16 v[40:43], a[152:155], a[176:179], v[40:43]
    v_exp_f32 v53, v53
    v_mfma_f32_16x16x32_bf16 v[32:35], a[156:159], v[124:127], v[32:35]
    ds_read_b64_tr_b16 a[152:153], v77 offset:24576
    v_mfma_f32_16x16x32_bf16 v[36:39], a[156:159], v[188:191], v[36:39]
    ds_read_b64_tr_b16 a[154:155], v77 offset:26624
    v_cvt_pk_bf16_f32 v214, v52, v53
    v_mfma_f32_16x16x32_bf16 v[40:43], a[156:159], a[180:183], v[40:43]
    v_exp_f32 v54, v54
    v_mfma_f32_16x16x32_bf16 v[32:35], a[160:163], v[128:131], v[32:35]
    ds_read_b64_tr_b16 a[156:157], v77 offset:28672
    v_mfma_f32_16x16x32_bf16 v[36:39], a[160:163], v[192:195], v[36:39]
    ds_read_b64_tr_b16 a[158:159], v77 offset:30720
    s_waitcnt lgkmcnt(6)
    v_mfma_f32_16x16x32_bf16 v[40:43], a[160:163], a[184:187], v[40:43]
    v_exp_f32 v55, v55
    v_mfma_f32_16x16x32_bf16 v[32:35], a[164:167], v[132:135], v[32:35]
    ds_read_b64_tr_b16 a[160:161], v77 offset:32768
    v_mfma_f32_16x16x32_bf16 v[36:39], a[164:167], v[196:199], v[36:39]
    ds_read_b64_tr_b16 a[162:163], v77 offset:34816
    v_cvt_pk_bf16_f32 v215, v54, v55
    v_mfma_f32_16x16x32_bf16 v[40:43], a[164:167], a[188:191], v[40:43]
    v_exp_f32 v56, v56
    v_mfma_f32_16x16x32_bf16 v[48:51], a[144:147], v[88:91], 0
    ds_read_b64_tr_b16 a[164:165], v77 offset:36864
    v_mfma_f32_16x16x32_bf16 v[52:55], a[144:147], v[152:155], 0
    ds_read_b64_tr_b16 a[166:167], v77 offset:38912
    s_waitcnt lgkmcnt(6)
    v_exp_f32 v57, v57
    v_exp_f32 v58, v58
    v_exp_f32 v59, v59
    v_cvt_pk_bf16_f32 v246, v56, v57
    v_cvt_pk_bf16_f32 v247, v58, v59
    v_mfma_f32_16x16x32_bf16 v[56:59], a[144:147], v[216:219], 0
    v_mfma_f32_16x16x32_bf16 v[48:51], a[148:151], v[92:95], v[48:51]
    ds_read_b64_tr_b16 a[144:145], v77 offset:40960
    v_mfma_f32_16x16x32_bf16 v[52:55], a[148:151], v[156:159], v[52:55]
    ds_read_b64_tr_b16 a[146:147], v77 offset:43008
    v_mfma_f32_16x16x32_bf16 v[56:59], a[148:151], v[220:223], v[56:59]
    v_mfma_f32_16x16x32_bf16 v[48:51], a[152:155], v[96:99], v[48:51]
    ds_read_b64_tr_b16 a[148:149], v77 offset:45056
    v_mfma_f32_16x16x32_bf16 v[52:55], a[152:155], v[160:163], v[52:55]
    ds_read_b64_tr_b16 a[150:151], v77 offset:47104
    s_waitcnt lgkmcnt(6)
    v_mfma_f32_16x16x32_bf16 v[56:59], a[152:155], v[224:227], v[56:59]
    ds_read_b128 a[64:67], v70 offset:16384
    v_mfma_f32_16x16x32_bf16 v[48:51], a[156:159], v[100:103], v[48:51]
    ds_read_b64_tr_b16 a[152:153], v77 offset:49152
    v_mfma_f32_16x16x32_bf16 v[52:55], a[156:159], v[164:167], v[52:55]
    ds_read_b64_tr_b16 a[154:155], v77 offset:51200
    v_mfma_f32_16x16x32_bf16 v[56:59], a[156:159], v[228:231], v[56:59]
    ds_read_b128 a[68:71], v71 offset:16384
    v_smfmac_f32_16x16x64_bf16 a[136:139], a[128:131], v[144:151], v84
    v_smfmac_f32_16x16x64_bf16 a[136:139], a[132:135], v[208:215], v84
    v_smfmac_f32_16x16x64_bf16 a[140:143], a[128:131], v[240:247], v84
    v_mfma_f32_16x16x32_bf16 v[48:51], a[160:163], v[104:107], v[48:51]
    ds_read_b64_tr_b16 a[156:157], v77 offset:53248
    v_mfma_f32_16x16x32_bf16 v[52:55], a[160:163], v[168:171], v[52:55]
    ds_read_b64_tr_b16 a[158:159], v77 offset:55296
    s_waitcnt lgkmcnt(8)
    v_mfma_f32_16x16x32_bf16 v[56:59], a[160:163], v[232:235], v[56:59]
    ds_read_b128 a[72:75], v70 offset:18432
    v_accvgpr_read_b32 v64, a136
    v_mfma_f32_16x16x32_bf16 v[48:51], a[164:167], v[108:111], v[48:51]
    ds_read_b64_tr_b16 a[160:161], v77 offset:57344
    v_accvgpr_read_b32 v85, a137
    v_mfma_f32_16x16x32_bf16 v[52:55], a[164:167], v[172:175], v[52:55]
    ds_read_b64_tr_b16 a[162:163], v77 offset:59392
    v_add_f32 v64, v64, v85
    v_mfma_f32_16x16x32_bf16 v[56:59], a[164:167], v[236:239], v[56:59]
    ds_read_b128 a[76:79], v71 offset:18432
    v_accvgpr_read_b32 v65, a138
    v_mfma_f32_16x16x32_bf16 v[48:51], a[144:147], v[112:115], v[48:51]
    ds_read_b64_tr_b16 a[164:165], v77 offset:61440
    v_accvgpr_read_b32 v86, a139
    v_mfma_f32_16x16x32_bf16 v[52:55], a[144:147], v[176:179], v[52:55]
    ds_read_b64_tr_b16 a[166:167], v77 offset:63488
    v_add_u32 v77, s96, v77
    v_mfma_f32_16x16x32_bf16 v[56:59], a[144:147], a[168:171], v[56:59]
    s_waitcnt lgkmcnt(9)
    s_waitcnt vmcnt(16)
    v_add_f32 v65, v65, v86
    v_mfma_f32_16x16x32_bf16 v[48:51], a[148:151], v[116:119], v[48:51]
    s_barrier
    ds_read_b64_tr_b16 a[144:145], v74 offset:16384
    v_accvgpr_read_b32 v66, a140
    v_mfma_f32_16x16x32_bf16 v[52:55], a[148:151], v[180:183], v[52:55]
    ds_read_b64_tr_b16 a[146:147], v74 offset:18432
    v_accvgpr_read_b32 v85, a141
    v_mfma_f32_16x16x32_bf16 v[56:59], a[148:151], a[172:175], v[56:59]
    s_xor_b32 s25, s21, 196736
    v_add_f32 v66, v66, v85
    v_cmp_nlt_f32_e64 s[54:55], v64, s28
    v_mfma_f32_16x16x32_bf16 v[48:51], a[152:155], v[120:123], v[48:51]
    ds_read_b64_tr_b16 a[148:149], v74 offset:20480
    s_add_u32 m0, m0, s95
    v_mfma_f32_16x16x32_bf16 v[52:55], a[152:155], v[184:187], v[52:55]
    ds_read_b64_tr_b16 a[150:151], v74 offset:22528
    s_waitcnt lgkmcnt(7)
    v_mfma_f32_16x16x32_bf16 v[56:59], a[152:155], a[176:179], v[56:59]
    buffer_load_dwordx4 v79, s[12:15], s25 offen sc0 sc1 lds
    v_mfma_f32_16x16x32_bf16 v[48:51], a[156:159], v[124:127], v[48:51]
    ds_read_b64_tr_b16 a[152:153], v74 offset:24576
    v_cmp_nlt_f32_e64 s[52:53], v65, s28
    v_mfma_f32_16x16x32_bf16 v[52:55], a[156:159], v[188:191], v[52:55]
    ds_read_b64_tr_b16 a[154:155], v74 offset:26624
    s_add_u32 s26, s25, s31
    v_mfma_f32_16x16x32_bf16 v[56:59], a[156:159], a[180:183], v[56:59]
    ds_read_b128 a[0:3], v70 offset:32768
    s_or_b64 s[54:55], s[54:55], s[52:53]
    v_mfma_f32_16x16x32_bf16 v[48:51], a[160:163], v[128:131], v[48:51]
    ds_read_b64_tr_b16 a[156:157], v74 offset:28672
    s_add_u32 m0, m0, s51
    v_mfma_f32_16x16x32_bf16 v[52:55], a[160:163], v[192:195], v[52:55]
    ds_read_b64_tr_b16 a[158:159], v74 offset:30720
    s_waitcnt lgkmcnt(7)
    v_mfma_f32_16x16x32_bf16 v[56:59], a[160:163], a[184:187], v[56:59]
    buffer_load_dwordx4 v79, s[12:15], s26 offen sc0 sc1 lds
    v_mfma_f32_16x16x32_bf16 v[48:51], a[164:167], v[132:135], v[48:51]
    ds_read_b64_tr_b16 a[160:161], v75 offset:16384
    v_cmp_nlt_f32_e64 s[52:53], v66, s28
    v_mfma_f32_16x16x32_bf16 v[52:55], a[164:167], v[196:199], v[52:55]
    ds_read_b64_tr_b16 a[162:163], v75 offset:18432
    s_or_b64 s[54:55], s[54:55], s[52:53]
    v_mfma_f32_16x16x32_bf16 v[56:59], a[164:167], a[188:191], v[56:59]
    ds_read_b128 a[4:7], v71 offset:32768
    s_add_u32 s25, s26, s31
    v_mfma_f32_16x16x32_bf16 v[0:3], a[144:147], v[136:139], v[0:3]
    ds_read_b64_tr_b16 a[164:165], v75 offset:20480
    v_mfma_f32_16x16x32_bf16 v[4:7], a[144:147], v[200:203], v[4:7]
    ds_read_b64_tr_b16 a[166:167], v75 offset:22528
    s_waitcnt lgkmcnt(8)
    v_mfma_f32_16x16x32_bf16 v[8:11], a[144:147], a[192:195], v[8:11]
    ds_read_b128 a[8:11], v70 offset:34816
    s_add_u32 m0, m0, s51
    v_mfma_f32_16x16x32_bf16 v[0:3], a[148:151], v[140:143], v[0:3]
    ds_read_b64_tr_b16 a[144:145], v75 offset:24576
    v_mfma_f32_16x16x32_bf16 v[4:7], a[148:151], v[204:207], v[4:7]
    ds_read_b64_tr_b16 a[146:147], v75 offset:26624
    v_mfma_f32_16x16x32_bf16 v[8:11], a[148:151], a[196:199], v[8:11]
    buffer_load_dwordx4 v79, s[12:15], s25 offen sc0 sc1 lds
    v_mfma_f32_16x16x32_bf16 v[0:3], a[152:155], v[144:147], v[0:3]
    ds_read_b64_tr_b16 a[148:149], v75 offset:28672
    v_mfma_f32_16x16x32_bf16 v[4:7], a[152:155], v[208:211], v[4:7]
    ds_read_b64_tr_b16 a[150:151], v75 offset:30720
    s_waitcnt lgkmcnt(8)
    v_mfma_f32_16x16x32_bf16 v[8:11], a[152:155], v[240:243], v[8:11]
    ds_read_b128 a[12:15], v71 offset:34816
    s_add_u32 s26, s25, s31
    v_mfma_f32_16x16x32_bf16 v[0:3], a[156:159], v[148:151], v[0:3]
    ds_read_b64_tr_b16 a[152:153], v76 offset:16384
    v_mfma_f32_16x16x32_bf16 v[4:7], a[156:159], v[212:215], v[4:7]
    ds_read_b64_tr_b16 a[154:155], v76 offset:18432
    v_mfma_f32_16x16x32_bf16 v[8:11], a[156:159], v[244:247], v[8:11]
    s_cmp_lg_u64 s[54:55], 0
    s_addc_u32 s30, s30, s30
    s_add_u32 m0, m0, s51
    v_mfma_f32_16x16x32_bf16 v[16:19], a[160:163], v[136:139], v[16:19]
    ds_read_b64_tr_b16 a[156:157], v76 offset:20480
    v_mfma_f32_16x16x32_bf16 v[20:23], a[160:163], v[200:203], v[20:23]
    ds_read_b64_tr_b16 a[158:159], v76 offset:22528
    s_waitcnt lgkmcnt(7)
    v_mfma_f32_16x16x32_bf16 v[24:27], a[160:163], a[192:195], v[24:27]
    buffer_load_dwordx4 v79, s[12:15], s26 offen sc0 sc1 lds
    v_mfma_f32_16x16x32_bf16 v[16:19], a[164:167], v[140:143], v[16:19]
    ds_read_b64_tr_b16 a[160:161], v76 offset:24576
    v_mfma_f32_16x16x32_bf16 v[20:23], a[164:167], v[204:207], v[20:23]
    ds_read_b64_tr_b16 a[162:163], v76 offset:26624
    v_mfma_f32_16x16x32_bf16 v[24:27], a[164:167], a[196:199], v[24:27]
    v_rcp_f32 v64, v64
    v_mfma_f32_16x16x32_bf16 v[16:19], a[144:147], v[144:147], v[16:19]
    ds_read_b64_tr_b16 a[164:165], v76 offset:28672
    v_mfma_f32_16x16x32_bf16 v[20:23], a[144:147], v[208:211], v[20:23]
    ds_read_b64_tr_b16 a[166:167], v76 offset:30720
    v_mul_f32 v0, v64, v0
    v_mfma_f32_16x16x32_bf16 v[24:27], a[144:147], v[240:243], v[24:27]
    s_waitcnt lgkmcnt(6)
    v_rcp_f32 v65, v65
    v_mfma_f32_16x16x32_bf16 v[16:19], a[148:151], v[148:151], v[16:19]
    ds_read_b64_tr_b16 a[144:145], v77 offset:16384
    v_mul_f32 v1, v64, v1
    v_mfma_f32_16x16x32_bf16 v[20:23], a[148:151], v[212:215], v[20:23]
    ds_read_b64_tr_b16 a[146:147], v77 offset:18432
    v_mul_f32 v2, v64, v2
    v_mfma_f32_16x16x32_bf16 v[24:27], a[148:151], v[244:247], v[24:27]
    s_waitcnt vmcnt(9)
    v_rcp_f32 v66, v66
    v_mfma_f32_16x16x32_bf16 v[32:35], a[152:155], v[136:139], v[32:35]
    ds_read_b64_tr_b16 a[148:149], v77 offset:20480
    v_mul_f32 v3, v64, v3
    v_mfma_f32_16x16x32_bf16 v[36:39], a[152:155], v[200:203], v[36:39]
    ds_read_b64_tr_b16 a[150:151], v77 offset:22528
    v_cvt_pk_bf16_f32 v0, v0, v1
    v_mfma_f32_16x16x32_bf16 v[40:43], a[152:155], a[192:195], v[40:43]
    s_waitcnt lgkmcnt(6)
    v_cvt_pk_bf16_f32 v1, v2, v3
    v_mul_f32 v4, v65, v4
    v_mfma_f32_16x16x32_bf16 v[32:35], a[156:159], v[140:143], v[32:35]
    ds_read_b64_tr_b16 a[152:153], v77 offset:24576
    v_mul_f32 v5, v65, v5
    v_mfma_f32_16x16x32_bf16 v[36:39], a[156:159], v[204:207], v[36:39]
    ds_read_b64_tr_b16 a[154:155], v77 offset:26624
    v_mul_f32 v6, v65, v6
    v_mfma_f32_16x16x32_bf16 v[40:43], a[156:159], a[196:199], v[40:43]
    ds_write_b64 v82, v[0:1] offset:0
    v_mfma_f32_16x16x32_bf16 v[32:35], a[160:163], v[144:147], v[32:35]
    ds_read_b64_tr_b16 a[156:157], v77 offset:28672
    v_mul_f32 v7, v65, v7
    v_mfma_f32_16x16x32_bf16 v[36:39], a[160:163], v[208:211], v[36:39]
L_w15:
    s_cbranch_execz L_w19
    ds_read_b64_tr_b16 a[158:159], v77 offset:30720
    v_cvt_pk_bf16_f32 v4, v4, v5
    v_mfma_f32_16x16x32_bf16 v[40:43], a[160:163], v[240:243], v[40:43]
    s_waitcnt lgkmcnt(7)
    s_waitcnt vmcnt(8)
    v_cvt_pk_bf16_f32 v5, v6, v7
    v_mfma_f32_16x16x32_bf16 v[32:35], a[164:167], v[148:151], v[32:35]
    s_barrier
    ds_read_b64_tr_b16 a[160:161], v74 offset:32768
    v_mul_f32 v8, v66, v8
    v_mfma_f32_16x16x32_bf16 v[36:39], a[164:167], v[212:215], v[36:39]
    ds_read_b64_tr_b16 a[162:163], v74 offset:34816
    v_mul_f32 v9, v66, v9
    v_mfma_f32_16x16x32_bf16 v[40:43], a[164:167], v[244:247], v[40:43]
    ds_write_b64 v82, v[4:5] offset:2048
    v_mfma_f32_16x16x32_bf16 v[48:51], a[144:147], v[136:139], v[48:51]
    ds_read_b64_tr_b16 a[164:165], v74 offset:36864
    s_xor_b32 s25, s21, 256
    v_mfma_f32_16x16x32_bf16 v[52:55], a[144:147], v[200:203], v[52:55]
    ds_read_b64_tr_b16 a[166:167], v74 offset:38912
    v_mul_f32 v10, v66, v10
    v_mfma_f32_16x16x32_bf16 v[56:59], a[144:147], a[192:195], v[56:59]
    s_waitcnt lgkmcnt(8)
    s_add_u32 m0, m0, s95
    v_mul_f32 v11, v66, v11
    v_mfma_f32_16x16x32_bf16 v[48:51], a[148:151], v[140:143], v[48:51]
    ds_read_b64_tr_b16 a[144:145], v74 offset:40960
    v_cvt_pk_bf16_f32 v8, v8, v9
    v_mfma_f32_16x16x32_bf16 v[52:55], a[148:151], v[204:207], v[52:55]
    ds_read_b64_tr_b16 a[146:147], v74 offset:43008
    v_cvt_pk_bf16_f32 v9, v10, v11
    v_mfma_f32_16x16x32_bf16 v[56:59], a[148:151], a[196:199], v[56:59]
    ds_write_b64 v82, v[8:9] offset:16384
    v_mfma_f32_16x16x32_bf16 v[48:51], a[152:155], v[144:147], v[48:51]
    ds_read_b64_tr_b16 a[148:149], v74 offset:45056
    v_xor_b32 v82, 32, v82
    v_mfma_f32_16x16x32_bf16 v[52:55], a[152:155], v[208:211], v[52:55]
    ds_read_b64_tr_b16 a[150:151], v74 offset:47104
    s_waitcnt lgkmcnt(8)
    v_mfma_f32_16x16x32_bf16 v[56:59], a[152:155], v[240:243], v[56:59]
    buffer_load_dwordx4 v79, s[12:15], s25 offen sc0 sc1 lds
    v_mfma_f32_16x16x32_bf16 v[48:51], a[156:159], v[148:151], v[48:51]
    ds_read_b64_tr_b16 a[152:153], v74 offset:49152
    s_add_u32 s26, s25, s31
    v_mfma_f32_16x16x32_bf16 v[52:55], a[156:159], v[212:215], v[52:55]
    ds_read_b64_tr_b16 a[154:155], v74 offset:51200
    v_mul_f32 v16, v64, v16
    v_mfma_f32_16x16x32_bf16 v[56:59], a[156:159], v[244:247], v[56:59]
    ds_read_b128 a[16:19], v70 offset:0
    s_add_u32 m0, m0, s51
    v_mfma_f32_16x16x32_bf16 v[0:3], a[160:163], v[88:91], 0
    ds_read_b64_tr_b16 a[156:157], v74 offset:53248
    v_mul_f32 v17, v64, v17
    v_mfma_f32_16x16x32_bf16 v[4:7], a[160:163], v[152:155], 0
    ds_read_b64_tr_b16 a[158:159], v74 offset:55296
    s_waitcnt lgkmcnt(8)
    v_mfma_f32_16x16x32_bf16 v[8:11], a[160:163], v[216:219], 0
    buffer_load_dwordx4 v79, s[12:15], s26 offen sc0 sc1 lds
    v_mfma_f32_16x16x32_bf16 v[0:3], a[164:167], v[92:95], v[0:3]
    ds_read_b64_tr_b16 a[160:161], v74 offset:57344
    s_add_u32 s43, s42, 8448
    v_mfma_f32_16x16x32_bf16 v[4:7], a[164:167], v[156:159], v[4:7]
    ds_read_b64_tr_b16 a[162:163], v74 offset:59392
    v_mul_f32 v18, v64, v18
    v_mfma_f32_16x16x32_bf16 v[8:11], a[164:167], v[220:223], v[8:11]
    ds_read_b128 a[20:23], v71 offset:0
    s_add_u32 s25, s26, s31
    v_mfma_f32_16x16x32_bf16 v[0:3], a[144:147], v[96:99], v[0:3]
    ds_read_b64_tr_b16 a[164:165], v74 offset:61440
    s_add_u32 m0, s44, 114688
    v_mfma_f32_16x16x32_bf16 v[4:7], a[144:147], v[160:163], v[4:7]
    ds_read_b64_tr_b16 a[166:167], v74 offset:63488
    v_subrev_u32 v74, s96, v74
    v_mfma_f32_16x16x32_bf16 v[8:11], a[144:147], v[224:227], v[8:11]
    s_waitcnt lgkmcnt(8)
    ds_read_b128 a[24:27], v70 offset:2048
    v_mfma_f32_16x16x32_bf16 v[0:3], a[148:151], v[100:103], v[0:3]
    ds_read_b64_tr_b16 a[144:145], v75 offset:32768
    v_mul_f32 v19, v64, v19
    v_mfma_f32_16x16x32_bf16 v[4:7], a[148:151], v[164:167], v[4:7]
    ds_read_b64_tr_b16 a[146:147], v75 offset:34816
    v_cvt_pk_bf16_f32 v16, v16, v17
    v_mfma_f32_16x16x32_bf16 v[8:11], a[148:151], v[228:231], v[8:11]
    ds_read_b128 a[28:31], v71 offset:2048
    v_cvt_pk_bf16_f32 v17, v18, v19
    v_mfma_f32_16x16x32_bf16 v[0:3], a[152:155], v[104:107], v[0:3]
    ds_read_b64_tr_b16 a[148:149], v75 offset:36864
    v_mul_f32 v20, v65, v20
    v_mfma_f32_16x16x32_bf16 v[4:7], a[152:155], v[168:171], v[4:7]
    ds_read_b64_tr_b16 a[150:151], v75 offset:38912
    v_mul_f32 v21, v65, v21
    v_mfma_f32_16x16x32_bf16 v[8:11], a[152:155], v[232:235], v[8:11]
    s_waitcnt lgkmcnt(9)
    v_mul_f32 v22, v65, v22
    v_mul_f32 v23, v65, v23
    v_mfma_f32_16x16x32_bf16 v[0:3], a[156:159], v[108:111], v[0:3]
    ds_read_b64_tr_b16 a[152:153], v75 offset:40960
    v_cvt_pk_bf16_f32 v20, v20, v21
    v_mfma_f32_16x16x32_bf16 v[4:7], a[156:159], v[172:175], v[4:7]
    ds_read_b64_tr_b16 a[154:155], v75 offset:43008
    v_cvt_pk_bf16_f32 v21, v22, v23
    v_mfma_f32_16x16x32_bf16 v[8:11], a[156:159], v[236:239], v[8:11]
    ds_write_b64 v82, v[16:17] offset:0
    v_mfma_f32_16x16x32_bf16 v[0:3], a[160:163], v[112:115], v[0:3]
    ds_read_b64_tr_b16 a[156:157], v75 offset:45056
    v_mul_f32 v24, v66, v24
    v_mfma_f32_16x16x32_bf16 v[4:7], a[160:163], v[176:179], v[4:7]
    ds_read_b64_tr_b16 a[158:159], v75 offset:47104
    v_mul_f32 v25, v66, v25
    v_mfma_f32_16x16x32_bf16 v[8:11], a[160:163], a[168:171], v[8:11]
    s_waitcnt lgkmcnt(8)
    v_mul_f32 v26, v66, v26
    v_mul_f32 v27, v66, v27
    v_mfma_f32_16x16x32_bf16 v[0:3], a[164:167], v[116:119], v[0:3]
    ds_read_b64_tr_b16 a[160:161], v75 offset:49152
    v_cvt_pk_bf16_f32 v24, v24, v25
    v_mfma_f32_16x16x32_bf16 v[4:7], a[164:167], v[180:183], v[4:7]
    ds_read_b64_tr_b16 a[162:163], v75 offset:51200
    v_cvt_pk_bf16_f32 v25, v26, v27
    v_mfma_f32_16x16x32_bf16 v[8:11], a[164:167], a[172:175], v[8:11]
    ds_write_b64 v82, v[20:21] offset:2048
    v_mfma_f32_16x16x32_bf16 v[16:19], a[144:147], v[88:91], 0
    ds_read_b64_tr_b16 a[164:165], v75 offset:53248
    v_mul_f32 v32, v64, v32
    v_mfma_f32_16x16x32_bf16 v[20:23], a[144:147], v[152:155], 0
    ds_read_b64_tr_b16 a[166:167], v75 offset:55296
    s_waitcnt lgkmcnt(8)
    ds_write_b64 v82, v[24:25] offset:16384
    v_mfma_f32_16x16x32_bf16 v[24:27], a[144:147], v[216:219], 0
    buffer_load_dwordx4 v78, s[4:7], s43 offen offset:0 sc0 sc1 nt lds
    v_mfma_f32_16x16x32_bf16 v[16:19], a[148:151], v[92:95], v[16:19]
    ds_read_b64_tr_b16 a[144:145], v75 offset:57344
    s_add_u32 m0, s23, 34816
    v_mfma_f32_16x16x32_bf16 v[20:23], a[148:151], v[156:159], v[20:23]
    ds_read_b64_tr_b16 a[146:147], v75 offset:59392
    v_xor_b32 v82, 96, v82
    v_mfma_f32_16x16x32_bf16 v[24:27], a[148:151], v[220:223], v[24:27]
    buffer_load_dwordx4 v79, s[12:15], s25 offen sc0 sc1 lds
    v_mfma_f32_16x16x32_bf16 v[16:19], a[152:155], v[96:99], v[16:19]
    ds_read_b64_tr_b16 a[148:149], v75 offset:61440
    s_add_u32 m0, s45, 114688
    v_mfma_f32_16x16x32_bf16 v[20:23], a[152:155], v[160:163], v[20:23]
    ds_read_b64_tr_b16 a[150:151], v75 offset:63488
    s_waitcnt lgkmcnt(8)
    v_mfma_f32_16x16x32_bf16 v[24:27], a[152:155], v[224:227], v[24:27]
    buffer_load_dwordx4 v72, s[4:7], s43 offen offset:0 sc0 sc1 nt lds
    v_mfma_f32_16x16x32_bf16 v[16:19], a[156:159], v[100:103], v[16:19]
    ds_read_b64_tr_b16 a[152:153], v76 offset:32768
    s_add_u32 s26, s25, s31
    v_mfma_f32_16x16x32_bf16 v[20:23], a[156:159], v[164:167], v[20:23]
    ds_read_b64_tr_b16 a[154:155], v76 offset:34816
    s_add_u32 m0, s23, 35840
    v_mfma_f32_16x16x32_bf16 v[24:27], a[156:159], v[228:231], v[24:27]
    buffer_load_dwordx4 v79, s[12:15], s26 offen sc0 sc1 lds
    v_mfma_f32_16x16x32_bf16 v[16:19], a[160:163], v[104:107], v[16:19]
    ds_read_b64_tr_b16 a[156:157], v76 offset:36864
    s_add_u32 m0, s44, 116608
    v_mfma_f32_16x16x32_bf16 v[20:23], a[160:163], v[168:171], v[20:23]
    ds_read_b64_tr_b16 a[158:159], v76 offset:38912
    s_waitcnt lgkmcnt(6)
    v_mfma_f32_16x16x32_bf16 v[24:27], a[160:163], v[232:235], v[24:27]
    buffer_load_dwordx4 v78, s[4:7], s43 offen offset:128 sc0 sc1 nt lds
    v_mfma_f32_16x16x32_bf16 v[16:19], a[164:167], v[108:111], v[16:19]
    ds_read_b64_tr_b16 a[160:161], v76 offset:40960
    s_xor_b32 s25, s21, 65792
    v_mfma_f32_16x16x32_bf16 v[20:23], a[164:167], v[172:175], v[20:23]
    ds_read_b64_tr_b16 a[162:163], v76 offset:43008
    s_add_u32 m0, s45, 116608
    v_mfma_f32_16x16x32_bf16 v[24:27], a[164:167], v[236:239], v[24:27]
    buffer_load_dwordx4 v72, s[4:7], s43 offen offset:128 sc0 sc1 nt lds
    v_mfma_f32_16x16x32_bf16 v[16:19], a[144:147], v[112:115], v[16:19]
    ds_read_b64_tr_b16 a[164:165], v76 offset:45056
    s_add_u32 m0, s23, 49152
    v_mfma_f32_16x16x32_bf16 v[20:23], a[144:147], v[176:179], v[20:23]
    ds_read_b64_tr_b16 a[166:167], v76 offset:47104
    s_waitcnt lgkmcnt(6)
    v_mfma_f32_16x16x32_bf16 v[24:27], a[144:147], a[168:171], v[24:27]
    buffer_load_dwordx4 v79, s[12:15], s25 offen sc0 sc1 lds
    v_mfma_f32_16x16x32_bf16 v[16:19], a[148:151], v[116:119], v[16:19]
    ds_read_b64_tr_b16 a[144:145], v76 offset:49152
    s_add_u32 s26, s25, s31
    v_mfma_f32_16x16x32_bf16 v[20:23], a[148:151], v[180:183], v[20:23]
    ds_read_b64_tr_b16 a[146:147], v76 offset:51200
    v_subrev_u32 v75, s96, v75
    v_mfma_f32_16x16x32_bf16 v[24:27], a[148:151], a[172:175], v[24:27]
    s_barrier
    v_mul_f32 v33, v64, v33
    v_mul_f32 v34, v64, v34
    v_mul_f32 v35, v64, v35
    v_cvt_pk_bf16_f32 v32, v32, v33
    v_cvt_pk_bf16_f32 v33, v34, v35
    ds_write_b64 v82, v[32:33] offset:0
    v_mfma_f32_16x16x32_bf16 v[32:35], a[152:155], v[88:91], 0
    ds_read_b64_tr_b16 a[148:149], v76 offset:53248
    s_add_u32 m0, m0, s51
    v_mul_f32 v36, v65, v36
    v_mul_f32 v37, v65, v37
    v_mul_f32 v38, v65, v38
    v_mul_f32 v39, v65, v39
    v_cvt_pk_bf16_f32 v36, v36, v37
    v_cvt_pk_bf16_f32 v37, v38, v39
    ds_write_b64 v82, v[36:37] offset:2048
    v_mfma_f32_16x16x32_bf16 v[36:39], a[152:155], v[152:155], 0
    ds_read_b64_tr_b16 a[150:151], v76 offset:55296
    s_waitcnt lgkmcnt(8)
    v_mul_f32 v40, v66, v40
    v_mul_f32 v41, v66, v41
    v_mul_f32 v42, v66, v42
    v_mul_f32 v43, v66, v43
    v_cvt_pk_bf16_f32 v40, v40, v41
    v_cvt_pk_bf16_f32 v41, v42, v43
    ds_write_b64 v82, v[40:41] offset:16384
    v_mfma_f32_16x16x32_bf16 v[40:43], a[152:155], v[216:219], 0
    buffer_load_dwordx4 v79, s[12:15], s26 offen sc0 sc1 lds
    v_mfma_f32_16x16x32_bf16 v[32:35], a[156:159], v[92:95], v[32:35]
    ds_read_b64_tr_b16 a[152:153], v76 offset:57344
    s_add_u32 s25, s26, s31
    v_mfma_f32_16x16x32_bf16 v[36:39], a[156:159], v[156:159], v[36:39]
    ds_read_b64_tr_b16 a[154:155], v76 offset:59392
    s_add_u32 m0, m0, s51
    v_mfma_f32_16x16x32_bf16 v[40:43], a[156:159], v[220:223], v[40:43]
    buffer_load_dwordx4 v79, s[12:15], s25 offen sc0 sc1 lds
    v_mfma_f32_16x16x32_bf16 v[32:35], a[160:163], v[96:99], v[32:35]
    ds_read_b64_tr_b16 a[156:157], v76 offset:61440
    s_add_u32 s26, s25, s31
    v_mfma_f32_16x16x32_bf16 v[36:39], a[160:163], v[160:163], v[36:39]
    ds_read_b64_tr_b16 a[158:159], v76 offset:63488
    s_add_u32 m0, m0, s51
    v_mfma_f32_16x16x32_bf16 v[40:43], a[160:163], v[224:227], v[40:43]
    s_waitcnt lgkmcnt(9)
    s_xor_b32 s3, s46, 0
    v_xor_b32 v82, 32, v82
    v_mfma_f32_16x16x32_bf16 v[32:35], a[164:167], v[100:103], v[32:35]
    ds_read_b64_tr_b16 a[160:161], v77 offset:32768
    s_add_u32 s48, s3, 0
    v_mfma_f32_16x16x32_bf16 v[36:39], a[164:167], v[164:167], v[36:39]
    ds_read_b64_tr_b16 a[162:163], v77 offset:34816
    v_subrev_u32 v76, s96, v76
    v_mfma_f32_16x16x32_bf16 v[40:43], a[164:167], v[228:231], v[40:43]
    buffer_load_dwordx4 v79, s[12:15], s26 offen sc0 sc1 lds
    v_mfma_f32_16x16x32_bf16 v[32:35], a[144:147], v[104:107], v[32:35]
    ds_read_b64_tr_b16 a[164:165], v77 offset:36864
    s_xor_b32 s25, s21, 131328
    v_mfma_f32_16x16x32_bf16 v[36:39], a[144:147], v[168:171], v[36:39]
    ds_read_b64_tr_b16 a[166:167], v77 offset:38912
    v_mul_f32 v48, v64, v48
    v_mfma_f32_16x16x32_bf16 v[40:43], a[144:147], v[232:235], v[40:43]
    s_waitcnt lgkmcnt(6)
    s_add_u32 m0, m0, s95
    v_mul_f32 v49, v64, v49
    v_mfma_f32_16x16x32_bf16 v[32:35], a[148:151], v[108:111], v[32:35]
    ds_read_b64_tr_b16 a[144:145], v77 offset:40960
    v_mul_f32 v50, v64, v50
    v_mfma_f32_16x16x32_bf16 v[36:39], a[148:151], v[172:175], v[36:39]
    ds_read_b64_tr_b16 a[146:147], v77 offset:43008
    v_mul_f32 v51, v64, v51
    v_mfma_f32_16x16x32_bf16 v[40:43], a[148:151], v[236:239], v[40:43]
    buffer_load_dwordx4 v79, s[12:15], s25 offen sc0 sc1 lds
    v_mfma_f32_16x16x32_bf16 v[32:35], a[152:155], v[112:115], v[32:35]
    ds_read_b64_tr_b16 a[148:149], v77 offset:45056
    v_cvt_pk_bf16_f32 v48, v48, v49
    v_mfma_f32_16x16x32_bf16 v[36:39], a[152:155], v[176:179], v[36:39]
    ds_read_b64_tr_b16 a[150:151], v77 offset:47104
    v_cvt_pk_bf16_f32 v49, v50, v51
    v_mfma_f32_16x16x32_bf16 v[40:43], a[152:155], a[168:171], v[40:43]
    s_waitcnt lgkmcnt(6)
    ds_write_b64 v82, v[48:49] offset:0
    v_mfma_f32_16x16x32_bf16 v[32:35], a[156:159], v[116:119], v[32:35]
    ds_read_b64_tr_b16 a[152:153], v77 offset:49152
    s_add_u32 s26, s25, s31
    v_mfma_f32_16x16x32_bf16 v[36:39], a[156:159], v[180:183], v[36:39]
    ds_read_b64_tr_b16 a[154:155], v77 offset:51200
    v_mul_f32 v52, v65, v52
    v_mfma_f32_16x16x32_bf16 v[40:43], a[156:159], a[172:175], v[40:43]
    s_add_u32 m0, m0, s51
    s_add_u32 s49, s48, s31
    v_mul_f32 v53, v65, v53
    v_mfma_f32_16x16x32_bf16 v[48:51], a[160:163], v[88:91], 0
    ds_read_b64_tr_b16 a[156:157], v77 offset:53248
    v_mul_f32 v54, v65, v54
    v_mul_f32 v55, v65, v55
    v_cvt_pk_bf16_f32 v52, v52, v53
    v_cvt_pk_bf16_f32 v53, v54, v55
    ds_write_b64 v82, v[52:53] offset:2048
    v_mfma_f32_16x16x32_bf16 v[52:55], a[160:163], v[152:155], 0
    ds_read_b64_tr_b16 a[158:159], v77 offset:55296
    s_waitcnt lgkmcnt(8)
    v_mul_f32 v56, v66, v56
    v_mul_f32 v57, v66, v57
    v_mul_f32 v58, v66, v58
    v_mul_f32 v59, v66, v59
    v_cvt_pk_bf16_f32 v56, v56, v57
    v_cvt_pk_bf16_f32 v57, v58, v59
    ds_write_b64 v82, v[56:57] offset:16384
    v_mfma_f32_16x16x32_bf16 v[56:59], a[160:163], v[216:219], 0
    buffer_load_dwordx4 v79, s[12:15], s26 offen sc0 sc1 lds
    v_mfma_f32_16x16x32_bf16 v[48:51], a[164:167], v[92:95], v[48:51]
    ds_read_b64_tr_b16 a[160:161], v77 offset:57344
    v_xor_b32 v82, 96, v82
    v_mfma_f32_16x16x32_bf16 v[52:55], a[164:167], v[156:159], v[52:55]
    ds_read_b64_tr_b16 a[162:163], v77 offset:59392
    v_mfma_f32_16x16x32_bf16 v[56:59], a[164:167], v[220:223], v[56:59]
    ds_read_b128 a[216:219], v83 offset:0
    v_mfma_f32_16x16x32_bf16 v[48:51], a[144:147], v[96:99], v[48:51]
    ds_read_b64_tr_b16 a[164:165], v77 offset:61440
    v_mfma_f32_16x16x32_bf16 v[52:55], a[144:147], v[160:163], v[52:55]
    ds_read_b64_tr_b16 a[166:167], v77 offset:63488
    v_subrev_u32 v77, s96, v77
    v_mfma_f32_16x16x32_bf16 v[56:59], a[144:147], v[224:227], v[56:59]
    s_waitcnt lgkmcnt(9)
    s_waitcnt vmcnt(14)
    s_add_u32 s25, s26, s31
    v_mfma_f32_16x16x32_bf16 v[48:51], a[148:151], v[100:103], v[48:51]
    s_barrier
    ds_read_b64_tr_b16 a[144:145], v74 offset:0
    s_add_u32 m0, m0, s51
    v_mfma_f32_16x16x32_bf16 v[52:55], a[148:151], v[164:167], v[52:55]
    ds_read_b64_tr_b16 a[146:147], v74 offset:2048
    v_mfma_f32_16x16x32_bf16 v[56:59], a[148:151], v[228:231], v[56:59]
    buffer_load_dwordx4 v79, s[12:15], s25 offen sc0 sc1 lds
    v_mfma_f32_16x16x32_bf16 v[48:51], a[152:155], v[104:107], v[48:51]
    ds_read_b64_tr_b16 a[148:149], v74 offset:4096
    s_add_u32 s26, s25, s31
    v_mfma_f32_16x16x32_bf16 v[52:55], a[152:155], v[168:171], v[52:55]
    ds_read_b64_tr_b16 a[150:151], v74 offset:6144
    s_waitcnt lgkmcnt(7)
    v_mfma_f32_16x16x32_bf16 v[56:59], a[152:155], v[232:235], v[56:59]
    ds_read_b128 a[220:223], v83 offset:1024
    s_add_u32 m0, m0, s51
    v_mfma_f32_16x16x32_bf16 v[48:51], a[156:159], v[108:111], v[48:51]
    ds_read_b64_tr_b16 a[152:153], v74 offset:8192
    v_mfma_f32_16x16x32_bf16 v[52:55], a[156:159], v[172:175], v[52:55]
    ds_read_b64_tr_b16 a[154:155], v74 offset:10240
    v_mfma_f32_16x16x32_bf16 v[56:59], a[156:159], v[236:239], v[56:59]
    buffer_load_dwordx4 v79, s[12:15], s26 offen sc0 sc1 lds
    v_mfma_f32_16x16x32_bf16 v[48:51], a[160:163], v[112:115], v[48:51]
    ds_read_b64_tr_b16 a[156:157], v74 offset:12288
    v_mfma_f32_16x16x32_bf16 v[52:55], a[160:163], v[176:179], v[52:55]
    ds_read_b64_tr_b16 a[158:159], v74 offset:14336
    s_waitcnt lgkmcnt(7)
    v_mfma_f32_16x16x32_bf16 v[56:59], a[160:163], a[168:171], v[56:59]
    buffer_store_dwordx4 a[216:219], v81, s[16:19], s48 offen sc1
    v_mfma_f32_16x16x32_bf16 v[48:51], a[164:167], v[116:119], v[48:51]
    ds_read_b64_tr_b16 a[160:161], v74 offset:16384
    v_mfma_f32_16x16x32_bf16 v[52:55], a[164:167], v[180:183], v[52:55]
    ds_read_b64_tr_b16 a[162:163], v74 offset:18432
    s_add_u32 s48, s49, s31
    v_mfma_f32_16x16x32_bf16 v[56:59], a[164:167], a[172:175], v[56:59]
    ds_read_b128 a[224:227], v83 offset:2048
    v_mfma_f32_16x16x32_bf16 v[0:3], a[144:147], v[120:123], v[0:3]
    ds_read_b64_tr_b16 a[164:165], v74 offset:20480
    v_mfma_f32_16x16x32_bf16 v[4:7], a[144:147], v[184:187], v[4:7]
    ds_read_b64_tr_b16 a[166:167], v74 offset:22528
    s_waitcnt lgkmcnt(7)
    v_mfma_f32_16x16x32_bf16 v[8:11], a[144:147], a[176:179], v[8:11]
    buffer_store_dwordx4 a[220:223], v81, s[16:19], s49 offen sc1
    v_mfma_f32_16x16x32_bf16 v[0:3], a[148:151], v[124:127], v[0:3]
    ds_read_b64_tr_b16 a[144:145], v74 offset:24576
    v_mfma_f32_16x16x32_bf16 v[4:7], a[148:151], v[188:191], v[4:7]
    ds_read_b64_tr_b16 a[146:147], v74 offset:26624
    v_mfma_f32_16x16x32_bf16 v[8:11], a[148:151], a[180:183], v[8:11]
    ds_read_b128 a[228:231], v83 offset:3072
    v_mfma_f32_16x16x32_bf16 v[0:3], a[152:155], v[128:131], v[0:3]
    ds_read_b64_tr_b16 a[148:149], v74 offset:28672
    v_mfma_f32_16x16x32_bf16 v[4:7], a[152:155], v[192:195], v[4:7]
    ds_read_b64_tr_b16 a[150:151], v74 offset:30720
    s_waitcnt lgkmcnt(8)
    v_mfma_f32_16x16x32_bf16 v[8:11], a[152:155], a[184:187], v[8:11]
    ds_read_b128 a[232:235], v83 offset:16384
    v_mfma_f32_16x16x32_bf16 v[0:3], a[156:159], v[132:135], v[0:3]
    ds_read_b64_tr_b16 a[152:153], v75 offset:0
    v_mfma_f32_16x16x32_bf16 v[4:7], a[156:159], v[196:199], v[4:7]
    ds_read_b64_tr_b16 a[154:155], v75 offset:2048
    v_mfma_f32_16x16x32_bf16 v[8:11], a[156:159], a[188:191], v[8:11]
    ds_read_b128 a[236:239], v83 offset:17408
    v_mfma_f32_16x16x32_bf16 v[0:3], a[160:163], v[136:139], v[0:3]
    ds_read_b64_tr_b16 a[156:157], v75 offset:4096
    v_mfma_f32_16x16x32_bf16 v[4:7], a[160:163], v[200:203], v[4:7]
    ds_read_b64_tr_b16 a[158:159], v75 offset:6144
    s_waitcnt lgkmcnt(9)
    v_mfma_f32_16x16x32_bf16 v[8:11], a[160:163], a[192:195], v[8:11]
    buffer_store_dwordx4 a[224:227], v81, s[16:19], s48 offen sc1
    v_mfma_f32_16x16x32_bf16 v[0:3], a[164:167], v[140:143], v[0:3]
    ds_read_b64_tr_b16 a[160:161], v75 offset:8192
    v_mfma_f32_16x16x32_bf16 v[4:7], a[164:167], v[204:207], v[4:7]
    ds_read_b64_tr_b16 a[162:163], v75 offset:10240
    v_mfma_f32_16x16x32_bf16 v[8:11], a[164:167], a[196:199], v[8:11]
    v_mfma_f32_16x16x32_bf16 v[0:3], a[144:147], v[144:147], v[0:3]
    ds_read_b64_tr_b16 a[164:165], v75 offset:12288
    v_mfma_f32_16x16x32_bf16 v[4:7], a[144:147], v[208:211], v[4:7]
    ds_read_b64_tr_b16 a[166:167], v75 offset:14336
    s_waitcnt lgkmcnt(7)
    v_mfma_f32_16x16x32_bf16 v[8:11], a[144:147], v[240:243], v[8:11]
    v_mfma_f32_16x16x32_bf16 v[0:3], a[148:151], v[148:151], v[0:3]
    ds_read_b64_tr_b16 a[144:145], v75 offset:16384
    v_mfma_f32_16x16x32_bf16 v[4:7], a[148:151], v[212:215], v[4:7]
    ds_read_b64_tr_b16 a[146:147], v75 offset:18432
    v_mfma_f32_16x16x32_bf16 v[8:11], a[148:151], v[244:247], v[8:11]
    v_mfma_f32_16x16x32_bf16 v[16:19], a[152:155], v[120:123], v[16:19]
    ds_read_b64_tr_b16 a[148:149], v75 offset:20480
    v_mfma_f32_16x16x32_bf16 v[20:23], a[152:155], v[184:187], v[20:23]
    ds_read_b64_tr_b16 a[150:151], v75 offset:22528
    v_mul_f32 v0, v64, v0
    v_mfma_f32_16x16x32_bf16 v[24:27], a[152:155], a[176:179], v[24:27]
    s_waitcnt lgkmcnt(6)
    v_mul_f32 v1, v64, v1
    v_mul_f32 v2, v64, v2
    v_mfma_f32_16x16x32_bf16 v[16:19], a[156:159], v[124:127], v[16:19]
    ds_read_b64_tr_b16 a[152:153], v75 offset:24576
    v_mul_f32 v3, v64, v3
    v_mfma_f32_16x16x32_bf16 v[20:23], a[156:159], v[188:191], v[20:23]
    ds_read_b64_tr_b16 a[154:155], v75 offset:26624
    v_cvt_pk_bf16_f32 v0, v0, v1
    v_mfma_f32_16x16x32_bf16 v[24:27], a[156:159], a[180:183], v[24:27]
    s_barrier
    v_mfma_f32_16x16x32_bf16 v[16:19], a[160:163], v[128:131], v[16:19]
    ds_read_b64_tr_b16 a[156:157], v75 offset:28672
    v_cvt_pk_bf16_f32 v1, v2, v3
    v_mfma_f32_16x16x32_bf16 v[20:23], a[160:163], v[192:195], v[20:23]
    ds_read_b64_tr_b16 a[158:159], v75 offset:30720
    s_waitcnt lgkmcnt(6)
    v_mfma_f32_16x16x32_bf16 v[24:27], a[160:163], a[184:187], v[24:27]
    ds_write_b64 v82, v[0:1] offset:0
    v_mfma_f32_16x16x32_bf16 v[16:19], a[164:167], v[132:135], v[16:19]
    ds_read_b64_tr_b16 a[160:161], v76 offset:0
    v_mul_f32 v4, v65, v4
    v_mfma_f32_16x16x32_bf16 v[20:23], a[164:167], v[196:199], v[20:23]
    ds_read_b64_tr_b16 a[162:163], v76 offset:2048
    v_mul_f32 v5, v65, v5
    v_mfma_f32_16x16x32_bf16 v[24:27], a[164:167], a[188:191], v[24:27]
    s_xor_b32 s25, s21, 196864
    v_mul_f32 v6, v65, v6
    v_mul_f32 v7, v65, v7
    v_mfma_f32_16x16x32_bf16 v[16:19], a[144:147], v[136:139], v[16:19]
    ds_read_b64_tr_b16 a[164:165], v76 offset:4096
    v_cvt_pk_bf16_f32 v4, v4, v5
    v_mfma_f32_16x16x32_bf16 v[20:23], a[144:147], v[200:203], v[20:23]
    ds_read_b64_tr_b16 a[166:167], v76 offset:6144
    v_cvt_pk_bf16_f32 v5, v6, v7
    v_mfma_f32_16x16x32_bf16 v[24:27], a[144:147], a[192:195], v[24:27]
    s_waitcnt lgkmcnt(7)
    ds_write_b64 v82, v[4:5] offset:2048
    v_mfma_f32_16x16x32_bf16 v[16:19], a[148:151], v[140:143], v[16:19]
    ds_read_b64_tr_b16 a[144:145], v76 offset:8192
    s_add_u32 m0, m0, s95
    v_mfma_f32_16x16x32_bf16 v[20:23], a[148:151], v[204:207], v[20:23]
    ds_read_b64_tr_b16 a[146:147], v76 offset:10240
    s_add_u32 s49, s48, s31
    v_mfma_f32_16x16x32_bf16 v[24:27], a[148:151], a[196:199], v[24:27]
    buffer_load_dwordx4 v79, s[12:15], s25 offen sc0 sc1 lds
    v_mfma_f32_16x16x32_bf16 v[16:19], a[152:155], v[144:147], v[16:19]
    ds_read_b64_tr_b16 a[148:149], v76 offset:12288
    v_mul_f32 v8, v66, v8
    v_mfma_f32_16x16x32_bf16 v[20:23], a[152:155], v[208:211], v[20:23]
    ds_read_b64_tr_b16 a[150:151], v76 offset:14336
    s_waitcnt lgkmcnt(7)
    v_mfma_f32_16x16x32_bf16 v[24:27], a[152:155], v[240:243], v[24:27]
    buffer_store_dwordx4 a[228:231], v81, s[16:19], s49 offen sc1
    v_mfma_f32_16x16x32_bf16 v[16:19], a[156:159], v[148:151], v[16:19]
    ds_read_b64_tr_b16 a[152:153], v76 offset:16384
    s_add_u32 s26, s25, s31
    v_mfma_f32_16x16x32_bf16 v[20:23], a[156:159], v[212:215], v[20:23]
    ds_read_b64_tr_b16 a[154:155], v76 offset:18432
    v_mul_f32 v9, v66, v9
    v_mfma_f32_16x16x32_bf16 v[24:27], a[156:159], v[244:247], v[24:27]
    s_add_u32 m0, m0, s51
    v_mul_f32 v10, v66, v10
    v_mul_f32 v11, v66, v11
    v_mfma_f32_16x16x32_bf16 v[32:35], a[160:163], v[120:123], v[32:35]
    ds_read_b64_tr_b16 a[156:157], v76 offset:20480
    v_cvt_pk_bf16_f32 v8, v8, v9
    v_mfma_f32_16x16x32_bf16 v[36:39], a[160:163], v[184:187], v[36:39]
    ds_read_b64_tr_b16 a[158:159], v76 offset:22528
    s_waitcnt lgkmcnt(6)
    v_mfma_f32_16x16x32_bf16 v[40:43], a[160:163], a[176:179], v[40:43]
    buffer_load_dwordx4 v79, s[12:15], s26 offen sc0 sc1 lds
    v_mfma_f32_16x16x32_bf16 v[32:35], a[164:167], v[124:127], v[32:35]
    ds_read_b64_tr_b16 a[160:161], v76 offset:24576
    v_cvt_pk_bf16_f32 v9, v10, v11
    v_mfma_f32_16x16x32_bf16 v[36:39], a[164:167], v[188:191], v[36:39]
    ds_read_b64_tr_b16 a[162:163], v76 offset:26624
    v_mul_f32 v16, v64, v16
    v_mfma_f32_16x16x32_bf16 v[40:43], a[164:167], a[180:183], v[40:43]
    ds_write_b64 v82, v[8:9] offset:16384
    v_mfma_f32_16x16x32_bf16 v[32:35], a[144:147], v[128:131], v[32:35]
    ds_read_b64_tr_b16 a[164:165], v76 offset:28672
    s_add_u32 s25, s26, s31
    v_mfma_f32_16x16x32_bf16 v[36:39], a[144:147], v[192:195], v[36:39]
    ds_read_b64_tr_b16 a[166:167], v76 offset:30720
    v_xor_b32 v82, 32, v82
    v_mfma_f32_16x16x32_bf16 v[40:43], a[144:147], a[184:187], v[40:43]
    s_waitcnt lgkmcnt(7)
    s_add_u32 m0, m0, s51
    v_mul_f32 v17, v64, v17
    v_mfma_f32_16x16x32_bf16 v[32:35], a[148:151], v[132:135], v[32:35]
    ds_read_b64_tr_b16 a[144:145], v77 offset:0
    v_mul_f32 v18, v64, v18
    v_mfma_f32_16x16x32_bf16 v[36:39], a[148:151], v[196:199], v[36:39]
    ds_read_b64_tr_b16 a[146:147], v77 offset:2048
    v_mul_f32 v19, v64, v19
    v_mfma_f32_16x16x32_bf16 v[40:43], a[148:151], a[188:191], v[40:43]
    buffer_load_dwordx4 v79, s[12:15], s25 offen sc0 sc1 lds
    v_mfma_f32_16x16x32_bf16 v[32:35], a[152:155], v[136:139], v[32:35]
    ds_read_b64_tr_b16 a[148:149], v77 offset:4096
    v_cvt_pk_bf16_f32 v16, v16, v17
    v_mfma_f32_16x16x32_bf16 v[36:39], a[152:155], v[200:203], v[36:39]
    ds_read_b64_tr_b16 a[150:151], v77 offset:6144
    v_cvt_pk_bf16_f32 v17, v18, v19
    v_mfma_f32_16x16x32_bf16 v[40:43], a[152:155], a[192:195], v[40:43]
    s_waitcnt lgkmcnt(7)
    ds_write_b64 v82, v[16:17] offset:0
    v_mfma_f32_16x16x32_bf16 v[32:35], a[156:159], v[140:143], v[32:35]
    ds_read_b64_tr_b16 a[152:153], v77 offset:8192
    s_add_u32 s26, s25, s31
    v_mfma_f32_16x16x32_bf16 v[36:39], a[156:159], v[204:207], v[36:39]
    ds_read_b64_tr_b16 a[154:155], v77 offset:10240
    v_mul_f32 v20, v65, v20
    v_mfma_f32_16x16x32_bf16 v[40:43], a[156:159], a[196:199], v[40:43]
    s_add_u32 m0, m0, s51
    v_mul_f32 v21, v65, v21
    v_mul_f32 v22, v65, v22
    v_mfma_f32_16x16x32_bf16 v[32:35], a[160:163], v[144:147], v[32:35]
    ds_read_b64_tr_b16 a[156:157], v77 offset:12288
    v_mul_f32 v23, v65, v23
    v_mfma_f32_16x16x32_bf16 v[36:39], a[160:163], v[208:211], v[36:39]
    ds_read_b64_tr_b16 a[158:159], v77 offset:14336
    s_waitcnt lgkmcnt(7)
    v_mfma_f32_16x16x32_bf16 v[40:43], a[160:163], v[240:243], v[40:43]
    buffer_load_dwordx4 v79, s[12:15], s26 offen sc0 sc1 lds
    v_mfma_f32_16x16x32_bf16 v[32:35], a[164:167], v[148:151], v[32:35]
    ds_read_b64_tr_b16 a[160:161], v77 offset:16384
    v_cvt_pk_bf16_f32 v20, v20, v21
    v_mfma_f32_16x16x32_bf16 v[36:39], a[164:167], v[212:215], v[36:39]
    ds_read_b64_tr_b16 a[162:163], v77 offset:18432
    v_cvt_pk_bf16_f32 v21, v22, v23
    v_mfma_f32_16x16x32_bf16 v[40:43], a[164:167], v[244:247], v[40:43]
    ds_write_b64 v82, v[20:21] offset:2048
    v_mfma_f32_16x16x32_bf16 v[48:51], a[144:147], v[120:123], v[48:51]
    ds_read_b64_tr_b16 a[164:165], v77 offset:20480
    s_xor_b32 s25, s21, 384
    v_mfma_f32_16x16x32_bf16 v[52:55], a[144:147], v[184:187], v[52:55]
    ds_read_b64_tr_b16 a[166:167], v77 offset:22528
    v_mul_f32 v24, v66, v24
    v_mfma_f32_16x16x32_bf16 v[56:59], a[144:147], a[176:179], v[56:59]
    s_waitcnt lgkmcnt(7)
    s_add_u32 m0, m0, s95
    v_mul_f32 v25, v66, v25
    v_mfma_f32_16x16x32_bf16 v[48:51], a[148:151], v[124:127], v[48:51]
    ds_read_b64_tr_b16 a[144:145], v77 offset:24576
    s_add_u32 s48, s49, s31
    v_mfma_f32_16x16x32_bf16 v[52:55], a[148:151], v[188:191], v[52:55]
    ds_read_b64_tr_b16 a[146:147], v77 offset:26624
    v_mul_f32 v26, v66, v26
    v_mfma_f32_16x16x32_bf16 v[56:59], a[148:151], a[180:183], v[56:59]
    buffer_load_dwordx4 v79, s[12:15], s25 offen sc0 sc1 lds
    v_mfma_f32_16x16x32_bf16 v[48:51], a[152:155], v[128:131], v[48:51]
    ds_read_b64_tr_b16 a[148:149], v77 offset:28672
    s_waitcnt vmcnt(17)
    v_mfma_f32_16x16x32_bf16 v[52:55], a[152:155], v[192:195], v[52:55]
    ds_read_b64_tr_b16 a[150:151], v77 offset:30720
    s_waitcnt lgkmcnt(7)
    v_mfma_f32_16x16x32_bf16 v[56:59], a[152:155], a[184:187], v[56:59]
    buffer_store_dwordx4 a[232:235], v81, s[16:19], s48 offen sc1
    v_mfma_f32_16x16x32_bf16 v[48:51], a[156:159], v[132:135], v[48:51]
    s_waitcnt vmcnt(14)
    s_add_u32 s26, s25, s31
    s_barrier
    ds_read_b64_tr_b16 a[152:153], v74 offset:32768
    v_mul_f32 v27, v66, v27
    v_mfma_f32_16x16x32_bf16 v[52:55], a[156:159], v[196:199], v[52:55]
    ds_read_b64_tr_b16 a[154:155], v74 offset:34816
    v_cvt_pk_bf16_f32 v24, v24, v25
    v_mfma_f32_16x16x32_bf16 v[56:59], a[156:159], a[188:191], v[56:59]
    ds_read_b128 a[48:51], v70 offset:0
    s_add_u32 m0, m0, s51
    v_mfma_f32_16x16x32_bf16 v[48:51], a[160:163], v[136:139], v[48:51]
    ds_read_b64_tr_b16 a[156:157], v74 offset:36864
    v_cvt_pk_bf16_f32 v25, v26, v27
    v_mfma_f32_16x16x32_bf16 v[52:55], a[160:163], v[200:203], v[52:55]
    ds_read_b64_tr_b16 a[158:159], v74 offset:38912
    s_waitcnt lgkmcnt(7)
    v_mfma_f32_16x16x32_bf16 v[56:59], a[160:163], a[192:195], v[56:59]
    ds_write_b64 v82, v[24:25] offset:16384
    v_mfma_f32_16x16x32_bf16 v[48:51], a[164:167], v[140:143], v[48:51]
    ds_read_b64_tr_b16 a[160:161], v74 offset:40960
L_w16:
    s_cbranch_execz L_w20
    v_xor_b32 v82, 96, v82
    v_mfma_f32_16x16x32_bf16 v[52:55], a[164:167], v[204:207], v[52:55]
    ds_read_b64_tr_b16 a[162:163], v74 offset:43008
    v_mul_f32 v32, v64, v32
    v_mfma_f32_16x16x32_bf16 v[56:59], a[164:167], a[196:199], v[56:59]
    buffer_load_dwordx4 v79, s[12:15], s26 offen sc0 sc1 lds
    v_mfma_f32_16x16x32_bf16 v[48:51], a[144:147], v[144:147], v[48:51]
    ds_read_b64_tr_b16 a[164:165], v74 offset:45056
    s_add_u32 s25, s26, s31
    v_mfma_f32_16x16x32_bf16 v[52:55], a[144:147], v[208:211], v[52:55]
    ds_read_b64_tr_b16 a[166:167], v74 offset:47104
    v_mul_f32 v33, v64, v33
    v_mfma_f32_16x16x32_bf16 v[56:59], a[144:147], v[240:243], v[56:59]
    s_waitcnt lgkmcnt(8)
    s_add_u32 m0, m0, s51
    v_mul_f32 v34, v64, v34
    v_mfma_f32_16x16x32_bf16 v[48:51], a[148:151], v[148:151], v[48:51]
    ds_read_b64_tr_b16 a[144:145], v74 offset:49152
    v_mul_f32 v35, v64, v35
    v_mfma_f32_16x16x32_bf16 v[52:55], a[148:151], v[212:215], v[52:55]
    ds_read_b64_tr_b16 a[146:147], v74 offset:51200
    v_cvt_pk_bf16_f32 v32, v32, v33
    v_mfma_f32_16x16x32_bf16 v[56:59], a[148:151], v[244:247], v[56:59]
    buffer_load_dwordx4 v79, s[12:15], s25 offen sc0 sc1 lds
    v_mfma_f32_16x16x32_bf16 v[0:3], a[152:155], v[88:91], 0
    ds_read_b64_tr_b16 a[148:149], v74 offset:53248
    v_cvt_pk_bf16_f32 v33, v34, v35
    v_mfma_f32_16x16x32_bf16 v[4:7], a[152:155], v[152:155], 0
    ds_read_b64_tr_b16 a[150:151], v74 offset:55296
    s_waitcnt lgkmcnt(6)
    v_mfma_f32_16x16x32_bf16 v[8:11], a[152:155], v[216:219], 0
    ds_write_b64 v82, v[32:33] offset:0
    v_mfma_f32_16x16x32_bf16 v[0:3], a[156:159], v[92:95], v[0:3]
    ds_read_b64_tr_b16 a[152:153], v74 offset:57344
    s_add_u32 s26, s25, s31
    v_mfma_f32_16x16x32_bf16 v[4:7], a[156:159], v[156:159], v[4:7]
    ds_read_b64_tr_b16 a[154:155], v74 offset:59392
    v_mul_f32 v36, v65, v36
    v_mfma_f32_16x16x32_bf16 v[8:11], a[156:159], v[220:223], v[8:11]
    ds_read_b128 a[52:55], v71 offset:0
    s_add_u32 m0, m0, s51
    v_mfma_f32_16x16x32_bf16 v[0:3], a[160:163], v[96:99], v[0:3]
    ds_read_b64_tr_b16 a[156:157], v74 offset:61440
    v_mul_f32 v37, v65, v37
    v_mfma_f32_16x16x32_bf16 v[4:7], a[160:163], v[160:163], v[4:7]
    ds_read_b64_tr_b16 a[158:159], v74 offset:63488
    s_waitcnt lgkmcnt(8)
    v_mfma_f32_16x16x32_bf16 v[8:11], a[160:163], v[224:227], v[8:11]
    buffer_load_dwordx4 v79, s[12:15], s26 offen sc0 sc1 lds
    v_mfma_f32_16x16x32_bf16 v[0:3], a[164:167], v[100:103], v[0:3]
    ds_read_b64_tr_b16 a[160:161], v75 offset:32768
    s_add_u32 s43, s42, 16640
    v_mfma_f32_16x16x32_bf16 v[4:7], a[164:167], v[164:167], v[4:7]
    ds_read_b64_tr_b16 a[162:163], v75 offset:34816
    s_add_u32 m0, s44, 114688
    v_mfma_f32_16x16x32_bf16 v[8:11], a[164:167], v[228:231], v[8:11]
    ds_read_b128 a[56:59], v70 offset:2048
    s_add_u32 s49, s48, s31
    v_mfma_f32_16x16x32_bf16 v[0:3], a[144:147], v[104:107], v[0:3]
    ds_read_b64_tr_b16 a[164:165], v75 offset:36864
    v_add_u32 v74, s96, v74
    v_mfma_f32_16x16x32_bf16 v[4:7], a[144:147], v[168:171], v[4:7]
    ds_read_b64_tr_b16 a[166:167], v75 offset:38912
    s_waitcnt lgkmcnt(8)
    v_mfma_f32_16x16x32_bf16 v[8:11], a[144:147], v[232:235], v[8:11]
    buffer_store_dwordx4 a[236:239], v81, s[16:19], s49 offen sc1
    v_mfma_f32_16x16x32_bf16 v[0:3], a[148:151], v[108:111], v[0:3]
    ds_read_b64_tr_b16 a[144:145], v75 offset:40960
    v_mul_f32 v38, v65, v38
    v_mfma_f32_16x16x32_bf16 v[4:7], a[148:151], v[172:175], v[4:7]
    ds_read_b64_tr_b16 a[146:147], v75 offset:43008
    v_mul_f32 v39, v65, v39
    v_mfma_f32_16x16x32_bf16 v[8:11], a[148:151], v[236:239], v[8:11]
    ds_read_b128 a[60:63], v71 offset:2048
    v_cvt_pk_bf16_f32 v36, v36, v37
    v_mfma_f32_16x16x32_bf16 v[0:3], a[152:155], v[112:115], v[0:3]
    ds_read_b64_tr_b16 a[148:149], v75 offset:45056
    v_cvt_pk_bf16_f32 v37, v38, v39
    v_mfma_f32_16x16x32_bf16 v[4:7], a[152:155], v[176:179], v[4:7]
    ds_read_b64_tr_b16 a[150:151], v75 offset:47104
    s_waitcnt lgkmcnt(8)
    v_mfma_f32_16x16x32_bf16 v[8:11], a[152:155], a[168:171], v[8:11]
    ds_write_b64 v82, v[36:37] offset:2048
    v_mfma_f32_16x16x32_bf16 v[0:3], a[156:159], v[116:119], v[0:3]
    ds_read_b64_tr_b16 a[152:153], v75 offset:49152
    v_mul_f32 v40, v66, v40
    v_mfma_f32_16x16x32_bf16 v[4:7], a[156:159], v[180:183], v[4:7]
    ds_read_b64_tr_b16 a[154:155], v75 offset:51200
    v_mul_f32 v41, v66, v41
    v_mfma_f32_16x16x32_bf16 v[8:11], a[156:159], a[172:175], v[8:11]
    v_mul_f32 v42, v66, v42
    v_mul_f32 v43, v66, v43
    v_mfma_f32_16x16x32_bf16 v[16:19], a[160:163], v[88:91], 0
    ds_read_b64_tr_b16 a[156:157], v75 offset:53248
    v_cvt_pk_bf16_f32 v40, v40, v41
    v_mfma_f32_16x16x32_bf16 v[20:23], a[160:163], v[152:155], 0
    ds_read_b64_tr_b16 a[158:159], v75 offset:55296
    v_cvt_pk_bf16_f32 v41, v42, v43
    v_mfma_f32_16x16x32_bf16 v[24:27], a[160:163], v[216:219], 0
    s_waitcnt lgkmcnt(8)
    ds_write_b64 v82, v[40:41] offset:16384
    v_mfma_f32_16x16x32_bf16 v[16:19], a[164:167], v[92:95], v[16:19]
    ds_read_b64_tr_b16 a[160:161], v75 offset:57344
    v_xor_b32 v82, 32, v82
    v_mfma_f32_16x16x32_bf16 v[20:23], a[164:167], v[156:159], v[20:23]
    ds_read_b64_tr_b16 a[162:163], v75 offset:59392
    v_mul_f32 v48, v64, v48
    v_mfma_f32_16x16x32_bf16 v[24:27], a[164:167], v[220:223], v[24:27]
    v_mul_f32 v49, v64, v49
    v_mul_f32 v50, v64, v50
    v_mfma_f32_16x16x32_bf16 v[16:19], a[144:147], v[96:99], v[16:19]
    ds_read_b64_tr_b16 a[164:165], v75 offset:61440
    v_mul_f32 v51, v64, v51
    v_mfma_f32_16x16x32_bf16 v[20:23], a[144:147], v[160:163], v[20:23]
    ds_read_b64_tr_b16 a[166:167], v75 offset:63488
    v_add_u32 v75, s96, v75
    v_mfma_f32_16x16x32_bf16 v[24:27], a[144:147], v[224:227], v[24:27]
    s_waitcnt lgkmcnt(7)
    v_cvt_pk_bf16_f32 v48, v48, v49
    v_cvt_pk_bf16_f32 v49, v50, v51
    v_mfma_f32_16x16x32_bf16 v[16:19], a[148:151], v[100:103], v[16:19]
    ds_read_b64_tr_b16 a[144:145], v76 offset:32768
    v_mul_f32 v52, v65, v52
    v_mfma_f32_16x16x32_bf16 v[20:23], a[148:151], v[164:167], v[20:23]
    ds_read_b64_tr_b16 a[146:147], v76 offset:34816
    v_mul_f32 v53, v65, v53
    v_mfma_f32_16x16x32_bf16 v[24:27], a[148:151], v[228:231], v[24:27]
    buffer_load_dwordx4 v78, s[4:7], s43 offen offset:0 sc0 sc1 nt lds
    v_mfma_f32_16x16x32_bf16 v[16:19], a[152:155], v[104:107], v[16:19]
    ds_read_b64_tr_b16 a[148:149], v76 offset:36864
    s_add_u32 m0, s45, 114688
    v_mfma_f32_16x16x32_bf16 v[20:23], a[152:155], v[168:171], v[20:23]
    ds_read_b64_tr_b16 a[150:151], v76 offset:38912
    s_waitcnt lgkmcnt(6)
    v_mfma_f32_16x16x32_bf16 v[24:27], a[152:155], v[232:235], v[24:27]
    ds_write_b64 v82, v[48:49] offset:0
    v_mfma_f32_16x16x32_bf16 v[16:19], a[156:159], v[108:111], v[16:19]
    ds_read_b64_tr_b16 a[152:153], v76 offset:40960
    s_xor_b32 s3, s46, 128
    v_mfma_f32_16x16x32_bf16 v[20:23], a[156:159], v[172:175], v[20:23]
    ds_read_b64_tr_b16 a[154:155], v76 offset:43008
    s_add_u32 s48, s3, 0
    v_mfma_f32_16x16x32_bf16 v[24:27], a[156:159], v[236:239], v[24:27]
    buffer_load_dwordx4 v72, s[4:7], s43 offen offset:0 sc0 sc1 nt lds
    v_mfma_f32_16x16x32_bf16 v[16:19], a[160:163], v[112:115], v[16:19]
    ds_read_b64_tr_b16 a[156:157], v76 offset:45056
    s_add_u32 m0, s44, 116608
    v_mfma_f32_16x16x32_bf16 v[20:23], a[160:163], v[176:179], v[20:23]
    ds_read_b64_tr_b16 a[158:159], v76 offset:47104
    s_waitcnt lgkmcnt(7)
    v_mfma_f32_16x16x32_bf16 v[24:27], a[160:163], a[168:171], v[24:27]
    buffer_load_dwordx4 v78, s[4:7], s43 offen offset:128 sc0 sc1 nt lds
    v_mfma_f32_16x16x32_bf16 v[16:19], a[164:167], v[116:119], v[16:19]
    ds_read_b64_tr_b16 a[160:161], v76 offset:49152
    s_add_u32 m0, s45, 116608
    v_mfma_f32_16x16x32_bf16 v[20:23], a[164:167], v[180:183], v[20:23]
    ds_read_b64_tr_b16 a[162:163], v76 offset:51200
    v_mul_f32 v54, v65, v54
    v_mfma_f32_16x16x32_bf16 v[24:27], a[164:167], a[172:175], v[24:27]
    buffer_load_dwordx4 v72, s[4:7], s43 offen offset:128 sc0 sc1 nt lds
    v_mfma_f32_16x16x32_bf16 v[32:35], a[144:147], v[88:91], 0
    ds_read_b64_tr_b16 a[164:165], v76 offset:53248
    v_mul_f32 v55, v65, v55
    v_mfma_f32_16x16x32_bf16 v[36:39], a[144:147], v[152:155], 0
    ds_read_b64_tr_b16 a[166:167], v76 offset:55296
    v_cvt_pk_bf16_f32 v52, v52, v53
    v_mfma_f32_16x16x32_bf16 v[40:43], a[144:147], v[216:219], 0
    s_waitcnt lgkmcnt(6)
    v_cvt_pk_bf16_f32 v53, v54, v55
    v_mul_f32 v56, v66, v56
    v_mfma_f32_16x16x32_bf16 v[32:35], a[148:151], v[92:95], v[32:35]
    ds_read_b64_tr_b16 a[144:145], v76 offset:57344
    v_mul_f32 v57, v66, v57
    v_mfma_f32_16x16x32_bf16 v[36:39], a[148:151], v[156:159], v[36:39]
    ds_read_b64_tr_b16 a[146:147], v76 offset:59392
    v_mul_f32 v58, v66, v58
    v_mfma_f32_16x16x32_bf16 v[40:43], a[148:151], v[220:223], v[40:43]
    ds_write_b64 v82, v[52:53] offset:2048
    v_mfma_f32_16x16x32_bf16 v[32:35], a[152:155], v[96:99], v[32:35]
    ds_read_b64_tr_b16 a[148:149], v76 offset:61440
    v_mul_f32 v59, v66, v59
    v_mfma_f32_16x16x32_bf16 v[36:39], a[152:155], v[160:163], v[36:39]
    ds_read_b64_tr_b16 a[150:151], v76 offset:63488
    v_add_u32 v76, s96, v76
    v_mfma_f32_16x16x32_bf16 v[40:43], a[152:155], v[224:227], v[40:43]
    s_waitcnt lgkmcnt(7)
    ds_read_b128 a[240:243], v83 offset:0
    v_mfma_f32_16x16x32_bf16 v[32:35], a[156:159], v[100:103], v[32:35]
    ds_read_b64_tr_b16 a[152:153], v77 offset:32768
    v_cvt_pk_bf16_f32 v56, v56, v57
    v_mfma_f32_16x16x32_bf16 v[36:39], a[156:159], v[164:167], v[36:39]
    ds_read_b64_tr_b16 a[154:155], v77 offset:34816
    v_cvt_pk_bf16_f32 v57, v58, v59
    v_mfma_f32_16x16x32_bf16 v[40:43], a[156:159], v[228:231], v[40:43]
    ds_write_b64 v82, v[56:57] offset:16384
    v_mfma_f32_16x16x32_bf16 v[32:35], a[160:163], v[104:107], v[32:35]
    ds_read_b64_tr_b16 a[156:157], v77 offset:36864
    v_xor_b32 v82, 96, v82
    v_mfma_f32_16x16x32_bf16 v[36:39], a[160:163], v[168:171], v[36:39]
    ds_read_b64_tr_b16 a[158:159], v77 offset:38912
    s_waitcnt lgkmcnt(9)
    v_mfma_f32_16x16x32_bf16 v[40:43], a[160:163], v[232:235], v[40:43]
    s_barrier
    v_mfma_f32_16x16x32_bf16 v[32:35], a[164:167], v[108:111], v[32:35]
    ds_read_b64_tr_b16 a[160:161], v77 offset:40960
    s_xor_b32 s25, s21, 65920
    v_mfma_f32_16x16x32_bf16 v[36:39], a[164:167], v[172:175], v[36:39]
    ds_read_b64_tr_b16 a[162:163], v77 offset:43008
    s_add_u32 m0, s23, 0
    v_mfma_f32_16x16x32_bf16 v[40:43], a[164:167], v[236:239], v[40:43]
    buffer_load_dwordx4 v79, s[12:15], s25 offen sc0 sc1 lds
    v_mfma_f32_16x16x32_bf16 v[32:35], a[144:147], v[112:115], v[32:35]
    ds_read_b64_tr_b16 a[164:165], v77 offset:45056
    s_add_u32 s26, s25, s31
    v_mfma_f32_16x16x32_bf16 v[36:39], a[144:147], v[176:179], v[36:39]
    ds_read_b64_tr_b16 a[166:167], v77 offset:47104
    s_add_u32 m0, m0, s51
    v_mfma_f32_16x16x32_bf16 v[40:43], a[144:147], a[168:171], v[40:43]
    s_waitcnt lgkmcnt(7)
    buffer_load_dwordx4 v79, s[12:15], s26 offen sc0 sc1 lds
    v_mfma_f32_16x16x32_bf16 v[32:35], a[148:151], v[116:119], v[32:35]
    ds_read_b64_tr_b16 a[144:145], v77 offset:49152
    s_add_u32 s25, s26, s31
    v_mfma_f32_16x16x32_bf16 v[36:39], a[148:151], v[180:183], v[36:39]
    ds_read_b64_tr_b16 a[146:147], v77 offset:51200
    s_add_u32 m0, m0, s51
    v_mfma_f32_16x16x32_bf16 v[40:43], a[148:151], a[172:175], v[40:43]
    buffer_store_dwordx4 a[240:243], v81, s[16:19], s48 offen sc1
    v_mfma_f32_16x16x32_bf16 v[48:51], a[152:155], v[88:91], 0
    ds_read_b64_tr_b16 a[148:149], v77 offset:53248
    s_add_u32 s49, s48, s31
    v_mfma_f32_16x16x32_bf16 v[52:55], a[152:155], v[152:155], 0
    ds_read_b64_tr_b16 a[150:151], v77 offset:55296
    s_waitcnt lgkmcnt(6)
    v_mfma_f32_16x16x32_bf16 v[56:59], a[152:155], v[216:219], 0
    buffer_load_dwordx4 v79, s[12:15], s25 offen sc0 sc1 lds
    v_mfma_f32_16x16x32_bf16 v[48:51], a[156:159], v[92:95], v[48:51]
    ds_read_b64_tr_b16 a[152:153], v77 offset:57344
    s_add_u32 s26, s25, s31
    v_mfma_f32_16x16x32_bf16 v[52:55], a[156:159], v[156:159], v[52:55]
    ds_read_b64_tr_b16 a[154:155], v77 offset:59392
    s_add_u32 m0, m0, s51
    v_mfma_f32_16x16x32_bf16 v[56:59], a[156:159], v[220:223], v[56:59]
    buffer_load_dwordx4 v79, s[12:15], s26 offen sc0 sc1 lds
    v_mfma_f32_16x16x32_bf16 v[48:51], a[160:163], v[96:99], v[48:51]
    ds_read_b64_tr_b16 a[156:157], v77 offset:61440
    s_xor_b32 s25, s21, 131456
    v_mfma_f32_16x16x32_bf16 v[52:55], a[160:163], v[160:163], v[52:55]
    ds_read_b64_tr_b16 a[158:159], v77 offset:63488
    s_add_u32 m0, m0, s95
    v_mfma_f32_16x16x32_bf16 v[56:59], a[160:163], v[224:227], v[56:59]
    s_waitcnt lgkmcnt(6)
    ds_read_b128 a[244:247], v83 offset:1024
    v_mfma_f32_16x16x32_bf16 v[48:51], a[164:167], v[100:103], v[48:51]
    buffer_load_dwordx4 v79, s[12:15], s25 offen sc0 sc1 lds
    s_waitcnt vmcnt(16)
    s_add_u32 s26, s25, s31
    s_barrier
    ds_read_b64_tr_b16 a[160:161], v74 offset:16384
    v_add_u32 v77, s96, v77
    v_mfma_f32_16x16x32_bf16 v[52:55], a[164:167], v[164:167], v[52:55]
    ds_read_b64_tr_b16 a[162:163], v74 offset:18432
    s_add_u32 m0, m0, s51
    v_mfma_f32_16x16x32_bf16 v[56:59], a[164:167], v[228:231], v[56:59]
    buffer_load_dwordx4 v79, s[12:15], s26 offen sc0 sc1 lds
    v_mfma_f32_16x16x32_bf16 v[48:51], a[144:147], v[104:107], v[48:51]
    ds_read_b64_tr_b16 a[164:165], v74 offset:20480
    s_add_u32 s25, s26, s31
    v_mfma_f32_16x16x32_bf16 v[52:55], a[144:147], v[168:171], v[52:55]
    ds_read_b64_tr_b16 a[166:167], v74 offset:22528
    s_waitcnt lgkmcnt(7)
    v_mfma_f32_16x16x32_bf16 v[56:59], a[144:147], v[232:235], v[56:59]
    s_add_u32 m0, m0, s51
    v_mfma_f32_16x16x32_bf16 v[48:51], a[148:151], v[108:111], v[48:51]
    ds_read_b64_tr_b16 a[144:145], v74 offset:24576
    v_mfma_f32_16x16x32_bf16 v[52:55], a[148:151], v[172:175], v[52:55]
    ds_read_b64_tr_b16 a[146:147], v74 offset:26624
    v_mfma_f32_16x16x32_bf16 v[56:59], a[148:151], v[236:239], v[56:59]
    buffer_load_dwordx4 v79, s[12:15], s25 offen sc0 sc1 lds
    v_mfma_f32_16x16x32_bf16 v[48:51], a[152:155], v[112:115], v[48:51]
    ds_read_b64_tr_b16 a[148:149], v74 offset:28672
    v_mfma_f32_16x16x32_bf16 v[52:55], a[152:155], v[176:179], v[52:55]
    ds_read_b64_tr_b16 a[150:151], v74 offset:30720
    s_waitcnt lgkmcnt(6)
    v_mfma_f32_16x16x32_bf16 v[56:59], a[152:155], a[168:171], v[56:59]
    buffer_store_dwordx4 a[244:247], v81, s[16:19], s49 offen sc1
    v_mfma_f32_16x16x32_bf16 v[48:51], a[156:159], v[116:119], v[48:51]
    ds_read_b64_tr_b16 a[152:153], v74 offset:32768
    s_add_u32 s26, s25, s31
    v_mfma_f32_16x16x32_bf16 v[52:55], a[156:159], v[180:183], v[52:55]
    ds_read_b64_tr_b16 a[154:155], v74 offset:34816
    v_mfma_f32_16x16x32_bf16 v[56:59], a[156:159], a[172:175], v[56:59]
    ds_read_b128 a[248:251], v83 offset:2048
    s_add_u32 m0, m0, s51
    v_mfma_f32_16x16x32_bf16 v[0:3], a[160:163], v[120:123], v[0:3]
    ds_read_b64_tr_b16 a[156:157], v74 offset:36864
    v_mfma_f32_16x16x32_bf16 v[4:7], a[160:163], v[184:187], v[4:7]
    ds_read_b64_tr_b16 a[158:159], v74 offset:38912
    s_waitcnt lgkmcnt(7)
    v_mfma_f32_16x16x32_bf16 v[8:11], a[160:163], a[176:179], v[8:11]
    buffer_load_dwordx4 v79, s[12:15], s26 offen sc0 sc1 lds
    v_mfma_f32_16x16x32_bf16 v[0:3], a[164:167], v[124:127], v[0:3]
    ds_read_b64_tr_b16 a[160:161], v74 offset:40960
    v_mfma_f32_16x16x32_bf16 v[4:7], a[164:167], v[188:191], v[4:7]
    ds_read_b64_tr_b16 a[162:163], v74 offset:43008
    s_add_u32 s48, s49, s31
    v_mfma_f32_16x16x32_bf16 v[8:11], a[164:167], a[180:183], v[8:11]
    ds_read_b128 a[252:255], v83 offset:3072
    v_mfma_f32_16x16x32_bf16 v[0:3], a[144:147], v[128:131], v[0:3]
    ds_read_b64_tr_b16 a[164:165], v74 offset:45056
    v_mfma_f32_16x16x32_bf16 v[4:7], a[144:147], v[192:195], v[4:7]
    ds_read_b64_tr_b16 a[166:167], v74 offset:47104
    s_waitcnt lgkmcnt(8)
    v_mfma_f32_16x16x32_bf16 v[8:11], a[144:147], a[184:187], v[8:11]
    ds_read_b128 a[200:203], v83 offset:16384
    v_mfma_f32_16x16x32_bf16 v[0:3], a[148:151], v[132:135], v[0:3]
    ds_read_b64_tr_b16 a[144:145], v75 offset:16384
    v_mfma_f32_16x16x32_bf16 v[4:7], a[148:151], v[196:199], v[4:7]
    ds_read_b64_tr_b16 a[146:147], v75 offset:18432
    v_mfma_f32_16x16x32_bf16 v[8:11], a[148:151], a[188:191], v[8:11]
    ds_read_b128 a[204:207], v83 offset:17408
    v_mfma_f32_16x16x32_bf16 v[0:3], a[152:155], v[136:139], v[0:3]
    ds_read_b64_tr_b16 a[148:149], v75 offset:20480
    v_mfma_f32_16x16x32_bf16 v[4:7], a[152:155], v[200:203], v[4:7]
    ds_read_b64_tr_b16 a[150:151], v75 offset:22528
    s_waitcnt lgkmcnt(9)
    v_mfma_f32_16x16x32_bf16 v[8:11], a[152:155], a[192:195], v[8:11]
    buffer_store_dwordx4 a[248:251], v81, s[16:19], s48 offen sc1
    v_mfma_f32_16x16x32_bf16 v[0:3], a[156:159], v[140:143], v[0:3]
    ds_read_b64_tr_b16 a[152:153], v75 offset:24576
    v_mfma_f32_16x16x32_bf16 v[4:7], a[156:159], v[204:207], v[4:7]
    ds_read_b64_tr_b16 a[154:155], v75 offset:26624
    v_mfma_f32_16x16x32_bf16 v[8:11], a[156:159], a[196:199], v[8:11]
    v_mfma_f32_16x16x32_bf16 v[0:3], a[160:163], v[144:147], v[0:3]
    ds_read_b64_tr_b16 a[156:157], v75 offset:28672
    v_mfma_f32_16x16x32_bf16 v[4:7], a[160:163], v[208:211], v[4:7]
    ds_read_b64_tr_b16 a[158:159], v75 offset:30720
    s_waitcnt lgkmcnt(7)
    v_mfma_f32_16x16x32_bf16 v[8:11], a[160:163], v[240:243], v[8:11]
    v_mfma_f32_16x16x32_bf16 v[0:3], a[164:167], v[148:151], v[0:3]
    ds_read_b64_tr_b16 a[160:161], v75 offset:32768
    v_mfma_f32_16x16x32_bf16 v[4:7], a[164:167], v[212:215], v[4:7]
    ds_read_b64_tr_b16 a[162:163], v75 offset:34816
    v_mfma_f32_16x16x32_bf16 v[8:11], a[164:167], v[244:247], v[8:11]
    v_mfma_f32_16x16x32_bf16 v[16:19], a[144:147], v[120:123], v[16:19]
    ds_read_b64_tr_b16 a[164:165], v75 offset:36864
    v_mfma_f32_16x16x32_bf16 v[20:23], a[144:147], v[184:187], v[20:23]
    ds_read_b64_tr_b16 a[166:167], v75 offset:38912
    v_mul_f32 v0, v64, v0
    v_mfma_f32_16x16x32_bf16 v[24:27], a[144:147], a[176:179], v[24:27]
    s_waitcnt lgkmcnt(6)
    v_mul_f32 v1, v64, v1
    v_mul_f32 v2, v64, v2
    v_mfma_f32_16x16x32_bf16 v[16:19], a[148:151], v[124:127], v[16:19]
    ds_read_b64_tr_b16 a[144:145], v75 offset:40960
    v_mul_f32 v3, v64, v3
    v_mfma_f32_16x16x32_bf16 v[20:23], a[148:151], v[188:191], v[20:23]
    ds_read_b64_tr_b16 a[146:147], v75 offset:43008
    v_cvt_pk_bf16_f32 v0, v0, v1
    v_mfma_f32_16x16x32_bf16 v[24:27], a[148:151], a[180:183], v[24:27]
    s_barrier
    v_mfma_f32_16x16x32_bf16 v[16:19], a[152:155], v[128:131], v[16:19]
    ds_read_b64_tr_b16 a[148:149], v75 offset:45056
    v_cvt_pk_bf16_f32 v1, v2, v3
    v_mfma_f32_16x16x32_bf16 v[20:23], a[152:155], v[192:195], v[20:23]
    ds_read_b64_tr_b16 a[150:151], v75 offset:47104
    s_waitcnt lgkmcnt(6)
    v_mfma_f32_16x16x32_bf16 v[24:27], a[152:155], a[184:187], v[24:27]
    ds_write_b64 v82, v[0:1] offset:0
    v_mfma_f32_16x16x32_bf16 v[16:19], a[156:159], v[132:135], v[16:19]
    ds_read_b64_tr_b16 a[152:153], v76 offset:16384
    v_mul_f32 v4, v65, v4
    v_mfma_f32_16x16x32_bf16 v[20:23], a[156:159], v[196:199], v[20:23]
    ds_read_b64_tr_b16 a[154:155], v76 offset:18432
    v_mul_f32 v5, v65, v5
    v_mfma_f32_16x16x32_bf16 v[24:27], a[156:159], a[188:191], v[24:27]
    s_xor_b32 s25, s21, 196992
    v_mul_f32 v6, v65, v6
    v_mul_f32 v7, v65, v7
    v_mfma_f32_16x16x32_bf16 v[16:19], a[160:163], v[136:139], v[16:19]
    ds_read_b64_tr_b16 a[156:157], v76 offset:20480
    v_cvt_pk_bf16_f32 v4, v4, v5
    v_mfma_f32_16x16x32_bf16 v[20:23], a[160:163], v[200:203], v[20:23]
    ds_read_b64_tr_b16 a[158:159], v76 offset:22528
    v_cvt_pk_bf16_f32 v5, v6, v7
    v_mfma_f32_16x16x32_bf16 v[24:27], a[160:163], a[192:195], v[24:27]
    s_waitcnt lgkmcnt(7)
    ds_write_b64 v82, v[4:5] offset:2048
    v_mfma_f32_16x16x32_bf16 v[16:19], a[164:167], v[140:143], v[16:19]
    ds_read_b64_tr_b16 a[160:161], v76 offset:24576
    s_add_u32 m0, m0, s95
    v_mfma_f32_16x16x32_bf16 v[20:23], a[164:167], v[204:207], v[20:23]
    ds_read_b64_tr_b16 a[162:163], v76 offset:26624
    v_mul_f32 v8, v66, v8
    v_mfma_f32_16x16x32_bf16 v[24:27], a[164:167], a[196:199], v[24:27]
    buffer_load_dwordx4 v79, s[12:15], s25 offen sc0 sc1 lds
    v_mfma_f32_16x16x32_bf16 v[16:19], a[144:147], v[144:147], v[16:19]
    ds_read_b64_tr_b16 a[164:165], v76 offset:28672
    v_mul_f32 v9, v66, v9
    v_mfma_f32_16x16x32_bf16 v[20:23], a[144:147], v[208:211], v[20:23]
    ds_read_b64_tr_b16 a[166:167], v76 offset:30720
    v_mul_f32 v10, v66, v10
    v_mfma_f32_16x16x32_bf16 v[24:27], a[144:147], v[240:243], v[24:27]
    s_waitcnt lgkmcnt(7)
    s_add_u32 s26, s25, s31
    v_mul_f32 v11, v66, v11
    v_mfma_f32_16x16x32_bf16 v[16:19], a[148:151], v[148:151], v[16:19]
    ds_read_b64_tr_b16 a[144:145], v76 offset:32768
    v_cvt_pk_bf16_f32 v8, v8, v9
    v_mfma_f32_16x16x32_bf16 v[20:23], a[148:151], v[212:215], v[20:23]
    ds_read_b64_tr_b16 a[146:147], v76 offset:34816
    v_cvt_pk_bf16_f32 v9, v10, v11
    v_mfma_f32_16x16x32_bf16 v[24:27], a[148:151], v[244:247], v[24:27]
    ds_write_b64 v82, v[8:9] offset:16384
    v_mfma_f32_16x16x32_bf16 v[32:35], a[152:155], v[120:123], v[32:35]
    ds_read_b64_tr_b16 a[148:149], v76 offset:36864
    s_add_u32 m0, m0, s51
    v_mfma_f32_16x16x32_bf16 v[36:39], a[152:155], v[184:187], v[36:39]
    ds_read_b64_tr_b16 a[150:151], v76 offset:38912
    s_waitcnt lgkmcnt(7)
    v_mfma_f32_16x16x32_bf16 v[40:43], a[152:155], a[176:179], v[40:43]
    buffer_load_dwordx4 v79, s[12:15], s26 offen sc0 sc1 lds
    v_mfma_f32_16x16x32_bf16 v[32:35], a[156:159], v[124:127], v[32:35]
    ds_read_b64_tr_b16 a[152:153], v76 offset:40960
    v_xor_b32 v82, 32, v82
    v_mfma_f32_16x16x32_bf16 v[36:39], a[156:159], v[188:191], v[36:39]
    ds_read_b64_tr_b16 a[154:155], v76 offset:43008
    v_mul_f32 v16, v64, v16
    v_mfma_f32_16x16x32_bf16 v[40:43], a[156:159], a[180:183], v[40:43]
    s_add_u32 s25, s26, s31
    v_mul_f32 v17, v64, v17
    v_mul_f32 v18, v64, v18
    v_mfma_f32_16x16x32_bf16 v[32:35], a[160:163], v[128:131], v[32:35]
    ds_read_b64_tr_b16 a[156:157], v76 offset:45056
    v_mul_f32 v19, v64, v19
    v_mfma_f32_16x16x32_bf16 v[36:39], a[160:163], v[192:195], v[36:39]
    ds_read_b64_tr_b16 a[158:159], v76 offset:47104
    v_cvt_pk_bf16_f32 v16, v16, v17
    v_mfma_f32_16x16x32_bf16 v[40:43], a[160:163], a[184:187], v[40:43]
    s_waitcnt lgkmcnt(7)
    s_add_u32 m0, m0, s51
    v_cvt_pk_bf16_f32 v17, v18, v19
    v_mfma_f32_16x16x32_bf16 v[32:35], a[164:167], v[132:135], v[32:35]
    ds_read_b64_tr_b16 a[160:161], v77 offset:16384
    s_add_u32 s49, s48, s31
    v_mfma_f32_16x16x32_bf16 v[36:39], a[164:167], v[196:199], v[36:39]
    ds_read_b64_tr_b16 a[162:163], v77 offset:18432
    v_mul_f32 v20, v65, v20
    v_mfma_f32_16x16x32_bf16 v[40:43], a[164:167], a[188:191], v[40:43]
    buffer_store_dwordx4 a[252:255], v81, s[16:19], s49 offen sc1
    v_mfma_f32_16x16x32_bf16 v[32:35], a[144:147], v[136:139], v[32:35]
    ds_read_b64_tr_b16 a[164:165], v77 offset:20480
    v_mul_f32 v21, v65, v21
    v_mfma_f32_16x16x32_bf16 v[36:39], a[144:147], v[200:203], v[36:39]
    ds_read_b64_tr_b16 a[166:167], v77 offset:22528
    s_waitcnt lgkmcnt(6)
    v_mfma_f32_16x16x32_bf16 v[40:43], a[144:147], a[192:195], v[40:43]
    buffer_load_dwordx4 v79, s[12:15], s25 offen sc0 sc1 lds
    v_mfma_f32_16x16x32_bf16 v[32:35], a[148:151], v[140:143], v[32:35]
    ds_read_b64_tr_b16 a[144:145], v77 offset:24576
    s_add_u32 s26, s25, s31
    v_mfma_f32_16x16x32_bf16 v[36:39], a[148:151], v[204:207], v[36:39]
    ds_read_b64_tr_b16 a[146:147], v77 offset:26624
    v_mul_f32 v22, v65, v22
    v_mfma_f32_16x16x32_bf16 v[40:43], a[148:151], a[196:199], v[40:43]
    ds_write_b64 v82, v[16:17] offset:0
    v_mfma_f32_16x16x32_bf16 v[32:35], a[152:155], v[144:147], v[32:35]
    ds_read_b64_tr_b16 a[148:149], v77 offset:28672
    s_add_u32 m0, m0, s51
    v_mfma_f32_16x16x32_bf16 v[36:39], a[152:155], v[208:211], v[36:39]
    ds_read_b64_tr_b16 a[150:151], v77 offset:30720
    s_waitcnt lgkmcnt(7)
    v_mfma_f32_16x16x32_bf16 v[40:43], a[152:155], v[240:243], v[40:43]
    buffer_load_dwordx4 v79, s[12:15], s26 offen sc0 sc1 lds
    v_mfma_f32_16x16x32_bf16 v[32:35], a[156:159], v[148:151], v[32:35]
    ds_read_b64_tr_b16 a[152:153], v77 offset:32768
    v_mul_f32 v23, v65, v23
    v_mfma_f32_16x16x32_bf16 v[36:39], a[156:159], v[212:215], v[36:39]
    ds_read_b64_tr_b16 a[154:155], v77 offset:34816
    v_cvt_pk_bf16_f32 v20, v20, v21
    v_mfma_f32_16x16x32_bf16 v[40:43], a[156:159], v[244:247], v[40:43]
    s_add_u32 s20, s20, 0x40000
    s_or_b32 s20, s20, s79
    v_cvt_pk_bf16_f32 v21, v22, v23
    v_mfma_f32_16x16x32_bf16 v[48:51], a[160:163], v[120:123], v[48:51]
    ds_read_b64_tr_b16 a[156:157], v77 offset:36864
    v_mul_f32 v24, v66, v24
    v_mfma_f32_16x16x32_bf16 v[52:55], a[160:163], v[184:187], v[52:55]
    ds_read_b64_tr_b16 a[158:159], v77 offset:38912
    s_waitcnt lgkmcnt(7)
    v_mfma_f32_16x16x32_bf16 v[56:59], a[160:163], a[176:179], v[56:59]
    ds_write_b64 v82, v[20:21] offset:2048
    v_mfma_f32_16x16x32_bf16 v[48:51], a[164:167], v[124:127], v[48:51]
    ds_read_b64_tr_b16 a[160:161], v77 offset:40960
    v_mul_f32 v25, v66, v25
    v_mfma_f32_16x16x32_bf16 v[52:55], a[164:167], v[188:191], v[52:55]
    ds_read_b64_tr_b16 a[162:163], v77 offset:43008
    v_mul_f32 v26, v66, v26
    v_mfma_f32_16x16x32_bf16 v[56:59], a[164:167], a[180:183], v[56:59]
    s_cmp_lt_u32 s29, 3
    s_cselect_b32 s10, s14, 0
    s_xor_b32 s24, s20, 0
    v_mfma_f32_16x16x32_bf16 v[48:51], a[144:147], v[128:131], v[48:51]
    ds_read_b64_tr_b16 a[164:165], v77 offset:45056
    s_add_u32 m0, s22, 49152
    v_mfma_f32_16x16x32_bf16 v[52:55], a[144:147], v[192:195], v[52:55]
    ds_read_b64_tr_b16 a[166:167], v77 offset:47104
    s_waitcnt lgkmcnt(7)
    v_mfma_f32_16x16x32_bf16 v[56:59], a[144:147], a[184:187], v[56:59]
    buffer_load_dwordx4 v78, s[8:11], s24 offen offset:0 sc0 sc1 lds
    v_mfma_f32_16x16x32_bf16 v[48:51], a[148:151], v[132:135], v[48:51]
    s_waitcnt vmcnt(17)
    s_waitcnt vmcnt(12)
    s_barrier
    ds_read_b64_tr_b16 a[144:145], v74 offset:49152
    v_mul_f32 v27, v66, v27
    v_mfma_f32_16x16x32_bf16 v[52:55], a[148:151], v[196:199], v[52:55]
    ds_read_b64_tr_b16 a[146:147], v74 offset:51200
    v_cvt_pk_bf16_f32 v24, v24, v25
    v_mfma_f32_16x16x32_bf16 v[56:59], a[148:151], a[188:191], v[56:59]
    ds_read_b128 a[80:83], v70 offset:0
    s_add_u32 m0, m0, s50
    v_mfma_f32_16x16x32_bf16 v[48:51], a[152:155], v[136:139], v[48:51]
    ds_read_b64_tr_b16 a[148:149], v74 offset:53248
    s_add_u32 s48, s49, s31
    v_mfma_f32_16x16x32_bf16 v[52:55], a[152:155], v[200:203], v[52:55]
    ds_read_b64_tr_b16 a[150:151], v74 offset:55296
    s_waitcnt lgkmcnt(7)
    v_mfma_f32_16x16x32_bf16 v[56:59], a[152:155], a[192:195], v[56:59]
    buffer_load_dwordx4 v78, s[8:11], s24 offen offset:128 sc0 sc1 lds
    v_mfma_f32_16x16x32_bf16 v[48:51], a[156:159], v[140:143], v[48:51]
    ds_read_b64_tr_b16 a[152:153], v74 offset:57344
    v_cvt_pk_bf16_f32 v25, v26, v27
    v_mfma_f32_16x16x32_bf16 v[52:55], a[156:159], v[204:207], v[52:55]
    ds_read_b64_tr_b16 a[154:155], v74 offset:59392
    v_mul_f32 v32, v64, v32
    v_mfma_f32_16x16x32_bf16 v[56:59], a[156:159], a[196:199], v[56:59]
    ds_write_b64 v82, v[24:25] offset:16384
    v_mfma_f32_16x16x32_bf16 v[48:51], a[160:163], v[144:147], v[48:51]
    ds_read_b64_tr_b16 a[156:157], v74 offset:61440
    v_xor_b32 v82, 96, v82
    v_mfma_f32_16x16x32_bf16 v[52:55], a[160:163], v[208:211], v[52:55]
    ds_read_b64_tr_b16 a[158:159], v74 offset:63488
    s_waitcnt lgkmcnt(8)
    v_mfma_f32_16x16x32_bf16 v[56:59], a[160:163], v[240:243], v[56:59]
    buffer_store_dwordx4 a[200:203], v81, s[16:19], s48 offen sc1
    v_mfma_f32_16x16x32_bf16 v[48:51], a[164:167], v[148:151], v[48:51]
    v_subrev_u32 v74, s96, v74
    ds_read_b64_tr_b16 a[160:161], v74 offset:0
    s_add_u32 m0, m0, s50
    v_mfma_f32_16x16x32_bf16 v[52:55], a[164:167], v[212:215], v[52:55]
    ds_read_b64_tr_b16 a[162:163], v74 offset:2048
    v_mul_f32 v33, v64, v33
    v_mfma_f32_16x16x32_bf16 v[56:59], a[164:167], v[244:247], v[56:59]
    buffer_load_dwordx4 v78, s[8:11], s24 offen offset:256 sc0 sc1 lds
    v_mfma_f32_16x16x32_bf16 v[0:3], a[144:147], v[88:91], 0
    ds_read_b64_tr_b16 a[164:165], v74 offset:4096
    v_mul_f32 v34, v64, v34
    v_mfma_f32_16x16x32_bf16 v[4:7], a[144:147], v[152:155], 0
    ds_read_b64_tr_b16 a[166:167], v74 offset:6144
    v_mul_f32 v35, v64, v35
    v_mfma_f32_16x16x32_bf16 v[8:11], a[144:147], v[216:219], 0
    s_waitcnt lgkmcnt(7)
    ds_read_b128 a[84:87], v71 offset:0
    v_mfma_f32_16x16x32_bf16 v[0:3], a[148:151], v[92:95], v[0:3]
    ds_read_b64_tr_b16 a[144:145], v74 offset:8192
    v_cvt_pk_bf16_f32 v32, v32, v33
    v_mfma_f32_16x16x32_bf16 v[4:7], a[148:151], v[156:159], v[4:7]
    ds_read_b64_tr_b16 a[146:147], v74 offset:10240
    v_cvt_pk_bf16_f32 v33, v34, v35
    v_mfma_f32_16x16x32_bf16 v[8:11], a[148:151], v[220:223], v[8:11]
    s_branch L_pg16
.p2align 12
.fill 512, 4, 0xbf800000
L_pg16:
    ds_write_b64 v82, v[32:33] offset:0
    v_mfma_f32_16x16x32_bf16 v[0:3], a[152:155], v[96:99], v[0:3]
    ds_read_b64_tr_b16 a[148:149], v74 offset:12288
    s_add_u32 m0, m0, s50
    v_mfma_f32_16x16x32_bf16 v[4:7], a[152:155], v[160:163], v[4:7]
    ds_read_b64_tr_b16 a[150:151], v74 offset:14336
L_w17:
    s_cbranch_execz L_w21
    s_waitcnt lgkmcnt(8)
    v_mfma_f32_16x16x32_bf16 v[8:11], a[152:155], v[224:227], v[8:11]
    buffer_load_dwordx4 v78, s[8:11], s24 offen offset:384 sc0 sc1 lds
    v_mfma_f32_16x16x32_bf16 v[0:3], a[156:159], v[100:103], v[0:3]
    ds_read_b64_tr_b16 a[152:153], v75 offset:49152
    v_mul_f32 v36, v65, v36
    v_mfma_f32_16x16x32_bf16 v[4:7], a[156:159], v[164:167], v[4:7]
    ds_read_b64_tr_b16 a[154:155], v75 offset:51200
    v_mul_f32 v37, v65, v37
    v_mfma_f32_16x16x32_bf16 v[8:11], a[156:159], v[228:231], v[8:11]
    ds_read_b128 a[88:91], v70 offset:2048
    v_mul_f32 v38, v65, v38
    v_mfma_f32_16x16x32_bf16 v[0:3], a[160:163], v[104:107], v[0:3]
    ds_read_b64_tr_b16 a[156:157], v75 offset:53248
    v_mul_f32 v39, v65, v39
    v_mfma_f32_16x16x32_bf16 v[4:7], a[160:163], v[168:171], v[4:7]
    ds_read_b64_tr_b16 a[158:159], v75 offset:55296
    s_add_u32 s49, s48, s31
    v_mfma_f32_16x16x32_bf16 v[8:11], a[160:163], v[232:235], v[8:11]
    s_waitcnt lgkmcnt(8)
    ds_read_b128 a[92:95], v71 offset:2048
    v_mfma_f32_16x16x32_bf16 v[0:3], a[164:167], v[108:111], v[0:3]
    ds_read_b64_tr_b16 a[160:161], v75 offset:57344
    v_cvt_pk_bf16_f32 v36, v36, v37
    v_mfma_f32_16x16x32_bf16 v[4:7], a[164:167], v[172:175], v[4:7]
    ds_read_b64_tr_b16 a[162:163], v75 offset:59392
    v_cvt_pk_bf16_f32 v37, v38, v39
    v_mfma_f32_16x16x32_bf16 v[8:11], a[164:167], v[236:239], v[8:11]
    ds_write_b64 v82, v[36:37] offset:2048
    v_mfma_f32_16x16x32_bf16 v[0:3], a[144:147], v[112:115], v[0:3]
    ds_read_b64_tr_b16 a[164:165], v75 offset:61440
    v_mul_f32 v40, v66, v40
    v_mfma_f32_16x16x32_bf16 v[4:7], a[144:147], v[176:179], v[4:7]
    ds_read_b64_tr_b16 a[166:167], v75 offset:63488
    s_waitcnt lgkmcnt(9)
    v_mfma_f32_16x16x32_bf16 v[8:11], a[144:147], a[168:171], v[8:11]
    buffer_store_dwordx4 a[204:207], v81, s[16:19], s49 offen sc1
    v_mfma_f32_16x16x32_bf16 v[0:3], a[148:151], v[116:119], v[0:3]
    v_subrev_u32 v75, s96, v75
    ds_read_b64_tr_b16 a[144:145], v75 offset:0
    v_mul_f32 v41, v66, v41
    v_mfma_f32_16x16x32_bf16 v[4:7], a[148:151], v[180:183], v[4:7]
    ds_read_b64_tr_b16 a[146:147], v75 offset:2048
    v_mul_f32 v42, v66, v42
    v_mfma_f32_16x16x32_bf16 v[8:11], a[148:151], a[172:175], v[8:11]
    v_mul_f32 v43, v66, v43
    v_cvt_pk_bf16_f32 v40, v40, v41
    v_mfma_f32_16x16x32_bf16 v[16:19], a[152:155], v[88:91], 0
    ds_read_b64_tr_b16 a[148:149], v75 offset:4096
    v_cvt_pk_bf16_f32 v41, v42, v43
    v_mfma_f32_16x16x32_bf16 v[20:23], a[152:155], v[152:155], 0
    ds_read_b64_tr_b16 a[150:151], v75 offset:6144
    s_waitcnt lgkmcnt(7)
    v_mfma_f32_16x16x32_bf16 v[24:27], a[152:155], v[216:219], 0
    ds_write_b64 v82, v[40:41] offset:16384
    v_mfma_f32_16x16x32_bf16 v[16:19], a[156:159], v[92:95], v[16:19]
    ds_read_b64_tr_b16 a[152:153], v75 offset:8192
    v_xor_b32 v82, 32, v82
    v_mfma_f32_16x16x32_bf16 v[20:23], a[156:159], v[156:159], v[20:23]
    ds_read_b64_tr_b16 a[154:155], v75 offset:10240
    v_mul_f32 v48, v64, v48
    v_mfma_f32_16x16x32_bf16 v[24:27], a[156:159], v[220:223], v[24:27]
    s_barrier
    v_mfma_f32_16x16x32_bf16 v[16:19], a[160:163], v[96:99], v[16:19]
    ds_read_b64_tr_b16 a[156:157], v75 offset:12288
    v_mul_f32 v49, v64, v49
    v_mfma_f32_16x16x32_bf16 v[20:23], a[160:163], v[160:163], v[20:23]
    ds_read_b64_tr_b16 a[158:159], v75 offset:14336
    v_mul_f32 v50, v64, v50
    v_mfma_f32_16x16x32_bf16 v[24:27], a[160:163], v[224:227], v[24:27]
    s_waitcnt lgkmcnt(7)
    v_mul_f32 v51, v64, v51
    v_cvt_pk_bf16_f32 v48, v48, v49
    v_mfma_f32_16x16x32_bf16 v[16:19], a[164:167], v[100:103], v[16:19]
    ds_read_b64_tr_b16 a[160:161], v76 offset:49152
    v_cvt_pk_bf16_f32 v49, v50, v51
    v_mfma_f32_16x16x32_bf16 v[20:23], a[164:167], v[164:167], v[20:23]
    ds_read_b64_tr_b16 a[162:163], v76 offset:51200
    v_mul_f32 v52, v65, v52
    v_mfma_f32_16x16x32_bf16 v[24:27], a[164:167], v[228:231], v[24:27]
    ds_write_b64 v82, v[48:49] offset:0
    v_mfma_f32_16x16x32_bf16 v[16:19], a[144:147], v[104:107], v[16:19]
    ds_read_b64_tr_b16 a[164:165], v76 offset:53248
    s_add_u32 s24, s24, s59
    v_mfma_f32_16x16x32_bf16 v[20:23], a[144:147], v[168:171], v[20:23]
    ds_read_b64_tr_b16 a[166:167], v76 offset:55296
    v_mul_f32 v53, v65, v53
    v_mfma_f32_16x16x32_bf16 v[24:27], a[144:147], v[232:235], v[24:27]
    s_waitcnt lgkmcnt(7)
    s_add_u32 m0, m0, s94
    v_mul_f32 v54, v65, v54
    v_mfma_f32_16x16x32_bf16 v[16:19], a[148:151], v[108:111], v[16:19]
    ds_read_b64_tr_b16 a[144:145], v76 offset:57344
    v_mul_f32 v55, v65, v55
    v_mfma_f32_16x16x32_bf16 v[20:23], a[148:151], v[172:175], v[20:23]
    ds_read_b64_tr_b16 a[146:147], v76 offset:59392
    v_cvt_pk_bf16_f32 v52, v52, v53
    v_mfma_f32_16x16x32_bf16 v[24:27], a[148:151], v[236:239], v[24:27]
    buffer_load_dwordx4 v78, s[8:11], s24 offen offset:0 sc0 sc1 lds
    v_mfma_f32_16x16x32_bf16 v[16:19], a[152:155], v[112:115], v[16:19]
    ds_read_b64_tr_b16 a[148:149], v76 offset:61440
    v_cvt_pk_bf16_f32 v53, v54, v55
    v_mfma_f32_16x16x32_bf16 v[20:23], a[152:155], v[176:179], v[20:23]
    ds_read_b64_tr_b16 a[150:151], v76 offset:63488
    s_waitcnt lgkmcnt(7)
    v_mfma_f32_16x16x32_bf16 v[24:27], a[152:155], a[168:171], v[24:27]
    ds_write_b64 v82, v[52:53] offset:2048
    v_mfma_f32_16x16x32_bf16 v[16:19], a[156:159], v[116:119], v[16:19]
    v_subrev_u32 v76, s96, v76
    ds_read_b64_tr_b16 a[152:153], v76 offset:0
    v_mul_f32 v56, v66, v56
    v_mfma_f32_16x16x32_bf16 v[20:23], a[156:159], v[180:183], v[20:23]
    ds_read_b64_tr_b16 a[154:155], v76 offset:2048
    v_mul_f32 v57, v66, v57
    v_mfma_f32_16x16x32_bf16 v[24:27], a[156:159], a[172:175], v[24:27]
    ds_read_b128 a[208:211], v83 offset:0
    s_add_u32 m0, m0, s50
    v_mfma_f32_16x16x32_bf16 v[32:35], a[160:163], v[88:91], 0
    ds_read_b64_tr_b16 a[156:157], v76 offset:4096
    s_xor_b32 s3, s46, 256
    v_mfma_f32_16x16x32_bf16 v[36:39], a[160:163], v[152:155], 0
    ds_read_b64_tr_b16 a[158:159], v76 offset:6144
    s_waitcnt lgkmcnt(8)
    v_mfma_f32_16x16x32_bf16 v[40:43], a[160:163], v[216:219], 0
    buffer_load_dwordx4 v78, s[8:11], s24 offen offset:128 sc0 sc1 lds
    v_mfma_f32_16x16x32_bf16 v[32:35], a[164:167], v[92:95], v[32:35]
    ds_read_b64_tr_b16 a[160:161], v76 offset:8192
    s_add_u32 s48, s3, 0
    v_mfma_f32_16x16x32_bf16 v[36:39], a[164:167], v[156:159], v[36:39]
    ds_read_b64_tr_b16 a[162:163], v76 offset:10240
    v_mul_f32 v58, v66, v58
    v_mfma_f32_16x16x32_bf16 v[40:43], a[164:167], v[220:223], v[40:43]
    s_add_u32 m0, m0, s50
    v_mul_f32 v59, v66, v59
    v_cvt_pk_bf16_f32 v56, v56, v57
    v_mfma_f32_16x16x32_bf16 v[32:35], a[144:147], v[96:99], v[32:35]
    ds_read_b64_tr_b16 a[164:165], v76 offset:12288
    v_cvt_pk_bf16_f32 v57, v58, v59
    v_mfma_f32_16x16x32_bf16 v[36:39], a[144:147], v[160:163], v[36:39]
    ds_read_b64_tr_b16 a[166:167], v76 offset:14336
    s_waitcnt lgkmcnt(7)
    v_mfma_f32_16x16x32_bf16 v[40:43], a[144:147], v[224:227], v[40:43]
    ds_write_b64 v82, v[56:57] offset:16384
    v_mfma_f32_16x16x32_bf16 v[32:35], a[148:151], v[100:103], v[32:35]
    ds_read_b64_tr_b16 a[144:145], v77 offset:49152
    v_xor_b32 v82, 96, v82
    v_mfma_f32_16x16x32_bf16 v[36:39], a[148:151], v[164:167], v[36:39]
    ds_read_b64_tr_b16 a[146:147], v77 offset:51200
    v_mfma_f32_16x16x32_bf16 v[40:43], a[148:151], v[228:231], v[40:43]
    buffer_load_dwordx4 v78, s[8:11], s24 offen offset:256 sc0 sc1 lds
    v_mfma_f32_16x16x32_bf16 v[32:35], a[152:155], v[104:107], v[32:35]
    ds_read_b64_tr_b16 a[148:149], v77 offset:53248
    s_add_u32 m0, m0, s50
    v_mfma_f32_16x16x32_bf16 v[36:39], a[152:155], v[168:171], v[36:39]
    ds_read_b64_tr_b16 a[150:151], v77 offset:55296
    s_waitcnt lgkmcnt(7)
    v_mfma_f32_16x16x32_bf16 v[40:43], a[152:155], v[232:235], v[40:43]
    buffer_store_dwordx4 a[208:211], v81, s[16:19], s48 offen sc1
    v_mfma_f32_16x16x32_bf16 v[32:35], a[156:159], v[108:111], v[32:35]
    ds_read_b64_tr_b16 a[152:153], v77 offset:57344
    v_mfma_f32_16x16x32_bf16 v[36:39], a[156:159], v[172:175], v[36:39]
    ds_read_b64_tr_b16 a[154:155], v77 offset:59392
    v_mfma_f32_16x16x32_bf16 v[40:43], a[156:159], v[236:239], v[40:43]
    buffer_load_dwordx4 v78, s[8:11], s24 offen offset:384 sc0 sc1 lds
    v_mfma_f32_16x16x32_bf16 v[32:35], a[160:163], v[112:115], v[32:35]
    ds_read_b64_tr_b16 a[156:157], v77 offset:61440
    s_add_u32 s24, s24, s59
    v_mfma_f32_16x16x32_bf16 v[36:39], a[160:163], v[176:179], v[36:39]
    ds_read_b64_tr_b16 a[158:159], v77 offset:63488
    v_subrev_u32 v77, s96, v77
    v_mfma_f32_16x16x32_bf16 v[40:43], a[160:163], a[168:171], v[40:43]
    s_waitcnt lgkmcnt(6)
    s_add_u32 m0, m0, s94
    v_mfma_f32_16x16x32_bf16 v[32:35], a[164:167], v[116:119], v[32:35]
    ds_read_b64_tr_b16 a[160:161], v77 offset:0
    v_mfma_f32_16x16x32_bf16 v[36:39], a[164:167], v[180:183], v[36:39]
    ds_read_b64_tr_b16 a[162:163], v77 offset:2048
    v_mfma_f32_16x16x32_bf16 v[40:43], a[164:167], a[172:175], v[40:43]
    buffer_load_dwordx4 v78, s[8:11], s24 offen offset:0 sc0 sc1 lds
    v_mfma_f32_16x16x32_bf16 v[48:51], a[144:147], v[88:91], 0
    ds_read_b64_tr_b16 a[164:165], v77 offset:4096
    v_mfma_f32_16x16x32_bf16 v[52:55], a[144:147], v[152:155], 0
    ds_read_b64_tr_b16 a[166:167], v77 offset:6144
    s_add_u32 s49, s48, s31
    v_mfma_f32_16x16x32_bf16 v[56:59], a[144:147], v[216:219], 0
    s_waitcnt lgkmcnt(6)
    ds_read_b128 a[212:215], v83 offset:1024
    v_mfma_f32_16x16x32_bf16 v[48:51], a[148:151], v[92:95], v[48:51]
    ds_read_b64_tr_b16 a[144:145], v77 offset:8192
    v_mfma_f32_16x16x32_bf16 v[52:55], a[148:151], v[156:159], v[52:55]
    ds_read_b64_tr_b16 a[146:147], v77 offset:10240
    v_mfma_f32_16x16x32_bf16 v[56:59], a[148:151], v[220:223], v[56:59]
    s_waitcnt vmcnt(12)
    v_mfma_f32_16x16x32_bf16 v[48:51], a[152:155], v[96:99], v[48:51]
    ds_read_b64_tr_b16 a[148:149], v77 offset:12288
    v_mfma_f32_16x16x32_bf16 v[52:55], a[152:155], v[160:163], v[52:55]
    ds_read_b64_tr_b16 a[150:151], v77 offset:14336
    s_waitcnt lgkmcnt(7)
    v_mfma_f32_16x16x32_bf16 v[56:59], a[152:155], v[224:227], v[56:59]
    s_barrier
    v_mfma_f32_16x16x32_bf16 v[48:51], a[156:159], v[100:103], v[48:51]
    ds_read_b64_tr_b16 a[152:153], v74 offset:16384
    s_add_u32 m0, m0, s50
    v_mfma_f32_16x16x32_bf16 v[52:55], a[156:159], v[164:167], v[52:55]
    ds_read_b64_tr_b16 a[154:155], v74 offset:18432
    v_mfma_f32_16x16x32_bf16 v[56:59], a[156:159], v[228:231], v[56:59]
    buffer_load_dwordx4 v78, s[8:11], s24 offen offset:128 sc0 sc1 lds
    v_mfma_f32_16x16x32_bf16 v[48:51], a[160:163], v[104:107], v[48:51]
    ds_read_b64_tr_b16 a[156:157], v74 offset:20480
    v_mfma_f32_16x16x32_bf16 v[52:55], a[160:163], v[168:171], v[52:55]
    ds_read_b64_tr_b16 a[158:159], v74 offset:22528
    s_waitcnt lgkmcnt(6)
    v_mfma_f32_16x16x32_bf16 v[56:59], a[160:163], v[232:235], v[56:59]
    buffer_store_dwordx4 a[212:215], v81, s[16:19], s49 offen sc1
    v_mfma_f32_16x16x32_bf16 v[48:51], a[164:167], v[108:111], v[48:51]
    ds_read_b64_tr_b16 a[160:161], v74 offset:24576
    s_add_u32 m0, m0, s50
    v_mfma_f32_16x16x32_bf16 v[52:55], a[164:167], v[172:175], v[52:55]
    ds_read_b64_tr_b16 a[162:163], v74 offset:26624
    v_mfma_f32_16x16x32_bf16 v[56:59], a[164:167], v[236:239], v[56:59]
    buffer_load_dwordx4 v78, s[8:11], s24 offen offset:256 sc0 sc1 lds
    v_mfma_f32_16x16x32_bf16 v[48:51], a[144:147], v[112:115], v[48:51]
    ds_read_b64_tr_b16 a[164:165], v74 offset:28672
    v_mfma_f32_16x16x32_bf16 v[52:55], a[144:147], v[176:179], v[52:55]
    ds_read_b64_tr_b16 a[166:167], v74 offset:30720
    s_waitcnt lgkmcnt(6)
    v_mfma_f32_16x16x32_bf16 v[56:59], a[144:147], a[168:171], v[56:59]
    ds_read_b128 a[216:219], v83 offset:2048
    v_mfma_f32_16x16x32_bf16 v[48:51], a[148:151], v[116:119], v[48:51]
    ds_read_b64_tr_b16 a[144:145], v74 offset:32768
    v_mfma_f32_16x16x32_bf16 v[52:55], a[148:151], v[180:183], v[52:55]
    ds_read_b64_tr_b16 a[146:147], v74 offset:34816
    v_mfma_f32_16x16x32_bf16 v[56:59], a[148:151], a[172:175], v[56:59]
    ds_read_b128 a[220:223], v83 offset:3072
    s_add_u32 m0, m0, s50
    v_mfma_f32_16x16x32_bf16 v[0:3], a[152:155], v[120:123], v[0:3]
    ds_read_b64_tr_b16 a[148:149], v74 offset:36864
    v_mfma_f32_16x16x32_bf16 v[4:7], a[152:155], v[184:187], v[4:7]
    ds_read_b64_tr_b16 a[150:151], v74 offset:38912
    s_waitcnt lgkmcnt(8)
    v_mfma_f32_16x16x32_bf16 v[8:11], a[152:155], a[176:179], v[8:11]
    buffer_load_dwordx4 v78, s[8:11], s24 offen offset:384 sc0 sc1 lds
    v_mfma_f32_16x16x32_bf16 v[0:3], a[156:159], v[124:127], v[0:3]
    ds_read_b64_tr_b16 a[152:153], v74 offset:40960
    v_mfma_f32_16x16x32_bf16 v[4:7], a[156:159], v[188:191], v[4:7]
    ds_read_b64_tr_b16 a[154:155], v74 offset:43008
    v_mfma_f32_16x16x32_bf16 v[8:11], a[156:159], a[180:183], v[8:11]
    ds_read_b128 a[224:227], v83 offset:16384
    v_mfma_f32_16x16x32_bf16 v[0:3], a[160:163], v[128:131], v[0:3]
    ds_read_b64_tr_b16 a[156:157], v74 offset:45056
    v_mfma_f32_16x16x32_bf16 v[4:7], a[160:163], v[192:195], v[4:7]
    ds_read_b64_tr_b16 a[158:159], v74 offset:47104
    s_waitcnt lgkmcnt(8)
    v_mfma_f32_16x16x32_bf16 v[8:11], a[160:163], a[184:187], v[8:11]
    ds_read_b128 a[228:231], v83 offset:17408
    v_mfma_f32_16x16x32_bf16 v[0:3], a[164:167], v[132:135], v[0:3]
    ds_read_b64_tr_b16 a[160:161], v75 offset:16384
    v_mfma_f32_16x16x32_bf16 v[4:7], a[164:167], v[196:199], v[4:7]
    ds_read_b64_tr_b16 a[162:163], v75 offset:18432
    s_add_u32 s48, s49, s31
    v_mfma_f32_16x16x32_bf16 v[8:11], a[164:167], a[188:191], v[8:11]
    v_mfma_f32_16x16x32_bf16 v[0:3], a[144:147], v[136:139], v[0:3]
    ds_read_b64_tr_b16 a[164:165], v75 offset:20480
    v_mfma_f32_16x16x32_bf16 v[4:7], a[144:147], v[200:203], v[4:7]
    ds_read_b64_tr_b16 a[166:167], v75 offset:22528
    s_waitcnt lgkmcnt(8)
    v_mfma_f32_16x16x32_bf16 v[8:11], a[144:147], a[192:195], v[8:11]
    v_mfma_f32_16x16x32_bf16 v[0:3], a[148:151], v[140:143], v[0:3]
    ds_read_b64_tr_b16 a[144:145], v75 offset:24576
    v_mfma_f32_16x16x32_bf16 v[4:7], a[148:151], v[204:207], v[4:7]
    ds_read_b64_tr_b16 a[146:147], v75 offset:26624
    v_mfma_f32_16x16x32_bf16 v[8:11], a[148:151], a[196:199], v[8:11]
    buffer_store_dwordx4 a[216:219], v81, s[16:19], s48 offen sc1
    v_mfma_f32_16x16x32_bf16 v[0:3], a[152:155], v[144:147], v[0:3]
    ds_read_b64_tr_b16 a[148:149], v75 offset:28672
    v_mfma_f32_16x16x32_bf16 v[4:7], a[152:155], v[208:211], v[4:7]
    s_branch L_pg17
.p2align 12
.fill 512, 4, 0xbf800000
L_pg17:
    ds_read_b64_tr_b16 a[150:151], v75 offset:30720
    s_waitcnt lgkmcnt(6)
    v_mfma_f32_16x16x32_bf16 v[8:11], a[152:155], v[240:243], v[8:11]
L_w18:
    s_cbranch_execz L_w22
    v_mfma_f32_16x16x32_bf16 v[0:3], a[156:159], v[148:151], v[0:3]
    ds_read_b64_tr_b16 a[152:153], v75 offset:32768
    v_mfma_f32_16x16x32_bf16 v[4:7], a[156:159], v[212:215], v[4:7]
    ds_read_b64_tr_b16 a[154:155], v75 offset:34816
    v_mfma_f32_16x16x32_bf16 v[8:11], a[156:159], v[244:247], v[8:11]
    v_mfma_f32_16x16x32_bf16 v[16:19], a[160:163], v[120:123], v[16:19]
    ds_read_b64_tr_b16 a[156:157], v75 offset:36864
    v_mfma_f32_16x16x32_bf16 v[20:23], a[160:163], v[184:187], v[20:23]
    ds_read_b64_tr_b16 a[158:159], v75 offset:38912
    v_mul_f32 v0, v64, v0
    v_mfma_f32_16x16x32_bf16 v[24:27], a[160:163], a[176:179], v[24:27]
    s_waitcnt lgkmcnt(6)
    v_mul_f32 v1, v64, v1
    v_mul_f32 v2, v64, v2
    v_mfma_f32_16x16x32_bf16 v[16:19], a[164:167], v[124:127], v[16:19]
    ds_read_b64_tr_b16 a[160:161], v75 offset:40960
    v_mul_f32 v3, v64, v3
    v_mfma_f32_16x16x32_bf16 v[20:23], a[164:167], v[188:191], v[20:23]
    ds_read_b64_tr_b16 a[162:163], v75 offset:43008
    v_cvt_pk_bf16_f32 v0, v0, v1
    v_mfma_f32_16x16x32_bf16 v[24:27], a[164:167], a[180:183], v[24:27]
    s_barrier
    v_mfma_f32_16x16x32_bf16 v[16:19], a[144:147], v[128:131], v[16:19]
    ds_read_b64_tr_b16 a[164:165], v75 offset:45056
    v_cvt_pk_bf16_f32 v1, v2, v3
    v_mfma_f32_16x16x32_bf16 v[20:23], a[144:147], v[192:195], v[20:23]
    ds_read_b64_tr_b16 a[166:167], v75 offset:47104
    s_waitcnt lgkmcnt(6)
    v_mfma_f32_16x16x32_bf16 v[24:27], a[144:147], a[184:187], v[24:27]
    ds_write_b64 v82, v[0:1] offset:0
    v_mfma_f32_16x16x32_bf16 v[16:19], a[148:151], v[132:135], v[16:19]
    ds_read_b64_tr_b16 a[144:145], v76 offset:16384
    v_mul_f32 v4, v65, v4
    v_mfma_f32_16x16x32_bf16 v[20:23], a[148:151], v[196:199], v[20:23]
    ds_read_b64_tr_b16 a[146:147], v76 offset:18432
    v_mul_f32 v5, v65, v5
    v_mfma_f32_16x16x32_bf16 v[24:27], a[148:151], a[188:191], v[24:27]
    s_add_u32 s24, s24, s59
    v_mul_f32 v6, v65, v6
    v_mul_f32 v7, v65, v7
    v_mfma_f32_16x16x32_bf16 v[16:19], a[152:155], v[136:139], v[16:19]
    ds_read_b64_tr_b16 a[148:149], v76 offset:20480
    v_cvt_pk_bf16_f32 v4, v4, v5
    v_mfma_f32_16x16x32_bf16 v[20:23], a[152:155], v[200:203], v[20:23]
    ds_read_b64_tr_b16 a[150:151], v76 offset:22528
    v_cvt_pk_bf16_f32 v5, v6, v7
    v_mfma_f32_16x16x32_bf16 v[24:27], a[152:155], a[192:195], v[24:27]
    s_waitcnt lgkmcnt(7)
    ds_write_b64 v82, v[4:5] offset:2048
    v_mfma_f32_16x16x32_bf16 v[16:19], a[156:159], v[140:143], v[16:19]
    ds_read_b64_tr_b16 a[152:153], v76 offset:24576
    s_add_u32 m0, s22, 0
    v_mfma_f32_16x16x32_bf16 v[20:23], a[156:159], v[204:207], v[20:23]
    ds_read_b64_tr_b16 a[154:155], v76 offset:26624
    v_mul_f32 v8, v66, v8
    v_mfma_f32_16x16x32_bf16 v[24:27], a[156:159], a[196:199], v[24:27]
    buffer_load_dwordx4 v78, s[8:11], s24 offen offset:0 sc0 sc1 lds
    v_mfma_f32_16x16x32_bf16 v[16:19], a[160:163], v[144:147], v[16:19]
    ds_read_b64_tr_b16 a[156:157], v76 offset:28672
    v_mul_f32 v9, v66, v9
    v_mfma_f32_16x16x32_bf16 v[20:23], a[160:163], v[208:211], v[20:23]
    ds_read_b64_tr_b16 a[158:159], v76 offset:30720
    v_mul_f32 v10, v66, v10
    v_mfma_f32_16x16x32_bf16 v[24:27], a[160:163], v[240:243], v[24:27]
    s_waitcnt lgkmcnt(7)
    v_mul_f32 v11, v66, v11
    v_cvt_pk_bf16_f32 v8, v8, v9
    v_mfma_f32_16x16x32_bf16 v[16:19], a[164:167], v[148:151], v[16:19]
    ds_read_b64_tr_b16 a[160:161], v76 offset:32768
    v_cvt_pk_bf16_f32 v9, v10, v11
    v_mfma_f32_16x16x32_bf16 v[20:23], a[164:167], v[212:215], v[20:23]
    ds_read_b64_tr_b16 a[162:163], v76 offset:34816
    s_add_u32 m0, m0, s50
    v_mfma_f32_16x16x32_bf16 v[24:27], a[164:167], v[244:247], v[24:27]
    ds_write_b64 v82, v[8:9] offset:16384
    v_mfma_f32_16x16x32_bf16 v[32:35], a[144:147], v[120:123], v[32:35]
    ds_read_b64_tr_b16 a[164:165], v76 offset:36864
    v_xor_b32 v82, 32, v82
    v_mfma_f32_16x16x32_bf16 v[36:39], a[144:147], v[184:187], v[36:39]
    ds_read_b64_tr_b16 a[166:167], v76 offset:38912
    s_waitcnt lgkmcnt(7)
    v_mfma_f32_16x16x32_bf16 v[40:43], a[144:147], a[176:179], v[40:43]
    buffer_load_dwordx4 v78, s[8:11], s24 offen offset:128 sc0 sc1 lds
    v_mfma_f32_16x16x32_bf16 v[32:35], a[148:151], v[124:127], v[32:35]
    ds_read_b64_tr_b16 a[144:145], v76 offset:40960
    s_add_u32 s49, s48, s31
    v_mfma_f32_16x16x32_bf16 v[36:39], a[148:151], v[188:191], v[36:39]
    ds_read_b64_tr_b16 a[146:147], v76 offset:43008
    v_mul_f32 v16, v64, v16
    v_mfma_f32_16x16x32_bf16 v[40:43], a[148:151], a[180:183], v[40:43]
    buffer_store_dwordx4 a[220:223], v81, s[16:19], s49 offen sc1
    v_mfma_f32_16x16x32_bf16 v[32:35], a[152:155], v[128:131], v[32:35]
    ds_read_b64_tr_b16 a[148:149], v76 offset:45056
    v_mul_f32 v17, v64, v17
    v_mfma_f32_16x16x32_bf16 v[36:39], a[152:155], v[192:195], v[36:39]
    ds_read_b64_tr_b16 a[150:151], v76 offset:47104
    v_mul_f32 v18, v64, v18
    v_mfma_f32_16x16x32_bf16 v[40:43], a[152:155], a[184:187], v[40:43]
    s_waitcnt lgkmcnt(7)
    s_add_u32 m0, m0, s50
    v_mul_f32 v19, v64, v19
    v_mfma_f32_16x16x32_bf16 v[32:35], a[156:159], v[132:135], v[32:35]
    ds_read_b64_tr_b16 a[152:153], v77 offset:16384
    v_cvt_pk_bf16_f32 v16, v16, v17
    v_mfma_f32_16x16x32_bf16 v[36:39], a[156:159], v[196:199], v[36:39]
    ds_read_b64_tr_b16 a[154:155], v77 offset:18432
    v_cvt_pk_bf16_f32 v17, v18, v19
    v_mfma_f32_16x16x32_bf16 v[40:43], a[156:159], a[188:191], v[40:43]
    buffer_load_dwordx4 v78, s[8:11], s24 offen offset:256 sc0 sc1 lds
    v_mfma_f32_16x16x32_bf16 v[32:35], a[160:163], v[136:139], v[32:35]
    ds_read_b64_tr_b16 a[156:157], v77 offset:20480
    v_mul_f32 v20, v65, v20
    v_mfma_f32_16x16x32_bf16 v[36:39], a[160:163], v[200:203], v[36:39]
    ds_read_b64_tr_b16 a[158:159], v77 offset:22528
    s_waitcnt lgkmcnt(6)
    v_mfma_f32_16x16x32_bf16 v[40:43], a[160:163], a[192:195], v[40:43]
    ds_write_b64 v82, v[16:17] offset:0
    v_mfma_f32_16x16x32_bf16 v[32:35], a[164:167], v[140:143], v[32:35]
    ds_read_b64_tr_b16 a[160:161], v77 offset:24576
    v_mul_f32 v21, v65, v21
    v_mfma_f32_16x16x32_bf16 v[36:39], a[164:167], v[204:207], v[36:39]
    ds_read_b64_tr_b16 a[162:163], v77 offset:26624
    v_mul_f32 v22, v65, v22
    v_mfma_f32_16x16x32_bf16 v[40:43], a[164:167], a[196:199], v[40:43]
    s_add_u32 m0, m0, s50
    v_mul_f32 v23, v65, v23
    v_cvt_pk_bf16_f32 v20, v20, v21
    v_mfma_f32_16x16x32_bf16 v[32:35], a[144:147], v[144:147], v[32:35]
    buffer_load_dwordx4 v78, s[8:11], s24 offen offset:384 sc0 sc1 lds
    v_mfma_f32_16x16x32_bf16 v[36:39], a[144:147], v[208:211], v[36:39]
    s_waitcnt lgkmcnt(5)
    v_cvt_pk_bf16_f32 v21, v22, v23
    v_mul_f32 v24, v66, v24
    v_mfma_f32_16x16x32_bf16 v[40:43], a[144:147], v[240:243], v[40:43]
    ds_write_b64 v82, v[20:21] offset:2048
    v_mfma_f32_16x16x32_bf16 v[32:35], a[148:151], v[148:151], v[32:35]
    ds_read_b64_tr_b16 a[144:145], v77 offset:28672
    v_mul_f32 v25, v66, v25
    v_mfma_f32_16x16x32_bf16 v[36:39], a[148:151], v[212:215], v[36:39]
    ds_read_b64_tr_b16 a[146:147], v77 offset:30720
    v_mul_f32 v26, v66, v26
    v_mfma_f32_16x16x32_bf16 v[40:43], a[148:151], v[244:247], v[40:43]
    v_mul_f32 v27, v66, v27
    v_cvt_pk_bf16_f32 v24, v24, v25
    v_mfma_f32_16x16x32_bf16 v[48:51], a[152:155], v[120:123], v[48:51]
    ds_read_b64_tr_b16 a[148:149], v77 offset:32768
    v_cvt_pk_bf16_f32 v25, v26, v27
    v_mfma_f32_16x16x32_bf16 v[52:55], a[152:155], v[184:187], v[52:55]
    ds_read_b64_tr_b16 a[150:151], v77 offset:34816
    s_waitcnt lgkmcnt(5)
    v_mfma_f32_16x16x32_bf16 v[56:59], a[152:155], a[176:179], v[56:59]
    ds_write_b64 v82, v[24:25] offset:16384
    v_mfma_f32_16x16x32_bf16 v[48:51], a[156:159], v[124:127], v[48:51]
    ds_read_b64_tr_b16 a[152:153], v77 offset:36864
    v_xor_b32 v82, 96, v82
    v_mfma_f32_16x16x32_bf16 v[52:55], a[156:159], v[188:191], v[52:55]
    ds_read_b64_tr_b16 a[154:155], v77 offset:38912
    v_mul_f32 v32, v64, v32
    v_mfma_f32_16x16x32_bf16 v[56:59], a[156:159], a[180:183], v[56:59]
    s_waitcnt vmcnt(17)
    v_mul_f32 v33, v64, v33
    v_mul_f32 v34, v64, v34
    v_mfma_f32_16x16x32_bf16 v[48:51], a[160:163], v[128:131], v[48:51]
    ds_read_b64_tr_b16 a[156:157], v77 offset:40960
    v_mul_f32 v35, v64, v35
    v_mfma_f32_16x16x32_bf16 v[52:55], a[160:163], v[192:195], v[52:55]
    ds_read_b64_tr_b16 a[158:159], v77 offset:43008
    v_cvt_pk_bf16_f32 v32, v32, v33
    v_mfma_f32_16x16x32_bf16 v[56:59], a[160:163], a[184:187], v[56:59]
    s_waitcnt lgkmcnt(5)
    v_cvt_pk_bf16_f32 v33, v34, v35
    v_mul_f32 v36, v65, v36
    v_mfma_f32_16x16x32_bf16 v[48:51], a[144:147], v[132:135], v[48:51]
    ds_read_b64_tr_b16 a[160:161], v77 offset:45056
    v_mul_f32 v37, v65, v37
    v_mfma_f32_16x16x32_bf16 v[52:55], a[144:147], v[196:199], v[52:55]
    ds_read_b64_tr_b16 a[162:163], v77 offset:47104
    v_mul_f32 v38, v65, v38
    v_mfma_f32_16x16x32_bf16 v[56:59], a[144:147], a[188:191], v[56:59]
    ds_write_b64 v82, v[32:33] offset:0
    v_mfma_f32_16x16x32_bf16 v[48:51], a[148:151], v[136:139], v[48:51]
    s_barrier
    ds_read_b128 a[144:147], v68 offset:49152
    s_add_u32 s48, s49, s31
    v_mfma_f32_16x16x32_bf16 v[52:55], a[148:151], v[200:203], v[52:55]
    buffer_store_dwordx4 a[224:227], v81, s[16:19], s48 offen sc1
    v_mfma_f32_16x16x32_bf16 v[56:59], a[148:151], a[192:195], v[56:59]
    s_waitcnt lgkmcnt(4)
    v_mul_f32 v39, v65, v39
    v_cvt_pk_bf16_f32 v36, v36, v37
    v_mfma_f32_16x16x32_bf16 v[48:51], a[152:155], v[140:143], v[48:51]
    ds_read_b128 a[148:151], v69 offset:49152
    v_cvt_pk_bf16_f32 v37, v38, v39
    v_mfma_f32_16x16x32_bf16 v[52:55], a[152:155], v[204:207], v[52:55]
    ds_write_b64 v82, v[36:37] offset:2048
    v_mfma_f32_16x16x32_bf16 v[56:59], a[152:155], a[196:199], v[56:59]
    v_mul_f32 v40, v66, v40
    v_mul_f32 v41, v66, v41
    v_mfma_f32_16x16x32_bf16 v[48:51], a[156:159], v[144:147], v[48:51]
    ds_read_b128 a[152:155], v68 offset:53248
    v_mul_f32 v42, v66, v42
    v_mfma_f32_16x16x32_bf16 v[52:55], a[156:159], v[208:211], v[52:55]
    s_waitcnt lgkmcnt(3)
    v_mul_f32 v43, v66, v43
    v_cvt_pk_bf16_f32 v40, v40, v41
    v_mfma_f32_16x16x32_bf16 v[56:59], a[156:159], v[240:243], v[56:59]
    v_cvt_pk_bf16_f32 v41, v42, v43
    v_mfma_f32_16x16x32_bf16 v[48:51], a[160:163], v[148:151], v[48:51]
    ds_read_b128 a[156:159], v69 offset:53248
    v_mfma_f32_16x16x32_bf16 v[52:55], a[160:163], v[212:215], v[52:55]
    ds_write_b64 v82, v[40:41] offset:16384
    v_mfma_f32_16x16x32_bf16 v[56:59], a[160:163], v[244:247], v[56:59]
    v_xor_b32 v82, 32, v82
    s_add_u32 s29, s29, 1
    s_cmp_lg_u32 s29, 4
    s_cbranch_scc1 L_segA
    s_waitcnt lgkmcnt(0)
    s_nop 7
    s_nop 1
    s_xor_b32 s3, s46, 384
    s_xor_b32 s49, s46, 256
    s_add_u32 s49, s49, 20480
    buffer_store_dwordx4 a[228:231], v81, s[16:19], s49 offen sc1
    v_mul_f32 v48, v64, v48
    v_mul_f32 v49, v64, v49
    v_mul_f32 v50, v64, v50
    v_mul_f32 v51, v64, v51
    v_cvt_pk_bf16_f32 v48, v48, v49
    v_cvt_pk_bf16_f32 v49, v50, v51
    ds_write_b64 v82, v[48:49] offset:0
    ds_read_b128 a[0:3], v83 offset:0
    ds_read_b128 a[4:7], v83 offset:1024
    v_mul_f32 v52, v65, v52
    v_mul_f32 v53, v65, v53
    v_mul_f32 v54, v65, v54
    v_mul_f32 v55, v65, v55
    v_cvt_pk_bf16_f32 v52, v52, v53
    v_cvt_pk_bf16_f32 v53, v54, v55
    ds_write_b64 v82, v[52:53] offset:2048
    ds_read_b128 a[8:11], v83 offset:2048
    ds_read_b128 a[12:15], v83 offset:3072
    s_add_u32 s48, s3, 0
    s_waitcnt lgkmcnt(4)
    buffer_store_dwordx4 a[0:3], v81, s[16:19], s48 offen sc1
    s_add_u32 s49, s3, 4096
    s_waitcnt lgkmcnt(3)
    buffer_store_dwordx4 a[4:7], v81, s[16:19], s49 offen sc1
    v_mul_f32 v56, v66, v56
    v_mul_f32 v57, v66, v57
    v_mul_f32 v58, v66, v58
    v_mul_f32 v59, v66, v59
    v_cvt_pk_bf16_f32 v56, v56, v57
    v_cvt_pk_bf16_f32 v57, v58, v59
    ds_write_b64 v82, v[56:57] offset:16384
    ds_read_b128 a[16:19], v83 offset:16384
    ds_read_b128 a[20:23], v83 offset:17408
    s_add_u32 s48, s3, 8192
    s_waitcnt lgkmcnt(4)
    buffer_store_dwordx4 a[8:11], v81, s[16:19], s48 offen sc1
    s_add_u32 s49, s3, 12288
    s_waitcnt lgkmcnt(3)
    buffer_store_dwordx4 a[12:15], v81, s[16:19], s49 offen sc1
    v_xor_b32 v82, 96, v82
    s_add_u32 s48, s3, 16384
    s_waitcnt lgkmcnt(1)
    buffer_store_dwordx4 a[16:19], v81, s[16:19], s48 offen sc1
    s_add_u32 s49, s3, 20480
    s_waitcnt lgkmcnt(0)
    buffer_store_dwordx4 a[20:23], v81, s[16:19], s49 offen sc1
L_fin:
    s_cmp_lg_u32 s30, 0
    s_cbranch_scc1 L_slow
    s_endpgm
L_slow:
    s_waitcnt vmcnt(0) lgkmcnt(0)
    v_mbcnt_lo_u32_b32 v100, -1, 0
    v_mbcnt_hi_u32_b32 v100, -1, v100
    v_and_b32 v106, 15, v100
    v_lshlrev_b32 v106, 9, v106
    v_lshrrev_b32 v100, 4, v100
    v_lshl_add_u32 v101, v100, 4, v106
    v_lshl_add_u32 v102, v100, 3, v106
    s_lshl_b32 s56, s70, 14
    v_subrev_u32 v103, s56, v79
    s_add_u32 s56, s23, 114688
    v_add_u32 v74, s56, v74
    s_add_u32 s56, s23, 114688
    v_add_u32 v75, s56, v75
    s_add_u32 s56, s23, 114688
    v_add_u32 v76, s56, v76
    s_add_u32 s56, s23, 114688
    v_add_u32 v77, s56, v77
    s_mov_b32 s10, s14
    s_mov_b32 s29, 0
L_sp_pass:
    s_bitcmp1_b32 s30, 3
    s_cbranch_scc0 L_sp_next
    s_mov_b32 s6, s64
    s_mov_b32 s18, s64
    s_add_u32 s56, s69, s29
    s_and_b32 s56, s56, 1
    s_sub_u32 s57, 4, s56
    s_mov_b32 s42, s60
L_sp_qb:
    buffer_load_dwordx4 a[0:3], v101, s[4:7], s42 offen offset:0
    buffer_load_dwordx4 a[4:7], v101, s[4:7], s42 offen offset:64
    buffer_load_dwordx4 a[8:11], v101, s[4:7], s42 offen offset:128
    buffer_load_dwordx4 a[12:15], v101, s[4:7], s42 offen offset:192
    buffer_load_dwordx4 a[16:19], v101, s[4:7], s42 offen offset:256
    buffer_load_dwordx4 a[20:23], v101, s[4:7], s42 offen offset:320
    buffer_load_dwordx4 a[24:27], v101, s[4:7], s42 offen offset:384
    buffer_load_dwordx4 a[28:31], v101, s[4:7], s42 offen offset:448
    v_mov_b32 v104, 0xff800000
    s_mov_b32 s24, s68
    s_mov_b32 s58, 0
L_sp_max:
    buffer_load_dwordx4 v[128:131], v101, s[8:11], s24 offen offset:0
    buffer_load_dwordx4 v[132:135], v101, s[8:11], s24 offen offset:64
    buffer_load_dwordx4 v[136:139], v101, s[8:11], s24 offen offset:128
    buffer_load_dwordx4 v[140:143], v101, s[8:11], s24 offen offset:192
    buffer_load_dwordx4 v[144:147], v101, s[8:11], s24 offen offset:256
    buffer_load_dwordx4 v[148:151], v101, s[8:11], s24 offen offset:320
    buffer_load_dwordx4 v[152:155], v101, s[8:11], s24 offen offset:384
    buffer_load_dwordx4 v[156:159], v101, s[8:11], s24 offen offset:448
    s_waitcnt vmcnt(0)
    v_mfma_f32_16x16x32_bf16 v[108:111], v[128:131], a[0:3], 0
    v_mfma_f32_16x16x32_bf16 v[108:111], v[132:135], a[4:7], v[108:111]
    v_mfma_f32_16x16x32_bf16 v[108:111], v[136:139], a[8:11], v[108:111]
    v_mfma_f32_16x16x32_bf16 v[108:111], v[140:143], a[12:15], v[108:111]
    v_mfma_f32_16x16x32_bf16 v[108:111], v[144:147], a[16:19], v[108:111]
    v_mfma_f32_16x16x32_bf16 v[108:111], v[148:151], a[20:23], v[108:111]
    v_mfma_f32_16x16x32_bf16 v[108:111], v[152:155], a[24:27], v[108:111]
    v_mfma_f32_16x16x32_bf16 v[108:111], v[156:159], a[28:31], v[108:111]
    s_add_u32 s24, s24, 8192
    s_nop 7
    s_nop 1
    v_max3_f32 v104, v104, v108, v109
    v_max3_f32 v104, v104, v110, v111
    s_add_u32 s58, s58, 1
    s_cmp_lt_u32 s58, 32
    s_cbranch_scc1 L_sp_max
    v_mov_b32 v106, v104
    s_nop 1
    v_permlane32_swap_b32 v104, v106
    s_nop 1
    v_max_f32 v104, v104, v106
    v_mov_b32 v106, v104
    s_nop 1
    v_permlane16_swap_b32 v104, v106
    s_nop 1
    v_max_f32 v104, v104, v106
    v_mul_f32_e64 v104, -v104, s27
    v_mov_b32 v105, 0
    v_mov_b32 v0, 0
    v_mov_b32 v1, 0
    v_mov_b32 v2, 0
    v_mov_b32 v3, 0
    v_mov_b32 v4, 0
    v_mov_b32 v5, 0
    v_mov_b32 v6, 0
    v_mov_b32 v7, 0
    v_mov_b32 v8, 0
    v_mov_b32 v9, 0
    v_mov_b32 v10, 0
    v_mov_b32 v11, 0
    v_mov_b32 v12, 0
    v_mov_b32 v13, 0
    v_mov_b32 v14, 0
    v_mov_b32 v15, 0
    v_mov_b32 v16, 0
    v_mov_b32 v17, 0
    v_mov_b32 v18, 0
    v_mov_b32 v19, 0
    v_mov_b32 v20, 0
    v_mov_b32 v21, 0
    v_mov_b32 v22, 0
    v_mov_b32 v23, 0
    v_mov_b32 v24, 0
    v_mov_b32 v25, 0
    v_mov_b32 v26, 0
    v_mov_b32 v27, 0
    v_mov_b32 v28, 0
    v_mov_b32 v29, 0
    v_mov_b32 v30, 0
    v_mov_b32 v31, 0
    v_mov_b32 v32, 0
    v_mov_b32 v33, 0
    v_mov_b32 v34, 0
    v_mov_b32 v35, 0
    v_mov_b32 v36, 0
    v_mov_b32 v37, 0
    v_mov_b32 v38, 0
    v_mov_b32 v39, 0
    v_mov_b32 v40, 0
    v_mov_b32 v41, 0
    v_mov_b32 v42, 0
    v_mov_b32 v43, 0
    v_mov_b32 v44, 0
    v_mov_b32 v45, 0
    v_mov_b32 v46, 0
    v_mov_b32 v47, 0
    v_mov_b32 v48, 0
    v_mov_b32 v49, 0
    v_mov_b32 v50, 0
    v_mov_b32 v51, 0
    v_mov_b32 v52, 0
    v_mov_b32 v53, 0
    v_mov_b32 v54, 0
    v_mov_b32 v55, 0
    v_mov_b32 v56, 0
    v_mov_b32 v57, 0
    v_mov_b32 v58, 0
    v_mov_b32 v59, 0
    v_mov_b32 v60, 0
    v_mov_b32 v61, 0
    v_mov_b32 v62, 0
    v_mov_b32 v63, 0
    s_mov_b32 s24, s68
    s_mov_b32 s21, s68
    s_mov_b32 s58, 0
L_sp_pv:
    buffer_load_dwordx4 v[128:131], v101, s[8:11], s24 offen offset:0
    buffer_load_dwordx4 v[132:135], v101, s[8:11], s24 offen offset:64
    buffer_load_dwordx4 v[136:139], v101, s[8:11], s24 offen offset:128
    buffer_load_dwordx4 v[140:143], v101, s[8:11], s24 offen offset:192
    buffer_load_dwordx4 v[144:147], v101, s[8:11], s24 offen offset:256
    buffer_load_dwordx4 v[148:151], v101, s[8:11], s24 offen offset:320
    buffer_load_dwordx4 v[152:155], v101, s[8:11], s24 offen offset:384
    buffer_load_dwordx4 v[156:159], v101, s[8:11], s24 offen offset:448
    s_waitcnt vmcnt(0)
    v_mfma_f32_16x16x32_bf16 v[108:111], v[128:131], a[0:3], 0
    v_mfma_f32_16x16x32_bf16 v[108:111], v[132:135], a[4:7], v[108:111]
    v_mfma_f32_16x16x32_bf16 v[108:111], v[136:139], a[8:11], v[108:111]
    v_mfma_f32_16x16x32_bf16 v[108:111], v[140:143], a[12:15], v[108:111]
    v_mfma_f32_16x16x32_bf16 v[108:111], v[144:147], a[16:19], v[108:111]
    v_mfma_f32_16x16x32_bf16 v[108:111], v[148:151], a[20:23], v[108:111]
    v_mfma_f32_16x16x32_bf16 v[108:111], v[152:155], a[24:27], v[108:111]
    v_mfma_f32_16x16x32_bf16 v[108:111], v[156:159], a[28:31], v[108:111]
    s_add_u32 s24, s24, 8192
    s_nop 7
    s_nop 1
    buffer_load_dwordx4 v[128:131], v101, s[8:11], s24 offen offset:0
    buffer_load_dwordx4 v[132:135], v101, s[8:11], s24 offen offset:64
    buffer_load_dwordx4 v[136:139], v101, s[8:11], s24 offen offset:128
    buffer_load_dwordx4 v[140:143], v101, s[8:11], s24 offen offset:192
    buffer_load_dwordx4 v[144:147], v101, s[8:11], s24 offen offset:256
    buffer_load_dwordx4 v[148:151], v101, s[8:11], s24 offen offset:320
    buffer_load_dwordx4 v[152:155], v101, s[8:11], s24 offen offset:384
    buffer_load_dwordx4 v[156:159], v101, s[8:11], s24 offen offset:448
    s_waitcnt vmcnt(0)
    v_mfma_f32_16x16x32_bf16 v[112:115], v[128:131], a[0:3], 0
    v_mfma_f32_16x16x32_bf16 v[112:115], v[132:135], a[4:7], v[112:115]
    v_mfma_f32_16x16x32_bf16 v[112:115], v[136:139], a[8:11], v[112:115]
    v_mfma_f32_16x16x32_bf16 v[112:115], v[140:143], a[12:15], v[112:115]
    v_mfma_f32_16x16x32_bf16 v[112:115], v[144:147], a[16:19], v[112:115]
    v_mfma_f32_16x16x32_bf16 v[112:115], v[148:151], a[20:23], v[112:115]
    v_mfma_f32_16x16x32_bf16 v[112:115], v[152:155], a[24:27], v[112:115]
    v_mfma_f32_16x16x32_bf16 v[112:115], v[156:159], a[28:31], v[112:115]
    s_add_u32 s24, s24, 8192
    s_nop 7
    s_nop 1
    v_fma_f32 v108, v108, s27, v104
    v_fma_f32 v109, v109, s27, v104
    v_fma_f32 v110, v110, s27, v104
    v_fma_f32 v111, v111, s27, v104
    v_fma_f32 v112, v112, s27, v104
    v_fma_f32 v113, v113, s27, v104
    v_fma_f32 v114, v114, s27, v104
    v_fma_f32 v115, v115, s27, v104
    v_exp_f32 v108, v108
    v_exp_f32 v109, v109
    v_exp_f32 v110, v110
    v_exp_f32 v111, v111
    v_exp_f32 v112, v112
    v_exp_f32 v113, v113
    v_exp_f32 v114, v114
    v_exp_f32 v115, v115
    s_nop 0
    v_add_f32 v105, v105, v108
    v_add_f32 v105, v105, v109
    v_add_f32 v105, v105, v110
    v_add_f32 v105, v105, v111
    v_add_f32 v105, v105, v112
    v_add_f32 v105, v105, v113
    v_add_f32 v105, v105, v114
    v_add_f32 v105, v105, v115
    v_cvt_pk_bf16_f32 v116, v108, v109
    v_cvt_pk_bf16_f32 v117, v110, v111
    v_cvt_pk_bf16_f32 v118, v112, v113
    v_cvt_pk_bf16_f32 v119, v114, v115
    s_add_u32 s25, s21, 0
    s_add_u32 m0, s23, 114688
    s_nop 0
    buffer_load_dwordx4 v103, s[12:15], s25 offen lds
    s_add_u32 s25, s21, 4096
    s_add_u32 m0, s23, 115712
    s_nop 0
    buffer_load_dwordx4 v103, s[12:15], s25 offen lds
    s_add_u32 s25, s21, 8192
    s_add_u32 m0, s23, 116736
    s_nop 0
    buffer_load_dwordx4 v103, s[12:15], s25 offen lds
    s_add_u32 s25, s21, 12288
    s_add_u32 m0, s23, 117760
    s_nop 0
    buffer_load_dwordx4 v103, s[12:15], s25 offen lds
    s_waitcnt vmcnt(0)
    ds_read_b64_tr_b16 v[128:129], v74
    ds_read_b64_tr_b16 v[130:131], v74 offset:2048
    ds_read_b64_tr_b16 v[132:133], v75
    ds_read_b64_tr_b16 v[134:135], v75 offset:2048
    ds_read_b64_tr_b16 v[136:137], v76
    ds_read_b64_tr_b16 v[138:139], v76 offset:2048
    ds_read_b64_tr_b16 v[140:141], v77
    ds_read_b64_tr_b16 v[142:143], v77 offset:2048
    s_waitcnt lgkmcnt(0)
    v_mfma_f32_16x16x32_bf16 v[0:3], v[128:131], v[116:119], v[0:3]
    v_mfma_f32_16x16x32_bf16 v[4:7], v[132:135], v[116:119], v[4:7]
    v_mfma_f32_16x16x32_bf16 v[8:11], v[136:139], v[116:119], v[8:11]
    v_mfma_f32_16x16x32_bf16 v[12:15], v[140:143], v[116:119], v[12:15]
    s_add_u32 s25, s21, 128
    s_add_u32 m0, s23, 114688
    s_nop 0
    buffer_load_dwordx4 v103, s[12:15], s25 offen lds
    s_add_u32 s25, s21, 4224
    s_add_u32 m0, s23, 115712
    s_nop 0
    buffer_load_dwordx4 v103, s[12:15], s25 offen lds
    s_add_u32 s25, s21, 8320
    s_add_u32 m0, s23, 116736
    s_nop 0
    buffer_load_dwordx4 v103, s[12:15], s25 offen lds
    s_add_u32 s25, s21, 12416
    s_add_u32 m0, s23, 117760
    s_nop 0
    buffer_load_dwordx4 v103, s[12:15], s25 offen lds
    s_waitcnt vmcnt(0)
    ds_read_b64_tr_b16 v[128:129], v74
    ds_read_b64_tr_b16 v[130:131], v74 offset:2048
    ds_read_b64_tr_b16 v[132:133], v75
    ds_read_b64_tr_b16 v[134:135], v75 offset:2048
    ds_read_b64_tr_b16 v[136:137], v76
    ds_read_b64_tr_b16 v[138:139], v76 offset:2048
    ds_read_b64_tr_b16 v[140:141], v77
    ds_read_b64_tr_b16 v[142:143], v77 offset:2048
    s_waitcnt lgkmcnt(0)
    v_mfma_f32_16x16x32_bf16 v[16:19], v[128:131], v[116:119], v[16:19]
    v_mfma_f32_16x16x32_bf16 v[20:23], v[132:135], v[116:119], v[20:23]
    v_mfma_f32_16x16x32_bf16 v[24:27], v[136:139], v[116:119], v[24:27]
    v_mfma_f32_16x16x32_bf16 v[28:31], v[140:143], v[116:119], v[28:31]
    s_add_u32 s25, s21, 256
    s_add_u32 m0, s23, 114688
    s_nop 0
    buffer_load_dwordx4 v103, s[12:15], s25 offen lds
    s_add_u32 s25, s21, 4352
    s_add_u32 m0, s23, 115712
    s_nop 0
    buffer_load_dwordx4 v103, s[12:15], s25 offen lds
    s_add_u32 s25, s21, 8448
    s_add_u32 m0, s23, 116736
    s_nop 0
    buffer_load_dwordx4 v103, s[12:15], s25 offen lds
    s_add_u32 s25, s21, 12544
    s_add_u32 m0, s23, 117760
    s_nop 0
    buffer_load_dwordx4 v103, s[12:15], s25 offen lds
    s_waitcnt vmcnt(0)
    ds_read_b64_tr_b16 v[128:129], v74
    ds_read_b64_tr_b16 v[130:131], v74 offset:2048
    ds_read_b64_tr_b16 v[132:133], v75
    ds_read_b64_tr_b16 v[134:135], v75 offset:2048
    ds_read_b64_tr_b16 v[136:137], v76
    ds_read_b64_tr_b16 v[138:139], v76 offset:2048
    ds_read_b64_tr_b16 v[140:141], v77
    ds_read_b64_tr_b16 v[142:143], v77 offset:2048
    s_waitcnt lgkmcnt(0)
    v_mfma_f32_16x16x32_bf16 v[32:35], v[128:131], v[116:119], v[32:35]
    v_mfma_f32_16x16x32_bf16 v[36:39], v[132:135], v[116:119], v[36:39]
    v_mfma_f32_16x16x32_bf16 v[40:43], v[136:139], v[116:119], v[40:43]
    v_mfma_f32_16x16x32_bf16 v[44:47], v[140:143], v[116:119], v[44:47]
    s_add_u32 s25, s21, 384
    s_add_u32 m0, s23, 114688
    s_nop 0
    buffer_load_dwordx4 v103, s[12:15], s25 offen lds
    s_add_u32 s25, s21, 4480
    s_add_u32 m0, s23, 115712
    s_nop 0
    buffer_load_dwordx4 v103, s[12:15], s25 offen lds
    s_add_u32 s25, s21, 8576
    s_add_u32 m0, s23, 116736
    s_nop 0
    buffer_load_dwordx4 v103, s[12:15], s25 offen lds
    s_add_u32 s25, s21, 12672
    s_add_u32 m0, s23, 117760
    s_nop 0
    buffer_load_dwordx4 v103, s[12:15], s25 offen lds
    s_waitcnt vmcnt(0)
    ds_read_b64_tr_b16 v[128:129], v74
    ds_read_b64_tr_b16 v[130:131], v74 offset:2048
    ds_read_b64_tr_b16 v[132:133], v75
    ds_read_b64_tr_b16 v[134:135], v75 offset:2048
    ds_read_b64_tr_b16 v[136:137], v76
    ds_read_b64_tr_b16 v[138:139], v76 offset:2048
    ds_read_b64_tr_b16 v[140:141], v77
    ds_read_b64_tr_b16 v[142:143], v77 offset:2048
    s_waitcnt lgkmcnt(0)
    v_mfma_f32_16x16x32_bf16 v[48:51], v[128:131], v[116:119], v[48:51]
    v_mfma_f32_16x16x32_bf16 v[52:55], v[132:135], v[116:119], v[52:55]
    v_mfma_f32_16x16x32_bf16 v[56:59], v[136:139], v[116:119], v[56:59]
    v_mfma_f32_16x16x32_bf16 v[60:63], v[140:143], v[116:119], v[60:63]
    s_add_u32 s21, s21, 16384
    s_add_u32 s58, s58, 1
    s_cmp_lt_u32 s58, 16
    s_cbranch_scc1 L_sp_pv
    v_mov_b32 v106, v105
    s_nop 1
    v_permlane32_swap_b32 v105, v106
    s_nop 1
    v_add_f32 v105, v105, v106
    v_mov_b32 v106, v105
    s_nop 1
    v_permlane16_swap_b32 v105, v106
    s_nop 1
    v_add_f32 v105, v105, v106
    v_rcp_f32 v105, v105
    s_nop 7
    v_mul_f32 v0, v105, v0
    v_mul_f32 v1, v105, v1
    v_mul_f32 v2, v105, v2
    v_mul_f32 v3, v105, v3
    v_mul_f32 v4, v105, v4
    v_mul_f32 v5, v105, v5
    v_mul_f32 v6, v105, v6
    v_mul_f32 v7, v105, v7
    v_mul_f32 v8, v105, v8
    v_mul_f32 v9, v105, v9
    v_mul_f32 v10, v105, v10
    v_mul_f32 v11, v105, v11
    v_mul_f32 v12, v105, v12
    v_mul_f32 v13, v105, v13
    v_mul_f32 v14, v105, v14
    v_mul_f32 v15, v105, v15
    v_mul_f32 v16, v105, v16
    v_mul_f32 v17, v105, v17
    v_mul_f32 v18, v105, v18
    v_mul_f32 v19, v105, v19
    v_mul_f32 v20, v105, v20
    v_mul_f32 v21, v105, v21
    v_mul_f32 v22, v105, v22
    v_mul_f32 v23, v105, v23
    v_mul_f32 v24, v105, v24
    v_mul_f32 v25, v105, v25
    v_mul_f32 v26, v105, v26
    v_mul_f32 v27, v105, v27
    v_mul_f32 v28, v105, v28
    v_mul_f32 v29, v105, v29
    v_mul_f32 v30, v105, v30
    v_mul_f32 v31, v105, v31
    v_mul_f32 v32, v105, v32
    v_mul_f32 v33, v105, v33
    v_mul_f32 v34, v105, v34
    v_mul_f32 v35, v105, v35
    v_mul_f32 v36, v105, v36
    v_mul_f32 v37, v105, v37
    v_mul_f32 v38, v105, v38
    v_mul_f32 v39, v105, v39
    v_mul_f32 v40, v105, v40
    v_mul_f32 v41, v105, v41
    v_mul_f32 v42, v105, v42
    v_mul_f32 v43, v105, v43
    v_mul_f32 v44, v105, v44
    v_mul_f32 v45, v105, v45
    v_mul_f32 v46, v105, v46
    v_mul_f32 v47, v105, v47
    v_mul_f32 v48, v105, v48
    v_mul_f32 v49, v105, v49
    v_mul_f32 v50, v105, v50
    v_mul_f32 v51, v105, v51
    v_mul_f32 v52, v105, v52
    v_mul_f32 v53, v105, v53
    v_mul_f32 v54, v105, v54
    v_mul_f32 v55, v105, v55
    v_mul_f32 v56, v105, v56
    v_mul_f32 v57, v105, v57
    v_mul_f32 v58, v105, v58
    v_mul_f32 v59, v105, v59
    v_mul_f32 v60, v105, v60
    v_mul_f32 v61, v105, v61
    v_mul_f32 v62, v105, v62
    v_mul_f32 v63, v105, v63
    v_cvt_pk_bf16_f32 v0, v0, v1
    v_cvt_pk_bf16_f32 v1, v2, v3
    buffer_store_dwordx2 v[0:1], v102, s[16:19], s42 offen offset:0
    v_cvt_pk_bf16_f32 v4, v4, v5
    v_cvt_pk_bf16_f32 v5, v6, v7
    buffer_store_dwordx2 v[4:5], v102, s[16:19], s42 offen offset:32
    v_cvt_pk_bf16_f32 v8, v8, v9
    v_cvt_pk_bf16_f32 v9, v10, v11
    buffer_store_dwordx2 v[8:9], v102, s[16:19], s42 offen offset:64
    v_cvt_pk_bf16_f32 v12, v12, v13
    v_cvt_pk_bf16_f32 v13, v14, v15
    buffer_store_dwordx2 v[12:13], v102, s[16:19], s42 offen offset:96
    v_cvt_pk_bf16_f32 v16, v16, v17
    v_cvt_pk_bf16_f32 v17, v18, v19
    buffer_store_dwordx2 v[16:17], v102, s[16:19], s42 offen offset:128
    v_cvt_pk_bf16_f32 v20, v20, v21
    v_cvt_pk_bf16_f32 v21, v22, v23
    buffer_store_dwordx2 v[20:21], v102, s[16:19], s42 offen offset:160
    v_cvt_pk_bf16_f32 v24, v24, v25
    v_cvt_pk_bf16_f32 v25, v26, v27
    buffer_store_dwordx2 v[24:25], v102, s[16:19], s42 offen offset:192
    v_cvt_pk_bf16_f32 v28, v28, v29
    v_cvt_pk_bf16_f32 v29, v30, v31
    buffer_store_dwordx2 v[28:29], v102, s[16:19], s42 offen offset:224
    v_cvt_pk_bf16_f32 v32, v32, v33
    v_cvt_pk_bf16_f32 v33, v34, v35
    buffer_store_dwordx2 v[32:33], v102, s[16:19], s42 offen offset:256
    v_cvt_pk_bf16_f32 v36, v36, v37
    v_cvt_pk_bf16_f32 v37, v38, v39
    buffer_store_dwordx2 v[36:37], v102, s[16:19], s42 offen offset:288
    v_cvt_pk_bf16_f32 v40, v40, v41
    v_cvt_pk_bf16_f32 v41, v42, v43
    buffer_store_dwordx2 v[40:41], v102, s[16:19], s42 offen offset:320
    v_cvt_pk_bf16_f32 v44, v44, v45
    v_cvt_pk_bf16_f32 v45, v46, v47
    buffer_store_dwordx2 v[44:45], v102, s[16:19], s42 offen offset:352
    v_cvt_pk_bf16_f32 v48, v48, v49
    v_cvt_pk_bf16_f32 v49, v50, v51
    buffer_store_dwordx2 v[48:49], v102, s[16:19], s42 offen offset:384
    v_cvt_pk_bf16_f32 v52, v52, v53
    v_cvt_pk_bf16_f32 v53, v54, v55
    buffer_store_dwordx2 v[52:53], v102, s[16:19], s42 offen offset:416
    v_cvt_pk_bf16_f32 v56, v56, v57
    v_cvt_pk_bf16_f32 v57, v58, v59
    buffer_store_dwordx2 v[56:57], v102, s[16:19], s42 offen offset:448
    v_cvt_pk_bf16_f32 v60, v60, v61
    v_cvt_pk_bf16_f32 v61, v62, v63
    buffer_store_dwordx2 v[60:61], v102, s[16:19], s42 offen offset:480
    s_waitcnt vmcnt(0)
    s_add_u32 s42, s42, 8192
    s_sub_u32 s57, s57, 1
    s_cmp_lg_u32 s57, 0
    s_cbranch_scc1 L_sp_qb
L_sp_next:
    s_lshl_b32 s30, s30, 1
    s_mov_b32 s60, s61
    s_mov_b32 s64, s65
    s_mov_b32 s61, s62
    s_mov_b32 s65, s66
    s_mov_b32 s62, s63
    s_mov_b32 s66, s67
    s_add_u32 s68, s68, 0x40000
    s_add_u32 s29, s29, 1
    s_cmp_lt_u32 s29, 4
    s_cbranch_scc1 L_sp_pass
L_end:
    s_endpgm
.section .rodata,"a"
.p2align 6
.amdhsa_kernel standalone__mha_softmax__near_ridge_kernel
  .amdhsa_next_free_vgpr 512
  .amdhsa_next_free_sgpr 102
  .amdhsa_accum_offset 256
  .amdhsa_group_segment_fixed_size 0
  .amdhsa_kernarg_size 48
  .amdhsa_user_sgpr_count 2
  .amdhsa_user_sgpr_kernarg_segment_ptr 1
  .amdhsa_system_sgpr_workgroup_id_x 1
.end_amdhsa_kernel
```
